```python
import torch

def _softmax(x, axis=-1):
    return torch.softmax(x, dim=axis)
def _gelu(x):
    return torch.nn.functional.gelu(x, approximate="tanh")
def _silu(x):
    return torch.nn.functional.silu(x)
def _sigmoid(x):
    return torch.sigmoid(x)
def _layernorm(x, axis=-1, eps=1e-5):
    m = x.mean(dim=axis, keepdim=True)
    v = x.var(dim=axis, keepdim=True, unbiased=False)
    return (x - m) / torch.sqrt(v + eps)
def _scatter_add(tgt, idx, src, axis=0):
    return tgt.clone().index_add_(axis, idx, src)
def _segment_sum(src, seg, n):
    out = torch.zeros((n,) + src.shape[1:], dtype=src.dtype)
    return out.index_add_(0, seg, src)
def _pad(x, pw):
    flat = tuple(v for pair in reversed(pw) for v in pair)
    return torch.nn.functional.pad(x, flat)

kernel_name = 'concat_heads__mha_block_cached__mha_block_cached__near_ridge'

def setup_inputs():

    _w = (lambda a: (lambda t: t.to(torch.bfloat16) if t.is_floating_point() else t)(torch.as_tensor(a)))
    def _A_setup():
        B, Sq, D = 16, 160, 512
        H, Sk, Dh = 32, 512, 128
        return {
            "x": _w((lambda *s: torch.randn(*s, dtype=torch.bfloat16) * 0.8)(B, Sq, D)),
            "k_cache": _w((lambda *s: torch.randn(*s, dtype=torch.bfloat16) * 0.8)(B, H, Sk, Dh)),
            "v_cache": _w((lambda *s: torch.randn(*s, dtype=torch.bfloat16) * 0.05)(B, H, Sk, Dh)),
            "wq": _w((lambda *s: torch.randn(*s, dtype=torch.bfloat16) * 0.8)(D, H * Dh) * (D ** -0.5)),
            "wo": _w((lambda *s: torch.randn(*s, dtype=torch.bfloat16) * 0.05)(H * Dh, D) * ((H * Dh) ** -0.5)),
        }
    _A_in = _A_setup()

    def _B_setup():
        B, Sq, D = 16, 160, 512
        H, Sk, Dh = 32, 512, 128
        return {
            "x": _w((lambda *s: torch.randn(*s, dtype=torch.bfloat16) * 0.8)(B, Sq, D)),
            "k_cache": _w((lambda *s: torch.randn(*s, dtype=torch.bfloat16) * 0.8)(B, H, Sk, Dh)),
            "v_cache": _w((lambda *s: torch.randn(*s, dtype=torch.bfloat16) * 0.05)(B, H, Sk, Dh)),
            "wq": _w((lambda *s: torch.randn(*s, dtype=torch.bfloat16) * 0.8)(D, H * Dh) * (D ** -0.5)),
            "wo": _w((lambda *s: torch.randn(*s, dtype=torch.bfloat16) * 0.05)(H * Dh, D) * ((H * Dh) ** -0.5)),
        }
    _B_in = _B_setup()

    return {
        "A_x": _A_in["x"],
        "A_k_cache": _A_in["k_cache"],
        "A_v_cache": _A_in["v_cache"],
        "A_wq": _A_in["wq"],
        "A_wo": _A_in["wo"],
        "B_x": _B_in["x"],
        "B_k_cache": _B_in["k_cache"],
        "B_v_cache": _B_in["v_cache"],
        "B_wq": _B_in["wq"],
        "B_wo": _B_in["wo"],
    }

def reference(A_x, A_k_cache, A_v_cache, A_wq, A_wo, B_x, B_k_cache, B_v_cache, B_wq, B_wo):
    def _A_ref(x, k_cache, v_cache, wq, wo):
        B, Sq, D = x.shape
        H, Dh = 32, 128
        q = (lambda x, *d: x.permute(*d))((x @ wq).reshape(B, Sq, H, Dh), 0, 2, 1, 3)
        scores = torch.einsum("bhqd,bhkd->bhqk", q, k_cache) * (Dh ** -0.5)
        p = _softmax(scores, axis=-1)
        o = torch.einsum("bhqk,bhkd->bhqd", p, v_cache)
        return (lambda x, *d: x.permute(*d))(o, 0, 2, 1, 3).reshape(B, Sq, H * Dh) @ wo

    def _B_ref(x, k_cache, v_cache, wq, wo):
        B, Sq, D = x.shape
        H, Dh = 32, 128
        q = (lambda x, *d: x.permute(*d))((x @ wq).reshape(B, Sq, H, Dh), 0, 2, 1, 3)
        scores = torch.einsum("bhqd,bhkd->bhqk", q, k_cache) * (Dh ** -0.5)
        p = _softmax(scores, axis=-1)
        o = torch.einsum("bhqk,bhkd->bhqd", p, v_cache)
        return (lambda x, *d: x.permute(*d))(o, 0, 2, 1, 3).reshape(B, Sq, H * Dh) @ wo

    a = _A_ref(A_x, A_k_cache, A_v_cache, A_wq, A_wo)
    b = _B_ref(B_x, B_k_cache, B_v_cache, B_wq, B_wo)
    return torch.concatenate([a, b], axis=-1)
```

```asm
; @launch grid=(256,1,1) block=(256,1,1) lds=163840
.amdgcn_target "amdgcn-amd-amdhsa--gfx950"
.text
.macro MM d, a, b, c
v_mfma_f32_16x16x32_bf16 \d, \a, \b, \c
.endm
.macro TR d, a:vararg
ds_read_b64_tr_b16 \d, \a
.endm
.macro CV d, a, b
v_cvt_pk_bf16_f32 \d, \a, \b
.endm
.globl concat_heads__mha_block_cached__mha_block_cached__near_ridge_kernel
.p2align 8
.type concat_heads__mha_block_cached__mha_block_cached__near_ridge_kernel,@function
concat_heads__mha_block_cached__mha_block_cached__near_ridge_kernel:
s_cmp_lt_u32 s2, 256
s_cbranch_scc1 L_go
s_endpgm
L_go:
s_load_dwordx16 s[64:79], s[0:1], 0
s_load_dwordx8 s[80:87], s[0:1], 64
s_load_dwordx2 s[88:89], s[0:1], 96
v_lshrrev_b32 v21, 6, v0
s_and_b32 s40, s2, 7
s_lshr_b32 s41, s2, 3
s_lshr_b32 s42, s40, 2
s_and_b32 s43, s40, 3
v_readfirstlane_b32 s33, v21
s_lshr_b32 s44, s41, 1
s_and_b32 s45, s41, 1
s_mov_b32 s3, s45
s_lshl_b32 s46, s43, 3
s_lshl_b32 s47, s45, 2
s_add_u32 s46, s46, s47
v_and_b32 v0, 63, v0
s_lshr_b32 s34, s33, 1
s_and_b32 s35, s33, 1
v_lshrrev_b32 v21, 3, v0
v_and_b32 v22, 7, v0
s_lshl_b32 s50, s35, 3
v_add_u32 v21, s50, v21
v_lshrrev_b32 v23, 1, v21
v_xor_b32 v23, v22, v23
v_lshlrev_b32 v23, 4, v23
s_mul_i32 s50, s34, 80
v_add_u32 v15, s50, v21
v_lshl_add_u32 v15, v15, 10, v23
v_bfe_u32 v23, v0, 4, 1
s_lshl_b32 s50, s35, 1
v_add_u32 v23, s50, v23
v_lshlrev_b32 v23, 1, v23
v_xor_b32 v23, v22, v23
v_lshlrev_b32 v23, 4, v23
v_lshl_add_u32 v16, v21, 13, v23
s_lshl_b32 s50, s35, 10
s_lshl_b32 s51, s34, 13
s_add_u32 s28, s51, s50
s_mul_i32 s51, s34, 10240
s_add_u32 s29, s51, s50
s_mul_i32 s52, s44, 163840
s_lshl_b32 s51, s34, 1
s_add_u32 s51, s46, s51
s_lshl_b32 s53, s51, 8
s_mov_b32 s14, 163840
s_mov_b32 s15, 0x20000
s_sub_u32 s18, 0x400000, s53
s_mov_b32 s19, 0x20000
s_mov_b32 s55, s43
s_mov_b32 s56, s42
s_mov_b32 s43, 0
s_mov_b32 s48, 0
s_cmp_eq_u32 s56, 0
s_waitcnt lgkmcnt(0)
s_cselect_b64 s[12:13], s[64:65], s[74:75]
s_cselect_b64 s[16:17], s[70:71], s[80:81]
s_add_u32 s12, s12, s52
s_addc_u32 s13, s13, 0
s_add_u32 s16, s16, s53
s_addc_u32 s17, s17, 0
s_add_u32 m0, s29, 0x23000
s_add_u32 s30, s48, 0x0
buffer_load_dwordx4 v15, s[12:15], s30 offen lds
s_add_u32 m0, s29, 0x23800
s_add_u32 s30, s48, 0x4000
buffer_load_dwordx4 v15, s[12:15], s30 offen lds
s_add_u32 m0, s29, 0x24000
s_add_u32 s30, s48, 0x8000
buffer_load_dwordx4 v15, s[12:15], s30 offen lds
s_add_u32 m0, s29, 0x24800
s_add_u32 s30, s48, 0xc000
buffer_load_dwordx4 v15, s[12:15], s30 offen lds
s_add_u32 m0, s29, 0x25000
s_add_u32 s30, s48, 0x10000
buffer_load_dwordx4 v15, s[12:15], s30 offen lds
s_add_u32 m0, s28, 0xc000
s_add_u32 s30, s43, 0x0
buffer_load_dwordx4 v16, s[16:19], s30 offen lds
s_add_u32 m0, s28, 0xcf80
s_nop 0
buffer_load_dwordx4 v16, s[16:19], s30 offen offset:128 lds
s_add_u32 m0, s28, 0xc800
s_add_u32 s30, s43, 0x20000
buffer_load_dwordx4 v16, s[16:19], s30 offen lds
s_add_u32 m0, s28, 0xd780
s_nop 0
buffer_load_dwordx4 v16, s[16:19], s30 offen offset:128 lds
s_mov_b32 s36, 0
s_cmp_eq_u32 s56, 0
s_cselect_b64 s[4:5], s[66:67], s[76:77]
s_cselect_b64 s[8:9], s[68:69], s[78:79]
s_cselect_b64 s[20:21], s[72:73], s[82:83]
s_lshl_b32 s51, s34, 1
s_add_u32 s51, s46, s51
s_lshl_b32 s50, s44, 5
s_add_u32 m0, s28, 0x10000
s_add_u32 s30, s43, 0x40000
s_add_u32 s50, s50, s51
s_lshl_b32 s50, s50, 17
s_add_u32 s4, s4, s50
s_addc_u32 s5, s5, 0
buffer_load_dwordx4 v16, s[16:19], s30 offen lds
s_mov_b32 s6, 0x40000
s_mov_b32 s7, 0x20000
s_add_u32 s8, s8, s50
s_addc_u32 s9, s9, 0
s_mov_b32 s10, 0x40000
s_mov_b32 s11, 0x20000
s_mul_i32 s98, s44, 3
s_lshr_b32 s50, s51, 1
s_add_u32 m0, s28, 0x10f80
s_mul_i32 s50, s50, 5
s_add_u32 s98, s98, s50
s_and_b32 s98, s98, 15
buffer_load_dwordx4 v16, s[16:19], s30 offen offset:128 lds
s_lshl_b32 s98, s98, 13
s_mov_b32 s42, s98
v_lshrrev_b32 v21, 3, v0
v_and_b32 v22, 7, v0
s_lshl_b32 s50, s35, 3
v_add_u32 v21, s50, v21
v_lshrrev_b32 v23, 1, v21
v_xor_b32 v23, v22, v23
v_lshlrev_b32 v23, 4, v23
s_add_u32 m0, s28, 0x10800
s_add_u32 s30, s43, 0x60000
v_lshl_add_u32 v13, v21, 8, v23
v_lshrrev_b32 v23, 4, v0
v_lshlrev_b32 v23, 1, v23
buffer_load_dwordx4 v16, s[16:19], s30 offen lds
v_xor_b32 v23, v22, v23
v_lshlrev_b32 v23, 4, v23
v_lshl_add_u32 v14, v21, 8, v23
v_lshl_add_u32 v17, v21, 10, v23
s_lshl_b32 s57, s34, 13
s_add_u32 m0, s28, 0x0
s_add_u32 s30, s42, 0x0
s_and_b32 s30, s30, 0x1ffff
v_lshrrev_b32 v21, 4, v0
v_lshlrev_b32 v21, 10, v21
v_bfe_u32 v22, v0, 2, 2
v_lshl_add_u32 v21, v22, 7, v21
buffer_load_dwordx4 v13, s[4:7], s30 offen nt lds
v_and_b32 v23, 3, v0
v_lshl_add_u32 v21, v23, 3, v21
s_add_u32 s50, s57, 49152
v_add_u32 v21, s50, v21
s_add_u32 m0, s28, 0x11780
s_add_u32 s30, s43, 0x60000
v_bfe_u32 v22, v0, 3, 2
v_xor_b32 v23, 0, v22
v_lshl_add_u32 v9, v23, 5, v21
buffer_load_dwordx4 v16, s[16:19], s30 offen offset:128 lds
v_xor_b32 v23, 1, v22
s_add_u32 m0, s28, 0xf80
s_add_u32 s30, s42, 0x0
s_and_b32 s30, s30, 0x1ffff
v_lshl_add_u32 v10, v23, 5, v21
v_xor_b32 v23, 2, v22
v_lshl_add_u32 v11, v23, 5, v21
v_xor_b32 v23, 3, v22
buffer_load_dwordx4 v13, s[4:7], s30 offen offset:128 nt lds
v_lshl_add_u32 v12, v23, 5, v21
v_and_b32 v21, 15, v0
v_lshlrev_b32 v21, 7, v21
s_mul_i32 s50, s35, 10240
s_add_u32 m0, s29, 0x1df80
s_add_u32 s30, s48, 0x0
s_add_u32 s50, s50, 122880
v_add_u32 v21, s50, v21
v_bfe_u32 v22, v0, 1, 3
buffer_load_dwordx4 v15, s[12:15], s30 offen offset:128 lds
v_lshrrev_b32 v23, 4, v0
s_add_u32 m0, s28, 0x800
s_add_u32 s30, s42, 0x1000
s_and_b32 s30, s30, 0x1ffff
v_xor_b32 v22, v23, v22
v_lshl_add_u32 v76, v22, 4, v21
v_xor_b32 v22, 4, v22
v_lshl_add_u32 v77, v22, 4, v21
buffer_load_dwordx4 v13, s[4:7], s30 offen nt lds
v_lshrrev_b32 v21, 5, v0
v_lshlrev_b32 v21, 10, v21
v_bfe_u32 v22, v0, 2, 3
v_lshl_add_u32 v21, v22, 7, v21
s_add_u32 m0, s29, 0x1e780
s_add_u32 s30, s48, 0x4000
v_and_b32 v23, 3, v0
v_lshl_add_u32 v21, v23, 3, v21
v_add_u32 v21, s57, v21
buffer_load_dwordx4 v15, s[12:15], s30 offen offset:128 lds
v_lshrrev_b32 v22, 1, v22
s_add_u32 m0, s28, 0x1780
s_add_u32 s30, s42, 0x1000
s_and_b32 s30, s30, 0x1ffff
v_xor_b32 v23, 0, v22
v_lshl_add_u32 v1, v23, 5, v21
v_xor_b32 v23, 1, v22
v_lshl_add_u32 v2, v23, 5, v21
buffer_load_dwordx4 v13, s[4:7], s30 offen offset:128 nt lds
v_xor_b32 v23, 2, v22
v_lshl_add_u32 v3, v23, 5, v21
v_xor_b32 v23, 3, v22
v_lshl_add_u32 v4, v23, 5, v21
s_add_u32 m0, s29, 0x1ef80
s_add_u32 s30, s48, 0x8000
v_bfe_u32 v21, v0, 3, 1
v_lshlrev_b32 v21, 10, v21
v_and_b32 v22, 7, v0
buffer_load_dwordx4 v15, s[12:15], s30 offen offset:128 lds
v_lshl_add_u32 v21, v22, 7, v21
s_add_u32 m0, s28, 0x4000
s_add_u32 s30, s42, 0x0
s_and_b32 s30, s30, 0x1ffff
v_bfe_u32 v22, v0, 4, 1
v_lshl_add_u32 v21, v22, 3, v21
v_add_u32 v21, s57, v21
v_bfe_u32 v22, v0, 1, 3
buffer_load_dwordx4 v14, s[8:11], s30 offen nt lds
v_lshrrev_b32 v23, 5, v0
v_xor_b32 v22, v23, v22
v_xor_b32 v23, 0, v22
v_lshl_add_u32 v5, v23, 4, v21
s_add_u32 m0, s29, 0x1f780
s_add_u32 s30, s48, 0xc000
v_xor_b32 v23, 2, v22
v_lshl_add_u32 v6, v23, 4, v21
v_xor_b32 v23, 4, v22
buffer_load_dwordx4 v15, s[12:15], s30 offen offset:128 lds
v_lshl_add_u32 v7, v23, 4, v21
s_add_u32 m0, s28, 0x4f80
s_add_u32 s30, s42, 0x0
s_and_b32 s30, s30, 0x1ffff
v_xor_b32 v23, 6, v22
v_lshl_add_u32 v8, v23, 4, v21
v_lshlrev_b32 v20, 4, v0
s_lshl_b32 s31, s34, 18
buffer_load_dwordx4 v14, s[8:11], s30 offen offset:128 nt lds
s_xor_b32 s32, s31, 0x40000
s_mov_b32 s38, 0x3e0293ee
s_mov_b32 s39, 0x3e0293ee
s_lshl_b32 s50, s46, 17
s_add_u32 m0, s29, 0x1ff80
s_add_u32 s30, s48, 0x10000
s_lshl_b32 s51, s34, 9
s_add_u32 s50, s50, s51
s_add_u32 s20, s20, s50
s_addc_u32 s21, s21, 0
buffer_load_dwordx4 v15, s[12:15], s30 offen offset:128 lds
s_sub_u32 s22, 0x80000, s51
s_mov_b32 s23, 0x20000
s_lshl_b32 s50, s56, 4
s_add_u32 s50, s50, s44
s_add_u32 m0, s28, 0x4800
s_add_u32 s30, s42, 0x1000
s_and_b32 s30, s30, 0x1ffff
s_lshl_b32 s51, s55, 1
s_add_u32 s51, s51, s45
s_lshl_b32 s52, s50, 3
s_add_u32 s52, s52, s51
buffer_load_dwordx4 v14, s[8:11], s30 offen nt lds
s_mul_i32 s52, s52, 163840
s_mul_i32 s53, s33, 40960
s_add_u32 s52, s52, s53
s_mov_b32 s24, s88
s_add_u32 m0, s28, 0x14000
s_add_u32 s30, s43, 0x80000
s_mov_b32 s25, s89
s_add_u32 s24, s24, s52
s_addc_u32 s25, s25, 0
buffer_load_dwordx4 v16, s[16:19], s30 offen lds
s_mov_b32 s26, 40960
s_add_u32 m0, s28, 0x5780
s_add_u32 s30, s42, 0x1000
s_and_b32 s30, s30, 0x1ffff
s_mov_b32 s27, 0x20000
s_mul_i32 s52, s50, 1310720
s_add_u32 s76, s88, s52
s_addc_u32 s77, s89, 0
buffer_load_dwordx4 v14, s[8:11], s30 offen offset:128 nt lds
s_mov_b32 s78, 1310720
s_mov_b32 s79, 0x20000
s_lshl_b32 s52, s50, 10
s_add_u32 s52, s52, 0x3000000
s_add_u32 m0, s28, 0x14f80
s_add_u32 s30, s43, 0x80000
s_add_u32 s80, s88, s52
s_addc_u32 s81, s89, 0
s_mov_b32 s82, 1024
buffer_load_dwordx4 v16, s[16:19], s30 offen offset:128 lds
s_mov_b32 s83, 0x20000
s_add_u32 m0, s28, 0x8000
s_add_u32 s30, s42, 0x2000
s_and_b32 s30, s30, 0x1ffff
s_lshl_b32 s52, s50, 2
s_add_u32 s86, s86, s52
s_addc_u32 s87, s87, 0
s_lshr_b32 s52, s51, 1
buffer_load_dwordx4 v13, s[4:7], s30 offen nt lds
s_mul_i32 s74, s52, 40960
s_and_b32 s54, s51, 1
s_lshl_b32 s53, s54, 10
s_add_u32 s74, s74, s53
s_add_u32 m0, s28, 0x14800
s_add_u32 s30, s43, 0xa0000
s_and_b32 s53, s52, 1
s_mul_i32 s53, s53, 80
s_mul_i32 s75, s44, 160
buffer_load_dwordx4 v16, s[16:19], s30 offen lds
s_add_u32 s75, s75, s53
s_add_u32 m0, s28, 0x8f80
s_add_u32 s30, s42, 0x2000
s_and_b32 s30, s30, 0x1ffff
s_lshl_b32 s75, s75, 11
s_lshl_b32 s53, s56, 10
s_add_u32 s75, s75, s53
s_lshr_b32 s53, s52, 1
buffer_load_dwordx4 v13, s[4:7], s30 offen offset:128 nt lds
s_lshl_b32 s53, s53, 9
s_add_u32 s75, s75, s53
s_lshl_b32 s53, s54, 6
s_add_u32 s75, s75, s53
s_add_u32 m0, s28, 0x15780
s_add_u32 s30, s43, 0xa0000
s_lshl_b32 s50, s44, 5
s_lshl_b32 s51, s35, 4
s_add_u32 s50, s50, s51
buffer_load_dwordx4 v16, s[16:19], s30 offen offset:128 lds
v_lshrrev_b32 v21, 2, v0
s_add_u32 m0, s28, 0x8800
s_add_u32 s30, s42, 0x3000
s_and_b32 s30, s30, 0x1ffff
v_add_u32 v21, s50, v21
v_and_b32 v22, 1, v0
v_lshlrev_b32 v22, 6, v22
v_lshl_add_u32 v23, v21, 10, v22
buffer_load_dwordx4 v13, s[4:7], s30 offen nt lds
v_and_b32 v22, 3, v0
v_lshlrev_b32 v22, 6, v22
v_lshl_add_u32 v21, v21, 13, v22
v_mov_b32 v78, 0
s_add_u32 m0, s28, 0x18000
s_add_u32 s30, s43, 0xc0000
s_min_u32 s50, s33, 2
s_lshl_b32 s50, s50, 7
buffer_load_dword v0, v78, s[80:83], s50 offen sc1
buffer_load_dwordx4 v16, s[16:19], s30 offen lds
buffer_load_dword a252, v78, s[80:83], 0 offen offset:384 sc1
s_add_u32 m0, s28, 0x9780
s_add_u32 s30, s42, 0x3000
s_and_b32 s30, s30, 0x1ffff
v_mov_b32 v44, 0x3f803f80
v_mov_b32 v79, 0
v_accvgpr_write_b32 a244, v44
v_accvgpr_write_b32 a245, v44
buffer_load_dwordx4 v13, s[4:7], s30 offen offset:128 nt lds
v_accvgpr_write_b32 a246, v44
s_add_u32 m0, s28, 0x18f80
s_add_u32 s30, s43, 0xc0000
buffer_load_dwordx4 v16, s[16:19], s30 offen offset:128 lds
v_accvgpr_write_b32 a247, v44
v_mov_b32 v24, 0
v_mov_b32 v25, 0
v_mov_b32 v26, 0
v_mov_b32 v27, 0
v_mov_b32 v28, 0
v_mov_b32 v29, 0
s_add_u32 m0, s28, 0x18800
s_add_u32 s30, s43, 0xe0000
buffer_load_dwordx4 v16, s[16:19], s30 offen lds
v_mov_b32 v30, 0
v_mov_b32 v31, 0
v_mov_b32 v32, 0
v_mov_b32 v33, 0
v_mov_b32 v34, 0
v_mov_b32 v35, 0
v_mov_b32 v36, 0
s_add_u32 m0, s28, 0x19780
s_nop 0
buffer_load_dwordx4 v16, s[16:19], s30 offen offset:128 lds
v_mov_b32 v37, 0
v_mov_b32 v38, 0
v_mov_b32 v39, 0
v_mov_b32 v40, 0
v_mov_b32 v41, 0
v_mov_b32 v42, 0
v_mov_b32 v43, 0
s_mul_i32 s46, s33, 20480
s_add_u32 s46, s46, 0
v_add_u32 v18, s46, v20
s_xor_b32 s47, s33, 2
s_mul_i32 s47, s47, 20480
s_add_u32 s47, s47, 0
v_add_u32 v19, s47, v20
s_getpc_b64 s[100:101]
L_pc:
s_lshr_b32 s46, s2, 3
s_lshl_b32 s46, s46, 2
s_add_u32 s46, s46, s33
s_mul_i32 s46, s46, 1024
v_and_b32 v80, 0xf0, v20
v_min_u32 v80, 112, v80
v_lshlrev_b32 v80, 3, v80
v_add_u32 v80, s46, v80
v_min_u32 v80, L_end-L_pc, v80
v_mov_b32 v81, s101
v_add_co_u32 v80, vcc, s100, v80
s_nop 1
v_addc_co_u32 v81, vcc, 0, v81, vcc
global_load_dword v22, v[80:81], off
s_lshl_b32 s46, s3, 8
buffer_load_dword v22, v21, s[16:19], s46 offen
s_waitcnt vmcnt(33)
s_barrier
TR a[80:81], v9 offset:0
TR a[82:83], v9 offset:512
TR a[84:85], v10 offset:0
TR a[86:87], v10 offset:512
TR a[88:89], v11 offset:0
TR a[90:91], v11 offset:512
TR a[92:93], v12 offset:0
TR a[94:95], v12 offset:512
TR a[96:97], v9 offset:4096
TR a[98:99], v9 offset:4608
TR a[100:101], v10 offset:4096
TR a[102:103], v10 offset:4608
TR a[104:105], v11 offset:4096
TR a[106:107], v11 offset:4608
TR a[108:109], v12 offset:4096
TR a[110:111], v12 offset:4608
ds_read_b128 a[0:3], v76 offset:20480
ds_read_b128 a[4:7], v76 offset:22528
ds_read_b128 a[8:11], v76 offset:24576
ds_read_b128 a[12:15], v76 offset:26624
ds_read_b128 a[16:19], v76 offset:28672
s_waitcnt lgkmcnt(4)
MM v[80:83], a[80:83], a[0:3], 0
s_waitcnt vmcnt(28)
s_barrier
s_add_u32 m0, s28, 0xc000
MM v[84:87], a[84:87], a[0:3], 0
s_add_u32 s30, s43, 0x100000
buffer_load_dwordx4 v16, s[16:19], s30 offen lds
MM v[88:91], a[88:91], a[0:3], 0
TR a[112:113], v9 offset:16384
TR a[114:115], v9 offset:16896
MM v[92:95], a[92:95], a[0:3], 0
s_add_u32 m0, s28, 0xcf80
MM v[96:99], a[96:99], a[0:3], 0
buffer_load_dwordx4 v16, s[16:19], s30 offen offset:128 lds
MM v[100:103], a[100:103], a[0:3], 0
TR a[116:117], v10 offset:16384
TR a[118:119], v10 offset:16896
MM v[104:107], a[104:107], a[0:3], 0
s_add_u32 m0, s28, 0xc800
s_add_u32 s30, s43, 0x120000
MM v[108:111], a[108:111], a[0:3], 0
s_waitcnt lgkmcnt(7)
buffer_load_dwordx4 v16, s[16:19], s30 offen lds
MM v[112:115], a[80:83], a[4:7], 0
TR a[120:121], v11 offset:16384
TR a[122:123], v11 offset:16896
MM v[116:119], a[84:87], a[4:7], 0
s_add_u32 m0, s28, 0xd780
MM v[120:123], a[88:91], a[4:7], 0
buffer_load_dwordx4 v16, s[16:19], s30 offen offset:128 lds
MM v[124:127], a[92:95], a[4:7], 0
TR a[124:125], v12 offset:16384
TR a[126:127], v12 offset:16896
MM v[128:131], a[96:99], a[4:7], 0
MM v[132:135], a[100:103], a[4:7], 0
TR a[128:129], v9 offset:20480
TR a[130:131], v9 offset:20992
MM v[136:139], a[104:107], a[4:7], 0
MM v[140:143], a[108:111], a[4:7], 0
s_waitcnt lgkmcnt(12)
TR a[132:133], v10 offset:20480
TR a[134:135], v10 offset:20992
MM v[144:147], a[80:83], a[8:11], 0
MM v[148:151], a[84:87], a[8:11], 0
TR a[136:137], v11 offset:20480
TR a[138:139], v11 offset:20992
MM v[152:155], a[88:91], a[8:11], 0
MM v[156:159], a[92:95], a[8:11], 0
TR a[140:141], v12 offset:20480
TR a[142:143], v12 offset:20992
MM v[160:163], a[96:99], a[8:11], 0
MM v[164:167], a[100:103], a[8:11], 0
ds_read_b128 a[20:23], v77 offset:20480
ds_read_b128 a[24:27], v77 offset:22528
MM v[168:171], a[104:107], a[8:11], 0
MM v[172:175], a[108:111], a[8:11], 0
s_waitcnt lgkmcnt(15)
ds_read_b128 a[28:31], v77 offset:24576
ds_read_b128 a[32:35], v77 offset:26624
MM v[176:179], a[80:83], a[12:15], 0
MM v[180:183], a[84:87], a[12:15], 0
ds_read_b128 a[36:39], v77 offset:28672
MM v[184:187], a[88:91], a[12:15], 0
MM v[188:191], a[92:95], a[12:15], 0
MM v[192:195], a[96:99], a[12:15], 0
MM v[196:199], a[100:103], a[12:15], 0
MM v[200:203], a[104:107], a[12:15], 0
MM v[204:207], a[108:111], a[12:15], 0
MM v[208:211], a[80:83], a[16:19], 0
MM v[212:215], a[84:87], a[16:19], 0
MM v[216:219], a[88:91], a[16:19], 0
MM v[220:223], a[92:95], a[16:19], 0
MM v[224:227], a[96:99], a[16:19], 0
MM v[228:231], a[100:103], a[16:19], 0
MM v[232:235], a[104:107], a[16:19], 0
MM v[236:239], a[108:111], a[16:19], 0
s_mov_b32 s96, 3
L_ZQ0:
s_add_u32 s43, s43, 0x100000
s_add_u32 s48, s48, 0x100
s_waitcnt lgkmcnt(4)
MM v[80:83], a[112:115], a[20:23], v[80:83]
s_waitcnt vmcnt(8) lgkmcnt(0)
s_barrier
s_add_u32 m0, s29, 0x23000
MM v[84:87], a[116:119], a[20:23], v[84:87]
s_add_u32 s30, s48, 0x0
buffer_load_dwordx4 v15, s[12:15], s30 offen lds
MM v[88:91], a[120:123], a[20:23], v[88:91]
TR a[80:81], v9 offset:32768
TR a[82:83], v9 offset:33280
MM v[92:95], a[124:127], a[20:23], v[92:95]
s_add_u32 m0, s29, 0x23800
s_add_u32 s30, s48, 0x4000
MM v[96:99], a[128:131], a[20:23], v[96:99]
buffer_load_dwordx4 v15, s[12:15], s30 offen lds
MM v[100:103], a[132:135], a[20:23], v[100:103]
TR a[84:85], v10 offset:32768
TR a[86:87], v10 offset:33280
MM v[104:107], a[136:139], a[20:23], v[104:107]
s_add_u32 m0, s29, 0x24000
s_add_u32 s30, s48, 0x8000
MM v[108:111], a[140:143], a[20:23], v[108:111]
buffer_load_dwordx4 v15, s[12:15], s30 offen lds
MM v[112:115], a[112:115], a[24:27], v[112:115]
TR a[88:89], v11 offset:32768
TR a[90:91], v11 offset:33280
MM v[116:119], a[116:119], a[24:27], v[116:119]
s_add_u32 m0, s29, 0x24800
s_add_u32 s30, s48, 0xc000
MM v[120:123], a[120:123], a[24:27], v[120:123]
buffer_load_dwordx4 v15, s[12:15], s30 offen lds
MM v[124:127], a[124:127], a[24:27], v[124:127]
TR a[92:93], v12 offset:32768
TR a[94:95], v12 offset:33280
MM v[128:131], a[128:131], a[24:27], v[128:131]
s_add_u32 m0, s29, 0x25000
s_add_u32 s30, s48, 0x10000
MM v[132:135], a[132:135], a[24:27], v[132:135]
buffer_load_dwordx4 v15, s[12:15], s30 offen lds
MM v[136:139], a[136:139], a[24:27], v[136:139]
TR a[96:97], v9 offset:36864
TR a[98:99], v9 offset:37376
MM v[140:143], a[140:143], a[24:27], v[140:143]
s_add_u32 m0, s28, 0x10000
s_add_u32 s30, s43, 0x40000
MM v[144:147], a[112:115], a[28:31], v[144:147]
buffer_load_dwordx4 v16, s[16:19], s30 offen lds
MM v[148:151], a[116:119], a[28:31], v[148:151]
TR a[100:101], v10 offset:36864
TR a[102:103], v10 offset:37376
MM v[152:155], a[120:123], a[28:31], v[152:155]
s_add_u32 m0, s28, 0x10f80
MM v[156:159], a[124:127], a[28:31], v[156:159]
buffer_load_dwordx4 v16, s[16:19], s30 offen offset:128 lds
MM v[160:163], a[128:131], a[28:31], v[160:163]
TR a[104:105], v11 offset:36864
TR a[106:107], v11 offset:37376
MM v[164:167], a[132:135], a[28:31], v[164:167]
s_add_u32 m0, s28, 0x10800
s_add_u32 s30, s43, 0x60000
MM v[168:171], a[136:139], a[28:31], v[168:171]
buffer_load_dwordx4 v16, s[16:19], s30 offen lds
MM v[172:175], a[140:143], a[28:31], v[172:175]
TR a[108:109], v12 offset:36864
TR a[110:111], v12 offset:37376
MM v[176:179], a[112:115], a[32:35], v[176:179]
s_add_u32 m0, s28, 0x11780
MM v[180:183], a[116:119], a[32:35], v[180:183]
buffer_load_dwordx4 v16, s[16:19], s30 offen offset:128 lds
MM v[184:187], a[120:123], a[32:35], v[184:187]
ds_read_b128 a[0:3], v76 offset:0
ds_read_b128 a[4:7], v76 offset:2048
MM v[188:191], a[124:127], a[32:35], v[188:191]
MM v[192:195], a[128:131], a[32:35], v[192:195]
ds_read_b128 a[8:11], v76 offset:4096
ds_read_b128 a[12:15], v76 offset:6144
MM v[196:199], a[132:135], a[32:35], v[196:199]
MM v[200:203], a[136:139], a[32:35], v[200:203]
ds_read_b128 a[16:19], v76 offset:8192
MM v[204:207], a[140:143], a[32:35], v[204:207]
MM v[208:211], a[112:115], a[36:39], v[208:211]
MM v[212:215], a[116:119], a[36:39], v[212:215]
MM v[216:219], a[120:123], a[36:39], v[216:219]
MM v[220:223], a[124:127], a[36:39], v[220:223]
MM v[224:227], a[128:131], a[36:39], v[224:227]
MM v[228:231], a[132:135], a[36:39], v[228:231]
MM v[232:235], a[136:139], a[36:39], v[232:235]
MM v[236:239], a[140:143], a[36:39], v[236:239]
s_waitcnt lgkmcnt(4)
MM v[80:83], a[80:83], a[0:3], v[80:83]
s_waitcnt vmcnt(13)
s_barrier
s_add_u32 m0, s28, 0x14000
MM v[84:87], a[84:87], a[0:3], v[84:87]
s_add_u32 s30, s43, 0x80000
buffer_load_dwordx4 v16, s[16:19], s30 offen lds
MM v[88:91], a[88:91], a[0:3], v[88:91]
TR a[112:113], v9 offset:49152
TR a[114:115], v9 offset:49664
MM v[92:95], a[92:95], a[0:3], v[92:95]
s_add_u32 m0, s28, 0x14f80
MM v[96:99], a[96:99], a[0:3], v[96:99]
buffer_load_dwordx4 v16, s[16:19], s30 offen offset:128 lds
MM v[100:103], a[100:103], a[0:3], v[100:103]
TR a[116:117], v10 offset:49152
TR a[118:119], v10 offset:49664
MM v[104:107], a[104:107], a[0:3], v[104:107]
s_add_u32 m0, s28, 0x14800
s_add_u32 s30, s43, 0xa0000
MM v[108:111], a[108:111], a[0:3], v[108:111]
s_waitcnt lgkmcnt(7)
buffer_load_dwordx4 v16, s[16:19], s30 offen lds
MM v[112:115], a[80:83], a[4:7], v[112:115]
TR a[120:121], v11 offset:49152
TR a[122:123], v11 offset:49664
MM v[116:119], a[84:87], a[4:7], v[116:119]
s_add_u32 m0, s28, 0x15780
MM v[120:123], a[88:91], a[4:7], v[120:123]
buffer_load_dwordx4 v16, s[16:19], s30 offen offset:128 lds
MM v[124:127], a[92:95], a[4:7], v[124:127]
TR a[124:125], v12 offset:49152
TR a[126:127], v12 offset:49664
MM v[128:131], a[96:99], a[4:7], v[128:131]
MM v[132:135], a[100:103], a[4:7], v[132:135]
TR a[128:129], v9 offset:53248
TR a[130:131], v9 offset:53760
MM v[136:139], a[104:107], a[4:7], v[136:139]
MM v[140:143], a[108:111], a[4:7], v[140:143]
s_waitcnt lgkmcnt(12)
TR a[132:133], v10 offset:53248
TR a[134:135], v10 offset:53760
MM v[144:147], a[80:83], a[8:11], v[144:147]
MM v[148:151], a[84:87], a[8:11], v[148:151]
TR a[136:137], v11 offset:53248
TR a[138:139], v11 offset:53760
MM v[152:155], a[88:91], a[8:11], v[152:155]
MM v[156:159], a[92:95], a[8:11], v[156:159]
TR a[140:141], v12 offset:53248
TR a[142:143], v12 offset:53760
MM v[160:163], a[96:99], a[8:11], v[160:163]
MM v[164:167], a[100:103], a[8:11], v[164:167]
ds_read_b128 a[20:23], v77 offset:0
ds_read_b128 a[24:27], v77 offset:2048
MM v[168:171], a[104:107], a[8:11], v[168:171]
MM v[172:175], a[108:111], a[8:11], v[172:175]
s_waitcnt lgkmcnt(15)
ds_read_b128 a[28:31], v77 offset:4096
ds_read_b128 a[32:35], v77 offset:6144
MM v[176:179], a[80:83], a[12:15], v[176:179]
MM v[180:183], a[84:87], a[12:15], v[180:183]
ds_read_b128 a[36:39], v77 offset:8192
MM v[184:187], a[88:91], a[12:15], v[184:187]
MM v[188:191], a[92:95], a[12:15], v[188:191]
MM v[192:195], a[96:99], a[12:15], v[192:195]
MM v[196:199], a[100:103], a[12:15], v[196:199]
MM v[200:203], a[104:107], a[12:15], v[200:203]
MM v[204:207], a[108:111], a[12:15], v[204:207]
MM v[208:211], a[80:83], a[16:19], v[208:211]
MM v[212:215], a[84:87], a[16:19], v[212:215]
MM v[216:219], a[88:91], a[16:19], v[216:219]
MM v[220:223], a[92:95], a[16:19], v[220:223]
MM v[224:227], a[96:99], a[16:19], v[224:227]
MM v[228:231], a[100:103], a[16:19], v[228:231]
MM v[232:235], a[104:107], a[16:19], v[232:235]
MM v[236:239], a[108:111], a[16:19], v[236:239]
s_waitcnt lgkmcnt(4)
MM v[80:83], a[112:115], a[20:23], v[80:83]
s_waitcnt vmcnt(8) lgkmcnt(0)
s_barrier
s_add_u32 m0, s29, 0x1df80
MM v[84:87], a[116:119], a[20:23], v[84:87]
s_add_u32 s30, s48, 0x0
buffer_load_dwordx4 v15, s[12:15], s30 offen offset:128 lds
MM v[88:91], a[120:123], a[20:23], v[88:91]
TR a[80:81], v9 offset:0
TR a[82:83], v9 offset:512
MM v[92:95], a[124:127], a[20:23], v[92:95]
s_add_u32 m0, s29, 0x1e780
s_add_u32 s30, s48, 0x4000
MM v[96:99], a[128:131], a[20:23], v[96:99]
buffer_load_dwordx4 v15, s[12:15], s30 offen offset:128 lds
MM v[100:103], a[132:135], a[20:23], v[100:103]
TR a[84:85], v10 offset:0
TR a[86:87], v10 offset:512
MM v[104:107], a[136:139], a[20:23], v[104:107]
s_add_u32 m0, s29, 0x1ef80
s_add_u32 s30, s48, 0x8000
MM v[108:111], a[140:143], a[20:23], v[108:111]
buffer_load_dwordx4 v15, s[12:15], s30 offen offset:128 lds
MM v[112:115], a[112:115], a[24:27], v[112:115]
TR a[88:89], v11 offset:0
TR a[90:91], v11 offset:512
MM v[116:119], a[116:119], a[24:27], v[116:119]
s_add_u32 m0, s29, 0x1f780
s_add_u32 s30, s48, 0xc000
MM v[120:123], a[120:123], a[24:27], v[120:123]
buffer_load_dwordx4 v15, s[12:15], s30 offen offset:128 lds
MM v[124:127], a[124:127], a[24:27], v[124:127]
TR a[92:93], v12 offset:0
TR a[94:95], v12 offset:512
MM v[128:131], a[128:131], a[24:27], v[128:131]
s_add_u32 m0, s29, 0x1ff80
s_add_u32 s30, s48, 0x10000
MM v[132:135], a[132:135], a[24:27], v[132:135]
buffer_load_dwordx4 v15, s[12:15], s30 offen offset:128 lds
MM v[136:139], a[136:139], a[24:27], v[136:139]
TR a[96:97], v9 offset:4096
TR a[98:99], v9 offset:4608
MM v[140:143], a[140:143], a[24:27], v[140:143]
s_add_u32 m0, s28, 0x18000
s_add_u32 s30, s43, 0xc0000
MM v[144:147], a[112:115], a[28:31], v[144:147]
buffer_load_dwordx4 v16, s[16:19], s30 offen lds
MM v[148:151], a[116:119], a[28:31], v[148:151]
TR a[100:101], v10 offset:4096
TR a[102:103], v10 offset:4608
MM v[152:155], a[120:123], a[28:31], v[152:155]
s_add_u32 m0, s28, 0x18f80
MM v[156:159], a[124:127], a[28:31], v[156:159]
buffer_load_dwordx4 v16, s[16:19], s30 offen offset:128 lds
MM v[160:163], a[128:131], a[28:31], v[160:163]
TR a[104:105], v11 offset:4096
TR a[106:107], v11 offset:4608
MM v[164:167], a[132:135], a[28:31], v[164:167]
s_add_u32 m0, s28, 0x18800
s_add_u32 s30, s43, 0xe0000
MM v[168:171], a[136:139], a[28:31], v[168:171]
buffer_load_dwordx4 v16, s[16:19], s30 offen lds
MM v[172:175], a[140:143], a[28:31], v[172:175]
TR a[108:109], v12 offset:4096
TR a[110:111], v12 offset:4608
MM v[176:179], a[112:115], a[32:35], v[176:179]
s_add_u32 m0, s28, 0x19780
MM v[180:183], a[116:119], a[32:35], v[180:183]
buffer_load_dwordx4 v16, s[16:19], s30 offen offset:128 lds
MM v[184:187], a[120:123], a[32:35], v[184:187]
ds_read_b128 a[0:3], v76 offset:20480
ds_read_b128 a[4:7], v76 offset:22528
MM v[188:191], a[124:127], a[32:35], v[188:191]
MM v[192:195], a[128:131], a[32:35], v[192:195]
ds_read_b128 a[8:11], v76 offset:24576
ds_read_b128 a[12:15], v76 offset:26624
MM v[196:199], a[132:135], a[32:35], v[196:199]
MM v[200:203], a[136:139], a[32:35], v[200:203]
ds_read_b128 a[16:19], v76 offset:28672
MM v[204:207], a[140:143], a[32:35], v[204:207]
MM v[208:211], a[112:115], a[36:39], v[208:211]
MM v[212:215], a[116:119], a[36:39], v[212:215]
MM v[216:219], a[120:123], a[36:39], v[216:219]
MM v[220:223], a[124:127], a[36:39], v[220:223]
MM v[224:227], a[128:131], a[36:39], v[224:227]
MM v[228:231], a[132:135], a[36:39], v[228:231]
MM v[232:235], a[136:139], a[36:39], v[232:235]
MM v[236:239], a[140:143], a[36:39], v[236:239]
s_waitcnt lgkmcnt(4)
MM v[80:83], a[80:83], a[0:3], v[80:83]
s_waitcnt vmcnt(13)
s_barrier
s_add_u32 m0, s28, 0xc000
MM v[84:87], a[84:87], a[0:3], v[84:87]
s_add_u32 s30, s43, 0x100000
buffer_load_dwordx4 v16, s[16:19], s30 offen lds
MM v[88:91], a[88:91], a[0:3], v[88:91]
TR a[112:113], v9 offset:16384
TR a[114:115], v9 offset:16896
MM v[92:95], a[92:95], a[0:3], v[92:95]
s_add_u32 m0, s28, 0xcf80
MM v[96:99], a[96:99], a[0:3], v[96:99]
buffer_load_dwordx4 v16, s[16:19], s30 offen offset:128 lds
MM v[100:103], a[100:103], a[0:3], v[100:103]
TR a[116:117], v10 offset:16384
TR a[118:119], v10 offset:16896
MM v[104:107], a[104:107], a[0:3], v[104:107]
s_add_u32 m0, s28, 0xc800
s_add_u32 s30, s43, 0x120000
MM v[108:111], a[108:111], a[0:3], v[108:111]
s_waitcnt lgkmcnt(7)
buffer_load_dwordx4 v16, s[16:19], s30 offen lds
MM v[112:115], a[80:83], a[4:7], v[112:115]
TR a[120:121], v11 offset:16384
TR a[122:123], v11 offset:16896
MM v[116:119], a[84:87], a[4:7], v[116:119]
s_add_u32 m0, s28, 0xd780
MM v[120:123], a[88:91], a[4:7], v[120:123]
buffer_load_dwordx4 v16, s[16:19], s30 offen offset:128 lds
MM v[124:127], a[92:95], a[4:7], v[124:127]
TR a[124:125], v12 offset:16384
TR a[126:127], v12 offset:16896
MM v[128:131], a[96:99], a[4:7], v[128:131]
MM v[132:135], a[100:103], a[4:7], v[132:135]
TR a[128:129], v9 offset:20480
TR a[130:131], v9 offset:20992
MM v[136:139], a[104:107], a[4:7], v[136:139]
MM v[140:143], a[108:111], a[4:7], v[140:143]
s_waitcnt lgkmcnt(12)
TR a[132:133], v10 offset:20480
TR a[134:135], v10 offset:20992
MM v[144:147], a[80:83], a[8:11], v[144:147]
MM v[148:151], a[84:87], a[8:11], v[148:151]
TR a[136:137], v11 offset:20480
TR a[138:139], v11 offset:20992
MM v[152:155], a[88:91], a[8:11], v[152:155]
MM v[156:159], a[92:95], a[8:11], v[156:159]
TR a[140:141], v12 offset:20480
TR a[142:143], v12 offset:20992
MM v[160:163], a[96:99], a[8:11], v[160:163]
MM v[164:167], a[100:103], a[8:11], v[164:167]
ds_read_b128 a[20:23], v77 offset:20480
ds_read_b128 a[24:27], v77 offset:22528
MM v[168:171], a[104:107], a[8:11], v[168:171]
MM v[172:175], a[108:111], a[8:11], v[172:175]
s_waitcnt lgkmcnt(15)
ds_read_b128 a[28:31], v77 offset:24576
ds_read_b128 a[32:35], v77 offset:26624
MM v[176:179], a[80:83], a[12:15], v[176:179]
MM v[180:183], a[84:87], a[12:15], v[180:183]
ds_read_b128 a[36:39], v77 offset:28672
MM v[184:187], a[88:91], a[12:15], v[184:187]
MM v[188:191], a[92:95], a[12:15], v[188:191]
MM v[192:195], a[96:99], a[12:15], v[192:195]
MM v[196:199], a[100:103], a[12:15], v[196:199]
MM v[200:203], a[104:107], a[12:15], v[200:203]
MM v[204:207], a[108:111], a[12:15], v[204:207]
MM v[208:211], a[80:83], a[16:19], v[208:211]
MM v[212:215], a[84:87], a[16:19], v[212:215]
MM v[216:219], a[88:91], a[16:19], v[216:219]
MM v[220:223], a[92:95], a[16:19], v[220:223]
MM v[224:227], a[96:99], a[16:19], v[224:227]
MM v[228:231], a[100:103], a[16:19], v[228:231]
MM v[232:235], a[104:107], a[16:19], v[232:235]
MM v[236:239], a[108:111], a[16:19], v[236:239]
s_sub_u32 s96, s96, 1
s_cmp_lg_u32 s96, 0
s_cbranch_scc1 L_ZQ0
s_waitcnt lgkmcnt(4)
MM v[80:83], a[112:115], a[20:23], v[80:83]
s_cmp_lg_u32 s3, 0
s_cbranch_scc1 L_far1
s_cmp_lg_u32 s33, 0
s_cbranch_scc1 L_Zann
s_mov_b32 s44, s86
s_mov_b32 s45, s87
s_mov_b32 s46, 4
s_mov_b32 s47, 0x20000
s_mov_b64 exec, 1
v_mov_b32 v45, 1
buffer_atomic_add v45, v78, s[44:47], 0 offen
s_mov_b64 exec, -1
L_Zann:
s_nop 4
s_waitcnt vmcnt(0) lgkmcnt(0)
s_barrier
MM v[84:87], a[116:119], a[20:23], v[84:87]
s_add_u32 m0, s28, 0x10000
s_add_u32 s30, s42, 0x4000
s_and_b32 s30, s30, 0x1ffff
MM v[88:91], a[120:123], a[20:23], v[88:91]
buffer_load_dwordx4 v13, s[4:7], s30 offen nt lds
MM v[92:95], a[124:127], a[20:23], v[92:95]
s_add_u32 m0, s28, 0x10f80
TR a[80:81], v9 offset:32768
TR a[82:83], v9 offset:33280
MM v[96:99], a[128:131], a[20:23], v[96:99]
buffer_load_dwordx4 v13, s[4:7], s30 offen offset:128 nt lds
MM v[100:103], a[132:135], a[20:23], v[100:103]
TR a[84:85], v10 offset:32768
TR a[86:87], v10 offset:33280
MM v[104:107], a[136:139], a[20:23], v[104:107]
MM v[108:111], a[140:143], a[20:23], v[108:111]
s_add_u32 m0, s28, 0x10800
s_add_u32 s30, s42, 0x5000
s_and_b32 s30, s30, 0x1ffff
MM v[112:115], a[112:115], a[24:27], v[112:115]
buffer_load_dwordx4 v13, s[4:7], s30 offen nt lds
MM v[116:119], a[116:119], a[24:27], v[116:119]
s_add_u32 m0, s28, 0x11780
TR a[88:89], v11 offset:32768
TR a[90:91], v11 offset:33280
MM v[120:123], a[120:123], a[24:27], v[120:123]
buffer_load_dwordx4 v13, s[4:7], s30 offen offset:128 nt lds
MM v[124:127], a[124:127], a[24:27], v[124:127]
TR a[92:93], v12 offset:32768
TR a[94:95], v12 offset:33280
MM v[128:131], a[128:131], a[24:27], v[128:131]
MM v[132:135], a[132:135], a[24:27], v[132:135]
s_add_u32 m0, s28, 0xc000
s_add_u32 s30, s42, 0x2000
s_and_b32 s30, s30, 0x1ffff
MM v[136:139], a[136:139], a[24:27], v[136:139]
buffer_load_dwordx4 v14, s[8:11], s30 offen nt lds
MM v[140:143], a[140:143], a[24:27], v[140:143]
s_add_u32 m0, s28, 0xcf80
TR a[96:97], v9 offset:36864
TR a[98:99], v9 offset:37376
MM v[144:147], a[112:115], a[28:31], v[144:147]
buffer_load_dwordx4 v14, s[8:11], s30 offen offset:128 nt lds
MM v[148:151], a[116:119], a[28:31], v[148:151]
TR a[100:101], v10 offset:36864
TR a[102:103], v10 offset:37376
MM v[152:155], a[120:123], a[28:31], v[152:155]
MM v[156:159], a[124:127], a[28:31], v[156:159]
s_add_u32 m0, s28, 0xc800
s_add_u32 s30, s42, 0x3000
s_and_b32 s30, s30, 0x1ffff
MM v[160:163], a[128:131], a[28:31], v[160:163]
buffer_load_dwordx4 v14, s[8:11], s30 offen nt lds
MM v[164:167], a[132:135], a[28:31], v[164:167]
s_add_u32 m0, s28, 0xd780
TR a[104:105], v11 offset:36864
TR a[106:107], v11 offset:37376
MM v[168:171], a[136:139], a[28:31], v[168:171]
buffer_load_dwordx4 v14, s[8:11], s30 offen offset:128 nt lds
MM v[172:175], a[140:143], a[28:31], v[172:175]
TR a[108:109], v12 offset:36864
TR a[110:111], v12 offset:37376
MM v[176:179], a[112:115], a[32:35], v[176:179]
MM v[180:183], a[116:119], a[32:35], v[180:183]
ds_read_b128 a[0:3], v76 offset:0
ds_read_b128 a[4:7], v76 offset:2048
MM v[184:187], a[120:123], a[32:35], v[184:187]
MM v[188:191], a[124:127], a[32:35], v[188:191]
ds_read_b128 a[8:11], v76 offset:4096
ds_read_b128 a[12:15], v76 offset:6144
MM v[192:195], a[128:131], a[32:35], v[192:195]
MM v[196:199], a[132:135], a[32:35], v[196:199]
ds_read_b128 a[16:19], v76 offset:8192
MM v[200:203], a[136:139], a[32:35], v[200:203]
MM v[204:207], a[140:143], a[32:35], v[204:207]
MM v[208:211], a[112:115], a[36:39], v[208:211]
MM v[212:215], a[116:119], a[36:39], v[212:215]
MM v[216:219], a[120:123], a[36:39], v[216:219]
MM v[220:223], a[124:127], a[36:39], v[220:223]
MM v[224:227], a[128:131], a[36:39], v[224:227]
MM v[228:231], a[132:135], a[36:39], v[228:231]
MM v[232:235], a[136:139], a[36:39], v[232:235]
MM v[236:239], a[140:143], a[36:39], v[236:239]
s_waitcnt lgkmcnt(4)
MM v[80:83], a[80:83], a[0:3], v[80:83]
s_barrier
s_add_u32 m0, s28, 0x14000
s_add_u32 s30, s42, 0x4000
MM v[84:87], a[84:87], a[0:3], v[84:87]
s_and_b32 s30, s30, 0x1ffff
buffer_load_dwordx4 v14, s[8:11], s30 offen nt lds
MM v[88:91], a[88:91], a[0:3], v[88:91]
s_add_u32 m0, s28, 0x14f80
TR a[112:113], v9 offset:49152
TR a[114:115], v9 offset:49664
MM v[92:95], a[92:95], a[0:3], v[92:95]
buffer_load_dwordx4 v14, s[8:11], s30 offen offset:128 nt lds
MM v[96:99], a[96:99], a[0:3], v[96:99]
TR a[116:117], v10 offset:49152
TR a[118:119], v10 offset:49664
MM v[100:103], a[100:103], a[0:3], v[100:103]
MM v[104:107], a[104:107], a[0:3], v[104:107]
s_add_u32 m0, s28, 0x14800
s_add_u32 s30, s42, 0x5000
s_and_b32 s30, s30, 0x1ffff
MM v[108:111], a[108:111], a[0:3], v[108:111]
s_waitcnt lgkmcnt(7)
buffer_load_dwordx4 v14, s[8:11], s30 offen nt lds
MM v[112:115], a[80:83], a[4:7], v[112:115]
s_add_u32 m0, s28, 0x15780
TR a[120:121], v11 offset:49152
TR a[122:123], v11 offset:49664
MM v[116:119], a[84:87], a[4:7], v[116:119]
buffer_load_dwordx4 v14, s[8:11], s30 offen offset:128 nt lds
MM v[120:123], a[88:91], a[4:7], v[120:123]
TR a[124:125], v12 offset:49152
TR a[126:127], v12 offset:49664
MM v[124:127], a[92:95], a[4:7], v[124:127]
MM v[128:131], a[96:99], a[4:7], v[128:131]
TR a[128:129], v9 offset:53248
TR a[130:131], v9 offset:53760
MM v[132:135], a[100:103], a[4:7], v[132:135]
MM v[136:139], a[104:107], a[4:7], v[136:139]
TR a[132:133], v10 offset:53248
TR a[134:135], v10 offset:53760
MM v[140:143], a[108:111], a[4:7], v[140:143]
s_waitcnt lgkmcnt(14)
MM v[144:147], a[80:83], a[8:11], v[144:147]
TR a[136:137], v11 offset:53248
TR a[138:139], v11 offset:53760
MM v[148:151], a[84:87], a[8:11], v[148:151]
MM v[152:155], a[88:91], a[8:11], v[152:155]
TR a[140:141], v12 offset:53248
TR a[142:143], v12 offset:53760
MM v[156:159], a[92:95], a[8:11], v[156:159]
MM v[160:163], a[96:99], a[8:11], v[160:163]
ds_read_b128 a[20:23], v77 offset:0
ds_read_b128 a[24:27], v77 offset:2048
MM v[164:167], a[100:103], a[8:11], v[164:167]
MM v[168:171], a[104:107], a[8:11], v[168:171]
ds_read_b128 a[28:31], v77 offset:4096
ds_read_b128 a[32:35], v77 offset:6144
MM v[172:175], a[108:111], a[8:11], v[172:175]
s_waitcnt lgkmcnt(15)
MM v[176:179], a[80:83], a[12:15], v[176:179]
ds_read_b128 a[36:39], v77 offset:8192
MM v[180:183], a[84:87], a[12:15], v[180:183]
MM v[184:187], a[88:91], a[12:15], v[184:187]
MM v[188:191], a[92:95], a[12:15], v[188:191]
MM v[192:195], a[96:99], a[12:15], v[192:195]
MM v[196:199], a[100:103], a[12:15], v[196:199]
MM v[200:203], a[104:107], a[12:15], v[200:203]
MM v[204:207], a[108:111], a[12:15], v[204:207]
MM v[208:211], a[80:83], a[16:19], v[208:211]
MM v[212:215], a[84:87], a[16:19], v[212:215]
MM v[216:219], a[88:91], a[16:19], v[216:219]
MM v[220:223], a[92:95], a[16:19], v[220:223]
MM v[224:227], a[96:99], a[16:19], v[224:227]
MM v[228:231], a[100:103], a[16:19], v[228:231]
MM v[232:235], a[104:107], a[16:19], v[232:235]
MM v[236:239], a[108:111], a[16:19], v[236:239]
s_waitcnt lgkmcnt(4)
MM v[80:83], a[112:115], a[20:23], v[80:83]
s_waitcnt lgkmcnt(0)
s_barrier
s_add_u32 m0, s28, 0x18000
MM v[84:87], a[116:119], a[20:23], v[84:87]
s_add_u32 s30, s42, 0x6000
s_and_b32 s30, s30, 0x1ffff
MM v[88:91], a[120:123], a[20:23], v[88:91]
buffer_load_dwordx4 v13, s[4:7], s30 offen nt lds
MM v[92:95], a[124:127], a[20:23], v[92:95]
s_add_u32 m0, s28, 0x18f80
MM v[96:99], a[128:131], a[20:23], v[96:99]
buffer_load_dwordx4 v13, s[4:7], s30 offen offset:128 nt lds
MM v[100:103], a[132:135], a[20:23], v[100:103]
MM v[104:107], a[136:139], a[20:23], v[104:107]
MM v[108:111], a[140:143], a[20:23], v[108:111]
s_add_u32 m0, s28, 0x18800
s_add_u32 s30, s42, 0x7000
s_and_b32 s30, s30, 0x1ffff
MM v[112:115], a[112:115], a[24:27], v[112:115]
buffer_load_dwordx4 v13, s[4:7], s30 offen nt lds
MM v[116:119], a[116:119], a[24:27], v[116:119]
s_add_u32 m0, s28, 0x19780
MM v[120:123], a[120:123], a[24:27], v[120:123]
buffer_load_dwordx4 v13, s[4:7], s30 offen offset:128 nt lds
MM v[124:127], a[124:127], a[24:27], v[124:127]
MM v[128:131], a[128:131], a[24:27], v[128:131]
MM v[132:135], a[132:135], a[24:27], v[132:135]
s_add_u32 m0, s28, 0x1c000
s_add_u32 s30, s42, 0x6000
s_and_b32 s30, s30, 0x1ffff
MM v[136:139], a[136:139], a[24:27], v[136:139]
buffer_load_dwordx4 v14, s[8:11], s30 offen nt lds
MM v[140:143], a[140:143], a[24:27], v[140:143]
s_add_u32 m0, s28, 0x1cf80
MM v[144:147], a[112:115], a[28:31], v[144:147]
buffer_load_dwordx4 v14, s[8:11], s30 offen offset:128 nt lds
MM v[148:151], a[116:119], a[28:31], v[148:151]
MM v[152:155], a[120:123], a[28:31], v[152:155]
MM v[156:159], a[124:127], a[28:31], v[156:159]
s_add_u32 m0, s28, 0x1c800
s_add_u32 s30, s42, 0x7000
s_and_b32 s30, s30, 0x1ffff
MM v[160:163], a[128:131], a[28:31], v[160:163]
buffer_load_dwordx4 v14, s[8:11], s30 offen nt lds
MM v[164:167], a[132:135], a[28:31], v[164:167]
s_add_u32 m0, s28, 0x1d780
MM v[168:171], a[136:139], a[28:31], v[168:171]
buffer_load_dwordx4 v14, s[8:11], s30 offen offset:128 nt lds
MM v[172:175], a[140:143], a[28:31], v[172:175]
MM v[176:179], a[112:115], a[32:35], v[176:179]
MM v[180:183], a[116:119], a[32:35], v[180:183]
MM v[184:187], a[120:123], a[32:35], v[184:187]
MM v[188:191], a[124:127], a[32:35], v[188:191]
MM v[192:195], a[128:131], a[32:35], v[192:195]
MM v[196:199], a[132:135], a[32:35], v[196:199]
MM v[200:203], a[136:139], a[32:35], v[200:203]
MM v[204:207], a[140:143], a[32:35], v[204:207]
MM v[208:211], a[112:115], a[36:39], v[208:211]
MM v[212:215], a[116:119], a[36:39], v[212:215]
MM v[216:219], a[120:123], a[36:39], v[216:219]
MM v[220:223], a[124:127], a[36:39], v[220:223]
MM v[224:227], a[128:131], a[36:39], v[224:227]
MM v[228:231], a[132:135], a[36:39], v[228:231]
MM v[232:235], a[136:139], a[36:39], v[232:235]
MM v[236:239], a[140:143], a[36:39], v[236:239]
v_pk_mul_f32 v[80:81], v[80:81], s[38:39]
s_mov_b32 s43, 0x0
s_mov_b32 s48, 0x0
v_pk_mul_f32 v[82:83], v[82:83], s[38:39]
v_pk_mul_f32 v[84:85], v[84:85], s[38:39]
v_pk_mul_f32 v[86:87], v[86:87], s[38:39]
CV v80, v80, v81
CV v81, v82, v83
CV v82, v84, v85
CV v83, v86, v87
v_accvgpr_write_b32 a0, v80
v_accvgpr_write_b32 a1, v81
v_accvgpr_write_b32 a2, v82
v_accvgpr_write_b32 a3, v83
v_pk_mul_f32 v[88:89], v[88:89], s[38:39]
v_pk_mul_f32 v[90:91], v[90:91], s[38:39]
v_pk_mul_f32 v[92:93], v[92:93], s[38:39]
v_pk_mul_f32 v[94:95], v[94:95], s[38:39]
CV v88, v88, v89
CV v89, v90, v91
CV v90, v92, v93
CV v91, v94, v95
v_accvgpr_write_b32 a4, v88
v_accvgpr_write_b32 a5, v89
v_accvgpr_write_b32 a6, v90
v_accvgpr_write_b32 a7, v91
v_pk_mul_f32 v[96:97], v[96:97], s[38:39]
v_pk_mul_f32 v[98:99], v[98:99], s[38:39]
v_pk_mul_f32 v[100:101], v[100:101], s[38:39]
v_pk_mul_f32 v[102:103], v[102:103], s[38:39]
CV v96, v96, v97
CV v97, v98, v99
CV v98, v100, v101
CV v99, v102, v103
v_accvgpr_write_b32 a8, v96
v_accvgpr_write_b32 a9, v97
v_accvgpr_write_b32 a10, v98
v_accvgpr_write_b32 a11, v99
v_pk_mul_f32 v[104:105], v[104:105], s[38:39]
v_pk_mul_f32 v[106:107], v[106:107], s[38:39]
v_pk_mul_f32 v[108:109], v[108:109], s[38:39]
v_pk_mul_f32 v[110:111], v[110:111], s[38:39]
CV v104, v104, v105
CV v105, v106, v107
CV v106, v108, v109
CV v107, v110, v111
v_accvgpr_write_b32 a12, v104
v_accvgpr_write_b32 a13, v105
v_accvgpr_write_b32 a14, v106
v_accvgpr_write_b32 a15, v107
v_pk_mul_f32 v[112:113], v[112:113], s[38:39]
v_pk_mul_f32 v[114:115], v[114:115], s[38:39]
v_pk_mul_f32 v[116:117], v[116:117], s[38:39]
v_pk_mul_f32 v[118:119], v[118:119], s[38:39]
CV v112, v112, v113
CV v113, v114, v115
CV v114, v116, v117
CV v115, v118, v119
v_accvgpr_write_b32 a16, v112
v_accvgpr_write_b32 a17, v113
v_accvgpr_write_b32 a18, v114
v_accvgpr_write_b32 a19, v115
v_pk_mul_f32 v[120:121], v[120:121], s[38:39]
v_pk_mul_f32 v[122:123], v[122:123], s[38:39]
v_pk_mul_f32 v[124:125], v[124:125], s[38:39]
v_pk_mul_f32 v[126:127], v[126:127], s[38:39]
CV v120, v120, v121
CV v121, v122, v123
CV v122, v124, v125
CV v123, v126, v127
v_accvgpr_write_b32 a20, v120
v_accvgpr_write_b32 a21, v121
v_accvgpr_write_b32 a22, v122
v_accvgpr_write_b32 a23, v123
v_pk_mul_f32 v[128:129], v[128:129], s[38:39]
v_pk_mul_f32 v[130:131], v[130:131], s[38:39]
v_pk_mul_f32 v[132:133], v[132:133], s[38:39]
v_pk_mul_f32 v[134:135], v[134:135], s[38:39]
CV v128, v128, v129
CV v129, v130, v131
CV v130, v132, v133
CV v131, v134, v135
v_accvgpr_write_b32 a24, v128
v_accvgpr_write_b32 a25, v129
v_accvgpr_write_b32 a26, v130
v_accvgpr_write_b32 a27, v131
v_pk_mul_f32 v[136:137], v[136:137], s[38:39]
v_pk_mul_f32 v[138:139], v[138:139], s[38:39]
v_pk_mul_f32 v[140:141], v[140:141], s[38:39]
v_pk_mul_f32 v[142:143], v[142:143], s[38:39]
CV v136, v136, v137
CV v137, v138, v139
CV v138, v140, v141
CV v139, v142, v143
v_accvgpr_write_b32 a28, v136
v_accvgpr_write_b32 a29, v137
v_accvgpr_write_b32 a30, v138
v_accvgpr_write_b32 a31, v139
v_pk_mul_f32 v[144:145], v[144:145], s[38:39]
v_pk_mul_f32 v[146:147], v[146:147], s[38:39]
v_pk_mul_f32 v[148:149], v[148:149], s[38:39]
v_pk_mul_f32 v[150:151], v[150:151], s[38:39]
CV v144, v144, v145
s_barrier
CV v145, v146, v147
CV v146, v148, v149
CV v147, v150, v151
TR a[112:113], v1 offset:16384
TR a[114:115], v1 offset:18432
v_accvgpr_write_b32 a32, v144
v_accvgpr_write_b32 a33, v145
v_accvgpr_write_b32 a34, v146
v_accvgpr_write_b32 a35, v147
TR a[116:117], v2 offset:16384
TR a[118:119], v2 offset:18432
v_pk_mul_f32 v[152:153], v[152:153], s[38:39]
v_pk_mul_f32 v[154:155], v[154:155], s[38:39]
v_pk_mul_f32 v[156:157], v[156:157], s[38:39]
v_pk_mul_f32 v[158:159], v[158:159], s[38:39]
TR a[120:121], v3 offset:16384
TR a[122:123], v3 offset:18432
CV v152, v152, v153
CV v153, v154, v155
CV v154, v156, v157
CV v155, v158, v159
TR a[124:125], v4 offset:16384
TR a[126:127], v4 offset:18432
v_accvgpr_write_b32 a36, v152
v_accvgpr_write_b32 a37, v153
v_accvgpr_write_b32 a38, v154
v_accvgpr_write_b32 a39, v155
TR a[128:129], v1 offset:20480
TR a[130:131], v1 offset:22528
v_pk_mul_f32 v[160:161], v[160:161], s[38:39]
v_pk_mul_f32 v[162:163], v[162:163], s[38:39]
v_pk_mul_f32 v[164:165], v[164:165], s[38:39]
v_pk_mul_f32 v[166:167], v[166:167], s[38:39]
TR a[132:133], v2 offset:20480
TR a[134:135], v2 offset:22528
CV v160, v160, v161
CV v161, v162, v163
CV v162, v164, v165
CV v163, v166, v167
TR a[136:137], v3 offset:20480
TR a[138:139], v3 offset:22528
v_accvgpr_write_b32 a40, v160
v_accvgpr_write_b32 a41, v161
v_accvgpr_write_b32 a42, v162
v_accvgpr_write_b32 a43, v163
TR a[140:141], v4 offset:20480
TR a[142:143], v4 offset:22528
v_pk_mul_f32 v[168:169], v[168:169], s[38:39]
v_pk_mul_f32 v[170:171], v[170:171], s[38:39]
v_pk_mul_f32 v[172:173], v[172:173], s[38:39]
v_pk_mul_f32 v[174:175], v[174:175], s[38:39]
ds_read_b64 a[80:81], v5 offset:0
ds_read_b64 a[82:83], v6 offset:0
CV v168, v168, v169
CV v169, v170, v171
CV v170, v172, v173
CV v171, v174, v175
ds_read_b64 a[84:85], v5 offset:2048
ds_read_b64 a[86:87], v6 offset:2048
v_accvgpr_write_b32 a44, v168
v_accvgpr_write_b32 a45, v169
v_accvgpr_write_b32 a46, v170
v_accvgpr_write_b32 a47, v171
ds_read_b64 a[88:89], v7 offset:0
ds_read_b64 a[90:91], v8 offset:0
v_pk_mul_f32 v[176:177], v[176:177], s[38:39]
v_pk_mul_f32 v[178:179], v[178:179], s[38:39]
v_pk_mul_f32 v[180:181], v[180:181], s[38:39]
v_pk_mul_f32 v[182:183], v[182:183], s[38:39]
ds_read_b64 a[92:93], v7 offset:2048
ds_read_b64 a[94:95], v8 offset:2048
CV v176, v176, v177
CV v177, v178, v179
CV v178, v180, v181
CV v179, v182, v183
ds_read_b64 a[96:97], v5 offset:4096
ds_read_b64 a[98:99], v6 offset:4096
v_accvgpr_write_b32 a48, v176
v_accvgpr_write_b32 a49, v177
v_accvgpr_write_b32 a50, v178
v_accvgpr_write_b32 a51, v179
ds_read_b64 a[100:101], v5 offset:6144
ds_read_b64 a[102:103], v6 offset:6144
v_pk_mul_f32 v[184:185], v[184:185], s[38:39]
v_pk_mul_f32 v[186:187], v[186:187], s[38:39]
v_pk_mul_f32 v[188:189], v[188:189], s[38:39]
v_pk_mul_f32 v[190:191], v[190:191], s[38:39]
ds_read_b64 a[104:105], v7 offset:4096
ds_read_b64 a[106:107], v8 offset:4096
CV v184, v184, v185
CV v185, v186, v187
CV v186, v188, v189
CV v187, v190, v191
ds_read_b64 a[108:109], v7 offset:6144
ds_read_b64 a[110:111], v8 offset:6144
v_accvgpr_write_b32 a52, v184
v_accvgpr_write_b32 a53, v185
v_accvgpr_write_b32 a54, v186
v_accvgpr_write_b32 a55, v187
v_pk_mul_f32 v[192:193], v[192:193], s[38:39]
v_pk_mul_f32 v[194:195], v[194:195], s[38:39]
v_pk_mul_f32 v[196:197], v[196:197], s[38:39]
v_pk_mul_f32 v[198:199], v[198:199], s[38:39]
CV v192, v192, v193
CV v193, v194, v195
CV v194, v196, v197
CV v195, v198, v199
v_accvgpr_write_b32 a56, v192
v_accvgpr_write_b32 a57, v193
v_accvgpr_write_b32 a58, v194
v_accvgpr_write_b32 a59, v195
v_pk_mul_f32 v[200:201], v[200:201], s[38:39]
v_pk_mul_f32 v[202:203], v[202:203], s[38:39]
v_pk_mul_f32 v[204:205], v[204:205], s[38:39]
v_pk_mul_f32 v[206:207], v[206:207], s[38:39]
CV v200, v200, v201
CV v201, v202, v203
CV v202, v204, v205
CV v203, v206, v207
v_accvgpr_write_b32 a60, v200
v_accvgpr_write_b32 a61, v201
v_accvgpr_write_b32 a62, v202
v_accvgpr_write_b32 a63, v203
v_pk_mul_f32 v[208:209], v[208:209], s[38:39]
v_pk_mul_f32 v[210:211], v[210:211], s[38:39]
v_pk_mul_f32 v[212:213], v[212:213], s[38:39]
v_pk_mul_f32 v[214:215], v[214:215], s[38:39]
CV v208, v208, v209
CV v209, v210, v211
CV v210, v212, v213
CV v211, v214, v215
v_accvgpr_write_b32 a64, v208
v_accvgpr_write_b32 a65, v209
v_accvgpr_write_b32 a66, v210
v_accvgpr_write_b32 a67, v211
v_pk_mul_f32 v[216:217], v[216:217], s[38:39]
v_pk_mul_f32 v[218:219], v[218:219], s[38:39]
v_pk_mul_f32 v[220:221], v[220:221], s[38:39]
v_pk_mul_f32 v[222:223], v[222:223], s[38:39]
CV v216, v216, v217
CV v217, v218, v219
CV v218, v220, v221
CV v219, v222, v223
v_accvgpr_write_b32 a68, v216
v_accvgpr_write_b32 a69, v217
v_accvgpr_write_b32 a70, v218
v_accvgpr_write_b32 a71, v219
v_pk_mul_f32 v[224:225], v[224:225], s[38:39]
v_pk_mul_f32 v[226:227], v[226:227], s[38:39]
v_pk_mul_f32 v[228:229], v[228:229], s[38:39]
v_pk_mul_f32 v[230:231], v[230:231], s[38:39]
CV v224, v224, v225
CV v225, v226, v227
CV v226, v228, v229
CV v227, v230, v231
v_accvgpr_write_b32 a72, v224
v_accvgpr_write_b32 a73, v225
v_accvgpr_write_b32 a74, v226
v_accvgpr_write_b32 a75, v227
v_pk_mul_f32 v[232:233], v[232:233], s[38:39]
v_pk_mul_f32 v[234:235], v[234:235], s[38:39]
v_pk_mul_f32 v[236:237], v[236:237], s[38:39]
v_pk_mul_f32 v[238:239], v[238:239], s[38:39]
CV v232, v232, v233
CV v233, v234, v235
CV v234, v236, v237
CV v235, v238, v239
v_accvgpr_write_b32 a76, v232
v_accvgpr_write_b32 a77, v233
v_accvgpr_write_b32 a78, v234
v_accvgpr_write_b32 a79, v235
L_ZAent0:
s_mov_b32 s99, 0x0
s_waitcnt lgkmcnt(8)
MM v[44:47], a[80:83], a[0:3], v[24:27]
MM v[48:51], a[84:87], a[0:3], v[24:27]
MM v[44:47], a[88:91], a[4:7], v[44:47]
MM v[48:51], a[92:95], a[4:7], v[48:51]
s_waitcnt lgkmcnt(0)
MM v[44:47], a[96:99], a[8:11], v[44:47]
MM v[48:51], a[100:103], a[8:11], v[48:51]
MM v[44:47], a[104:107], a[12:15], v[44:47]
MM v[48:51], a[108:111], a[12:15], v[48:51]
MM v[52:55], a[80:83], a[16:19], v[28:31]
MM v[56:59], a[84:87], a[16:19], v[28:31]
MM v[52:55], a[88:91], a[20:23], v[52:55]
MM v[56:59], a[92:95], a[20:23], v[56:59]
MM v[52:55], a[96:99], a[24:27], v[52:55]
MM v[56:59], a[100:103], a[24:27], v[56:59]
MM v[52:55], a[104:107], a[28:31], v[52:55]
v_exp_f32 v44, v44
MM v[56:59], a[108:111], a[28:31], v[56:59]
v_exp_f32 v45, v45
MM v[60:63], a[80:83], a[32:35], v[32:35]
v_exp_f32 v46, v46
MM v[64:67], a[84:87], a[32:35], v[32:35]
v_exp_f32 v47, v47
MM v[60:63], a[88:91], a[36:39], v[60:63]
CV v240, v44, v45
CV v241, v46, v47
v_exp_f32 v48, v48
v_exp_f32 v49, v49
v_exp_f32 v50, v50
v_exp_f32 v51, v51
MM v[64:67], a[92:95], a[36:39], v[64:67]
CV v242, v48, v49
CV v243, v50, v51
MM v[60:63], a[96:99], a[40:43], v[60:63]
v_exp_f32 v52, v52
MM v[64:67], a[100:103], a[40:43], v[64:67]
v_exp_f32 v53, v53
MM v[60:63], a[104:107], a[44:47], v[60:63]
v_exp_f32 v54, v54
MM v[64:67], a[108:111], a[44:47], v[64:67]
v_exp_f32 v55, v55
MM v[80:83], a[112:115], v[240:243], 0
CV v244, v52, v53
CV v245, v54, v55
MM v[84:87], a[116:119], v[240:243], 0
v_exp_f32 v56, v56
MM v[88:91], a[120:123], v[240:243], 0
v_exp_f32 v57, v57
MM v[92:95], a[124:127], v[240:243], 0
v_exp_f32 v58, v58
MM v[96:99], a[128:131], v[240:243], 0
v_exp_f32 v59, v59
MM v[100:103], a[132:135], v[240:243], 0
CV v246, v56, v57
CV v247, v58, v59
MM v[104:107], a[136:139], v[240:243], 0
v_exp_f32 v60, v60
MM v[108:111], a[140:143], v[240:243], 0
v_exp_f32 v61, v61
MM a[224:227], a[244:247], v[240:243], 0
v_exp_f32 v62, v62
MM v[68:71], a[80:83], a[48:51], v[36:39]
v_exp_f32 v63, v63
MM v[72:75], a[84:87], a[48:51], v[36:39]
CV v248, v60, v61
CV v249, v62, v63
MM v[68:71], a[88:91], a[52:55], v[68:71]
v_exp_f32 v64, v64
MM v[72:75], a[92:95], a[52:55], v[72:75]
v_exp_f32 v65, v65
MM v[68:71], a[96:99], a[56:59], v[68:71]
v_exp_f32 v66, v66
MM v[72:75], a[100:103], a[56:59], v[72:75]
v_exp_f32 v67, v67
MM v[68:71], a[104:107], a[60:63], v[68:71]
CV v250, v64, v65
CV v251, v66, v67
MM v[72:75], a[108:111], a[60:63], v[72:75]
MM v[112:115], a[112:115], v[244:247], 0
MM v[116:119], a[116:119], v[244:247], 0
MM v[120:123], a[120:123], v[244:247], 0
MM v[124:127], a[124:127], v[244:247], 0
MM v[128:131], a[128:131], v[244:247], 0
v_exp_f32 v68, v68
MM v[132:135], a[132:135], v[244:247], 0
v_exp_f32 v69, v69
MM v[136:139], a[136:139], v[244:247], 0
v_exp_f32 v70, v70
MM v[140:143], a[140:143], v[244:247], 0
v_exp_f32 v71, v71
MM a[228:231], a[244:247], v[244:247], 0
s_waitcnt vmcnt(12)
s_barrier
s_add_u32 m0, s28, 0x0
MM v[44:47], a[80:83], a[64:67], v[40:43]
s_add_u32 s30, s42, 0x8000
s_and_b32 s30, s30, 0x1ffff
s_waitcnt vmcnt(4)
MM v[48:51], a[84:87], a[64:67], v[40:43]
buffer_load_dwordx4 v13, s[4:7], s30 offen nt lds
MM v[44:47], a[88:91], a[68:71], v[44:47]
s_add_u32 m0, s28, 0xf80
ds_read_b64 a[80:81], v5 offset:32768
ds_read_b64 a[82:83], v6 offset:32768
MM v[48:51], a[92:95], a[68:71], v[48:51]
buffer_load_dwordx4 v13, s[4:7], s30 offen offset:128 nt lds
MM v[44:47], a[96:99], a[72:75], v[44:47]
ds_read_b64 a[84:85], v5 offset:34816
ds_read_b64 a[86:87], v6 offset:34816
MM v[48:51], a[100:103], a[72:75], v[48:51]
CV v252, v68, v69
CV v253, v70, v71
MM v[44:47], a[104:107], a[76:79], v[44:47]
ds_read_b64 a[88:89], v7 offset:32768
ds_read_b64 a[90:91], v8 offset:32768
MM v[48:51], a[108:111], a[76:79], v[48:51]
v_exp_f32 v72, v72
MM v[144:147], a[112:115], v[248:251], 0
ds_read_b64 a[92:93], v7 offset:34816
ds_read_b64 a[94:95], v8 offset:34816
MM v[148:151], a[116:119], v[248:251], 0
v_exp_f32 v73, v73
MM v[152:155], a[120:123], v[248:251], 0
ds_read_b64 a[96:97], v5 offset:36864
ds_read_b64 a[98:99], v6 offset:36864
MM v[156:159], a[124:127], v[248:251], 0
v_exp_f32 v74, v74
MM v[160:163], a[128:131], v[248:251], 0
ds_read_b64 a[100:101], v5 offset:38912
ds_read_b64 a[102:103], v6 offset:38912
MM v[164:167], a[132:135], v[248:251], 0
v_exp_f32 v75, v75
MM v[168:171], a[136:139], v[248:251], 0
ds_read_b64 a[104:105], v7 offset:36864
ds_read_b64 a[106:107], v8 offset:36864
MM v[172:175], a[140:143], v[248:251], 0
CV v254, v72, v73
CV v255, v74, v75
MM a[232:235], a[244:247], v[248:251], 0
s_waitcnt lgkmcnt(6)
ds_read_b64 a[108:109], v7 offset:38912
ds_read_b64 a[110:111], v8 offset:38912
MM v[52:55], a[80:83], a[0:3], v[24:27]
v_exp_f32 v44, v44
MM v[56:59], a[84:87], a[0:3], v[24:27]
v_exp_f32 v45, v45
MM v[52:55], a[88:91], a[4:7], v[52:55]
v_exp_f32 v46, v46
MM v[56:59], a[92:95], a[4:7], v[56:59]
s_waitcnt lgkmcnt(4)
s_add_u32 m0, s28, 0x800
s_add_u32 s30, s42, 0x9000
MM v[52:55], a[96:99], a[8:11], v[52:55]
s_and_b32 s30, s30, 0x1ffff
s_waitcnt vmcnt(4)
MM v[56:59], a[100:103], a[8:11], v[56:59]
s_waitcnt lgkmcnt(2)
buffer_load_dwordx4 v13, s[4:7], s30 offen nt lds
MM v[52:55], a[104:107], a[12:15], v[52:55]
s_waitcnt lgkmcnt(0)
s_add_u32 m0, s28, 0x1780
MM v[56:59], a[108:111], a[12:15], v[56:59]
buffer_load_dwordx4 v13, s[4:7], s30 offen offset:128 nt lds
MM v[176:179], a[112:115], v[252:255], 0
v_exp_f32 v47, v47
MM v[180:183], a[116:119], v[252:255], 0
CV v240, v44, v45
CV v241, v46, v47
MM v[184:187], a[120:123], v[252:255], 0
v_exp_f32 v48, v48
MM v[188:191], a[124:127], v[252:255], 0
v_exp_f32 v49, v49
MM v[192:195], a[128:131], v[252:255], 0
v_exp_f32 v50, v50
MM v[196:199], a[132:135], v[252:255], 0
v_exp_f32 v51, v51
MM v[200:203], a[136:139], v[252:255], 0
CV v242, v48, v49
CV v243, v50, v51
MM v[204:207], a[140:143], v[252:255], 0
v_exp_f32 v52, v52
MM a[236:239], a[244:247], v[252:255], 0
v_exp_f32 v53, v53
MM v[60:63], a[80:83], a[16:19], v[28:31]
v_exp_f32 v54, v54
MM v[64:67], a[84:87], a[16:19], v[28:31]
v_exp_f32 v55, v55
MM v[60:63], a[88:91], a[20:23], v[60:63]
CV v244, v52, v53
CV v245, v54, v55
MM v[64:67], a[92:95], a[20:23], v[64:67]
v_exp_f32 v56, v56
MM v[60:63], a[96:99], a[24:27], v[60:63]
v_exp_f32 v57, v57
MM v[64:67], a[100:103], a[24:27], v[64:67]
v_exp_f32 v58, v58
MM v[60:63], a[104:107], a[28:31], v[60:63]
v_exp_f32 v59, v59
MM v[64:67], a[108:111], a[28:31], v[64:67]
s_add_u32 m0, s28, 0x4000
s_add_u32 s30, s42, 0x8000
s_and_b32 s30, s30, 0x1ffff
MM v[208:211], a[112:115], v[240:243], 0
s_waitcnt vmcnt(4)
buffer_load_dwordx4 v14, s[8:11], s30 offen nt lds
MM v[212:215], a[116:119], v[240:243], 0
s_add_u32 m0, s28, 0x4f80
TR a[112:113], v1 offset:49152
TR a[114:115], v1 offset:51200
MM v[216:219], a[120:123], v[240:243], 0
buffer_load_dwordx4 v14, s[8:11], s30 offen offset:128 nt lds
MM v[220:223], a[124:127], v[240:243], 0
TR a[116:117], v2 offset:49152
TR a[118:119], v2 offset:51200
MM v[224:227], a[128:131], v[240:243], 0
CV v246, v56, v57
CV v247, v58, v59
MM v[228:231], a[132:135], v[240:243], 0
TR a[120:121], v3 offset:49152
TR a[122:123], v3 offset:51200
MM v[232:235], a[136:139], v[240:243], 0
v_exp_f32 v60, v60
MM v[236:239], a[140:143], v[240:243], 0
TR a[124:125], v4 offset:49152
TR a[126:127], v4 offset:51200
MM a[240:243], a[244:247], v[240:243], 0
v_exp_f32 v61, v61
MM v[68:71], a[80:83], a[32:35], v[32:35]
TR a[128:129], v1 offset:53248
TR a[130:131], v1 offset:55296
MM v[72:75], a[84:87], a[32:35], v[32:35]
v_exp_f32 v62, v62
MM v[68:71], a[88:91], a[36:39], v[68:71]
TR a[132:133], v2 offset:53248
TR a[134:135], v2 offset:55296
MM v[72:75], a[92:95], a[36:39], v[72:75]
v_exp_f32 v63, v63
MM v[68:71], a[96:99], a[40:43], v[68:71]
TR a[136:137], v3 offset:53248
TR a[138:139], v3 offset:55296
MM v[72:75], a[100:103], a[40:43], v[72:75]
CV v248, v60, v61
CV v249, v62, v63
MM v[68:71], a[104:107], a[44:47], v[68:71]
TR a[140:141], v4 offset:53248
TR a[142:143], v4 offset:55296
MM v[72:75], a[108:111], a[44:47], v[72:75]
s_waitcnt lgkmcnt(8)
v_exp_f32 v64, v64
MM v[80:83], a[112:115], v[244:247], v[80:83]
v_exp_f32 v65, v65
MM v[84:87], a[116:119], v[244:247], v[84:87]
v_exp_f32 v66, v66
MM v[88:91], a[120:123], v[244:247], v[88:91]
s_add_u32 m0, s28, 0x4800
s_add_u32 s30, s42, 0x9000
s_and_b32 s30, s30, 0x1ffff
MM v[92:95], a[124:127], v[244:247], v[92:95]
s_waitcnt lgkmcnt(4)
s_waitcnt vmcnt(4)
MM v[96:99], a[128:131], v[244:247], v[96:99]
buffer_load_dwordx4 v14, s[8:11], s30 offen nt lds
MM v[100:103], a[132:135], v[244:247], v[100:103]
s_waitcnt lgkmcnt(2)
s_add_u32 m0, s28, 0x5780
MM v[104:107], a[136:139], v[244:247], v[104:107]
s_waitcnt lgkmcnt(0)
buffer_load_dwordx4 v14, s[8:11], s30 offen offset:128 nt lds
MM v[108:111], a[140:143], v[244:247], v[108:111]
v_exp_f32 v67, v67
MM a[224:227], a[244:247], v[244:247], a[224:227]
CV v250, v64, v65
CV v251, v66, v67
MM v[44:47], a[80:83], a[48:51], v[36:39]
v_exp_f32 v68, v68
MM v[48:51], a[84:87], a[48:51], v[36:39]
v_exp_f32 v69, v69
MM v[44:47], a[88:91], a[52:55], v[44:47]
v_exp_f32 v70, v70
MM v[48:51], a[92:95], a[52:55], v[48:51]
v_exp_f32 v71, v71
MM v[44:47], a[96:99], a[56:59], v[44:47]
CV v252, v68, v69
CV v253, v70, v71
MM v[48:51], a[100:103], a[56:59], v[48:51]
v_exp_f32 v72, v72
MM v[44:47], a[104:107], a[60:63], v[44:47]
v_exp_f32 v73, v73
MM v[48:51], a[108:111], a[60:63], v[48:51]
v_exp_f32 v74, v74
MM v[112:115], a[112:115], v[248:251], v[112:115]
v_exp_f32 v75, v75
MM v[116:119], a[116:119], v[248:251], v[116:119]
CV v254, v72, v73
CV v255, v74, v75
MM v[120:123], a[120:123], v[248:251], v[120:123]
v_exp_f32 v44, v44
MM v[124:127], a[124:127], v[248:251], v[124:127]
v_exp_f32 v45, v45
MM v[128:131], a[128:131], v[248:251], v[128:131]
v_exp_f32 v46, v46
MM v[132:135], a[132:135], v[248:251], v[132:135]
v_exp_f32 v47, v47
MM v[136:139], a[136:139], v[248:251], v[136:139]
CV v240, v44, v45
CV v241, v46, v47
MM v[140:143], a[140:143], v[248:251], v[140:143]
v_exp_f32 v48, v48
MM a[228:231], a[244:247], v[248:251], a[228:231]
s_mov_b32 s96, 3
L_ZA0:
s_add_u32 s42, s42, 0x8000
s_add_u32 s99, s99, 0xc000
s_and_b32 s97, s99, 0x20000
s_waitcnt vmcnt(16)
s_barrier
MM v[52:55], a[80:83], a[64:67], v[40:43]
s_add_u32 m0, s28, 0x8000
s_add_u32 s30, s42, 0x2000
s_and_b32 s30, s30, 0x1ffff
MM v[56:59], a[84:87], a[64:67], v[40:43]
s_waitcnt vmcnt(4)
buffer_load_dwordx4 v13, s[4:7], s30 offen nt lds
MM v[52:55], a[88:91], a[68:71], v[52:55]
s_add_u32 m0, s28, 0x8f80
v_add_u32 v5, 0x10000, v5
v_add_u32 v6, 0x10000, v6
MM v[56:59], a[92:95], a[68:71], v[56:59]
buffer_load_dwordx4 v13, s[4:7], s30 offen offset:128 nt lds
MM v[52:55], a[96:99], a[72:75], v[52:55]
ds_read_b64 a[80:81], v5 offset:0
ds_read_b64 a[82:83], v6 offset:0
MM v[56:59], a[100:103], a[72:75], v[56:59]
v_exp_f32 v49, v49
MM v[52:55], a[104:107], a[76:79], v[52:55]
ds_read_b64 a[84:85], v5 offset:2048
ds_read_b64 a[86:87], v6 offset:2048
MM v[56:59], a[108:111], a[76:79], v[56:59]
v_add_u32 v7, 0x10000, v7
v_add_u32 v8, 0x10000, v8
MM v[144:147], a[112:115], v[252:255], v[144:147]
ds_read_b64 a[88:89], v7 offset:0
ds_read_b64 a[90:91], v8 offset:0
MM v[148:151], a[116:119], v[252:255], v[148:151]
v_exp_f32 v50, v50
MM v[152:155], a[120:123], v[252:255], v[152:155]
ds_read_b64 a[92:93], v7 offset:2048
ds_read_b64 a[94:95], v8 offset:2048
MM v[156:159], a[124:127], v[252:255], v[156:159]
v_exp_f32 v51, v51
MM v[160:163], a[128:131], v[252:255], v[160:163]
ds_read_b64 a[96:97], v5 offset:4096
ds_read_b64 a[98:99], v6 offset:4096
MM v[164:167], a[132:135], v[252:255], v[164:167]
CV v242, v48, v49
CV v243, v50, v51
MM v[168:171], a[136:139], v[252:255], v[168:171]
ds_read_b64 a[100:101], v5 offset:6144
ds_read_b64 a[102:103], v6 offset:6144
MM v[172:175], a[140:143], v[252:255], v[172:175]
ds_read_b64 a[104:105], v7 offset:4096
ds_read_b64 a[106:107], v8 offset:4096
MM a[232:235], a[244:247], v[252:255], a[232:235]
s_waitcnt lgkmcnt(8)
ds_read_b64 a[108:109], v7 offset:6144
ds_read_b64 a[110:111], v8 offset:6144
MM v[60:63], a[80:83], a[0:3], v[24:27]
v_exp_f32 v52, v52
MM v[64:67], a[84:87], a[0:3], v[24:27]
v_exp_f32 v53, v53
MM v[60:63], a[88:91], a[4:7], v[60:63]
s_waitcnt lgkmcnt(8)
v_exp_f32 v54, v54
MM v[64:67], a[92:95], a[4:7], v[64:67]
s_waitcnt lgkmcnt(6)
s_add_u32 m0, s28, 0x8800
s_add_u32 s30, s42, 0x3000
MM v[60:63], a[96:99], a[8:11], v[60:63]
s_waitcnt lgkmcnt(4)
s_and_b32 s30, s30, 0x1ffff
s_waitcnt vmcnt(4)
MM v[64:67], a[100:103], a[8:11], v[64:67]
s_waitcnt lgkmcnt(2)
buffer_load_dwordx4 v13, s[4:7], s30 offen nt lds
MM v[60:63], a[104:107], a[12:15], v[60:63]
s_waitcnt lgkmcnt(0)
s_add_u32 m0, s28, 0x9780
v_add_u32 v1, 0x10000, v1
MM v[64:67], a[108:111], a[12:15], v[64:67]
buffer_load_dwordx4 v13, s[4:7], s30 offen offset:128 nt lds
MM v[176:179], a[112:115], v[240:243], v[176:179]
v_exp_f32 v55, v55
MM v[180:183], a[116:119], v[240:243], v[180:183]
CV v244, v52, v53
CV v245, v54, v55
MM v[184:187], a[120:123], v[240:243], v[184:187]
v_exp_f32 v56, v56
MM v[188:191], a[124:127], v[240:243], v[188:191]
v_exp_f32 v57, v57
MM v[192:195], a[128:131], v[240:243], v[192:195]
v_exp_f32 v58, v58
MM v[196:199], a[132:135], v[240:243], v[196:199]
v_exp_f32 v59, v59
MM v[200:203], a[136:139], v[240:243], v[200:203]
CV v246, v56, v57
CV v247, v58, v59
MM v[204:207], a[140:143], v[240:243], v[204:207]
v_exp_f32 v60, v60
MM a[236:239], a[244:247], v[240:243], a[236:239]
v_exp_f32 v61, v61
MM v[68:71], a[80:83], a[16:19], v[28:31]
v_exp_f32 v62, v62
MM v[72:75], a[84:87], a[16:19], v[28:31]
v_exp_f32 v63, v63
MM v[68:71], a[88:91], a[20:23], v[68:71]
CV v248, v60, v61
CV v249, v62, v63
MM v[72:75], a[92:95], a[20:23], v[72:75]
v_exp_f32 v64, v64
MM v[68:71], a[96:99], a[24:27], v[68:71]
v_exp_f32 v65, v65
MM v[72:75], a[100:103], a[24:27], v[72:75]
v_exp_f32 v66, v66
MM v[68:71], a[104:107], a[28:31], v[68:71]
v_exp_f32 v67, v67
MM v[72:75], a[108:111], a[28:31], v[72:75]
s_add_u32 m0, s28, 0xc000
s_add_u32 s30, s42, 0x2000
s_and_b32 s30, s30, 0x1ffff
MM v[208:211], a[112:115], v[244:247], v[208:211]
s_waitcnt vmcnt(4)
buffer_load_dwordx4 v14, s[8:11], s30 offen nt lds
MM v[212:215], a[116:119], v[244:247], v[212:215]
s_add_u32 m0, s28, 0xcf80
TR a[112:113], v1 offset:16384
TR a[114:115], v1 offset:18432
MM v[216:219], a[120:123], v[244:247], v[216:219]
buffer_load_dwordx4 v14, s[8:11], s30 offen offset:128 nt lds
MM v[220:223], a[124:127], v[244:247], v[220:223]
CV v250, v64, v65
v_add_u32 v2, 0x10000, v2
MM v[224:227], a[128:131], v[244:247], v[224:227]
TR a[116:117], v2 offset:16384
TR a[118:119], v2 offset:18432
MM v[228:231], a[132:135], v[244:247], v[228:231]
CV v251, v66, v67
v_add_u32 v3, 0x10000, v3
MM v[232:235], a[136:139], v[244:247], v[232:235]
TR a[120:121], v3 offset:16384
TR a[122:123], v3 offset:18432
MM v[236:239], a[140:143], v[244:247], v[236:239]
v_add_u32 v4, 0x10000, v4
MM a[240:243], a[244:247], v[244:247], a[240:243]
TR a[124:125], v4 offset:16384
TR a[126:127], v4 offset:18432
MM v[44:47], a[80:83], a[32:35], v[32:35]
v_exp_f32 v68, v68
MM v[48:51], a[84:87], a[32:35], v[32:35]
TR a[128:129], v1 offset:20480
TR a[130:131], v1 offset:22528
MM v[44:47], a[88:91], a[36:39], v[44:47]
v_exp_f32 v69, v69
MM v[48:51], a[92:95], a[36:39], v[48:51]
TR a[132:133], v2 offset:20480
TR a[134:135], v2 offset:22528
MM v[44:47], a[96:99], a[40:43], v[44:47]
v_exp_f32 v70, v70
MM v[48:51], a[100:103], a[40:43], v[48:51]
TR a[136:137], v3 offset:20480
TR a[138:139], v3 offset:22528
MM v[44:47], a[104:107], a[44:47], v[44:47]
v_exp_f32 v71, v71
MM v[48:51], a[108:111], a[44:47], v[48:51]
s_waitcnt lgkmcnt(6)
TR a[140:141], v4 offset:20480
TR a[142:143], v4 offset:22528
MM v[80:83], a[112:115], v[248:251], v[80:83]
CV v252, v68, v69
CV v253, v70, v71
MM v[84:87], a[116:119], v[248:251], v[84:87]
v_exp_f32 v72, v72
MM v[88:91], a[120:123], v[248:251], v[88:91]
s_add_u32 m0, s28, 0xc800
s_add_u32 s30, s42, 0x3000
s_and_b32 s30, s30, 0x1ffff
MM v[92:95], a[124:127], v[248:251], v[92:95]
s_waitcnt lgkmcnt(4)
s_waitcnt vmcnt(4)
MM v[96:99], a[128:131], v[248:251], v[96:99]
buffer_load_dwordx4 v14, s[8:11], s30 offen nt lds
MM v[100:103], a[132:135], v[248:251], v[100:103]
s_waitcnt lgkmcnt(2)
s_add_u32 m0, s28, 0xd780
MM v[104:107], a[136:139], v[248:251], v[104:107]
s_waitcnt lgkmcnt(0)
buffer_load_dwordx4 v14, s[8:11], s30 offen offset:128 nt lds
MM v[108:111], a[140:143], v[248:251], v[108:111]
v_exp_f32 v73, v73
MM a[224:227], a[244:247], v[248:251], a[224:227]
v_exp_f32 v74, v74
MM v[52:55], a[80:83], a[48:51], v[36:39]
v_exp_f32 v75, v75
MM v[56:59], a[84:87], a[48:51], v[36:39]
CV v254, v72, v73
CV v255, v74, v75
MM v[52:55], a[88:91], a[52:55], v[52:55]
v_exp_f32 v44, v44
MM v[56:59], a[92:95], a[52:55], v[56:59]
v_exp_f32 v45, v45
MM v[52:55], a[96:99], a[56:59], v[52:55]
v_exp_f32 v46, v46
MM v[56:59], a[100:103], a[56:59], v[56:59]
v_exp_f32 v47, v47
MM v[52:55], a[104:107], a[60:63], v[52:55]
CV v240, v44, v45
CV v241, v46, v47
MM v[56:59], a[108:111], a[60:63], v[56:59]
v_exp_f32 v48, v48
MM v[112:115], a[112:115], v[252:255], v[112:115]
v_exp_f32 v49, v49
MM v[116:119], a[116:119], v[252:255], v[116:119]
v_exp_f32 v50, v50
MM v[120:123], a[120:123], v[252:255], v[120:123]
v_exp_f32 v51, v51
MM v[124:127], a[124:127], v[252:255], v[124:127]
CV v242, v48, v49
CV v243, v50, v51
MM v[128:131], a[128:131], v[252:255], v[128:131]
v_exp_f32 v52, v52
MM v[132:135], a[132:135], v[252:255], v[132:135]
v_exp_f32 v53, v53
MM v[136:139], a[136:139], v[252:255], v[136:139]
v_exp_f32 v54, v54
MM v[140:143], a[140:143], v[252:255], v[140:143]
v_exp_f32 v55, v55
MM a[228:231], a[244:247], v[252:255], a[228:231]
s_waitcnt vmcnt(16)
s_barrier
s_add_u32 m0, s28, 0x10000
MM v[60:63], a[80:83], a[64:67], v[40:43]
s_add_u32 s30, s42, 0x4000
s_and_b32 s30, s30, 0x1ffff
s_waitcnt vmcnt(4)
MM v[64:67], a[84:87], a[64:67], v[40:43]
buffer_load_dwordx4 v13, s[4:7], s30 offen nt lds
MM v[60:63], a[88:91], a[68:71], v[60:63]
s_add_u32 m0, s28, 0x10f80
ds_read_b64 a[80:81], v5 offset:32768
ds_read_b64 a[82:83], v6 offset:32768
MM v[64:67], a[92:95], a[68:71], v[64:67]
buffer_load_dwordx4 v13, s[4:7], s30 offen offset:128 nt lds
MM v[60:63], a[96:99], a[72:75], v[60:63]
ds_read_b64 a[84:85], v5 offset:34816
ds_read_b64 a[86:87], v6 offset:34816
MM v[64:67], a[100:103], a[72:75], v[64:67]
CV v244, v52, v53
CV v245, v54, v55
MM v[60:63], a[104:107], a[76:79], v[60:63]
ds_read_b64 a[88:89], v7 offset:32768
ds_read_b64 a[90:91], v8 offset:32768
MM v[64:67], a[108:111], a[76:79], v[64:67]
v_exp_f32 v56, v56
MM v[144:147], a[112:115], v[240:243], v[144:147]
ds_read_b64 a[92:93], v7 offset:34816
ds_read_b64 a[94:95], v8 offset:34816
MM v[148:151], a[116:119], v[240:243], v[148:151]
v_exp_f32 v57, v57
MM v[152:155], a[120:123], v[240:243], v[152:155]
ds_read_b64 a[96:97], v5 offset:36864
ds_read_b64 a[98:99], v6 offset:36864
MM v[156:159], a[124:127], v[240:243], v[156:159]
v_exp_f32 v58, v58
MM v[160:163], a[128:131], v[240:243], v[160:163]
ds_read_b64 a[100:101], v5 offset:38912
ds_read_b64 a[102:103], v6 offset:38912
MM v[164:167], a[132:135], v[240:243], v[164:167]
v_exp_f32 v59, v59
MM v[168:171], a[136:139], v[240:243], v[168:171]
ds_read_b64 a[104:105], v7 offset:36864
ds_read_b64 a[106:107], v8 offset:36864
MM v[172:175], a[140:143], v[240:243], v[172:175]
CV v246, v56, v57
CV v247, v58, v59
MM a[232:235], a[244:247], v[240:243], a[232:235]
s_waitcnt lgkmcnt(6)
ds_read_b64 a[108:109], v7 offset:38912
ds_read_b64 a[110:111], v8 offset:38912
MM v[68:71], a[80:83], a[0:3], v[24:27]
v_exp_f32 v60, v60
MM v[72:75], a[84:87], a[0:3], v[24:27]
v_exp_f32 v61, v61
MM v[68:71], a[88:91], a[4:7], v[68:71]
v_exp_f32 v62, v62
MM v[72:75], a[92:95], a[4:7], v[72:75]
s_waitcnt lgkmcnt(4)
s_add_u32 m0, s28, 0x10800
s_add_u32 s30, s42, 0x5000
MM v[68:71], a[96:99], a[8:11], v[68:71]
s_and_b32 s30, s30, 0x1ffff
s_waitcnt vmcnt(4)
MM v[72:75], a[100:103], a[8:11], v[72:75]
s_waitcnt lgkmcnt(2)
buffer_load_dwordx4 v13, s[4:7], s30 offen nt lds
MM v[68:71], a[104:107], a[12:15], v[68:71]
s_waitcnt lgkmcnt(0)
s_add_u32 m0, s28, 0x11780
MM v[72:75], a[108:111], a[12:15], v[72:75]
buffer_load_dwordx4 v13, s[4:7], s30 offen offset:128 nt lds
MM v[176:179], a[112:115], v[244:247], v[176:179]
v_exp_f32 v63, v63
MM v[180:183], a[116:119], v[244:247], v[180:183]
CV v248, v60, v61
CV v249, v62, v63
MM v[184:187], a[120:123], v[244:247], v[184:187]
v_exp_f32 v64, v64
MM v[188:191], a[124:127], v[244:247], v[188:191]
v_exp_f32 v65, v65
MM v[192:195], a[128:131], v[244:247], v[192:195]
v_exp_f32 v66, v66
MM v[196:199], a[132:135], v[244:247], v[196:199]
v_exp_f32 v67, v67
MM v[200:203], a[136:139], v[244:247], v[200:203]
CV v250, v64, v65
CV v251, v66, v67
MM v[204:207], a[140:143], v[244:247], v[204:207]
v_exp_f32 v68, v68
MM a[236:239], a[244:247], v[244:247], a[236:239]
v_exp_f32 v69, v69
MM v[44:47], a[80:83], a[16:19], v[28:31]
v_exp_f32 v70, v70
MM v[48:51], a[84:87], a[16:19], v[28:31]
v_exp_f32 v71, v71
MM v[44:47], a[88:91], a[20:23], v[44:47]
CV v252, v68, v69
CV v253, v70, v71
MM v[48:51], a[92:95], a[20:23], v[48:51]
v_exp_f32 v72, v72
MM v[44:47], a[96:99], a[24:27], v[44:47]
v_exp_f32 v73, v73
MM v[48:51], a[100:103], a[24:27], v[48:51]
v_exp_f32 v74, v74
MM v[44:47], a[104:107], a[28:31], v[44:47]
v_exp_f32 v75, v75
MM v[48:51], a[108:111], a[28:31], v[48:51]
s_add_u32 m0, s28, 0x14000
s_add_u32 s30, s42, 0x4000
s_and_b32 s30, s30, 0x1ffff
MM v[208:211], a[112:115], v[248:251], v[208:211]
s_waitcnt vmcnt(4)
buffer_load_dwordx4 v14, s[8:11], s30 offen nt lds
MM v[212:215], a[116:119], v[248:251], v[212:215]
s_add_u32 m0, s28, 0x14f80
TR a[112:113], v1 offset:49152
TR a[114:115], v1 offset:51200
MM v[216:219], a[120:123], v[248:251], v[216:219]
buffer_load_dwordx4 v14, s[8:11], s30 offen offset:128 nt lds
MM v[220:223], a[124:127], v[248:251], v[220:223]
TR a[116:117], v2 offset:49152
TR a[118:119], v2 offset:51200
MM v[224:227], a[128:131], v[248:251], v[224:227]
CV v254, v72, v73
CV v255, v74, v75
MM v[228:231], a[132:135], v[248:251], v[228:231]
TR a[120:121], v3 offset:49152
TR a[122:123], v3 offset:51200
MM v[232:235], a[136:139], v[248:251], v[232:235]
v_exp_f32 v44, v44
MM v[236:239], a[140:143], v[248:251], v[236:239]
TR a[124:125], v4 offset:49152
TR a[126:127], v4 offset:51200
MM a[240:243], a[244:247], v[248:251], a[240:243]
v_exp_f32 v45, v45
MM v[52:55], a[80:83], a[32:35], v[32:35]
TR a[128:129], v1 offset:53248
TR a[130:131], v1 offset:55296
MM v[56:59], a[84:87], a[32:35], v[32:35]
v_exp_f32 v46, v46
MM v[52:55], a[88:91], a[36:39], v[52:55]
TR a[132:133], v2 offset:53248
TR a[134:135], v2 offset:55296
MM v[56:59], a[92:95], a[36:39], v[56:59]
v_exp_f32 v47, v47
MM v[52:55], a[96:99], a[40:43], v[52:55]
TR a[136:137], v3 offset:53248
TR a[138:139], v3 offset:55296
MM v[56:59], a[100:103], a[40:43], v[56:59]
CV v240, v44, v45
CV v241, v46, v47
MM v[52:55], a[104:107], a[44:47], v[52:55]
TR a[140:141], v4 offset:53248
TR a[142:143], v4 offset:55296
MM v[56:59], a[108:111], a[44:47], v[56:59]
s_waitcnt lgkmcnt(8)
v_exp_f32 v48, v48
MM v[80:83], a[112:115], v[252:255], v[80:83]
v_exp_f32 v49, v49
MM v[84:87], a[116:119], v[252:255], v[84:87]
v_exp_f32 v50, v50
MM v[88:91], a[120:123], v[252:255], v[88:91]
s_add_u32 m0, s28, 0x14800
s_add_u32 s30, s42, 0x5000
s_and_b32 s30, s30, 0x1ffff
MM v[92:95], a[124:127], v[252:255], v[92:95]
s_waitcnt lgkmcnt(4)
s_waitcnt vmcnt(4)
v_add_u32 v5, 0xffff0000, v5
MM v[96:99], a[128:131], v[252:255], v[96:99]
buffer_load_dwordx4 v14, s[8:11], s30 offen nt lds
MM v[100:103], a[132:135], v[252:255], v[100:103]
s_waitcnt lgkmcnt(2)
s_add_u32 m0, s28, 0x15780
v_add_u32 v6, 0xffff0000, v6
MM v[104:107], a[136:139], v[252:255], v[104:107]
s_waitcnt lgkmcnt(0)
buffer_load_dwordx4 v14, s[8:11], s30 offen offset:128 nt lds
MM v[108:111], a[140:143], v[252:255], v[108:111]
v_exp_f32 v51, v51
MM a[224:227], a[244:247], v[252:255], a[224:227]
CV v242, v48, v49
CV v243, v50, v51
MM v[60:63], a[80:83], a[48:51], v[36:39]
v_exp_f32 v52, v52
MM v[64:67], a[84:87], a[48:51], v[36:39]
v_exp_f32 v53, v53
MM v[60:63], a[88:91], a[52:55], v[60:63]
v_exp_f32 v54, v54
MM v[64:67], a[92:95], a[52:55], v[64:67]
v_exp_f32 v55, v55
MM v[60:63], a[96:99], a[56:59], v[60:63]
CV v244, v52, v53
CV v245, v54, v55
MM v[64:67], a[100:103], a[56:59], v[64:67]
v_exp_f32 v56, v56
MM v[60:63], a[104:107], a[60:63], v[60:63]
v_exp_f32 v57, v57
MM v[64:67], a[108:111], a[60:63], v[64:67]
v_exp_f32 v58, v58
MM v[112:115], a[112:115], v[240:243], v[112:115]
v_exp_f32 v59, v59
MM v[116:119], a[116:119], v[240:243], v[116:119]
CV v246, v56, v57
CV v247, v58, v59
MM v[120:123], a[120:123], v[240:243], v[120:123]
v_exp_f32 v60, v60
MM v[124:127], a[124:127], v[240:243], v[124:127]
v_exp_f32 v61, v61
MM v[128:131], a[128:131], v[240:243], v[128:131]
v_exp_f32 v62, v62
MM v[132:135], a[132:135], v[240:243], v[132:135]
v_exp_f32 v63, v63
MM v[136:139], a[136:139], v[240:243], v[136:139]
CV v248, v60, v61
CV v249, v62, v63
MM v[140:143], a[140:143], v[240:243], v[140:143]
v_exp_f32 v64, v64
MM a[228:231], a[244:247], v[240:243], a[228:231]
s_waitcnt vmcnt(16)
s_barrier
s_add_u32 m0, s28, 0x18000
MM v[68:71], a[80:83], a[64:67], v[40:43]
s_add_u32 s30, s42, 0x6000
s_and_b32 s30, s30, 0x1ffff
s_waitcnt vmcnt(4)
MM v[72:75], a[84:87], a[64:67], v[40:43]
buffer_load_dwordx4 v13, s[4:7], s30 offen nt lds
MM v[68:71], a[88:91], a[68:71], v[68:71]
s_add_u32 m0, s28, 0x18f80
ds_read_b64 a[80:81], v5 offset:0
ds_read_b64 a[82:83], v6 offset:0
MM v[72:75], a[92:95], a[68:71], v[72:75]
buffer_load_dwordx4 v13, s[4:7], s30 offen offset:128 nt lds
MM v[68:71], a[96:99], a[72:75], v[68:71]
ds_read_b64 a[84:85], v5 offset:2048
ds_read_b64 a[86:87], v6 offset:2048
MM v[72:75], a[100:103], a[72:75], v[72:75]
v_add_u32 v7, 0xffff0000, v7
v_add_u32 v8, 0xffff0000, v8
MM v[68:71], a[104:107], a[76:79], v[68:71]
ds_read_b64 a[88:89], v7 offset:0
ds_read_b64 a[90:91], v8 offset:0
MM v[72:75], a[108:111], a[76:79], v[72:75]
v_exp_f32 v65, v65
MM v[144:147], a[112:115], v[244:247], v[144:147]
ds_read_b64 a[92:93], v7 offset:2048
ds_read_b64 a[94:95], v8 offset:2048
MM v[148:151], a[116:119], v[244:247], v[148:151]
v_exp_f32 v66, v66
MM v[152:155], a[120:123], v[244:247], v[152:155]
ds_read_b64 a[96:97], v5 offset:4096
ds_read_b64 a[98:99], v6 offset:4096
MM v[156:159], a[124:127], v[244:247], v[156:159]
v_exp_f32 v67, v67
MM v[160:163], a[128:131], v[244:247], v[160:163]
ds_read_b64 a[100:101], v5 offset:6144
ds_read_b64 a[102:103], v6 offset:6144
MM v[164:167], a[132:135], v[244:247], v[164:167]
CV v250, v64, v65
CV v251, v66, v67
MM v[168:171], a[136:139], v[244:247], v[168:171]
ds_read_b64 a[104:105], v7 offset:4096
ds_read_b64 a[106:107], v8 offset:4096
MM v[172:175], a[140:143], v[244:247], v[172:175]
v_exp_f32 v68, v68
MM a[232:235], a[244:247], v[244:247], a[232:235]
s_waitcnt lgkmcnt(6)
ds_read_b64 a[108:109], v7 offset:6144
ds_read_b64 a[110:111], v8 offset:6144
MM v[44:47], a[80:83], a[0:3], v[24:27]
v_exp_f32 v69, v69
MM v[48:51], a[84:87], a[0:3], v[24:27]
v_exp_f32 v70, v70
MM v[44:47], a[88:91], a[4:7], v[44:47]
v_exp_f32 v71, v71
MM v[48:51], a[92:95], a[4:7], v[48:51]
s_waitcnt lgkmcnt(4)
s_add_u32 m0, s28, 0x18800
s_add_u32 s30, s42, 0x7000
MM v[44:47], a[96:99], a[8:11], v[44:47]
s_and_b32 s30, s30, 0x1ffff
s_waitcnt vmcnt(4)
CV v252, v68, v69
MM v[48:51], a[100:103], a[8:11], v[48:51]
s_waitcnt lgkmcnt(2)
buffer_load_dwordx4 v13, s[4:7], s30 offen nt lds
MM v[44:47], a[104:107], a[12:15], v[44:47]
s_waitcnt lgkmcnt(0)
s_add_u32 m0, s28, 0x19780
CV v253, v70, v71
MM v[48:51], a[108:111], a[12:15], v[48:51]
buffer_load_dwordx4 v13, s[4:7], s30 offen offset:128 nt lds
MM v[176:179], a[112:115], v[248:251], v[176:179]
v_exp_f32 v72, v72
MM v[180:183], a[116:119], v[248:251], v[180:183]
v_exp_f32 v73, v73
MM v[184:187], a[120:123], v[248:251], v[184:187]
v_exp_f32 v74, v74
MM v[188:191], a[124:127], v[248:251], v[188:191]
v_exp_f32 v75, v75
MM v[192:195], a[128:131], v[248:251], v[192:195]
CV v254, v72, v73
CV v255, v74, v75
MM v[196:199], a[132:135], v[248:251], v[196:199]
v_exp_f32 v44, v44
MM v[200:203], a[136:139], v[248:251], v[200:203]
v_exp_f32 v45, v45
MM v[204:207], a[140:143], v[248:251], v[204:207]
v_exp_f32 v46, v46
MM a[236:239], a[244:247], v[248:251], a[236:239]
v_exp_f32 v47, v47
MM v[52:55], a[80:83], a[16:19], v[28:31]
CV v240, v44, v45
CV v241, v46, v47
MM v[56:59], a[84:87], a[16:19], v[28:31]
v_exp_f32 v48, v48
MM v[52:55], a[88:91], a[20:23], v[52:55]
v_exp_f32 v49, v49
MM v[56:59], a[92:95], a[20:23], v[56:59]
v_exp_f32 v50, v50
MM v[52:55], a[96:99], a[24:27], v[52:55]
v_exp_f32 v51, v51
MM v[56:59], a[100:103], a[24:27], v[56:59]
CV v242, v48, v49
CV v243, v50, v51
MM v[52:55], a[104:107], a[28:31], v[52:55]
v_add_u32 v1, 0xffff0000, v1
v_add_u32 v2, 0xffff0000, v2
MM v[56:59], a[108:111], a[28:31], v[56:59]
s_add_u32 m0, s28, 0x1c000
s_add_u32 s30, s42, 0x6000
s_and_b32 s30, s30, 0x1ffff
MM v[208:211], a[112:115], v[252:255], v[208:211]
s_waitcnt vmcnt(4)
buffer_load_dwordx4 v14, s[8:11], s30 offen nt lds
MM v[212:215], a[116:119], v[252:255], v[212:215]
s_add_u32 m0, s28, 0x1cf80
TR a[112:113], v1 offset:16384
TR a[114:115], v1 offset:18432
MM v[216:219], a[120:123], v[252:255], v[216:219]
buffer_load_dwordx4 v14, s[8:11], s30 offen offset:128 nt lds
MM v[220:223], a[124:127], v[252:255], v[220:223]
TR a[116:117], v2 offset:16384
TR a[118:119], v2 offset:18432
MM v[224:227], a[128:131], v[252:255], v[224:227]
v_add_u32 v3, 0xffff0000, v3
v_add_u32 v4, 0xffff0000, v4
MM v[228:231], a[132:135], v[252:255], v[228:231]
TR a[120:121], v3 offset:16384
TR a[122:123], v3 offset:18432
MM v[232:235], a[136:139], v[252:255], v[232:235]
v_exp_f32 v52, v52
MM v[236:239], a[140:143], v[252:255], v[236:239]
TR a[124:125], v4 offset:16384
TR a[126:127], v4 offset:18432
MM a[240:243], a[244:247], v[252:255], a[240:243]
v_exp_f32 v53, v53
MM v[60:63], a[80:83], a[32:35], v[32:35]
TR a[128:129], v1 offset:20480
TR a[130:131], v1 offset:22528
MM v[64:67], a[84:87], a[32:35], v[32:35]
v_exp_f32 v54, v54
MM v[60:63], a[88:91], a[36:39], v[60:63]
TR a[132:133], v2 offset:20480
TR a[134:135], v2 offset:22528
MM v[64:67], a[92:95], a[36:39], v[64:67]
v_exp_f32 v55, v55
MM v[60:63], a[96:99], a[40:43], v[60:63]
TR a[136:137], v3 offset:20480
TR a[138:139], v3 offset:22528
MM v[64:67], a[100:103], a[40:43], v[64:67]
CV v244, v52, v53
CV v245, v54, v55
MM v[60:63], a[104:107], a[44:47], v[60:63]
TR a[140:141], v4 offset:20480
TR a[142:143], v4 offset:22528
MM v[64:67], a[108:111], a[44:47], v[64:67]
s_waitcnt lgkmcnt(8)
v_exp_f32 v56, v56
MM v[80:83], a[112:115], v[240:243], v[80:83]
v_exp_f32 v57, v57
MM v[84:87], a[116:119], v[240:243], v[84:87]
v_exp_f32 v58, v58
MM v[88:91], a[120:123], v[240:243], v[88:91]
s_add_u32 m0, s28, 0x1c800
s_add_u32 s30, s42, 0x7000
s_and_b32 s30, s30, 0x1ffff
MM v[92:95], a[124:127], v[240:243], v[92:95]
s_waitcnt lgkmcnt(4)
s_waitcnt vmcnt(4)
MM v[96:99], a[128:131], v[240:243], v[96:99]
buffer_load_dwordx4 v14, s[8:11], s30 offen nt lds
MM v[100:103], a[132:135], v[240:243], v[100:103]
s_waitcnt lgkmcnt(2)
s_add_u32 m0, s28, 0x1d780
MM v[104:107], a[136:139], v[240:243], v[104:107]
s_waitcnt lgkmcnt(0)
buffer_load_dwordx4 v14, s[8:11], s30 offen offset:128 nt lds
MM v[108:111], a[140:143], v[240:243], v[108:111]
v_exp_f32 v59, v59
MM a[224:227], a[244:247], v[240:243], a[224:227]
CV v246, v56, v57
CV v247, v58, v59
MM v[68:71], a[80:83], a[48:51], v[36:39]
v_exp_f32 v60, v60
MM v[72:75], a[84:87], a[48:51], v[36:39]
v_exp_f32 v61, v61
MM v[68:71], a[88:91], a[52:55], v[68:71]
v_exp_f32 v62, v62
MM v[72:75], a[92:95], a[52:55], v[72:75]
v_exp_f32 v63, v63
MM v[68:71], a[96:99], a[56:59], v[68:71]
CV v248, v60, v61
CV v249, v62, v63
MM v[72:75], a[100:103], a[56:59], v[72:75]
v_exp_f32 v64, v64
MM v[68:71], a[104:107], a[60:63], v[68:71]
v_exp_f32 v65, v65
MM v[72:75], a[108:111], a[60:63], v[72:75]
v_exp_f32 v66, v66
MM v[112:115], a[112:115], v[244:247], v[112:115]
v_exp_f32 v67, v67
MM v[116:119], a[116:119], v[244:247], v[116:119]
CV v250, v64, v65
CV v251, v66, v67
MM v[120:123], a[120:123], v[244:247], v[120:123]
v_exp_f32 v68, v68
MM v[124:127], a[124:127], v[244:247], v[124:127]
v_exp_f32 v69, v69
MM v[128:131], a[128:131], v[244:247], v[128:131]
v_exp_f32 v70, v70
MM v[132:135], a[132:135], v[244:247], v[132:135]
v_exp_f32 v71, v71
MM v[136:139], a[136:139], v[244:247], v[136:139]
CV v252, v68, v69
CV v253, v70, v71
MM v[140:143], a[140:143], v[244:247], v[140:143]
v_exp_f32 v72, v72
MM a[228:231], a[244:247], v[244:247], a[228:231]
s_waitcnt vmcnt(16)
s_barrier
s_add_u32 m0, s28, 0x0
MM v[44:47], a[80:83], a[64:67], v[40:43]
s_add_u32 s30, s42, 0x8000
s_and_b32 s30, s30, 0x1ffff
s_add_u32 s30, s30, s97
MM v[48:51], a[84:87], a[64:67], v[40:43]
s_waitcnt vmcnt(4)
buffer_load_dwordx4 v13, s[4:7], s30 offen nt lds
MM v[44:47], a[88:91], a[68:71], v[44:47]
s_add_u32 m0, s28, 0xf80
ds_read_b64 a[80:81], v5 offset:32768
ds_read_b64 a[82:83], v6 offset:32768
MM v[48:51], a[92:95], a[68:71], v[48:51]
buffer_load_dwordx4 v13, s[4:7], s30 offen offset:128 nt lds
MM v[44:47], a[96:99], a[72:75], v[44:47]
ds_read_b64 a[84:85], v5 offset:34816
ds_read_b64 a[86:87], v6 offset:34816
MM v[48:51], a[100:103], a[72:75], v[48:51]
v_exp_f32 v73, v73
MM v[44:47], a[104:107], a[76:79], v[44:47]
ds_read_b64 a[88:89], v7 offset:32768
ds_read_b64 a[90:91], v8 offset:32768
MM v[48:51], a[108:111], a[76:79], v[48:51]
v_exp_f32 v74, v74
MM v[144:147], a[112:115], v[248:251], v[144:147]
ds_read_b64 a[92:93], v7 offset:34816
ds_read_b64 a[94:95], v8 offset:34816
MM v[148:151], a[116:119], v[248:251], v[148:151]
v_exp_f32 v75, v75
MM v[152:155], a[120:123], v[248:251], v[152:155]
ds_read_b64 a[96:97], v5 offset:36864
ds_read_b64 a[98:99], v6 offset:36864
MM v[156:159], a[124:127], v[248:251], v[156:159]
CV v254, v72, v73
CV v255, v74, v75
MM v[160:163], a[128:131], v[248:251], v[160:163]
ds_read_b64 a[100:101], v5 offset:38912
ds_read_b64 a[102:103], v6 offset:38912
MM v[164:167], a[132:135], v[248:251], v[164:167]
v_exp_f32 v44, v44
MM v[168:171], a[136:139], v[248:251], v[168:171]
ds_read_b64 a[104:105], v7 offset:36864
ds_read_b64 a[106:107], v8 offset:36864
MM v[172:175], a[140:143], v[248:251], v[172:175]
v_exp_f32 v45, v45
MM a[232:235], a[244:247], v[248:251], a[232:235]
s_waitcnt lgkmcnt(6)
ds_read_b64 a[108:109], v7 offset:38912
ds_read_b64 a[110:111], v8 offset:38912
MM v[52:55], a[80:83], a[0:3], v[24:27]
v_exp_f32 v46, v46
MM v[56:59], a[84:87], a[0:3], v[24:27]
v_exp_f32 v47, v47
MM v[52:55], a[88:91], a[4:7], v[52:55]
CV v240, v44, v45
CV v241, v46, v47
MM v[56:59], a[92:95], a[4:7], v[56:59]
s_waitcnt lgkmcnt(4)
s_add_u32 m0, s28, 0x800
s_add_u32 s30, s42, 0x9000
MM v[52:55], a[96:99], a[8:11], v[52:55]
s_and_b32 s30, s30, 0x1ffff
s_add_u32 s30, s30, s97
s_waitcnt vmcnt(4)
MM v[56:59], a[100:103], a[8:11], v[56:59]
s_waitcnt lgkmcnt(2)
buffer_load_dwordx4 v13, s[4:7], s30 offen nt lds
MM v[52:55], a[104:107], a[12:15], v[52:55]
s_waitcnt lgkmcnt(0)
s_add_u32 m0, s28, 0x1780
MM v[56:59], a[108:111], a[12:15], v[56:59]
buffer_load_dwordx4 v13, s[4:7], s30 offen offset:128 nt lds
MM v[176:179], a[112:115], v[252:255], v[176:179]
v_exp_f32 v48, v48
MM v[180:183], a[116:119], v[252:255], v[180:183]
v_exp_f32 v49, v49
MM v[184:187], a[120:123], v[252:255], v[184:187]
v_exp_f32 v50, v50
MM v[188:191], a[124:127], v[252:255], v[188:191]
v_exp_f32 v51, v51
MM v[192:195], a[128:131], v[252:255], v[192:195]
CV v242, v48, v49
CV v243, v50, v51
MM v[196:199], a[132:135], v[252:255], v[196:199]
v_exp_f32 v52, v52
MM v[200:203], a[136:139], v[252:255], v[200:203]
v_exp_f32 v53, v53
MM v[204:207], a[140:143], v[252:255], v[204:207]
v_exp_f32 v54, v54
MM a[236:239], a[244:247], v[252:255], a[236:239]
v_exp_f32 v55, v55
MM v[60:63], a[80:83], a[16:19], v[28:31]
CV v244, v52, v53
CV v245, v54, v55
MM v[64:67], a[84:87], a[16:19], v[28:31]
v_exp_f32 v56, v56
MM v[60:63], a[88:91], a[20:23], v[60:63]
v_exp_f32 v57, v57
MM v[64:67], a[92:95], a[20:23], v[64:67]
v_exp_f32 v58, v58
MM v[60:63], a[96:99], a[24:27], v[60:63]
v_exp_f32 v59, v59
MM v[64:67], a[100:103], a[24:27], v[64:67]
CV v246, v56, v57
CV v247, v58, v59
MM v[60:63], a[104:107], a[28:31], v[60:63]
MM v[64:67], a[108:111], a[28:31], v[64:67]
s_add_u32 m0, s28, 0x4000
s_add_u32 s30, s42, 0x8000
s_and_b32 s30, s30, 0x1ffff
MM v[208:211], a[112:115], v[240:243], v[208:211]
s_add_u32 s30, s30, s97
s_waitcnt vmcnt(4)
TR a[112:113], v1 offset:49152
MM v[212:215], a[116:119], v[240:243], v[212:215]
buffer_load_dwordx4 v14, s[8:11], s30 offen nt lds
MM v[216:219], a[120:123], v[240:243], v[216:219]
s_add_u32 m0, s28, 0x4f80
TR a[114:115], v1 offset:51200
TR a[116:117], v2 offset:49152
MM v[220:223], a[124:127], v[240:243], v[220:223]
buffer_load_dwordx4 v14, s[8:11], s30 offen offset:128 nt lds
MM v[224:227], a[128:131], v[240:243], v[224:227]
TR a[118:119], v2 offset:51200
TR a[120:121], v3 offset:49152
MM v[228:231], a[132:135], v[240:243], v[228:231]
v_exp_f32 v60, v60
MM v[232:235], a[136:139], v[240:243], v[232:235]
TR a[122:123], v3 offset:51200
TR a[124:125], v4 offset:49152
MM v[236:239], a[140:143], v[240:243], v[236:239]
v_exp_f32 v61, v61
MM a[240:243], a[244:247], v[240:243], a[240:243]
TR a[126:127], v4 offset:51200
TR a[128:129], v1 offset:53248
MM v[68:71], a[80:83], a[32:35], v[32:35]
v_exp_f32 v62, v62
MM v[72:75], a[84:87], a[32:35], v[32:35]
TR a[130:131], v1 offset:55296
TR a[132:133], v2 offset:53248
MM v[68:71], a[88:91], a[36:39], v[68:71]
v_exp_f32 v63, v63
MM v[72:75], a[92:95], a[36:39], v[72:75]
TR a[134:135], v2 offset:55296
TR a[136:137], v3 offset:53248
MM v[68:71], a[96:99], a[40:43], v[68:71]
CV v248, v60, v61
CV v249, v62, v63
MM v[72:75], a[100:103], a[40:43], v[72:75]
TR a[138:139], v3 offset:55296
TR a[140:141], v4 offset:53248
MM v[68:71], a[104:107], a[44:47], v[68:71]
v_exp_f32 v64, v64
MM v[72:75], a[108:111], a[44:47], v[72:75]
s_waitcnt lgkmcnt(7)
TR a[142:143], v4 offset:55296
MM v[80:83], a[112:115], v[244:247], v[80:83]
v_exp_f32 v65, v65
MM v[84:87], a[116:119], v[244:247], v[84:87]
v_exp_f32 v66, v66
MM v[88:91], a[120:123], v[244:247], v[88:91]
v_exp_f32 v67, v67
MM v[92:95], a[124:127], v[244:247], v[92:95]
s_waitcnt lgkmcnt(4)
s_add_u32 m0, s28, 0x4800
s_add_u32 s30, s42, 0x9000
MM v[96:99], a[128:131], v[244:247], v[96:99]
s_and_b32 s30, s30, 0x1ffff
s_add_u32 s30, s30, s97
s_waitcnt vmcnt(4)
MM v[100:103], a[132:135], v[244:247], v[100:103]
s_waitcnt lgkmcnt(2)
buffer_load_dwordx4 v14, s[8:11], s30 offen nt lds
MM v[104:107], a[136:139], v[244:247], v[104:107]
s_waitcnt lgkmcnt(0)
s_add_u32 m0, s28, 0x5780
CV v250, v64, v65
MM v[108:111], a[140:143], v[244:247], v[108:111]
buffer_load_dwordx4 v14, s[8:11], s30 offen offset:128 nt lds
MM a[224:227], a[244:247], v[244:247], a[224:227]
CV v251, v66, v67
MM v[44:47], a[80:83], a[48:51], v[36:39]
v_exp_f32 v68, v68
MM v[48:51], a[84:87], a[48:51], v[36:39]
v_exp_f32 v69, v69
MM v[44:47], a[88:91], a[52:55], v[44:47]
v_exp_f32 v70, v70
MM v[48:51], a[92:95], a[52:55], v[48:51]
v_exp_f32 v71, v71
MM v[44:47], a[96:99], a[56:59], v[44:47]
CV v252, v68, v69
CV v253, v70, v71
MM v[48:51], a[100:103], a[56:59], v[48:51]
v_exp_f32 v72, v72
MM v[44:47], a[104:107], a[60:63], v[44:47]
v_exp_f32 v73, v73
MM v[48:51], a[108:111], a[60:63], v[48:51]
v_exp_f32 v74, v74
MM v[112:115], a[112:115], v[248:251], v[112:115]
v_exp_f32 v75, v75
MM v[116:119], a[116:119], v[248:251], v[116:119]
CV v254, v72, v73
CV v255, v74, v75
MM v[120:123], a[120:123], v[248:251], v[120:123]
v_exp_f32 v44, v44
MM v[124:127], a[124:127], v[248:251], v[124:127]
v_exp_f32 v45, v45
MM v[128:131], a[128:131], v[248:251], v[128:131]
v_exp_f32 v46, v46
MM v[132:135], a[132:135], v[248:251], v[132:135]
v_exp_f32 v47, v47
MM v[136:139], a[136:139], v[248:251], v[136:139]
CV v240, v44, v45
CV v241, v46, v47
MM v[140:143], a[140:143], v[248:251], v[140:143]
v_exp_f32 v48, v48
MM a[228:231], a[244:247], v[248:251], a[228:231]
s_sub_u32 s96, s96, 1
s_cmp_lg_u32 s96, 0
s_cbranch_scc1 L_ZA0
s_waitcnt vmcnt(16)
s_barrier
s_add_u32 m0, s28, 0x8000
MM v[52:55], a[80:83], a[64:67], v[40:43]
s_add_u32 s30, s42, 0xa000
s_and_b32 s30, s30, 0x1ffff
s_add_u32 s30, s30, 0x20000
MM v[56:59], a[84:87], a[64:67], v[40:43]
s_mov_b32 s41, 0x100
buffer_load_dwordx4 v13, s[4:7], s30 offen nt lds
MM v[52:55], a[88:91], a[68:71], v[52:55]
s_add_u32 m0, s29, 0x23000
s_add_u32 s30, s48, 0x0
v_add_u32 v5, 0x10000, v5
MM v[56:59], a[92:95], a[68:71], v[56:59]
buffer_load_dwordx4 v15, s[12:15], s30 offen lds
MM v[52:55], a[96:99], a[72:75], v[52:55]
s_add_u32 m0, s28, 0x8f80
s_add_u32 s30, s42, 0xa000
s_and_b32 s30, s30, 0x1ffff
MM v[56:59], a[100:103], a[72:75], v[56:59]
s_add_u32 s30, s30, 0x20000
buffer_load_dwordx4 v13, s[4:7], s30 offen offset:128 nt lds
MM v[52:55], a[104:107], a[76:79], v[52:55]
s_add_u32 m0, s29, 0x23800
s_add_u32 s30, s48, 0x4000
ds_read_b64 a[80:81], v5 offset:0
MM v[56:59], a[108:111], a[76:79], v[56:59]
buffer_load_dwordx4 v15, s[12:15], s30 offen lds
MM v[144:147], a[112:115], v[252:255], v[144:147]
v_add_u32 v6, 0x10000, v6
v_add_u32 v7, 0x10000, v7
MM v[148:151], a[116:119], v[252:255], v[148:151]
s_add_u32 m0, s29, 0x24000
s_add_u32 s30, s48, 0x8000
ds_read_b64 a[82:83], v6 offset:0
MM v[152:155], a[120:123], v[252:255], v[152:155]
ds_read_b64 a[84:85], v5 offset:2048
ds_read_b64 a[86:87], v6 offset:2048
MM v[156:159], a[124:127], v[252:255], v[156:159]
buffer_load_dwordx4 v15, s[12:15], s30 offen lds
MM v[160:163], a[128:131], v[252:255], v[160:163]
ds_read_b64 a[88:89], v7 offset:0
v_add_u32 v8, 0x10000, v8
ds_read_b64 a[90:91], v8 offset:0
MM v[164:167], a[132:135], v[252:255], v[164:167]
s_add_u32 m0, s29, 0x24800
s_add_u32 s30, s48, 0xc000
ds_read_b64 a[92:93], v7 offset:2048
ds_read_b64 a[94:95], v8 offset:2048
MM v[168:171], a[136:139], v[252:255], v[168:171]
ds_read_b64 a[96:97], v5 offset:4096
ds_read_b64 a[98:99], v6 offset:4096
MM v[172:175], a[140:143], v[252:255], v[172:175]
ds_read_b64 a[100:101], v5 offset:6144
ds_read_b64 a[102:103], v6 offset:6144
MM a[232:235], a[244:247], v[252:255], a[232:235]
s_waitcnt lgkmcnt(10)
buffer_load_dwordx4 v15, s[12:15], s30 offen lds
ds_read_b64 a[104:105], v7 offset:4096
ds_read_b64 a[106:107], v8 offset:4096
MM v[60:63], a[80:83], a[0:3], v[24:27]
s_waitcnt lgkmcnt(10)
ds_read_b64 a[108:109], v7 offset:6144
ds_read_b64 a[110:111], v8 offset:6144
MM v[64:67], a[84:87], a[0:3], v[24:27]
s_waitcnt lgkmcnt(10)
s_add_u32 m0, s29, 0x25000
s_add_u32 s30, s48, 0x10000
MM v[60:63], a[88:91], a[4:7], v[60:63]
s_waitcnt lgkmcnt(8)
v_exp_f32 v49, v49
v_exp_f32 v50, v50
v_exp_f32 v51, v51
buffer_load_dword v22, v21, s[16:19], s41 offen
MM v[64:67], a[92:95], a[4:7], v[64:67]
s_waitcnt lgkmcnt(6)
buffer_load_dwordx4 v15, s[12:15], s30 offen lds
MM v[60:63], a[96:99], a[8:11], v[60:63]
s_waitcnt lgkmcnt(4)
CV v242, v48, v49
CV v243, v50, v51
MM v[64:67], a[100:103], a[8:11], v[64:67]
s_waitcnt lgkmcnt(2)
s_add_u32 m0, s28, 0xc000
s_add_u32 s30, s43, 0x100
MM v[60:63], a[104:107], a[12:15], v[60:63]
s_waitcnt lgkmcnt(0)
buffer_load_dwordx4 v16, s[16:19], s30 offen lds
MM v[64:67], a[108:111], a[12:15], v[64:67]
s_add_u32 m0, s28, 0x8800
s_add_u32 s30, s42, 0xb000
s_and_b32 s30, s30, 0x1ffff
MM v[176:179], a[112:115], v[240:243], v[176:179]
s_add_u32 s30, s30, 0x20000
buffer_load_dwordx4 v13, s[4:7], s30 offen nt lds
MM v[180:183], a[116:119], v[240:243], v[180:183]
s_add_u32 m0, s28, 0xcf80
s_add_u32 s30, s43, 0x100
v_add_u32 v1, 0x10000, v1
MM v[184:187], a[120:123], v[240:243], v[184:187]
buffer_load_dwordx4 v16, s[16:19], s30 offen offset:128 lds
MM v[188:191], a[124:127], v[240:243], v[188:191]
s_add_u32 m0, s28, 0x9780
s_add_u32 s30, s42, 0xb000
s_and_b32 s30, s30, 0x1ffff
MM v[192:195], a[128:131], v[240:243], v[192:195]
s_add_u32 s30, s30, 0x20000
buffer_load_dwordx4 v13, s[4:7], s30 offen offset:128 nt lds
MM v[196:199], a[132:135], v[240:243], v[196:199]
s_add_u32 m0, s28, 0xc800
s_add_u32 s30, s43, 0x20100
v_add_u32 v2, 0x10000, v2
MM v[200:203], a[136:139], v[240:243], v[200:203]
buffer_load_dwordx4 v16, s[16:19], s30 offen lds
MM v[204:207], a[140:143], v[240:243], v[204:207]
v_exp_f32 v52, v52
MM a[236:239], a[244:247], v[240:243], a[236:239]
s_add_u32 m0, s28, 0xd780
v_exp_f32 v53, v53
MM v[68:71], a[80:83], a[16:19], v[28:31]
buffer_load_dwordx4 v16, s[16:19], s30 offen offset:128 lds
MM v[72:75], a[84:87], a[16:19], v[28:31]
v_exp_f32 v54, v54
MM v[68:71], a[88:91], a[20:23], v[68:71]
v_exp_f32 v55, v55
CV v244, v52, v53
CV v245, v54, v55
v_exp_f32 v56, v56
v_exp_f32 v57, v57
v_exp_f32 v58, v58
v_exp_f32 v59, v59
MM v[72:75], a[92:95], a[20:23], v[72:75]
CV v246, v56, v57
CV v247, v58, v59
MM v[68:71], a[96:99], a[24:27], v[68:71]
v_exp_f32 v60, v60
MM v[72:75], a[100:103], a[24:27], v[72:75]
v_exp_f32 v61, v61
MM v[68:71], a[104:107], a[28:31], v[68:71]
v_exp_f32 v62, v62
MM v[72:75], a[108:111], a[28:31], v[72:75]
v_exp_f32 v63, v63
MM v[208:211], a[112:115], v[244:247], v[208:211]
TR a[112:113], v1 offset:16384
TR a[114:115], v1 offset:18432
MM v[212:215], a[116:119], v[244:247], v[212:215]
CV v248, v60, v61
CV v249, v62, v63
MM v[216:219], a[120:123], v[244:247], v[216:219]
TR a[116:117], v2 offset:16384
TR a[118:119], v2 offset:18432
MM v[220:223], a[124:127], v[244:247], v[220:223]
v_exp_f32 v64, v64
MM v[224:227], a[128:131], v[244:247], v[224:227]
v_exp_f32 v65, v65
MM v[228:231], a[132:135], v[244:247], v[228:231]
v_exp_f32 v66, v66
MM v[232:235], a[136:139], v[244:247], v[232:235]
v_exp_f32 v67, v67
MM v[236:239], a[140:143], v[244:247], v[236:239]
v_add_u32 v3, 0x10000, v3
CV v250, v64, v65
MM a[240:243], a[244:247], v[244:247], a[240:243]
TR a[120:121], v3 offset:16384
TR a[122:123], v3 offset:18432
MM v[44:47], a[80:83], a[32:35], v[32:35]
v_add_u32 v4, 0x10000, v4
CV v251, v66, v67
MM v[48:51], a[84:87], a[32:35], v[32:35]
TR a[124:125], v4 offset:16384
TR a[126:127], v4 offset:18432
MM v[44:47], a[88:91], a[36:39], v[44:47]
v_exp_f32 v68, v68
MM v[48:51], a[92:95], a[36:39], v[48:51]
TR a[128:129], v1 offset:20480
TR a[130:131], v1 offset:22528
MM v[44:47], a[96:99], a[40:43], v[44:47]
v_exp_f32 v69, v69
MM v[48:51], a[100:103], a[40:43], v[48:51]
TR a[132:133], v2 offset:20480
TR a[134:135], v2 offset:22528
MM v[44:47], a[104:107], a[44:47], v[44:47]
TR a[136:137], v3 offset:20480
TR a[138:139], v3 offset:22528
MM v[48:51], a[108:111], a[44:47], v[48:51]
s_waitcnt lgkmcnt(8)
TR a[140:141], v4 offset:20480
TR a[142:143], v4 offset:22528
MM v[80:83], a[112:115], v[248:251], v[80:83]
v_exp_f32 v70, v70
MM v[84:87], a[116:119], v[248:251], v[84:87]
v_exp_f32 v71, v71
MM v[88:91], a[120:123], v[248:251], v[88:91]
s_waitcnt lgkmcnt(8)
CV v252, v68, v69
CV v253, v70, v71
MM v[92:95], a[124:127], v[248:251], v[92:95]
s_waitcnt lgkmcnt(6)
v_exp_f32 v72, v72
MM v[96:99], a[128:131], v[248:251], v[96:99]
s_waitcnt lgkmcnt(4)
v_exp_f32 v73, v73
MM v[100:103], a[132:135], v[248:251], v[100:103]
s_waitcnt lgkmcnt(2)
v_exp_f32 v74, v74
MM v[104:107], a[136:139], v[248:251], v[104:107]
s_waitcnt lgkmcnt(0)
v_exp_f32 v75, v75
MM v[108:111], a[140:143], v[248:251], v[108:111]
CV v254, v72, v73
CV v255, v74, v75
MM a[224:227], a[244:247], v[248:251], a[224:227]
v_exp_f32 v44, v44
MM v[52:55], a[80:83], a[48:51], v[36:39]
v_exp_f32 v45, v45
MM v[56:59], a[84:87], a[48:51], v[36:39]
v_exp_f32 v46, v46
MM v[52:55], a[88:91], a[52:55], v[52:55]
v_exp_f32 v47, v47
MM v[56:59], a[92:95], a[52:55], v[56:59]
CV v240, v44, v45
CV v241, v46, v47
MM v[52:55], a[96:99], a[56:59], v[52:55]
v_exp_f32 v48, v48
MM v[56:59], a[100:103], a[56:59], v[56:59]
v_exp_f32 v49, v49
MM v[52:55], a[104:107], a[60:63], v[52:55]
v_exp_f32 v50, v50
MM v[56:59], a[108:111], a[60:63], v[56:59]
v_exp_f32 v51, v51
MM v[112:115], a[112:115], v[252:255], v[112:115]
CV v242, v48, v49
CV v243, v50, v51
MM v[116:119], a[116:119], v[252:255], v[116:119]
MM v[120:123], a[120:123], v[252:255], v[120:123]
v_exp_f32 v52, v52
MM v[124:127], a[124:127], v[252:255], v[124:127]
v_exp_f32 v53, v53
MM v[128:131], a[128:131], v[252:255], v[128:131]
v_exp_f32 v54, v54
MM v[132:135], a[132:135], v[252:255], v[132:135]
v_exp_f32 v55, v55
MM v[136:139], a[136:139], v[252:255], v[136:139]
CV v244, v52, v53
CV v245, v54, v55
MM v[140:143], a[140:143], v[252:255], v[140:143]
v_exp_f32 v56, v56
MM a[228:231], a[244:247], v[252:255], a[228:231]
s_waitcnt vmcnt(22)
s_barrier
s_add_u32 m0, s28, 0x10000
MM v[60:63], a[80:83], a[64:67], v[40:43]
s_add_u32 s30, s43, 0x40100
buffer_load_dwordx4 v16, s[16:19], s30 offen lds
MM v[64:67], a[84:87], a[64:67], v[40:43]
ds_read_b64 a[80:81], v5 offset:32768
ds_read_b64 a[82:83], v6 offset:32768
MM v[60:63], a[88:91], a[68:71], v[60:63]
s_add_u32 m0, s28, 0x10f80
v_exp_f32 v57, v57
MM v[64:67], a[92:95], a[68:71], v[64:67]
buffer_load_dwordx4 v16, s[16:19], s30 offen offset:128 lds
MM v[60:63], a[96:99], a[72:75], v[60:63]
ds_read_b64 a[84:85], v5 offset:34816
ds_read_b64 a[86:87], v6 offset:34816
MM v[64:67], a[100:103], a[72:75], v[64:67]
s_add_u32 m0, s28, 0x10800
s_add_u32 s30, s43, 0x60100
MM v[60:63], a[104:107], a[76:79], v[60:63]
buffer_load_dwordx4 v16, s[16:19], s30 offen lds
MM v[64:67], a[108:111], a[76:79], v[64:67]
ds_read_b64 a[88:89], v7 offset:32768
ds_read_b64 a[90:91], v8 offset:32768
MM v[144:147], a[112:115], v[240:243], v[144:147]
s_add_u32 m0, s28, 0x11780
v_exp_f32 v58, v58
MM v[148:151], a[116:119], v[240:243], v[148:151]
buffer_load_dwordx4 v16, s[16:19], s30 offen offset:128 lds
MM v[152:155], a[120:123], v[240:243], v[152:155]
ds_read_b64 a[92:93], v7 offset:34816
ds_read_b64 a[94:95], v8 offset:34816
MM v[156:159], a[124:127], v[240:243], v[156:159]
s_add_u32 m0, s28, 0x14000
s_add_u32 s30, s43, 0x80100
MM v[160:163], a[128:131], v[240:243], v[160:163]
buffer_load_dwordx4 v16, s[16:19], s30 offen lds
MM v[164:167], a[132:135], v[240:243], v[164:167]
ds_read_b64 a[96:97], v5 offset:36864
ds_read_b64 a[98:99], v6 offset:36864
MM v[168:171], a[136:139], v[240:243], v[168:171]
s_add_u32 m0, s28, 0x14f80
ds_read_b64 a[100:101], v5 offset:38912
ds_read_b64 a[102:103], v6 offset:38912
MM v[172:175], a[140:143], v[240:243], v[172:175]
ds_read_b64 a[104:105], v7 offset:36864
ds_read_b64 a[106:107], v8 offset:36864
MM a[232:235], a[244:247], v[240:243], a[232:235]
s_waitcnt lgkmcnt(8)
buffer_load_dwordx4 v16, s[16:19], s30 offen offset:128 lds
MM v[68:71], a[80:83], a[0:3], v[24:27]
ds_read_b64 a[108:109], v7 offset:38912
ds_read_b64 a[110:111], v8 offset:38912
MM v[72:75], a[84:87], a[0:3], v[24:27]
s_add_u32 m0, s28, 0x14800
s_add_u32 s30, s43, 0xa0100
MM v[68:71], a[88:91], a[4:7], v[68:71]
s_waitcnt lgkmcnt(8)
v_exp_f32 v59, v59
MM v[72:75], a[92:95], a[4:7], v[72:75]
s_waitcnt lgkmcnt(6)
buffer_load_dwordx4 v16, s[16:19], s30 offen lds
MM v[68:71], a[96:99], a[8:11], v[68:71]
s_waitcnt lgkmcnt(4)
CV v246, v56, v57
CV v247, v58, v59
MM v[72:75], a[100:103], a[8:11], v[72:75]
s_waitcnt lgkmcnt(2)
s_add_u32 m0, s28, 0x15780
MM v[68:71], a[104:107], a[12:15], v[68:71]
s_waitcnt lgkmcnt(0)
buffer_load_dwordx4 v16, s[16:19], s30 offen offset:128 lds
MM v[72:75], a[108:111], a[12:15], v[72:75]
v_exp_f32 v60, v60
MM v[176:179], a[112:115], v[244:247], v[176:179]
v_exp_f32 v61, v61
MM v[180:183], a[116:119], v[244:247], v[180:183]
v_exp_f32 v62, v62
MM v[184:187], a[120:123], v[244:247], v[184:187]
v_exp_f32 v63, v63
MM v[188:191], a[124:127], v[244:247], v[188:191]
CV v248, v60, v61
CV v249, v62, v63
MM v[192:195], a[128:131], v[244:247], v[192:195]
v_exp_f32 v64, v64
MM v[196:199], a[132:135], v[244:247], v[196:199]
v_exp_f32 v65, v65
MM v[200:203], a[136:139], v[244:247], v[200:203]
v_exp_f32 v66, v66
MM v[204:207], a[140:143], v[244:247], v[204:207]
v_exp_f32 v67, v67
MM a[236:239], a[244:247], v[244:247], a[236:239]
CV v250, v64, v65
CV v251, v66, v67
MM v[44:47], a[80:83], a[16:19], v[28:31]
v_exp_f32 v68, v68
MM v[48:51], a[84:87], a[16:19], v[28:31]
v_exp_f32 v69, v69
MM v[44:47], a[88:91], a[20:23], v[44:47]
v_exp_f32 v70, v70
MM v[48:51], a[92:95], a[20:23], v[48:51]
v_exp_f32 v71, v71
MM v[44:47], a[96:99], a[24:27], v[44:47]
CV v252, v68, v69
CV v253, v70, v71
MM v[48:51], a[100:103], a[24:27], v[48:51]
v_exp_f32 v72, v72
MM v[44:47], a[104:107], a[28:31], v[44:47]
v_exp_f32 v73, v73
MM v[48:51], a[108:111], a[28:31], v[48:51]
v_exp_f32 v74, v74
MM v[208:211], a[112:115], v[248:251], v[208:211]
TR a[112:113], v1 offset:49152
TR a[114:115], v1 offset:51200
MM v[212:215], a[116:119], v[248:251], v[212:215]
v_exp_f32 v75, v75
MM v[216:219], a[120:123], v[248:251], v[216:219]
TR a[116:117], v2 offset:49152
TR a[118:119], v2 offset:51200
MM v[220:223], a[124:127], v[248:251], v[220:223]
CV v254, v72, v73
CV v255, v74, v75
MM v[224:227], a[128:131], v[248:251], v[224:227]
TR a[120:121], v3 offset:49152
TR a[122:123], v3 offset:51200
MM v[228:231], a[132:135], v[248:251], v[228:231]
v_exp_f32 v44, v44
MM v[232:235], a[136:139], v[248:251], v[232:235]
TR a[124:125], v4 offset:49152
TR a[126:127], v4 offset:51200
MM v[236:239], a[140:143], v[248:251], v[236:239]
v_exp_f32 v45, v45
MM a[240:243], a[244:247], v[248:251], a[240:243]
TR a[128:129], v1 offset:53248
TR a[130:131], v1 offset:55296
MM v[52:55], a[80:83], a[32:35], v[32:35]
v_exp_f32 v46, v46
MM v[56:59], a[84:87], a[32:35], v[32:35]
TR a[132:133], v2 offset:53248
TR a[134:135], v2 offset:55296
MM v[52:55], a[88:91], a[36:39], v[52:55]
v_exp_f32 v47, v47
MM v[56:59], a[92:95], a[36:39], v[56:59]
TR a[136:137], v3 offset:53248
TR a[138:139], v3 offset:55296
MM v[52:55], a[96:99], a[40:43], v[52:55]
CV v240, v44, v45
CV v241, v46, v47
MM v[56:59], a[100:103], a[40:43], v[56:59]
TR a[140:141], v4 offset:53248
TR a[142:143], v4 offset:55296
MM v[52:55], a[104:107], a[44:47], v[52:55]
v_exp_f32 v48, v48
MM v[56:59], a[108:111], a[44:47], v[56:59]
s_waitcnt lgkmcnt(8)
v_exp_f32 v49, v49
MM v[80:83], a[112:115], v[252:255], v[80:83]
v_exp_f32 v50, v50
MM v[84:87], a[116:119], v[252:255], v[84:87]
v_exp_f32 v51, v51
MM v[88:91], a[120:123], v[252:255], v[88:91]
CV v242, v48, v49
CV v243, v50, v51
MM v[92:95], a[124:127], v[252:255], v[92:95]
s_waitcnt lgkmcnt(2)
v_exp_f32 v52, v52
MM v[96:99], a[128:131], v[252:255], v[96:99]
v_exp_f32 v53, v53
MM v[100:103], a[132:135], v[252:255], v[100:103]
v_exp_f32 v54, v54
MM v[104:107], a[136:139], v[252:255], v[104:107]
s_waitcnt lgkmcnt(0)
v_exp_f32 v55, v55
MM v[108:111], a[140:143], v[252:255], v[108:111]
CV v244, v52, v53
CV v245, v54, v55
MM a[224:227], a[244:247], v[252:255], a[224:227]
v_exp_f32 v56, v56
MM v[60:63], a[80:83], a[48:51], v[36:39]
v_exp_f32 v57, v57
MM v[64:67], a[84:87], a[48:51], v[36:39]
v_exp_f32 v58, v58
MM v[60:63], a[88:91], a[52:55], v[60:63]
v_exp_f32 v59, v59
MM v[64:67], a[92:95], a[52:55], v[64:67]
CV v246, v56, v57
CV v247, v58, v59
MM v[60:63], a[96:99], a[56:59], v[60:63]
MM v[64:67], a[100:103], a[56:59], v[64:67]
MM v[60:63], a[104:107], a[60:63], v[60:63]
MM v[64:67], a[108:111], a[60:63], v[64:67]
MM v[112:115], a[112:115], v[240:243], v[112:115]
MM v[116:119], a[116:119], v[240:243], v[116:119]
MM v[120:123], a[120:123], v[240:243], v[120:123]
MM v[124:127], a[124:127], v[240:243], v[124:127]
MM v[128:131], a[128:131], v[240:243], v[128:131]
MM v[132:135], a[132:135], v[240:243], v[132:135]
MM v[136:139], a[136:139], v[240:243], v[136:139]
v_exp_f32 v60, v60
MM v[140:143], a[140:143], v[240:243], v[140:143]
v_exp_f32 v61, v61
MM a[228:231], a[244:247], v[240:243], a[228:231]
v_exp_f32 v62, v62
MM v[68:71], a[80:83], a[64:67], v[40:43]
v_exp_f32 v63, v63
MM v[72:75], a[84:87], a[64:67], v[40:43]
CV v248, v60, v61
CV v249, v62, v63
MM v[68:71], a[88:91], a[68:71], v[68:71]
v_exp_f32 v64, v64
MM v[72:75], a[92:95], a[68:71], v[72:75]
v_exp_f32 v65, v65
MM v[68:71], a[96:99], a[72:75], v[68:71]
v_exp_f32 v66, v66
MM v[72:75], a[100:103], a[72:75], v[72:75]
v_exp_f32 v67, v67
MM v[68:71], a[104:107], a[76:79], v[68:71]
CV v250, v64, v65
CV v251, v66, v67
MM v[72:75], a[108:111], a[76:79], v[72:75]
MM v[144:147], a[112:115], v[244:247], v[144:147]
MM v[148:151], a[116:119], v[244:247], v[148:151]
MM v[152:155], a[120:123], v[244:247], v[152:155]
MM v[156:159], a[124:127], v[244:247], v[156:159]
MM v[160:163], a[128:131], v[244:247], v[160:163]
v_exp_f32 v68, v68
MM v[164:167], a[132:135], v[244:247], v[164:167]
v_exp_f32 v69, v69
MM v[168:171], a[136:139], v[244:247], v[168:171]
v_exp_f32 v70, v70
MM v[172:175], a[140:143], v[244:247], v[172:175]
v_exp_f32 v71, v71
MM a[232:235], a[244:247], v[244:247], a[232:235]
CV v252, v68, v69
CV v253, v70, v71
MM v[176:179], a[112:115], v[248:251], v[176:179]
v_exp_f32 v72, v72
MM v[180:183], a[116:119], v[248:251], v[180:183]
v_exp_f32 v73, v73
MM v[184:187], a[120:123], v[248:251], v[184:187]
v_exp_f32 v74, v74
MM v[188:191], a[124:127], v[248:251], v[188:191]
v_exp_f32 v75, v75
MM v[192:195], a[128:131], v[248:251], v[192:195]
CV v254, v72, v73
CV v255, v74, v75
MM v[196:199], a[132:135], v[248:251], v[196:199]
MM v[200:203], a[136:139], v[248:251], v[200:203]
MM v[204:207], a[140:143], v[248:251], v[204:207]
MM a[236:239], a[244:247], v[248:251], a[236:239]
MM v[208:211], a[112:115], v[252:255], v[208:211]
MM v[212:215], a[116:119], v[252:255], v[212:215]
MM v[216:219], a[120:123], v[252:255], v[216:219]
MM v[220:223], a[124:127], v[252:255], v[220:223]
MM v[224:227], a[128:131], v[252:255], v[224:227]
MM v[228:231], a[132:135], v[252:255], v[228:231]
MM v[232:235], a[136:139], v[252:255], v[232:235]
MM v[236:239], a[140:143], v[252:255], v[236:239]
MM a[240:243], a[244:247], v[252:255], a[240:243]
v_accvgpr_read_b32 v44, a224
v_accvgpr_read_b32 v46, a228
v_accvgpr_read_b32 v48, a232
v_accvgpr_read_b32 v50, a236
s_nop 3
v_accvgpr_read_b32 v52, a240
v_subrev_u32 v56, 0x2b800000, v44
v_subrev_u32 v57, 0x2b800000, v46
v_subrev_u32 v58, 0x2b800000, v48
v_subrev_u32 v59, 0x2b800000, v50
v_subrev_u32 v60, 0x2b800000, v52
v_max3_u32 v56, v56, v57, v58
v_max3_u32 v56, v56, v59, v60
v_cmp_lt_u32 vcc, 0x28000000, v56
v_rcp_f32 v44, v44
v_rcp_f32 v46, v46
v_rcp_f32 v48, v48
v_rcp_f32 v50, v50
v_rcp_f32 v52, v52
s_cmp_lg_u64 vcc, 0
s_cselect_b32 s40, 1, 0
v_mov_b32 v57, s40
s_lshl_b32 s40, s33, 2
v_add_u32 v58, 0x20000, v79
v_add_u32 v59, s40, v58
ds_write_b32 v59, v57
v_pk_mul_f32 v[80:81], v[80:81], v[44:45] op_sel_hi:[1,0]
v_pk_mul_f32 v[82:83], v[82:83], v[44:45] op_sel_hi:[1,0]
v_pk_mul_f32 v[84:85], v[84:85], v[44:45] op_sel_hi:[1,0]
v_pk_mul_f32 v[86:87], v[86:87], v[44:45] op_sel_hi:[1,0]
CV v80, v80, v81
CV v81, v82, v83
CV v82, v84, v85
CV v83, v86, v87
v_pk_mul_f32 v[88:89], v[88:89], v[44:45] op_sel_hi:[1,0]
v_pk_mul_f32 v[90:91], v[90:91], v[44:45] op_sel_hi:[1,0]
v_pk_mul_f32 v[92:93], v[92:93], v[44:45] op_sel_hi:[1,0]
v_pk_mul_f32 v[94:95], v[94:95], v[44:45] op_sel_hi:[1,0]
CV v84, v88, v89
CV v85, v90, v91
CV v86, v92, v93
CV v87, v94, v95
s_waitcnt lgkmcnt(0)
s_barrier
ds_read_b128 v[60:63], v58
v_pk_mul_f32 v[96:97], v[96:97], v[44:45] op_sel_hi:[1,0]
v_pk_mul_f32 v[98:99], v[98:99], v[44:45] op_sel_hi:[1,0]
v_pk_mul_f32 v[100:101], v[100:101], v[44:45] op_sel_hi:[1,0]
v_pk_mul_f32 v[102:103], v[102:103], v[44:45] op_sel_hi:[1,0]
CV v88, v96, v97
CV v89, v98, v99
CV v90, v100, v101
CV v91, v102, v103
v_pk_mul_f32 v[104:105], v[104:105], v[44:45] op_sel_hi:[1,0]
v_pk_mul_f32 v[106:107], v[106:107], v[44:45] op_sel_hi:[1,0]
v_pk_mul_f32 v[108:109], v[108:109], v[44:45] op_sel_hi:[1,0]
v_pk_mul_f32 v[110:111], v[110:111], v[44:45] op_sel_hi:[1,0]
CV v92, v104, v105
CV v93, v106, v107
CV v94, v108, v109
CV v95, v110, v111
v_pk_mul_f32 v[112:113], v[112:113], v[46:47] op_sel_hi:[1,0]
v_pk_mul_f32 v[114:115], v[114:115], v[46:47] op_sel_hi:[1,0]
v_pk_mul_f32 v[116:117], v[116:117], v[46:47] op_sel_hi:[1,0]
v_pk_mul_f32 v[118:119], v[118:119], v[46:47] op_sel_hi:[1,0]
CV v96, v112, v113
CV v97, v114, v115
CV v98, v116, v117
CV v99, v118, v119
v_pk_mul_f32 v[120:121], v[120:121], v[46:47] op_sel_hi:[1,0]
v_pk_mul_f32 v[122:123], v[122:123], v[46:47] op_sel_hi:[1,0]
v_pk_mul_f32 v[124:125], v[124:125], v[46:47] op_sel_hi:[1,0]
v_pk_mul_f32 v[126:127], v[126:127], v[46:47] op_sel_hi:[1,0]
s_waitcnt lgkmcnt(0)
v_or3_b32 v60, v60, v61, v62
v_or_b32 v60, v60, v63
CV v100, v120, v121
CV v101, v122, v123
v_readfirstlane_b32 s40, v60
CV v102, v124, v125
CV v103, v126, v127
v_pk_mul_f32 v[128:129], v[128:129], v[46:47] op_sel_hi:[1,0]
v_pk_mul_f32 v[130:131], v[130:131], v[46:47] op_sel_hi:[1,0]
s_or_b32 s40, s40, s36
s_cbranch_scc1 L_ZFB0
L_ZRet0:
s_waitcnt vmcnt(8)
s_barrier
v_pk_mul_f32 v[132:133], v[132:133], v[46:47] op_sel_hi:[1,0]
v_pk_mul_f32 v[134:135], v[134:135], v[46:47] op_sel_hi:[1,0]
s_add_u32 m0, s29, 0x1df80
s_add_u32 s30, s48, 0x0
TR a[80:81], v9 offset:0
CV v104, v128, v129
CV v105, v130, v131
CV v106, v132, v133
buffer_load_dwordx4 v15, s[12:15], s30 offen offset:128 lds
CV v107, v134, v135
s_add_u32 m0, s29, 0x1e780
s_add_u32 s30, s48, 0x4000
TR a[82:83], v9 offset:512
v_pk_mul_f32 v[136:137], v[136:137], v[46:47] op_sel_hi:[1,0]
v_pk_mul_f32 v[138:139], v[138:139], v[46:47] op_sel_hi:[1,0]
v_pk_mul_f32 v[140:141], v[140:141], v[46:47] op_sel_hi:[1,0]
buffer_load_dwordx4 v15, s[12:15], s30 offen offset:128 lds
v_pk_mul_f32 v[142:143], v[142:143], v[46:47] op_sel_hi:[1,0]
s_add_u32 m0, s29, 0x1ef80
s_add_u32 s30, s48, 0x8000
TR a[84:85], v10 offset:0
CV v108, v136, v137
CV v109, v138, v139
CV v110, v140, v141
buffer_load_dwordx4 v15, s[12:15], s30 offen offset:128 lds
CV v111, v142, v143
s_add_u32 m0, s29, 0x1f780
s_add_u32 s30, s48, 0xc000
TR a[86:87], v10 offset:512
v_pk_mul_f32 v[144:145], v[144:145], v[48:49] op_sel_hi:[1,0]
v_pk_mul_f32 v[146:147], v[146:147], v[48:49] op_sel_hi:[1,0]
v_pk_mul_f32 v[148:149], v[148:149], v[48:49] op_sel_hi:[1,0]
buffer_load_dwordx4 v15, s[12:15], s30 offen offset:128 lds
v_pk_mul_f32 v[150:151], v[150:151], v[48:49] op_sel_hi:[1,0]
s_add_u32 m0, s29, 0x1ff80
s_add_u32 s30, s48, 0x10000
TR a[88:89], v11 offset:0
CV v112, v144, v145
CV v113, v146, v147
CV v114, v148, v149
buffer_load_dwordx4 v15, s[12:15], s30 offen offset:128 lds
CV v115, v150, v151
s_add_u32 m0, s28, 0x18000
s_add_u32 s30, s43, 0xc0100
TR a[90:91], v11 offset:512
v_pk_mul_f32 v[152:153], v[152:153], v[48:49] op_sel_hi:[1,0]
v_pk_mul_f32 v[154:155], v[154:155], v[48:49] op_sel_hi:[1,0]
v_pk_mul_f32 v[156:157], v[156:157], v[48:49] op_sel_hi:[1,0]
buffer_load_dwordx4 v16, s[16:19], s30 offen lds
v_pk_mul_f32 v[158:159], v[158:159], v[48:49] op_sel_hi:[1,0]
s_add_u32 m0, s28, 0x18f80
TR a[92:93], v12 offset:0
TR a[94:95], v12 offset:512
CV v116, v152, v153
CV v117, v154, v155
CV v118, v156, v157
buffer_load_dwordx4 v16, s[16:19], s30 offen offset:128 lds
CV v119, v158, v159
s_add_u32 m0, s28, 0x18800
s_add_u32 s30, s43, 0xe0100
TR a[96:97], v9 offset:4096
v_pk_mul_f32 v[160:161], v[160:161], v[48:49] op_sel_hi:[1,0]
v_pk_mul_f32 v[162:163], v[162:163], v[48:49] op_sel_hi:[1,0]
v_pk_mul_f32 v[164:165], v[164:165], v[48:49] op_sel_hi:[1,0]
buffer_load_dwordx4 v16, s[16:19], s30 offen lds
v_pk_mul_f32 v[166:167], v[166:167], v[48:49] op_sel_hi:[1,0]
s_add_u32 m0, s28, 0x19780
TR a[98:99], v9 offset:4608
TR a[100:101], v10 offset:4096
CV v120, v160, v161
CV v121, v162, v163
CV v122, v164, v165
buffer_load_dwordx4 v16, s[16:19], s30 offen offset:128 lds
CV v123, v166, v167
TR a[102:103], v10 offset:4608
TR a[104:105], v11 offset:4096
v_pk_mul_f32 v[168:169], v[168:169], v[48:49] op_sel_hi:[1,0]
v_pk_mul_f32 v[170:171], v[170:171], v[48:49] op_sel_hi:[1,0]
v_pk_mul_f32 v[172:173], v[172:173], v[48:49] op_sel_hi:[1,0]
v_pk_mul_f32 v[174:175], v[174:175], v[48:49] op_sel_hi:[1,0]
TR a[106:107], v11 offset:4608
TR a[108:109], v12 offset:4096
CV v124, v168, v169
CV v125, v170, v171
CV v126, v172, v173
CV v127, v174, v175
TR a[110:111], v12 offset:4608
ds_read_b128 a[0:3], v76 offset:20480
v_pk_mul_f32 v[176:177], v[176:177], v[50:51] op_sel_hi:[1,0]
v_pk_mul_f32 v[178:179], v[178:179], v[50:51] op_sel_hi:[1,0]
v_pk_mul_f32 v[180:181], v[180:181], v[50:51] op_sel_hi:[1,0]
v_pk_mul_f32 v[182:183], v[182:183], v[50:51] op_sel_hi:[1,0]
ds_read_b128 a[4:7], v76 offset:22528
ds_read_b128 a[8:11], v76 offset:24576
CV v128, v176, v177
CV v129, v178, v179
CV v130, v180, v181
CV v131, v182, v183
ds_read_b128 a[12:15], v76 offset:26624
ds_read_b128 a[16:19], v76 offset:28672
v_pk_mul_f32 v[184:185], v[184:185], v[50:51] op_sel_hi:[1,0]
v_pk_mul_f32 v[186:187], v[186:187], v[50:51] op_sel_hi:[1,0]
v_pk_mul_f32 v[188:189], v[188:189], v[50:51] op_sel_hi:[1,0]
v_pk_mul_f32 v[190:191], v[190:191], v[50:51] op_sel_hi:[1,0]
CV v132, v184, v185
CV v133, v186, v187
CV v134, v188, v189
CV v135, v190, v191
v_pk_mul_f32 v[192:193], v[192:193], v[50:51] op_sel_hi:[1,0]
v_pk_mul_f32 v[194:195], v[194:195], v[50:51] op_sel_hi:[1,0]
v_pk_mul_f32 v[196:197], v[196:197], v[50:51] op_sel_hi:[1,0]
v_pk_mul_f32 v[198:199], v[198:199], v[50:51] op_sel_hi:[1,0]
CV v136, v192, v193
CV v137, v194, v195
CV v138, v196, v197
CV v139, v198, v199
v_pk_mul_f32 v[200:201], v[200:201], v[50:51] op_sel_hi:[1,0]
v_pk_mul_f32 v[202:203], v[202:203], v[50:51] op_sel_hi:[1,0]
v_pk_mul_f32 v[204:205], v[204:205], v[50:51] op_sel_hi:[1,0]
v_pk_mul_f32 v[206:207], v[206:207], v[50:51] op_sel_hi:[1,0]
CV v140, v200, v201
CV v141, v202, v203
CV v142, v204, v205
CV v143, v206, v207
v_pk_mul_f32 v[208:209], v[208:209], v[52:53] op_sel_hi:[1,0]
v_pk_mul_f32 v[210:211], v[210:211], v[52:53] op_sel_hi:[1,0]
v_pk_mul_f32 v[212:213], v[212:213], v[52:53] op_sel_hi:[1,0]
v_pk_mul_f32 v[214:215], v[214:215], v[52:53] op_sel_hi:[1,0]
CV v144, v208, v209
CV v145, v210, v211
CV v146, v212, v213
CV v147, v214, v215
v_pk_mul_f32 v[216:217], v[216:217], v[52:53] op_sel_hi:[1,0]
v_pk_mul_f32 v[218:219], v[218:219], v[52:53] op_sel_hi:[1,0]
v_pk_mul_f32 v[220:221], v[220:221], v[52:53] op_sel_hi:[1,0]
v_pk_mul_f32 v[222:223], v[222:223], v[52:53] op_sel_hi:[1,0]
CV v148, v216, v217
CV v149, v218, v219
CV v150, v220, v221
CV v151, v222, v223
v_pk_mul_f32 v[224:225], v[224:225], v[52:53] op_sel_hi:[1,0]
v_pk_mul_f32 v[226:227], v[226:227], v[52:53] op_sel_hi:[1,0]
v_pk_mul_f32 v[228:229], v[228:229], v[52:53] op_sel_hi:[1,0]
v_pk_mul_f32 v[230:231], v[230:231], v[52:53] op_sel_hi:[1,0]
CV v152, v224, v225
CV v153, v226, v227
CV v154, v228, v229
CV v155, v230, v231
v_pk_mul_f32 v[232:233], v[232:233], v[52:53] op_sel_hi:[1,0]
v_pk_mul_f32 v[234:235], v[234:235], v[52:53] op_sel_hi:[1,0]
v_pk_mul_f32 v[236:237], v[236:237], v[52:53] op_sel_hi:[1,0]
v_pk_mul_f32 v[238:239], v[238:239], v[52:53] op_sel_hi:[1,0]
CV v156, v232, v233
CV v157, v234, v235
CV v158, v236, v237
CV v159, v238, v239
v_accvgpr_write_b32 a144, v80
v_accvgpr_write_b32 a145, v81
v_accvgpr_write_b32 a146, v82
v_accvgpr_write_b32 a147, v83
v_accvgpr_write_b32 a148, v84
v_accvgpr_write_b32 a149, v85
v_accvgpr_write_b32 a150, v86
v_accvgpr_write_b32 a151, v87
v_accvgpr_write_b32 a152, v88
v_accvgpr_write_b32 a153, v89
v_accvgpr_write_b32 a154, v90
v_accvgpr_write_b32 a155, v91
v_accvgpr_write_b32 a156, v92
v_accvgpr_write_b32 a157, v93
v_accvgpr_write_b32 a158, v94
v_accvgpr_write_b32 a159, v95
v_accvgpr_write_b32 a160, v96
v_accvgpr_write_b32 a161, v97
v_accvgpr_write_b32 a162, v98
v_accvgpr_write_b32 a163, v99
v_accvgpr_write_b32 a164, v100
v_accvgpr_write_b32 a165, v101
v_accvgpr_write_b32 a166, v102
v_accvgpr_write_b32 a167, v103
v_accvgpr_write_b32 a168, v104
v_accvgpr_write_b32 a169, v105
v_accvgpr_write_b32 a170, v106
v_accvgpr_write_b32 a171, v107
v_accvgpr_write_b32 a172, v108
v_accvgpr_write_b32 a173, v109
v_accvgpr_write_b32 a174, v110
v_accvgpr_write_b32 a175, v111
v_accvgpr_write_b32 a176, v112
v_accvgpr_write_b32 a177, v113
v_accvgpr_write_b32 a178, v114
v_accvgpr_write_b32 a179, v115
v_accvgpr_write_b32 a180, v116
v_accvgpr_write_b32 a181, v117
v_accvgpr_write_b32 a182, v118
v_accvgpr_write_b32 a183, v119
v_accvgpr_write_b32 a184, v120
v_accvgpr_write_b32 a185, v121
v_accvgpr_write_b32 a186, v122
v_accvgpr_write_b32 a187, v123
v_accvgpr_write_b32 a188, v124
v_accvgpr_write_b32 a189, v125
v_accvgpr_write_b32 a190, v126
v_accvgpr_write_b32 a191, v127
v_accvgpr_write_b32 a192, v128
v_accvgpr_write_b32 a193, v129
v_accvgpr_write_b32 a194, v130
v_accvgpr_write_b32 a195, v131
v_accvgpr_write_b32 a196, v132
v_accvgpr_write_b32 a197, v133
v_accvgpr_write_b32 a198, v134
v_accvgpr_write_b32 a199, v135
v_accvgpr_write_b32 a200, v136
v_accvgpr_write_b32 a201, v137
v_accvgpr_write_b32 a202, v138
v_accvgpr_write_b32 a203, v139
v_accvgpr_write_b32 a204, v140
v_accvgpr_write_b32 a205, v141
v_accvgpr_write_b32 a206, v142
v_accvgpr_write_b32 a207, v143
v_accvgpr_write_b32 a208, v144
v_accvgpr_write_b32 a209, v145
v_accvgpr_write_b32 a210, v146
v_accvgpr_write_b32 a211, v147
v_accvgpr_write_b32 a212, v148
v_accvgpr_write_b32 a213, v149
v_accvgpr_write_b32 a214, v150
v_accvgpr_write_b32 a215, v151
v_accvgpr_write_b32 a216, v152
v_accvgpr_write_b32 a217, v153
v_accvgpr_write_b32 a218, v154
v_accvgpr_write_b32 a219, v155
v_accvgpr_write_b32 a220, v156
v_accvgpr_write_b32 a221, v157
v_accvgpr_write_b32 a222, v158
v_accvgpr_write_b32 a223, v159
s_waitcnt lgkmcnt(4)
MM v[80:83], a[80:83], a[0:3], 0
s_waitcnt vmcnt(13)
s_barrier
s_add_u32 m0, s28, 0xc000
MM v[84:87], a[84:87], a[0:3], 0
s_add_u32 s30, s43, 0x100100
buffer_load_dwordx4 v16, s[16:19], s30 offen lds
MM v[88:91], a[88:91], a[0:3], 0
TR a[112:113], v9 offset:16384
TR a[114:115], v9 offset:16896
MM v[92:95], a[92:95], a[0:3], 0
s_add_u32 m0, s28, 0xcf80
MM v[96:99], a[96:99], a[0:3], 0
buffer_load_dwordx4 v16, s[16:19], s30 offen offset:128 lds
MM v[100:103], a[100:103], a[0:3], 0
TR a[116:117], v10 offset:16384
TR a[118:119], v10 offset:16896
MM v[104:107], a[104:107], a[0:3], 0
s_add_u32 m0, s28, 0xc800
s_add_u32 s30, s43, 0x120100
MM v[108:111], a[108:111], a[0:3], 0
s_waitcnt lgkmcnt(7)
buffer_load_dwordx4 v16, s[16:19], s30 offen lds
MM v[112:115], a[80:83], a[4:7], 0
TR a[120:121], v11 offset:16384
TR a[122:123], v11 offset:16896
MM v[116:119], a[84:87], a[4:7], 0
s_add_u32 m0, s28, 0xd780
MM v[120:123], a[88:91], a[4:7], 0
buffer_load_dwordx4 v16, s[16:19], s30 offen offset:128 lds
MM v[124:127], a[92:95], a[4:7], 0
TR a[124:125], v12 offset:16384
TR a[126:127], v12 offset:16896
MM v[128:131], a[96:99], a[4:7], 0
MM v[132:135], a[100:103], a[4:7], 0
TR a[128:129], v9 offset:20480
TR a[130:131], v9 offset:20992
MM v[136:139], a[104:107], a[4:7], 0
MM v[140:143], a[108:111], a[4:7], 0
s_waitcnt lgkmcnt(12)
TR a[132:133], v10 offset:20480
TR a[134:135], v10 offset:20992
MM v[144:147], a[80:83], a[8:11], 0
MM v[148:151], a[84:87], a[8:11], 0
TR a[136:137], v11 offset:20480
TR a[138:139], v11 offset:20992
MM v[152:155], a[88:91], a[8:11], 0
MM v[156:159], a[92:95], a[8:11], 0
TR a[140:141], v12 offset:20480
TR a[142:143], v12 offset:20992
MM v[160:163], a[96:99], a[8:11], 0
MM v[164:167], a[100:103], a[8:11], 0
ds_read_b128 a[20:23], v77 offset:20480
ds_read_b128 a[24:27], v77 offset:22528
MM v[168:171], a[104:107], a[8:11], 0
MM v[172:175], a[108:111], a[8:11], 0
s_waitcnt lgkmcnt(15)
ds_read_b128 a[28:31], v77 offset:24576
ds_read_b128 a[32:35], v77 offset:26624
MM v[176:179], a[80:83], a[12:15], 0
MM v[180:183], a[84:87], a[12:15], 0
ds_read_b128 a[36:39], v77 offset:28672
MM v[184:187], a[88:91], a[12:15], 0
MM v[188:191], a[92:95], a[12:15], 0
MM v[192:195], a[96:99], a[12:15], 0
MM v[196:199], a[100:103], a[12:15], 0
MM v[200:203], a[104:107], a[12:15], 0
MM v[204:207], a[108:111], a[12:15], 0
MM v[208:211], a[80:83], a[16:19], 0
MM v[212:215], a[84:87], a[16:19], 0
MM v[216:219], a[88:91], a[16:19], 0
MM v[220:223], a[92:95], a[16:19], 0
MM v[224:227], a[96:99], a[16:19], 0
MM v[228:231], a[100:103], a[16:19], 0
MM v[232:235], a[104:107], a[16:19], 0
MM v[236:239], a[108:111], a[16:19], 0
s_mov_b32 s96, 3
L_ZQ1:
s_add_u32 s43, s43, 0x100000
s_add_u32 s48, s48, 0x100
s_waitcnt lgkmcnt(4)
MM v[80:83], a[112:115], a[20:23], v[80:83]
s_waitcnt vmcnt(8) lgkmcnt(0)
s_barrier
s_add_u32 m0, s29, 0x23000
MM v[84:87], a[116:119], a[20:23], v[84:87]
s_add_u32 s30, s48, 0x0
buffer_load_dwordx4 v15, s[12:15], s30 offen lds
MM v[88:91], a[120:123], a[20:23], v[88:91]
TR a[80:81], v9 offset:32768
TR a[82:83], v9 offset:33280
MM v[92:95], a[124:127], a[20:23], v[92:95]
s_add_u32 m0, s29, 0x23800
s_add_u32 s30, s48, 0x4000
MM v[96:99], a[128:131], a[20:23], v[96:99]
buffer_load_dwordx4 v15, s[12:15], s30 offen lds
MM v[100:103], a[132:135], a[20:23], v[100:103]
TR a[84:85], v10 offset:32768
TR a[86:87], v10 offset:33280
MM v[104:107], a[136:139], a[20:23], v[104:107]
s_add_u32 m0, s29, 0x24000
s_add_u32 s30, s48, 0x8000
MM v[108:111], a[140:143], a[20:23], v[108:111]
buffer_load_dwordx4 v15, s[12:15], s30 offen lds
MM v[112:115], a[112:115], a[24:27], v[112:115]
TR a[88:89], v11 offset:32768
TR a[90:91], v11 offset:33280
MM v[116:119], a[116:119], a[24:27], v[116:119]
s_add_u32 m0, s29, 0x24800
s_add_u32 s30, s48, 0xc000
MM v[120:123], a[120:123], a[24:27], v[120:123]
buffer_load_dwordx4 v15, s[12:15], s30 offen lds
MM v[124:127], a[124:127], a[24:27], v[124:127]
TR a[92:93], v12 offset:32768
TR a[94:95], v12 offset:33280
MM v[128:131], a[128:131], a[24:27], v[128:131]
s_add_u32 m0, s29, 0x25000
s_add_u32 s30, s48, 0x10000
MM v[132:135], a[132:135], a[24:27], v[132:135]
buffer_load_dwordx4 v15, s[12:15], s30 offen lds
MM v[136:139], a[136:139], a[24:27], v[136:139]
TR a[96:97], v9 offset:36864
TR a[98:99], v9 offset:37376
MM v[140:143], a[140:143], a[24:27], v[140:143]
s_add_u32 m0, s28, 0x10000
s_add_u32 s30, s43, 0x40100
MM v[144:147], a[112:115], a[28:31], v[144:147]
buffer_load_dwordx4 v16, s[16:19], s30 offen lds
MM v[148:151], a[116:119], a[28:31], v[148:151]
TR a[100:101], v10 offset:36864
TR a[102:103], v10 offset:37376
MM v[152:155], a[120:123], a[28:31], v[152:155]
s_add_u32 m0, s28, 0x10f80
MM v[156:159], a[124:127], a[28:31], v[156:159]
buffer_load_dwordx4 v16, s[16:19], s30 offen offset:128 lds
MM v[160:163], a[128:131], a[28:31], v[160:163]
TR a[104:105], v11 offset:36864
TR a[106:107], v11 offset:37376
MM v[164:167], a[132:135], a[28:31], v[164:167]
s_add_u32 m0, s28, 0x10800
s_add_u32 s30, s43, 0x60100
MM v[168:171], a[136:139], a[28:31], v[168:171]
buffer_load_dwordx4 v16, s[16:19], s30 offen lds
MM v[172:175], a[140:143], a[28:31], v[172:175]
TR a[108:109], v12 offset:36864
TR a[110:111], v12 offset:37376
MM v[176:179], a[112:115], a[32:35], v[176:179]
s_add_u32 m0, s28, 0x11780
MM v[180:183], a[116:119], a[32:35], v[180:183]
buffer_load_dwordx4 v16, s[16:19], s30 offen offset:128 lds
MM v[184:187], a[120:123], a[32:35], v[184:187]
ds_read_b128 a[0:3], v76 offset:0
ds_read_b128 a[4:7], v76 offset:2048
MM v[188:191], a[124:127], a[32:35], v[188:191]
MM v[192:195], a[128:131], a[32:35], v[192:195]
ds_read_b128 a[8:11], v76 offset:4096
ds_read_b128 a[12:15], v76 offset:6144
MM v[196:199], a[132:135], a[32:35], v[196:199]
MM v[200:203], a[136:139], a[32:35], v[200:203]
ds_read_b128 a[16:19], v76 offset:8192
MM v[204:207], a[140:143], a[32:35], v[204:207]
MM v[208:211], a[112:115], a[36:39], v[208:211]
MM v[212:215], a[116:119], a[36:39], v[212:215]
MM v[216:219], a[120:123], a[36:39], v[216:219]
MM v[220:223], a[124:127], a[36:39], v[220:223]
MM v[224:227], a[128:131], a[36:39], v[224:227]
MM v[228:231], a[132:135], a[36:39], v[228:231]
MM v[232:235], a[136:139], a[36:39], v[232:235]
MM v[236:239], a[140:143], a[36:39], v[236:239]
s_waitcnt lgkmcnt(4)
MM v[80:83], a[80:83], a[0:3], v[80:83]
s_waitcnt vmcnt(13)
s_barrier
s_add_u32 m0, s28, 0x14000
MM v[84:87], a[84:87], a[0:3], v[84:87]
s_add_u32 s30, s43, 0x80100
buffer_load_dwordx4 v16, s[16:19], s30 offen lds
MM v[88:91], a[88:91], a[0:3], v[88:91]
TR a[112:113], v9 offset:49152
TR a[114:115], v9 offset:49664
MM v[92:95], a[92:95], a[0:3], v[92:95]
s_add_u32 m0, s28, 0x14f80
MM v[96:99], a[96:99], a[0:3], v[96:99]
buffer_load_dwordx4 v16, s[16:19], s30 offen offset:128 lds
MM v[100:103], a[100:103], a[0:3], v[100:103]
TR a[116:117], v10 offset:49152
TR a[118:119], v10 offset:49664
MM v[104:107], a[104:107], a[0:3], v[104:107]
s_add_u32 m0, s28, 0x14800
s_add_u32 s30, s43, 0xa0100
MM v[108:111], a[108:111], a[0:3], v[108:111]
s_waitcnt lgkmcnt(7)
buffer_load_dwordx4 v16, s[16:19], s30 offen lds
MM v[112:115], a[80:83], a[4:7], v[112:115]
TR a[120:121], v11 offset:49152
TR a[122:123], v11 offset:49664
MM v[116:119], a[84:87], a[4:7], v[116:119]
s_add_u32 m0, s28, 0x15780
MM v[120:123], a[88:91], a[4:7], v[120:123]
buffer_load_dwordx4 v16, s[16:19], s30 offen offset:128 lds
MM v[124:127], a[92:95], a[4:7], v[124:127]
TR a[124:125], v12 offset:49152
TR a[126:127], v12 offset:49664
MM v[128:131], a[96:99], a[4:7], v[128:131]
MM v[132:135], a[100:103], a[4:7], v[132:135]
TR a[128:129], v9 offset:53248
TR a[130:131], v9 offset:53760
MM v[136:139], a[104:107], a[4:7], v[136:139]
MM v[140:143], a[108:111], a[4:7], v[140:143]
s_waitcnt lgkmcnt(12)
TR a[132:133], v10 offset:53248
TR a[134:135], v10 offset:53760
MM v[144:147], a[80:83], a[8:11], v[144:147]
MM v[148:151], a[84:87], a[8:11], v[148:151]
TR a[136:137], v11 offset:53248
TR a[138:139], v11 offset:53760
MM v[152:155], a[88:91], a[8:11], v[152:155]
MM v[156:159], a[92:95], a[8:11], v[156:159]
TR a[140:141], v12 offset:53248
TR a[142:143], v12 offset:53760
MM v[160:163], a[96:99], a[8:11], v[160:163]
MM v[164:167], a[100:103], a[8:11], v[164:167]
ds_read_b128 a[20:23], v77 offset:0
ds_read_b128 a[24:27], v77 offset:2048
MM v[168:171], a[104:107], a[8:11], v[168:171]
MM v[172:175], a[108:111], a[8:11], v[172:175]
s_waitcnt lgkmcnt(15)
ds_read_b128 a[28:31], v77 offset:4096
ds_read_b128 a[32:35], v77 offset:6144
MM v[176:179], a[80:83], a[12:15], v[176:179]
MM v[180:183], a[84:87], a[12:15], v[180:183]
ds_read_b128 a[36:39], v77 offset:8192
MM v[184:187], a[88:91], a[12:15], v[184:187]
MM v[188:191], a[92:95], a[12:15], v[188:191]
MM v[192:195], a[96:99], a[12:15], v[192:195]
MM v[196:199], a[100:103], a[12:15], v[196:199]
MM v[200:203], a[104:107], a[12:15], v[200:203]
MM v[204:207], a[108:111], a[12:15], v[204:207]
MM v[208:211], a[80:83], a[16:19], v[208:211]
MM v[212:215], a[84:87], a[16:19], v[212:215]
MM v[216:219], a[88:91], a[16:19], v[216:219]
MM v[220:223], a[92:95], a[16:19], v[220:223]
MM v[224:227], a[96:99], a[16:19], v[224:227]
MM v[228:231], a[100:103], a[16:19], v[228:231]
MM v[232:235], a[104:107], a[16:19], v[232:235]
MM v[236:239], a[108:111], a[16:19], v[236:239]
s_waitcnt lgkmcnt(4)
MM v[80:83], a[112:115], a[20:23], v[80:83]
s_waitcnt vmcnt(8) lgkmcnt(0)
s_barrier
s_add_u32 m0, s29, 0x1df80
MM v[84:87], a[116:119], a[20:23], v[84:87]
s_add_u32 s30, s48, 0x0
buffer_load_dwordx4 v15, s[12:15], s30 offen offset:128 lds
MM v[88:91], a[120:123], a[20:23], v[88:91]
TR a[80:81], v9 offset:0
TR a[82:83], v9 offset:512
MM v[92:95], a[124:127], a[20:23], v[92:95]
s_add_u32 m0, s29, 0x1e780
s_add_u32 s30, s48, 0x4000
MM v[96:99], a[128:131], a[20:23], v[96:99]
buffer_load_dwordx4 v15, s[12:15], s30 offen offset:128 lds
MM v[100:103], a[132:135], a[20:23], v[100:103]
TR a[84:85], v10 offset:0
TR a[86:87], v10 offset:512
MM v[104:107], a[136:139], a[20:23], v[104:107]
s_add_u32 m0, s29, 0x1ef80
s_add_u32 s30, s48, 0x8000
MM v[108:111], a[140:143], a[20:23], v[108:111]
buffer_load_dwordx4 v15, s[12:15], s30 offen offset:128 lds
MM v[112:115], a[112:115], a[24:27], v[112:115]
TR a[88:89], v11 offset:0
TR a[90:91], v11 offset:512
MM v[116:119], a[116:119], a[24:27], v[116:119]
s_add_u32 m0, s29, 0x1f780
s_add_u32 s30, s48, 0xc000
MM v[120:123], a[120:123], a[24:27], v[120:123]
buffer_load_dwordx4 v15, s[12:15], s30 offen offset:128 lds
MM v[124:127], a[124:127], a[24:27], v[124:127]
TR a[92:93], v12 offset:0
TR a[94:95], v12 offset:512
MM v[128:131], a[128:131], a[24:27], v[128:131]
s_add_u32 m0, s29, 0x1ff80
s_add_u32 s30, s48, 0x10000
MM v[132:135], a[132:135], a[24:27], v[132:135]
buffer_load_dwordx4 v15, s[12:15], s30 offen offset:128 lds
MM v[136:139], a[136:139], a[24:27], v[136:139]
TR a[96:97], v9 offset:4096
TR a[98:99], v9 offset:4608
MM v[140:143], a[140:143], a[24:27], v[140:143]
s_add_u32 m0, s28, 0x18000
s_add_u32 s30, s43, 0xc0100
MM v[144:147], a[112:115], a[28:31], v[144:147]
buffer_load_dwordx4 v16, s[16:19], s30 offen lds
MM v[148:151], a[116:119], a[28:31], v[148:151]
TR a[100:101], v10 offset:4096
TR a[102:103], v10 offset:4608
MM v[152:155], a[120:123], a[28:31], v[152:155]
s_add_u32 m0, s28, 0x18f80
MM v[156:159], a[124:127], a[28:31], v[156:159]
buffer_load_dwordx4 v16, s[16:19], s30 offen offset:128 lds
MM v[160:163], a[128:131], a[28:31], v[160:163]
TR a[104:105], v11 offset:4096
TR a[106:107], v11 offset:4608
MM v[164:167], a[132:135], a[28:31], v[164:167]
s_add_u32 m0, s28, 0x18800
s_add_u32 s30, s43, 0xe0100
MM v[168:171], a[136:139], a[28:31], v[168:171]
buffer_load_dwordx4 v16, s[16:19], s30 offen lds
MM v[172:175], a[140:143], a[28:31], v[172:175]
TR a[108:109], v12 offset:4096
TR a[110:111], v12 offset:4608
MM v[176:179], a[112:115], a[32:35], v[176:179]
s_add_u32 m0, s28, 0x19780
MM v[180:183], a[116:119], a[32:35], v[180:183]
buffer_load_dwordx4 v16, s[16:19], s30 offen offset:128 lds
MM v[184:187], a[120:123], a[32:35], v[184:187]
ds_read_b128 a[0:3], v76 offset:20480
ds_read_b128 a[4:7], v76 offset:22528
MM v[188:191], a[124:127], a[32:35], v[188:191]
MM v[192:195], a[128:131], a[32:35], v[192:195]
ds_read_b128 a[8:11], v76 offset:24576
ds_read_b128 a[12:15], v76 offset:26624
MM v[196:199], a[132:135], a[32:35], v[196:199]
MM v[200:203], a[136:139], a[32:35], v[200:203]
ds_read_b128 a[16:19], v76 offset:28672
MM v[204:207], a[140:143], a[32:35], v[204:207]
MM v[208:211], a[112:115], a[36:39], v[208:211]
MM v[212:215], a[116:119], a[36:39], v[212:215]
MM v[216:219], a[120:123], a[36:39], v[216:219]
MM v[220:223], a[124:127], a[36:39], v[220:223]
MM v[224:227], a[128:131], a[36:39], v[224:227]
MM v[228:231], a[132:135], a[36:39], v[228:231]
MM v[232:235], a[136:139], a[36:39], v[232:235]
MM v[236:239], a[140:143], a[36:39], v[236:239]
s_waitcnt lgkmcnt(4)
MM v[80:83], a[80:83], a[0:3], v[80:83]
s_waitcnt vmcnt(13)
s_barrier
s_add_u32 m0, s28, 0xc000
MM v[84:87], a[84:87], a[0:3], v[84:87]
s_add_u32 s30, s43, 0x100100
buffer_load_dwordx4 v16, s[16:19], s30 offen lds
MM v[88:91], a[88:91], a[0:3], v[88:91]
TR a[112:113], v9 offset:16384
TR a[114:115], v9 offset:16896
MM v[92:95], a[92:95], a[0:3], v[92:95]
s_add_u32 m0, s28, 0xcf80
MM v[96:99], a[96:99], a[0:3], v[96:99]
buffer_load_dwordx4 v16, s[16:19], s30 offen offset:128 lds
MM v[100:103], a[100:103], a[0:3], v[100:103]
TR a[116:117], v10 offset:16384
TR a[118:119], v10 offset:16896
MM v[104:107], a[104:107], a[0:3], v[104:107]
s_add_u32 m0, s28, 0xc800
s_add_u32 s30, s43, 0x120100
MM v[108:111], a[108:111], a[0:3], v[108:111]
s_waitcnt lgkmcnt(7)
buffer_load_dwordx4 v16, s[16:19], s30 offen lds
MM v[112:115], a[80:83], a[4:7], v[112:115]
TR a[120:121], v11 offset:16384
TR a[122:123], v11 offset:16896
MM v[116:119], a[84:87], a[4:7], v[116:119]
s_add_u32 m0, s28, 0xd780
MM v[120:123], a[88:91], a[4:7], v[120:123]
buffer_load_dwordx4 v16, s[16:19], s30 offen offset:128 lds
MM v[124:127], a[92:95], a[4:7], v[124:127]
TR a[124:125], v12 offset:16384
TR a[126:127], v12 offset:16896
MM v[128:131], a[96:99], a[4:7], v[128:131]
MM v[132:135], a[100:103], a[4:7], v[132:135]
TR a[128:129], v9 offset:20480
TR a[130:131], v9 offset:20992
MM v[136:139], a[104:107], a[4:7], v[136:139]
MM v[140:143], a[108:111], a[4:7], v[140:143]
s_waitcnt lgkmcnt(12)
TR a[132:133], v10 offset:20480
TR a[134:135], v10 offset:20992
MM v[144:147], a[80:83], a[8:11], v[144:147]
MM v[148:151], a[84:87], a[8:11], v[148:151]
TR a[136:137], v11 offset:20480
TR a[138:139], v11 offset:20992
MM v[152:155], a[88:91], a[8:11], v[152:155]
MM v[156:159], a[92:95], a[8:11], v[156:159]
TR a[140:141], v12 offset:20480
TR a[142:143], v12 offset:20992
MM v[160:163], a[96:99], a[8:11], v[160:163]
MM v[164:167], a[100:103], a[8:11], v[164:167]
ds_read_b128 a[20:23], v77 offset:20480
ds_read_b128 a[24:27], v77 offset:22528
MM v[168:171], a[104:107], a[8:11], v[168:171]
MM v[172:175], a[108:111], a[8:11], v[172:175]
s_waitcnt lgkmcnt(15)
ds_read_b128 a[28:31], v77 offset:24576
ds_read_b128 a[32:35], v77 offset:26624
MM v[176:179], a[80:83], a[12:15], v[176:179]
MM v[180:183], a[84:87], a[12:15], v[180:183]
ds_read_b128 a[36:39], v77 offset:28672
MM v[184:187], a[88:91], a[12:15], v[184:187]
MM v[188:191], a[92:95], a[12:15], v[188:191]
MM v[192:195], a[96:99], a[12:15], v[192:195]
MM v[196:199], a[100:103], a[12:15], v[196:199]
MM v[200:203], a[104:107], a[12:15], v[200:203]
MM v[204:207], a[108:111], a[12:15], v[204:207]
MM v[208:211], a[80:83], a[16:19], v[208:211]
MM v[212:215], a[84:87], a[16:19], v[212:215]
MM v[216:219], a[88:91], a[16:19], v[216:219]
MM v[220:223], a[92:95], a[16:19], v[220:223]
MM v[224:227], a[96:99], a[16:19], v[224:227]
MM v[228:231], a[100:103], a[16:19], v[228:231]
MM v[232:235], a[104:107], a[16:19], v[232:235]
MM v[236:239], a[108:111], a[16:19], v[236:239]
s_sub_u32 s96, s96, 1
s_cmp_lg_u32 s96, 0
s_cbranch_scc1 L_ZQ1
s_waitcnt lgkmcnt(4)
MM v[80:83], a[112:115], a[20:23], v[80:83]
s_waitcnt vmcnt(0) lgkmcnt(0)
s_barrier
s_add_u32 m0, s28, 0x10000
MM v[84:87], a[116:119], a[20:23], v[84:87]
s_add_u32 s30, s42, 0xc000
s_and_b32 s30, s30, 0x1ffff
s_add_u32 s30, s30, 0x20000
MM v[88:91], a[120:123], a[20:23], v[88:91]
buffer_load_dwordx4 v13, s[4:7], s30 offen nt lds
MM v[92:95], a[124:127], a[20:23], v[92:95]
s_add_u32 m0, s28, 0x10f80
TR a[80:81], v9 offset:32768
TR a[82:83], v9 offset:33280
MM v[96:99], a[128:131], a[20:23], v[96:99]
buffer_load_dwordx4 v13, s[4:7], s30 offen offset:128 nt lds
MM v[100:103], a[132:135], a[20:23], v[100:103]
TR a[84:85], v10 offset:32768
TR a[86:87], v10 offset:33280
MM v[104:107], a[136:139], a[20:23], v[104:107]
MM v[108:111], a[140:143], a[20:23], v[108:111]
s_add_u32 m0, s28, 0x10800
s_add_u32 s30, s42, 0xd000
s_and_b32 s30, s30, 0x1ffff
MM v[112:115], a[112:115], a[24:27], v[112:115]
s_add_u32 s30, s30, 0x20000
buffer_load_dwordx4 v13, s[4:7], s30 offen nt lds
MM v[116:119], a[116:119], a[24:27], v[116:119]
s_add_u32 m0, s28, 0x11780
TR a[88:89], v11 offset:32768
TR a[90:91], v11 offset:33280
MM v[120:123], a[120:123], a[24:27], v[120:123]
buffer_load_dwordx4 v13, s[4:7], s30 offen offset:128 nt lds
MM v[124:127], a[124:127], a[24:27], v[124:127]
TR a[92:93], v12 offset:32768
TR a[94:95], v12 offset:33280
MM v[128:131], a[128:131], a[24:27], v[128:131]
MM v[132:135], a[132:135], a[24:27], v[132:135]
s_add_u32 m0, s28, 0xc000
s_add_u32 s30, s42, 0xa000
s_and_b32 s30, s30, 0x1ffff
MM v[136:139], a[136:139], a[24:27], v[136:139]
s_add_u32 s30, s30, 0x20000
buffer_load_dwordx4 v14, s[8:11], s30 offen nt lds
MM v[140:143], a[140:143], a[24:27], v[140:143]
s_add_u32 m0, s28, 0xcf80
TR a[96:97], v9 offset:36864
TR a[98:99], v9 offset:37376
MM v[144:147], a[112:115], a[28:31], v[144:147]
buffer_load_dwordx4 v14, s[8:11], s30 offen offset:128 nt lds
MM v[148:151], a[116:119], a[28:31], v[148:151]
TR a[100:101], v10 offset:36864
TR a[102:103], v10 offset:37376
MM v[152:155], a[120:123], a[28:31], v[152:155]
MM v[156:159], a[124:127], a[28:31], v[156:159]
s_add_u32 m0, s28, 0xc800
s_add_u32 s30, s42, 0xb000
s_and_b32 s30, s30, 0x1ffff
MM v[160:163], a[128:131], a[28:31], v[160:163]
s_add_u32 s30, s30, 0x20000
buffer_load_dwordx4 v14, s[8:11], s30 offen nt lds
MM v[164:167], a[132:135], a[28:31], v[164:167]
s_add_u32 m0, s28, 0xd780
TR a[104:105], v11 offset:36864
TR a[106:107], v11 offset:37376
MM v[168:171], a[136:139], a[28:31], v[168:171]
buffer_load_dwordx4 v14, s[8:11], s30 offen offset:128 nt lds
MM v[172:175], a[140:143], a[28:31], v[172:175]
TR a[108:109], v12 offset:36864
TR a[110:111], v12 offset:37376
MM v[176:179], a[112:115], a[32:35], v[176:179]
MM v[180:183], a[116:119], a[32:35], v[180:183]
ds_read_b128 a[0:3], v76 offset:0
ds_read_b128 a[4:7], v76 offset:2048
MM v[184:187], a[120:123], a[32:35], v[184:187]
MM v[188:191], a[124:127], a[32:35], v[188:191]
ds_read_b128 a[8:11], v76 offset:4096
ds_read_b128 a[12:15], v76 offset:6144
MM v[192:195], a[128:131], a[32:35], v[192:195]
MM v[196:199], a[132:135], a[32:35], v[196:199]
ds_read_b128 a[16:19], v76 offset:8192
MM v[200:203], a[136:139], a[32:35], v[200:203]
MM v[204:207], a[140:143], a[32:35], v[204:207]
MM v[208:211], a[112:115], a[36:39], v[208:211]
MM v[212:215], a[116:119], a[36:39], v[212:215]
MM v[216:219], a[120:123], a[36:39], v[216:219]
MM v[220:223], a[124:127], a[36:39], v[220:223]
MM v[224:227], a[128:131], a[36:39], v[224:227]
MM v[228:231], a[132:135], a[36:39], v[228:231]
MM v[232:235], a[136:139], a[36:39], v[232:235]
MM v[236:239], a[140:143], a[36:39], v[236:239]
s_waitcnt lgkmcnt(4)
MM v[80:83], a[80:83], a[0:3], v[80:83]
s_barrier
s_add_u32 m0, s28, 0x14000
s_add_u32 s30, s42, 0xc000
MM v[84:87], a[84:87], a[0:3], v[84:87]
s_and_b32 s30, s30, 0x1ffff
s_add_u32 s30, s30, 0x20000
TR a[112:113], v9 offset:49152
MM v[88:91], a[88:91], a[0:3], v[88:91]
buffer_load_dwordx4 v14, s[8:11], s30 offen nt lds
MM v[92:95], a[92:95], a[0:3], v[92:95]
s_add_u32 m0, s28, 0x14f80
TR a[114:115], v9 offset:49664
TR a[116:117], v10 offset:49152
MM v[96:99], a[96:99], a[0:3], v[96:99]
buffer_load_dwordx4 v14, s[8:11], s30 offen offset:128 nt lds
MM v[100:103], a[100:103], a[0:3], v[100:103]
TR a[118:119], v10 offset:49664
TR a[120:121], v11 offset:49152
MM v[104:107], a[104:107], a[0:3], v[104:107]
MM v[108:111], a[108:111], a[0:3], v[108:111]
s_waitcnt lgkmcnt(8)
s_add_u32 m0, s28, 0x14800
s_add_u32 s30, s42, 0xd000
MM v[112:115], a[80:83], a[4:7], v[112:115]
s_and_b32 s30, s30, 0x1ffff
s_add_u32 s30, s30, 0x20000
TR a[122:123], v11 offset:49664
MM v[116:119], a[84:87], a[4:7], v[116:119]
buffer_load_dwordx4 v14, s[8:11], s30 offen nt lds
MM v[120:123], a[88:91], a[4:7], v[120:123]
s_add_u32 m0, s28, 0x15780
TR a[124:125], v12 offset:49152
TR a[126:127], v12 offset:49664
MM v[124:127], a[92:95], a[4:7], v[124:127]
buffer_load_dwordx4 v14, s[8:11], s30 offen offset:128 nt lds
MM v[128:131], a[96:99], a[4:7], v[128:131]
TR a[128:129], v9 offset:53248
TR a[130:131], v9 offset:53760
MM v[132:135], a[100:103], a[4:7], v[132:135]
MM v[136:139], a[104:107], a[4:7], v[136:139]
TR a[132:133], v10 offset:53248
TR a[134:135], v10 offset:53760
MM v[140:143], a[108:111], a[4:7], v[140:143]
s_waitcnt lgkmcnt(14)
MM v[144:147], a[80:83], a[8:11], v[144:147]
TR a[136:137], v11 offset:53248
TR a[138:139], v11 offset:53760
MM v[148:151], a[84:87], a[8:11], v[148:151]
MM v[152:155], a[88:91], a[8:11], v[152:155]
TR a[140:141], v12 offset:53248
TR a[142:143], v12 offset:53760
MM v[156:159], a[92:95], a[8:11], v[156:159]
MM v[160:163], a[96:99], a[8:11], v[160:163]
ds_read_b128 a[20:23], v77 offset:0
ds_read_b128 a[24:27], v77 offset:2048
MM v[164:167], a[100:103], a[8:11], v[164:167]
MM v[168:171], a[104:107], a[8:11], v[168:171]
ds_read_b128 a[28:31], v77 offset:4096
ds_read_b128 a[32:35], v77 offset:6144
MM v[172:175], a[108:111], a[8:11], v[172:175]
s_waitcnt lgkmcnt(15)
MM v[176:179], a[80:83], a[12:15], v[176:179]
ds_read_b128 a[36:39], v77 offset:8192
MM v[180:183], a[84:87], a[12:15], v[180:183]
MM v[184:187], a[88:91], a[12:15], v[184:187]
MM v[188:191], a[92:95], a[12:15], v[188:191]
MM v[192:195], a[96:99], a[12:15], v[192:195]
MM v[196:199], a[100:103], a[12:15], v[196:199]
MM v[200:203], a[104:107], a[12:15], v[200:203]
MM v[204:207], a[108:111], a[12:15], v[204:207]
MM v[208:211], a[80:83], a[16:19], v[208:211]
MM v[212:215], a[84:87], a[16:19], v[212:215]
MM v[216:219], a[88:91], a[16:19], v[216:219]
MM v[220:223], a[92:95], a[16:19], v[220:223]
MM v[224:227], a[96:99], a[16:19], v[224:227]
MM v[228:231], a[100:103], a[16:19], v[228:231]
MM v[232:235], a[104:107], a[16:19], v[232:235]
MM v[236:239], a[108:111], a[16:19], v[236:239]
s_waitcnt lgkmcnt(4)
MM v[80:83], a[112:115], a[20:23], v[80:83]
s_waitcnt lgkmcnt(0)
s_barrier
s_add_u32 m0, s28, 0x18000
MM v[84:87], a[116:119], a[20:23], v[84:87]
s_add_u32 s30, s42, 0xe000
s_and_b32 s30, s30, 0x1ffff
s_add_u32 s30, s30, 0x20000
MM v[88:91], a[120:123], a[20:23], v[88:91]
buffer_load_dwordx4 v13, s[4:7], s30 offen nt lds
MM v[92:95], a[124:127], a[20:23], v[92:95]
s_add_u32 m0, s28, 0x18f80
MM v[96:99], a[128:131], a[20:23], v[96:99]
buffer_load_dwordx4 v13, s[4:7], s30 offen offset:128 nt lds
MM v[100:103], a[132:135], a[20:23], v[100:103]
MM v[104:107], a[136:139], a[20:23], v[104:107]
MM v[108:111], a[140:143], a[20:23], v[108:111]
s_add_u32 m0, s28, 0x18800
s_add_u32 s30, s42, 0xf000
s_and_b32 s30, s30, 0x1ffff
MM v[112:115], a[112:115], a[24:27], v[112:115]
s_add_u32 s30, s30, 0x20000
buffer_load_dwordx4 v13, s[4:7], s30 offen nt lds
MM v[116:119], a[116:119], a[24:27], v[116:119]
s_add_u32 m0, s28, 0x19780
MM v[120:123], a[120:123], a[24:27], v[120:123]
buffer_load_dwordx4 v13, s[4:7], s30 offen offset:128 nt lds
MM v[124:127], a[124:127], a[24:27], v[124:127]
MM v[128:131], a[128:131], a[24:27], v[128:131]
MM v[132:135], a[132:135], a[24:27], v[132:135]
s_add_u32 m0, s28, 0x1c000
s_add_u32 s30, s42, 0xe000
s_and_b32 s30, s30, 0x1ffff
MM v[136:139], a[136:139], a[24:27], v[136:139]
s_add_u32 s30, s30, 0x20000
buffer_load_dwordx4 v14, s[8:11], s30 offen nt lds
MM v[140:143], a[140:143], a[24:27], v[140:143]
s_add_u32 m0, s28, 0x1cf80
MM v[144:147], a[112:115], a[28:31], v[144:147]
buffer_load_dwordx4 v14, s[8:11], s30 offen offset:128 nt lds
MM v[148:151], a[116:119], a[28:31], v[148:151]
MM v[152:155], a[120:123], a[28:31], v[152:155]
MM v[156:159], a[124:127], a[28:31], v[156:159]
s_add_u32 m0, s28, 0x1c800
s_add_u32 s30, s42, 0xf000
s_and_b32 s30, s30, 0x1ffff
MM v[160:163], a[128:131], a[28:31], v[160:163]
s_add_u32 s30, s30, 0x20000
buffer_load_dwordx4 v14, s[8:11], s30 offen nt lds
MM v[164:167], a[132:135], a[28:31], v[164:167]
s_add_u32 m0, s28, 0x1d780
MM v[168:171], a[136:139], a[28:31], v[168:171]
buffer_load_dwordx4 v14, s[8:11], s30 offen offset:128 nt lds
MM v[172:175], a[140:143], a[28:31], v[172:175]
MM v[176:179], a[112:115], a[32:35], v[176:179]
MM v[180:183], a[116:119], a[32:35], v[180:183]
MM v[184:187], a[120:123], a[32:35], v[184:187]
MM v[188:191], a[124:127], a[32:35], v[188:191]
MM v[192:195], a[128:131], a[32:35], v[192:195]
MM v[196:199], a[132:135], a[32:35], v[196:199]
MM v[200:203], a[136:139], a[32:35], v[200:203]
MM v[204:207], a[140:143], a[32:35], v[204:207]
MM v[208:211], a[112:115], a[36:39], v[208:211]
MM v[212:215], a[116:119], a[36:39], v[212:215]
MM v[216:219], a[120:123], a[36:39], v[216:219]
MM v[220:223], a[124:127], a[36:39], v[220:223]
MM v[224:227], a[128:131], a[36:39], v[224:227]
MM v[228:231], a[132:135], a[36:39], v[228:231]
MM v[232:235], a[136:139], a[36:39], v[232:235]
MM v[236:239], a[140:143], a[36:39], v[236:239]
v_pk_mul_f32 v[80:81], v[80:81], s[38:39]
s_mov_b32 s43, 0x0
s_mov_b32 s48, 0x0
v_pk_mul_f32 v[82:83], v[82:83], s[38:39]
v_pk_mul_f32 v[84:85], v[84:85], s[38:39]
v_pk_mul_f32 v[86:87], v[86:87], s[38:39]
CV v80, v80, v81
CV v81, v82, v83
CV v82, v84, v85
CV v83, v86, v87
v_accvgpr_write_b32 a0, v80
v_accvgpr_write_b32 a1, v81
v_accvgpr_write_b32 a2, v82
v_accvgpr_write_b32 a3, v83
v_pk_mul_f32 v[88:89], v[88:89], s[38:39]
v_pk_mul_f32 v[90:91], v[90:91], s[38:39]
v_pk_mul_f32 v[92:93], v[92:93], s[38:39]
v_pk_mul_f32 v[94:95], v[94:95], s[38:39]
CV v88, v88, v89
CV v89, v90, v91
CV v90, v92, v93
CV v91, v94, v95
v_accvgpr_write_b32 a4, v88
v_accvgpr_write_b32 a5, v89
v_accvgpr_write_b32 a6, v90
v_accvgpr_write_b32 a7, v91
v_pk_mul_f32 v[96:97], v[96:97], s[38:39]
v_pk_mul_f32 v[98:99], v[98:99], s[38:39]
v_pk_mul_f32 v[100:101], v[100:101], s[38:39]
v_pk_mul_f32 v[102:103], v[102:103], s[38:39]
CV v96, v96, v97
CV v97, v98, v99
CV v98, v100, v101
CV v99, v102, v103
v_accvgpr_write_b32 a8, v96
v_accvgpr_write_b32 a9, v97
v_accvgpr_write_b32 a10, v98
v_accvgpr_write_b32 a11, v99
v_pk_mul_f32 v[104:105], v[104:105], s[38:39]
v_pk_mul_f32 v[106:107], v[106:107], s[38:39]
v_pk_mul_f32 v[108:109], v[108:109], s[38:39]
v_pk_mul_f32 v[110:111], v[110:111], s[38:39]
CV v104, v104, v105
CV v105, v106, v107
CV v106, v108, v109
CV v107, v110, v111
v_accvgpr_write_b32 a12, v104
v_accvgpr_write_b32 a13, v105
v_accvgpr_write_b32 a14, v106
v_accvgpr_write_b32 a15, v107
v_pk_mul_f32 v[112:113], v[112:113], s[38:39]
v_pk_mul_f32 v[114:115], v[114:115], s[38:39]
v_pk_mul_f32 v[116:117], v[116:117], s[38:39]
v_pk_mul_f32 v[118:119], v[118:119], s[38:39]
CV v112, v112, v113
CV v113, v114, v115
CV v114, v116, v117
CV v115, v118, v119
v_accvgpr_write_b32 a16, v112
v_accvgpr_write_b32 a17, v113
v_accvgpr_write_b32 a18, v114
v_accvgpr_write_b32 a19, v115
v_pk_mul_f32 v[120:121], v[120:121], s[38:39]
v_pk_mul_f32 v[122:123], v[122:123], s[38:39]
v_pk_mul_f32 v[124:125], v[124:125], s[38:39]
v_pk_mul_f32 v[126:127], v[126:127], s[38:39]
CV v120, v120, v121
CV v121, v122, v123
CV v122, v124, v125
CV v123, v126, v127
v_accvgpr_write_b32 a20, v120
v_accvgpr_write_b32 a21, v121
v_accvgpr_write_b32 a22, v122
v_accvgpr_write_b32 a23, v123
v_add_u32 v1, 0xffff0000, v1
v_add_u32 v2, 0xffff0000, v2
v_pk_mul_f32 v[128:129], v[128:129], s[38:39]
v_pk_mul_f32 v[130:131], v[130:131], s[38:39]
v_pk_mul_f32 v[132:133], v[132:133], s[38:39]
v_pk_mul_f32 v[134:135], v[134:135], s[38:39]
v_add_u32 v3, 0xffff0000, v3
v_add_u32 v4, 0xffff0000, v4
CV v128, v128, v129
CV v129, v130, v131
CV v130, v132, v133
CV v131, v134, v135
v_add_u32 v5, 0xffff0000, v5
v_add_u32 v6, 0xffff0000, v6
v_accvgpr_write_b32 a24, v128
v_accvgpr_write_b32 a25, v129
v_accvgpr_write_b32 a26, v130
v_accvgpr_write_b32 a27, v131
v_add_u32 v7, 0xffff0000, v7
v_add_u32 v8, 0xffff0000, v8
v_pk_mul_f32 v[136:137], v[136:137], s[38:39]
v_pk_mul_f32 v[138:139], v[138:139], s[38:39]
v_pk_mul_f32 v[140:141], v[140:141], s[38:39]
v_pk_mul_f32 v[142:143], v[142:143], s[38:39]
CV v136, v136, v137
CV v137, v138, v139
CV v138, v140, v141
CV v139, v142, v143
v_accvgpr_write_b32 a28, v136
v_accvgpr_write_b32 a29, v137
v_accvgpr_write_b32 a30, v138
v_accvgpr_write_b32 a31, v139
v_pk_mul_f32 v[144:145], v[144:145], s[38:39]
v_pk_mul_f32 v[146:147], v[146:147], s[38:39]
v_pk_mul_f32 v[148:149], v[148:149], s[38:39]
v_pk_mul_f32 v[150:151], v[150:151], s[38:39]
CV v144, v144, v145
s_barrier
CV v145, v146, v147
CV v146, v148, v149
CV v147, v150, v151
TR a[112:113], v1 offset:16384
TR a[114:115], v1 offset:18432
v_accvgpr_write_b32 a32, v144
v_accvgpr_write_b32 a33, v145
v_accvgpr_write_b32 a34, v146
v_accvgpr_write_b32 a35, v147
TR a[116:117], v2 offset:16384
TR a[118:119], v2 offset:18432
v_pk_mul_f32 v[152:153], v[152:153], s[38:39]
v_pk_mul_f32 v[154:155], v[154:155], s[38:39]
v_pk_mul_f32 v[156:157], v[156:157], s[38:39]
v_pk_mul_f32 v[158:159], v[158:159], s[38:39]
TR a[120:121], v3 offset:16384
TR a[122:123], v3 offset:18432
CV v152, v152, v153
CV v153, v154, v155
CV v154, v156, v157
CV v155, v158, v159
TR a[124:125], v4 offset:16384
TR a[126:127], v4 offset:18432
v_accvgpr_write_b32 a36, v152
v_accvgpr_write_b32 a37, v153
v_accvgpr_write_b32 a38, v154
v_accvgpr_write_b32 a39, v155
TR a[128:129], v1 offset:20480
TR a[130:131], v1 offset:22528
v_pk_mul_f32 v[160:161], v[160:161], s[38:39]
v_pk_mul_f32 v[162:163], v[162:163], s[38:39]
v_pk_mul_f32 v[164:165], v[164:165], s[38:39]
v_pk_mul_f32 v[166:167], v[166:167], s[38:39]
TR a[132:133], v2 offset:20480
TR a[134:135], v2 offset:22528
CV v160, v160, v161
CV v161, v162, v163
CV v162, v164, v165
CV v163, v166, v167
TR a[136:137], v3 offset:20480
TR a[138:139], v3 offset:22528
v_accvgpr_write_b32 a40, v160
v_accvgpr_write_b32 a41, v161
v_accvgpr_write_b32 a42, v162
v_accvgpr_write_b32 a43, v163
TR a[140:141], v4 offset:20480
TR a[142:143], v4 offset:22528
v_pk_mul_f32 v[168:169], v[168:169], s[38:39]
v_pk_mul_f32 v[170:171], v[170:171], s[38:39]
v_pk_mul_f32 v[172:173], v[172:173], s[38:39]
v_pk_mul_f32 v[174:175], v[174:175], s[38:39]
ds_read_b64 a[80:81], v5 offset:0
ds_read_b64 a[82:83], v6 offset:0
CV v168, v168, v169
CV v169, v170, v171
CV v170, v172, v173
CV v171, v174, v175
ds_read_b64 a[84:85], v5 offset:2048
ds_read_b64 a[86:87], v6 offset:2048
v_accvgpr_write_b32 a44, v168
v_accvgpr_write_b32 a45, v169
v_accvgpr_write_b32 a46, v170
v_accvgpr_write_b32 a47, v171
ds_read_b64 a[88:89], v7 offset:0
ds_read_b64 a[90:91], v8 offset:0
v_pk_mul_f32 v[176:177], v[176:177], s[38:39]
v_pk_mul_f32 v[178:179], v[178:179], s[38:39]
v_pk_mul_f32 v[180:181], v[180:181], s[38:39]
v_pk_mul_f32 v[182:183], v[182:183], s[38:39]
ds_read_b64 a[92:93], v7 offset:2048
ds_read_b64 a[94:95], v8 offset:2048
CV v176, v176, v177
CV v177, v178, v179
CV v178, v180, v181
CV v179, v182, v183
ds_read_b64 a[96:97], v5 offset:4096
ds_read_b64 a[98:99], v6 offset:4096
v_accvgpr_write_b32 a48, v176
v_accvgpr_write_b32 a49, v177
v_accvgpr_write_b32 a50, v178
v_accvgpr_write_b32 a51, v179
ds_read_b64 a[100:101], v5 offset:6144
ds_read_b64 a[102:103], v6 offset:6144
v_pk_mul_f32 v[184:185], v[184:185], s[38:39]
v_pk_mul_f32 v[186:187], v[186:187], s[38:39]
v_pk_mul_f32 v[188:189], v[188:189], s[38:39]
v_pk_mul_f32 v[190:191], v[190:191], s[38:39]
ds_read_b64 a[104:105], v7 offset:4096
ds_read_b64 a[106:107], v8 offset:4096
CV v184, v184, v185
CV v185, v186, v187
CV v186, v188, v189
CV v187, v190, v191
ds_read_b64 a[108:109], v7 offset:6144
ds_read_b64 a[110:111], v8 offset:6144
v_accvgpr_write_b32 a52, v184
v_accvgpr_write_b32 a53, v185
v_accvgpr_write_b32 a54, v186
v_accvgpr_write_b32 a55, v187
v_pk_mul_f32 v[192:193], v[192:193], s[38:39]
v_pk_mul_f32 v[194:195], v[194:195], s[38:39]
v_pk_mul_f32 v[196:197], v[196:197], s[38:39]
v_pk_mul_f32 v[198:199], v[198:199], s[38:39]
CV v192, v192, v193
CV v193, v194, v195
CV v194, v196, v197
CV v195, v198, v199
v_accvgpr_write_b32 a56, v192
v_accvgpr_write_b32 a57, v193
v_accvgpr_write_b32 a58, v194
v_accvgpr_write_b32 a59, v195
v_pk_mul_f32 v[200:201], v[200:201], s[38:39]
v_pk_mul_f32 v[202:203], v[202:203], s[38:39]
v_pk_mul_f32 v[204:205], v[204:205], s[38:39]
v_pk_mul_f32 v[206:207], v[206:207], s[38:39]
CV v200, v200, v201
CV v201, v202, v203
CV v202, v204, v205
CV v203, v206, v207
v_accvgpr_write_b32 a60, v200
v_accvgpr_write_b32 a61, v201
v_accvgpr_write_b32 a62, v202
v_accvgpr_write_b32 a63, v203
v_pk_mul_f32 v[208:209], v[208:209], s[38:39]
v_pk_mul_f32 v[210:211], v[210:211], s[38:39]
v_pk_mul_f32 v[212:213], v[212:213], s[38:39]
v_pk_mul_f32 v[214:215], v[214:215], s[38:39]
CV v208, v208, v209
CV v209, v210, v211
CV v210, v212, v213
CV v211, v214, v215
v_accvgpr_write_b32 a64, v208
v_accvgpr_write_b32 a65, v209
v_accvgpr_write_b32 a66, v210
v_accvgpr_write_b32 a67, v211
v_pk_mul_f32 v[216:217], v[216:217], s[38:39]
v_pk_mul_f32 v[218:219], v[218:219], s[38:39]
v_pk_mul_f32 v[220:221], v[220:221], s[38:39]
v_pk_mul_f32 v[222:223], v[222:223], s[38:39]
CV v216, v216, v217
CV v217, v218, v219
CV v218, v220, v221
CV v219, v222, v223
v_accvgpr_write_b32 a68, v216
v_accvgpr_write_b32 a69, v217
v_accvgpr_write_b32 a70, v218
v_accvgpr_write_b32 a71, v219
v_pk_mul_f32 v[224:225], v[224:225], s[38:39]
v_pk_mul_f32 v[226:227], v[226:227], s[38:39]
v_pk_mul_f32 v[228:229], v[228:229], s[38:39]
v_pk_mul_f32 v[230:231], v[230:231], s[38:39]
CV v224, v224, v225
CV v225, v226, v227
CV v226, v228, v229
CV v227, v230, v231
v_accvgpr_write_b32 a72, v224
v_accvgpr_write_b32 a73, v225
v_accvgpr_write_b32 a74, v226
v_accvgpr_write_b32 a75, v227
v_pk_mul_f32 v[232:233], v[232:233], s[38:39]
v_pk_mul_f32 v[234:235], v[234:235], s[38:39]
v_pk_mul_f32 v[236:237], v[236:237], s[38:39]
v_pk_mul_f32 v[238:239], v[238:239], s[38:39]
CV v232, v232, v233
CV v233, v234, v235
CV v234, v236, v237
CV v235, v238, v239
v_accvgpr_write_b32 a76, v232
v_accvgpr_write_b32 a77, v233
v_accvgpr_write_b32 a78, v234
v_accvgpr_write_b32 a79, v235
s_add_u32 s4, s4, 0x20000
s_addc_u32 s5, s5, 0
s_mov_b32 s6, 0x20000
s_add_u32 s8, s8, 0x20000
s_addc_u32 s9, s9, 0
s_mov_b32 s10, 0x20000
L_ZAent1:
s_mov_b32 s99, 0x0
s_waitcnt lgkmcnt(8)
MM v[44:47], a[80:83], a[0:3], v[24:27]
MM v[48:51], a[84:87], a[0:3], v[24:27]
MM v[44:47], a[88:91], a[4:7], v[44:47]
MM v[48:51], a[92:95], a[4:7], v[48:51]
s_waitcnt lgkmcnt(0)
MM v[44:47], a[96:99], a[8:11], v[44:47]
MM v[48:51], a[100:103], a[8:11], v[48:51]
MM v[44:47], a[104:107], a[12:15], v[44:47]
MM v[48:51], a[108:111], a[12:15], v[48:51]
MM v[52:55], a[80:83], a[16:19], v[28:31]
MM v[56:59], a[84:87], a[16:19], v[28:31]
MM v[52:55], a[88:91], a[20:23], v[52:55]
MM v[56:59], a[92:95], a[20:23], v[56:59]
MM v[52:55], a[96:99], a[24:27], v[52:55]
MM v[56:59], a[100:103], a[24:27], v[56:59]
MM v[52:55], a[104:107], a[28:31], v[52:55]
v_exp_f32 v44, v44
MM v[56:59], a[108:111], a[28:31], v[56:59]
v_exp_f32 v45, v45
MM v[60:63], a[80:83], a[32:35], v[32:35]
v_exp_f32 v46, v46
MM v[64:67], a[84:87], a[32:35], v[32:35]
v_exp_f32 v47, v47
MM v[60:63], a[88:91], a[36:39], v[60:63]
CV v240, v44, v45
CV v241, v46, v47
v_exp_f32 v48, v48
v_exp_f32 v49, v49
v_exp_f32 v50, v50
v_exp_f32 v51, v51
MM v[64:67], a[92:95], a[36:39], v[64:67]
CV v242, v48, v49
CV v243, v50, v51
MM v[60:63], a[96:99], a[40:43], v[60:63]
v_exp_f32 v52, v52
MM v[64:67], a[100:103], a[40:43], v[64:67]
v_exp_f32 v53, v53
MM v[60:63], a[104:107], a[44:47], v[60:63]
v_exp_f32 v54, v54
MM v[64:67], a[108:111], a[44:47], v[64:67]
v_exp_f32 v55, v55
MM v[80:83], a[112:115], v[240:243], 0
CV v244, v52, v53
CV v245, v54, v55
MM v[84:87], a[116:119], v[240:243], 0
v_exp_f32 v56, v56
MM v[88:91], a[120:123], v[240:243], 0
v_exp_f32 v57, v57
MM v[92:95], a[124:127], v[240:243], 0
v_exp_f32 v58, v58
MM v[96:99], a[128:131], v[240:243], 0
v_exp_f32 v59, v59
MM v[100:103], a[132:135], v[240:243], 0
CV v246, v56, v57
CV v247, v58, v59
MM v[104:107], a[136:139], v[240:243], 0
v_exp_f32 v60, v60
MM v[108:111], a[140:143], v[240:243], 0
v_exp_f32 v61, v61
MM a[224:227], a[244:247], v[240:243], 0
v_exp_f32 v62, v62
MM v[68:71], a[80:83], a[48:51], v[36:39]
v_exp_f32 v63, v63
MM v[72:75], a[84:87], a[48:51], v[36:39]
CV v248, v60, v61
CV v249, v62, v63
MM v[68:71], a[88:91], a[52:55], v[68:71]
v_exp_f32 v64, v64
MM v[72:75], a[92:95], a[52:55], v[72:75]
v_exp_f32 v65, v65
MM v[68:71], a[96:99], a[56:59], v[68:71]
v_exp_f32 v66, v66
MM v[72:75], a[100:103], a[56:59], v[72:75]
v_exp_f32 v67, v67
MM v[68:71], a[104:107], a[60:63], v[68:71]
CV v250, v64, v65
CV v251, v66, v67
MM v[72:75], a[108:111], a[60:63], v[72:75]
MM v[112:115], a[112:115], v[244:247], 0
MM v[116:119], a[116:119], v[244:247], 0
MM v[120:123], a[120:123], v[244:247], 0
MM v[124:127], a[124:127], v[244:247], 0
MM v[128:131], a[128:131], v[244:247], 0
v_exp_f32 v68, v68
MM v[132:135], a[132:135], v[244:247], 0
v_exp_f32 v69, v69
MM v[136:139], a[136:139], v[244:247], 0
v_exp_f32 v70, v70
MM v[140:143], a[140:143], v[244:247], 0
v_exp_f32 v71, v71
MM a[228:231], a[244:247], v[244:247], 0
s_waitcnt vmcnt(12)
s_barrier
s_add_u32 m0, s28, 0x0
MM v[44:47], a[80:83], a[64:67], v[40:43]
s_add_u32 s30, s42, 0x10000
s_and_b32 s30, s30, 0x1ffff
s_waitcnt vmcnt(4)
MM v[48:51], a[84:87], a[64:67], v[40:43]
buffer_load_dwordx4 v13, s[4:7], s30 offen nt lds
MM v[44:47], a[88:91], a[68:71], v[44:47]
s_add_u32 m0, s28, 0xf80
ds_read_b64 a[80:81], v5 offset:32768
ds_read_b64 a[82:83], v6 offset:32768
MM v[48:51], a[92:95], a[68:71], v[48:51]
buffer_load_dwordx4 v13, s[4:7], s30 offen offset:128 nt lds
MM v[44:47], a[96:99], a[72:75], v[44:47]
ds_read_b64 a[84:85], v5 offset:34816
ds_read_b64 a[86:87], v6 offset:34816
MM v[48:51], a[100:103], a[72:75], v[48:51]
CV v252, v68, v69
CV v253, v70, v71
MM v[44:47], a[104:107], a[76:79], v[44:47]
ds_read_b64 a[88:89], v7 offset:32768
ds_read_b64 a[90:91], v8 offset:32768
MM v[48:51], a[108:111], a[76:79], v[48:51]
v_exp_f32 v72, v72
MM v[144:147], a[112:115], v[248:251], 0
ds_read_b64 a[92:93], v7 offset:34816
ds_read_b64 a[94:95], v8 offset:34816
MM v[148:151], a[116:119], v[248:251], 0
v_exp_f32 v73, v73
MM v[152:155], a[120:123], v[248:251], 0
ds_read_b64 a[96:97], v5 offset:36864
ds_read_b64 a[98:99], v6 offset:36864
MM v[156:159], a[124:127], v[248:251], 0
v_exp_f32 v74, v74
MM v[160:163], a[128:131], v[248:251], 0
ds_read_b64 a[100:101], v5 offset:38912
ds_read_b64 a[102:103], v6 offset:38912
MM v[164:167], a[132:135], v[248:251], 0
v_exp_f32 v75, v75
MM v[168:171], a[136:139], v[248:251], 0
ds_read_b64 a[104:105], v7 offset:36864
ds_read_b64 a[106:107], v8 offset:36864
MM v[172:175], a[140:143], v[248:251], 0
CV v254, v72, v73
CV v255, v74, v75
MM a[232:235], a[244:247], v[248:251], 0
s_waitcnt lgkmcnt(6)
ds_read_b64 a[108:109], v7 offset:38912
ds_read_b64 a[110:111], v8 offset:38912
MM v[52:55], a[80:83], a[0:3], v[24:27]
v_exp_f32 v44, v44
MM v[56:59], a[84:87], a[0:3], v[24:27]
v_exp_f32 v45, v45
MM v[52:55], a[88:91], a[4:7], v[52:55]
v_exp_f32 v46, v46
MM v[56:59], a[92:95], a[4:7], v[56:59]
s_waitcnt lgkmcnt(4)
s_add_u32 m0, s28, 0x800
s_add_u32 s30, s42, 0x11000
MM v[52:55], a[96:99], a[8:11], v[52:55]
s_and_b32 s30, s30, 0x1ffff
s_waitcnt vmcnt(4)
MM v[56:59], a[100:103], a[8:11], v[56:59]
s_waitcnt lgkmcnt(2)
buffer_load_dwordx4 v13, s[4:7], s30 offen nt lds
MM v[52:55], a[104:107], a[12:15], v[52:55]
s_waitcnt lgkmcnt(0)
s_add_u32 m0, s28, 0x1780
MM v[56:59], a[108:111], a[12:15], v[56:59]
buffer_load_dwordx4 v13, s[4:7], s30 offen offset:128 nt lds
MM v[176:179], a[112:115], v[252:255], 0
v_exp_f32 v47, v47
MM v[180:183], a[116:119], v[252:255], 0
CV v240, v44, v45
CV v241, v46, v47
MM v[184:187], a[120:123], v[252:255], 0
v_exp_f32 v48, v48
MM v[188:191], a[124:127], v[252:255], 0
v_exp_f32 v49, v49
MM v[192:195], a[128:131], v[252:255], 0
v_exp_f32 v50, v50
MM v[196:199], a[132:135], v[252:255], 0
v_exp_f32 v51, v51
MM v[200:203], a[136:139], v[252:255], 0
CV v242, v48, v49
CV v243, v50, v51
MM v[204:207], a[140:143], v[252:255], 0
v_exp_f32 v52, v52
MM a[236:239], a[244:247], v[252:255], 0
v_exp_f32 v53, v53
MM v[60:63], a[80:83], a[16:19], v[28:31]
v_exp_f32 v54, v54
MM v[64:67], a[84:87], a[16:19], v[28:31]
v_exp_f32 v55, v55
MM v[60:63], a[88:91], a[20:23], v[60:63]
CV v244, v52, v53
CV v245, v54, v55
MM v[64:67], a[92:95], a[20:23], v[64:67]
v_exp_f32 v56, v56
MM v[60:63], a[96:99], a[24:27], v[60:63]
v_exp_f32 v57, v57
MM v[64:67], a[100:103], a[24:27], v[64:67]
v_exp_f32 v58, v58
MM v[60:63], a[104:107], a[28:31], v[60:63]
v_exp_f32 v59, v59
MM v[64:67], a[108:111], a[28:31], v[64:67]
s_add_u32 m0, s28, 0x4000
s_add_u32 s30, s42, 0x10000
s_and_b32 s30, s30, 0x1ffff
MM v[208:211], a[112:115], v[240:243], 0
s_waitcnt vmcnt(4)
buffer_load_dwordx4 v14, s[8:11], s30 offen nt lds
MM v[212:215], a[116:119], v[240:243], 0
s_add_u32 m0, s28, 0x4f80
TR a[112:113], v1 offset:49152
TR a[114:115], v1 offset:51200
MM v[216:219], a[120:123], v[240:243], 0
buffer_load_dwordx4 v14, s[8:11], s30 offen offset:128 nt lds
MM v[220:223], a[124:127], v[240:243], 0
TR a[116:117], v2 offset:49152
TR a[118:119], v2 offset:51200
MM v[224:227], a[128:131], v[240:243], 0
CV v246, v56, v57
CV v247, v58, v59
MM v[228:231], a[132:135], v[240:243], 0
TR a[120:121], v3 offset:49152
TR a[122:123], v3 offset:51200
MM v[232:235], a[136:139], v[240:243], 0
v_exp_f32 v60, v60
MM v[236:239], a[140:143], v[240:243], 0
TR a[124:125], v4 offset:49152
TR a[126:127], v4 offset:51200
MM a[240:243], a[244:247], v[240:243], 0
v_exp_f32 v61, v61
MM v[68:71], a[80:83], a[32:35], v[32:35]
TR a[128:129], v1 offset:53248
TR a[130:131], v1 offset:55296
MM v[72:75], a[84:87], a[32:35], v[32:35]
v_exp_f32 v62, v62
MM v[68:71], a[88:91], a[36:39], v[68:71]
TR a[132:133], v2 offset:53248
TR a[134:135], v2 offset:55296
MM v[72:75], a[92:95], a[36:39], v[72:75]
v_exp_f32 v63, v63
MM v[68:71], a[96:99], a[40:43], v[68:71]
TR a[136:137], v3 offset:53248
TR a[138:139], v3 offset:55296
MM v[72:75], a[100:103], a[40:43], v[72:75]
CV v248, v60, v61
CV v249, v62, v63
MM v[68:71], a[104:107], a[44:47], v[68:71]
TR a[140:141], v4 offset:53248
TR a[142:143], v4 offset:55296
MM v[72:75], a[108:111], a[44:47], v[72:75]
s_waitcnt lgkmcnt(8)
v_exp_f32 v64, v64
MM v[80:83], a[112:115], v[244:247], v[80:83]
v_exp_f32 v65, v65
MM v[84:87], a[116:119], v[244:247], v[84:87]
v_exp_f32 v66, v66
MM v[88:91], a[120:123], v[244:247], v[88:91]
s_add_u32 m0, s28, 0x4800
s_add_u32 s30, s42, 0x11000
s_and_b32 s30, s30, 0x1ffff
MM v[92:95], a[124:127], v[244:247], v[92:95]
s_waitcnt lgkmcnt(4)
s_waitcnt vmcnt(4)
MM v[96:99], a[128:131], v[244:247], v[96:99]
buffer_load_dwordx4 v14, s[8:11], s30 offen nt lds
MM v[100:103], a[132:135], v[244:247], v[100:103]
s_waitcnt lgkmcnt(2)
s_add_u32 m0, s28, 0x5780
MM v[104:107], a[136:139], v[244:247], v[104:107]
s_waitcnt lgkmcnt(0)
buffer_load_dwordx4 v14, s[8:11], s30 offen offset:128 nt lds
MM v[108:111], a[140:143], v[244:247], v[108:111]
v_exp_f32 v67, v67
MM a[224:227], a[244:247], v[244:247], a[224:227]
CV v250, v64, v65
CV v251, v66, v67
MM v[44:47], a[80:83], a[48:51], v[36:39]
v_exp_f32 v68, v68
MM v[48:51], a[84:87], a[48:51], v[36:39]
v_exp_f32 v69, v69
MM v[44:47], a[88:91], a[52:55], v[44:47]
v_exp_f32 v70, v70
MM v[48:51], a[92:95], a[52:55], v[48:51]
v_exp_f32 v71, v71
MM v[44:47], a[96:99], a[56:59], v[44:47]
CV v252, v68, v69
CV v253, v70, v71
MM v[48:51], a[100:103], a[56:59], v[48:51]
v_exp_f32 v72, v72
MM v[44:47], a[104:107], a[60:63], v[44:47]
v_exp_f32 v73, v73
MM v[48:51], a[108:111], a[60:63], v[48:51]
v_exp_f32 v74, v74
MM v[112:115], a[112:115], v[248:251], v[112:115]
v_exp_f32 v75, v75
MM v[116:119], a[116:119], v[248:251], v[116:119]
CV v254, v72, v73
CV v255, v74, v75
MM v[120:123], a[120:123], v[248:251], v[120:123]
v_exp_f32 v44, v44
MM v[124:127], a[124:127], v[248:251], v[124:127]
v_exp_f32 v45, v45
MM v[128:131], a[128:131], v[248:251], v[128:131]
v_exp_f32 v46, v46
MM v[132:135], a[132:135], v[248:251], v[132:135]
v_exp_f32 v47, v47
MM v[136:139], a[136:139], v[248:251], v[136:139]
CV v240, v44, v45
CV v241, v46, v47
MM v[140:143], a[140:143], v[248:251], v[140:143]
v_exp_f32 v48, v48
MM a[228:231], a[244:247], v[248:251], a[228:231]
s_mov_b32 s96, 3
L_ZA1:
s_add_u32 s42, s42, 0x8000
s_add_u32 s99, s99, 0xc000
s_and_b32 s97, s99, 0x20000
s_waitcnt vmcnt(16)
s_barrier
MM v[52:55], a[80:83], a[64:67], v[40:43]
s_add_u32 m0, s28, 0x8000
s_add_u32 s30, s42, 0xa000
s_and_b32 s30, s30, 0x1ffff
MM v[56:59], a[84:87], a[64:67], v[40:43]
s_waitcnt vmcnt(4)
buffer_load_dwordx4 v13, s[4:7], s30 offen nt lds
MM v[52:55], a[88:91], a[68:71], v[52:55]
s_add_u32 m0, s28, 0x8f80
v_add_u32 v5, 0x10000, v5
v_add_u32 v6, 0x10000, v6
MM v[56:59], a[92:95], a[68:71], v[56:59]
buffer_load_dwordx4 v13, s[4:7], s30 offen offset:128 nt lds
MM v[52:55], a[96:99], a[72:75], v[52:55]
ds_read_b64 a[80:81], v5 offset:0
ds_read_b64 a[82:83], v6 offset:0
MM v[56:59], a[100:103], a[72:75], v[56:59]
v_exp_f32 v49, v49
MM v[52:55], a[104:107], a[76:79], v[52:55]
ds_read_b64 a[84:85], v5 offset:2048
ds_read_b64 a[86:87], v6 offset:2048
MM v[56:59], a[108:111], a[76:79], v[56:59]
v_add_u32 v7, 0x10000, v7
v_add_u32 v8, 0x10000, v8
MM v[144:147], a[112:115], v[252:255], v[144:147]
ds_read_b64 a[88:89], v7 offset:0
ds_read_b64 a[90:91], v8 offset:0
MM v[148:151], a[116:119], v[252:255], v[148:151]
v_exp_f32 v50, v50
MM v[152:155], a[120:123], v[252:255], v[152:155]
ds_read_b64 a[92:93], v7 offset:2048
ds_read_b64 a[94:95], v8 offset:2048
MM v[156:159], a[124:127], v[252:255], v[156:159]
v_exp_f32 v51, v51
MM v[160:163], a[128:131], v[252:255], v[160:163]
ds_read_b64 a[96:97], v5 offset:4096
ds_read_b64 a[98:99], v6 offset:4096
MM v[164:167], a[132:135], v[252:255], v[164:167]
CV v242, v48, v49
CV v243, v50, v51
MM v[168:171], a[136:139], v[252:255], v[168:171]
ds_read_b64 a[100:101], v5 offset:6144
ds_read_b64 a[102:103], v6 offset:6144
MM v[172:175], a[140:143], v[252:255], v[172:175]
ds_read_b64 a[104:105], v7 offset:4096
ds_read_b64 a[106:107], v8 offset:4096
MM a[232:235], a[244:247], v[252:255], a[232:235]
s_waitcnt lgkmcnt(8)
ds_read_b64 a[108:109], v7 offset:6144
ds_read_b64 a[110:111], v8 offset:6144
MM v[60:63], a[80:83], a[0:3], v[24:27]
v_exp_f32 v52, v52
MM v[64:67], a[84:87], a[0:3], v[24:27]
v_exp_f32 v53, v53
MM v[60:63], a[88:91], a[4:7], v[60:63]
s_waitcnt lgkmcnt(8)
v_exp_f32 v54, v54
MM v[64:67], a[92:95], a[4:7], v[64:67]
s_waitcnt lgkmcnt(6)
s_add_u32 m0, s28, 0x8800
s_add_u32 s30, s42, 0xb000
MM v[60:63], a[96:99], a[8:11], v[60:63]
s_waitcnt lgkmcnt(4)
s_and_b32 s30, s30, 0x1ffff
s_waitcnt vmcnt(4)
MM v[64:67], a[100:103], a[8:11], v[64:67]
s_waitcnt lgkmcnt(2)
buffer_load_dwordx4 v13, s[4:7], s30 offen nt lds
MM v[60:63], a[104:107], a[12:15], v[60:63]
s_waitcnt lgkmcnt(0)
s_add_u32 m0, s28, 0x9780
v_add_u32 v1, 0x10000, v1
MM v[64:67], a[108:111], a[12:15], v[64:67]
buffer_load_dwordx4 v13, s[4:7], s30 offen offset:128 nt lds
MM v[176:179], a[112:115], v[240:243], v[176:179]
v_exp_f32 v55, v55
MM v[180:183], a[116:119], v[240:243], v[180:183]
CV v244, v52, v53
CV v245, v54, v55
MM v[184:187], a[120:123], v[240:243], v[184:187]
v_exp_f32 v56, v56
MM v[188:191], a[124:127], v[240:243], v[188:191]
v_exp_f32 v57, v57
MM v[192:195], a[128:131], v[240:243], v[192:195]
v_exp_f32 v58, v58
MM v[196:199], a[132:135], v[240:243], v[196:199]
v_exp_f32 v59, v59
MM v[200:203], a[136:139], v[240:243], v[200:203]
CV v246, v56, v57
CV v247, v58, v59
MM v[204:207], a[140:143], v[240:243], v[204:207]
v_exp_f32 v60, v60
MM a[236:239], a[244:247], v[240:243], a[236:239]
v_exp_f32 v61, v61
MM v[68:71], a[80:83], a[16:19], v[28:31]
v_exp_f32 v62, v62
MM v[72:75], a[84:87], a[16:19], v[28:31]
v_exp_f32 v63, v63
MM v[68:71], a[88:91], a[20:23], v[68:71]
CV v248, v60, v61
CV v249, v62, v63
MM v[72:75], a[92:95], a[20:23], v[72:75]
v_exp_f32 v64, v64
MM v[68:71], a[96:99], a[24:27], v[68:71]
v_exp_f32 v65, v65
MM v[72:75], a[100:103], a[24:27], v[72:75]
v_exp_f32 v66, v66
MM v[68:71], a[104:107], a[28:31], v[68:71]
v_exp_f32 v67, v67
MM v[72:75], a[108:111], a[28:31], v[72:75]
s_add_u32 m0, s28, 0xc000
s_add_u32 s30, s42, 0xa000
s_and_b32 s30, s30, 0x1ffff
MM v[208:211], a[112:115], v[244:247], v[208:211]
s_waitcnt vmcnt(4)
buffer_load_dwordx4 v14, s[8:11], s30 offen nt lds
MM v[212:215], a[116:119], v[244:247], v[212:215]
s_add_u32 m0, s28, 0xcf80
TR a[112:113], v1 offset:16384
TR a[114:115], v1 offset:18432
MM v[216:219], a[120:123], v[244:247], v[216:219]
buffer_load_dwordx4 v14, s[8:11], s30 offen offset:128 nt lds
MM v[220:223], a[124:127], v[244:247], v[220:223]
CV v250, v64, v65
v_add_u32 v2, 0x10000, v2
MM v[224:227], a[128:131], v[244:247], v[224:227]
TR a[116:117], v2 offset:16384
TR a[118:119], v2 offset:18432
MM v[228:231], a[132:135], v[244:247], v[228:231]
CV v251, v66, v67
v_add_u32 v3, 0x10000, v3
MM v[232:235], a[136:139], v[244:247], v[232:235]
TR a[120:121], v3 offset:16384
TR a[122:123], v3 offset:18432
MM v[236:239], a[140:143], v[244:247], v[236:239]
v_add_u32 v4, 0x10000, v4
MM a[240:243], a[244:247], v[244:247], a[240:243]
TR a[124:125], v4 offset:16384
TR a[126:127], v4 offset:18432
MM v[44:47], a[80:83], a[32:35], v[32:35]
v_exp_f32 v68, v68
MM v[48:51], a[84:87], a[32:35], v[32:35]
TR a[128:129], v1 offset:20480
TR a[130:131], v1 offset:22528
MM v[44:47], a[88:91], a[36:39], v[44:47]
v_exp_f32 v69, v69
MM v[48:51], a[92:95], a[36:39], v[48:51]
TR a[132:133], v2 offset:20480
TR a[134:135], v2 offset:22528
MM v[44:47], a[96:99], a[40:43], v[44:47]
v_exp_f32 v70, v70
MM v[48:51], a[100:103], a[40:43], v[48:51]
TR a[136:137], v3 offset:20480
TR a[138:139], v3 offset:22528
MM v[44:47], a[104:107], a[44:47], v[44:47]
v_exp_f32 v71, v71
MM v[48:51], a[108:111], a[44:47], v[48:51]
s_waitcnt lgkmcnt(6)
TR a[140:141], v4 offset:20480
TR a[142:143], v4 offset:22528
MM v[80:83], a[112:115], v[248:251], v[80:83]
CV v252, v68, v69
CV v253, v70, v71
MM v[84:87], a[116:119], v[248:251], v[84:87]
v_exp_f32 v72, v72
MM v[88:91], a[120:123], v[248:251], v[88:91]
s_add_u32 m0, s28, 0xc800
s_add_u32 s30, s42, 0xb000
s_and_b32 s30, s30, 0x1ffff
MM v[92:95], a[124:127], v[248:251], v[92:95]
s_waitcnt lgkmcnt(4)
s_waitcnt vmcnt(4)
MM v[96:99], a[128:131], v[248:251], v[96:99]
buffer_load_dwordx4 v14, s[8:11], s30 offen nt lds
MM v[100:103], a[132:135], v[248:251], v[100:103]
s_waitcnt lgkmcnt(2)
s_add_u32 m0, s28, 0xd780
MM v[104:107], a[136:139], v[248:251], v[104:107]
s_waitcnt lgkmcnt(0)
buffer_load_dwordx4 v14, s[8:11], s30 offen offset:128 nt lds
MM v[108:111], a[140:143], v[248:251], v[108:111]
v_exp_f32 v73, v73
MM a[224:227], a[244:247], v[248:251], a[224:227]
v_exp_f32 v74, v74
MM v[52:55], a[80:83], a[48:51], v[36:39]
v_exp_f32 v75, v75
MM v[56:59], a[84:87], a[48:51], v[36:39]
CV v254, v72, v73
CV v255, v74, v75
MM v[52:55], a[88:91], a[52:55], v[52:55]
v_exp_f32 v44, v44
MM v[56:59], a[92:95], a[52:55], v[56:59]
v_exp_f32 v45, v45
MM v[52:55], a[96:99], a[56:59], v[52:55]
v_exp_f32 v46, v46
MM v[56:59], a[100:103], a[56:59], v[56:59]
v_exp_f32 v47, v47
MM v[52:55], a[104:107], a[60:63], v[52:55]
CV v240, v44, v45
CV v241, v46, v47
MM v[56:59], a[108:111], a[60:63], v[56:59]
v_exp_f32 v48, v48
MM v[112:115], a[112:115], v[252:255], v[112:115]
v_exp_f32 v49, v49
MM v[116:119], a[116:119], v[252:255], v[116:119]
v_exp_f32 v50, v50
MM v[120:123], a[120:123], v[252:255], v[120:123]
v_exp_f32 v51, v51
MM v[124:127], a[124:127], v[252:255], v[124:127]
CV v242, v48, v49
CV v243, v50, v51
MM v[128:131], a[128:131], v[252:255], v[128:131]
v_exp_f32 v52, v52
MM v[132:135], a[132:135], v[252:255], v[132:135]
v_exp_f32 v53, v53
MM v[136:139], a[136:139], v[252:255], v[136:139]
v_exp_f32 v54, v54
MM v[140:143], a[140:143], v[252:255], v[140:143]
v_exp_f32 v55, v55
MM a[228:231], a[244:247], v[252:255], a[228:231]
s_waitcnt vmcnt(16)
s_barrier
s_add_u32 m0, s28, 0x10000
MM v[60:63], a[80:83], a[64:67], v[40:43]
s_add_u32 s30, s42, 0xc000
s_and_b32 s30, s30, 0x1ffff
s_waitcnt vmcnt(4)
MM v[64:67], a[84:87], a[64:67], v[40:43]
buffer_load_dwordx4 v13, s[4:7], s30 offen nt lds
MM v[60:63], a[88:91], a[68:71], v[60:63]
s_add_u32 m0, s28, 0x10f80
ds_read_b64 a[80:81], v5 offset:32768
ds_read_b64 a[82:83], v6 offset:32768
MM v[64:67], a[92:95], a[68:71], v[64:67]
buffer_load_dwordx4 v13, s[4:7], s30 offen offset:128 nt lds
MM v[60:63], a[96:99], a[72:75], v[60:63]
ds_read_b64 a[84:85], v5 offset:34816
ds_read_b64 a[86:87], v6 offset:34816
MM v[64:67], a[100:103], a[72:75], v[64:67]
CV v244, v52, v53
CV v245, v54, v55
MM v[60:63], a[104:107], a[76:79], v[60:63]
ds_read_b64 a[88:89], v7 offset:32768
ds_read_b64 a[90:91], v8 offset:32768
MM v[64:67], a[108:111], a[76:79], v[64:67]
v_exp_f32 v56, v56
MM v[144:147], a[112:115], v[240:243], v[144:147]
ds_read_b64 a[92:93], v7 offset:34816
ds_read_b64 a[94:95], v8 offset:34816
MM v[148:151], a[116:119], v[240:243], v[148:151]
v_exp_f32 v57, v57
MM v[152:155], a[120:123], v[240:243], v[152:155]
ds_read_b64 a[96:97], v5 offset:36864
ds_read_b64 a[98:99], v6 offset:36864
MM v[156:159], a[124:127], v[240:243], v[156:159]
v_exp_f32 v58, v58
MM v[160:163], a[128:131], v[240:243], v[160:163]
ds_read_b64 a[100:101], v5 offset:38912
ds_read_b64 a[102:103], v6 offset:38912
MM v[164:167], a[132:135], v[240:243], v[164:167]
v_exp_f32 v59, v59
MM v[168:171], a[136:139], v[240:243], v[168:171]
ds_read_b64 a[104:105], v7 offset:36864
ds_read_b64 a[106:107], v8 offset:36864
MM v[172:175], a[140:143], v[240:243], v[172:175]
CV v246, v56, v57
CV v247, v58, v59
MM a[232:235], a[244:247], v[240:243], a[232:235]
s_waitcnt lgkmcnt(6)
ds_read_b64 a[108:109], v7 offset:38912
ds_read_b64 a[110:111], v8 offset:38912
MM v[68:71], a[80:83], a[0:3], v[24:27]
v_exp_f32 v60, v60
MM v[72:75], a[84:87], a[0:3], v[24:27]
v_exp_f32 v61, v61
MM v[68:71], a[88:91], a[4:7], v[68:71]
v_exp_f32 v62, v62
MM v[72:75], a[92:95], a[4:7], v[72:75]
s_waitcnt lgkmcnt(4)
s_add_u32 m0, s28, 0x10800
s_add_u32 s30, s42, 0xd000
MM v[68:71], a[96:99], a[8:11], v[68:71]
s_and_b32 s30, s30, 0x1ffff
s_waitcnt vmcnt(4)
MM v[72:75], a[100:103], a[8:11], v[72:75]
s_waitcnt lgkmcnt(2)
buffer_load_dwordx4 v13, s[4:7], s30 offen nt lds
MM v[68:71], a[104:107], a[12:15], v[68:71]
s_waitcnt lgkmcnt(0)
s_add_u32 m0, s28, 0x11780
MM v[72:75], a[108:111], a[12:15], v[72:75]
buffer_load_dwordx4 v13, s[4:7], s30 offen offset:128 nt lds
MM v[176:179], a[112:115], v[244:247], v[176:179]
v_exp_f32 v63, v63
MM v[180:183], a[116:119], v[244:247], v[180:183]
CV v248, v60, v61
CV v249, v62, v63
MM v[184:187], a[120:123], v[244:247], v[184:187]
v_exp_f32 v64, v64
MM v[188:191], a[124:127], v[244:247], v[188:191]
v_exp_f32 v65, v65
MM v[192:195], a[128:131], v[244:247], v[192:195]
v_exp_f32 v66, v66
MM v[196:199], a[132:135], v[244:247], v[196:199]
v_exp_f32 v67, v67
MM v[200:203], a[136:139], v[244:247], v[200:203]
CV v250, v64, v65
CV v251, v66, v67
MM v[204:207], a[140:143], v[244:247], v[204:207]
v_exp_f32 v68, v68
MM a[236:239], a[244:247], v[244:247], a[236:239]
v_exp_f32 v69, v69
MM v[44:47], a[80:83], a[16:19], v[28:31]
v_exp_f32 v70, v70
MM v[48:51], a[84:87], a[16:19], v[28:31]
v_exp_f32 v71, v71
MM v[44:47], a[88:91], a[20:23], v[44:47]
CV v252, v68, v69
CV v253, v70, v71
MM v[48:51], a[92:95], a[20:23], v[48:51]
v_exp_f32 v72, v72
MM v[44:47], a[96:99], a[24:27], v[44:47]
v_exp_f32 v73, v73
MM v[48:51], a[100:103], a[24:27], v[48:51]
v_exp_f32 v74, v74
MM v[44:47], a[104:107], a[28:31], v[44:47]
v_exp_f32 v75, v75
MM v[48:51], a[108:111], a[28:31], v[48:51]
s_add_u32 m0, s28, 0x14000
s_add_u32 s30, s42, 0xc000
s_and_b32 s30, s30, 0x1ffff
MM v[208:211], a[112:115], v[248:251], v[208:211]
s_waitcnt vmcnt(4)
buffer_load_dwordx4 v14, s[8:11], s30 offen nt lds
MM v[212:215], a[116:119], v[248:251], v[212:215]
s_add_u32 m0, s28, 0x14f80
TR a[112:113], v1 offset:49152
TR a[114:115], v1 offset:51200
MM v[216:219], a[120:123], v[248:251], v[216:219]
buffer_load_dwordx4 v14, s[8:11], s30 offen offset:128 nt lds
MM v[220:223], a[124:127], v[248:251], v[220:223]
TR a[116:117], v2 offset:49152
TR a[118:119], v2 offset:51200
MM v[224:227], a[128:131], v[248:251], v[224:227]
CV v254, v72, v73
CV v255, v74, v75
MM v[228:231], a[132:135], v[248:251], v[228:231]
TR a[120:121], v3 offset:49152
TR a[122:123], v3 offset:51200
MM v[232:235], a[136:139], v[248:251], v[232:235]
v_exp_f32 v44, v44
MM v[236:239], a[140:143], v[248:251], v[236:239]
TR a[124:125], v4 offset:49152
TR a[126:127], v4 offset:51200
MM a[240:243], a[244:247], v[248:251], a[240:243]
v_exp_f32 v45, v45
MM v[52:55], a[80:83], a[32:35], v[32:35]
TR a[128:129], v1 offset:53248
TR a[130:131], v1 offset:55296
MM v[56:59], a[84:87], a[32:35], v[32:35]
v_exp_f32 v46, v46
MM v[52:55], a[88:91], a[36:39], v[52:55]
TR a[132:133], v2 offset:53248
TR a[134:135], v2 offset:55296
MM v[56:59], a[92:95], a[36:39], v[56:59]
v_exp_f32 v47, v47
MM v[52:55], a[96:99], a[40:43], v[52:55]
TR a[136:137], v3 offset:53248
TR a[138:139], v3 offset:55296
MM v[56:59], a[100:103], a[40:43], v[56:59]
CV v240, v44, v45
CV v241, v46, v47
MM v[52:55], a[104:107], a[44:47], v[52:55]
TR a[140:141], v4 offset:53248
TR a[142:143], v4 offset:55296
MM v[56:59], a[108:111], a[44:47], v[56:59]
s_waitcnt lgkmcnt(8)
v_exp_f32 v48, v48
MM v[80:83], a[112:115], v[252:255], v[80:83]
v_exp_f32 v49, v49
MM v[84:87], a[116:119], v[252:255], v[84:87]
v_exp_f32 v50, v50
MM v[88:91], a[120:123], v[252:255], v[88:91]
s_add_u32 m0, s28, 0x14800
s_add_u32 s30, s42, 0xd000
s_and_b32 s30, s30, 0x1ffff
MM v[92:95], a[124:127], v[252:255], v[92:95]
s_waitcnt lgkmcnt(4)
s_waitcnt vmcnt(4)
v_add_u32 v5, 0xffff0000, v5
MM v[96:99], a[128:131], v[252:255], v[96:99]
buffer_load_dwordx4 v14, s[8:11], s30 offen nt lds
MM v[100:103], a[132:135], v[252:255], v[100:103]
s_waitcnt lgkmcnt(2)
s_add_u32 m0, s28, 0x15780
v_add_u32 v6, 0xffff0000, v6
MM v[104:107], a[136:139], v[252:255], v[104:107]
s_waitcnt lgkmcnt(0)
buffer_load_dwordx4 v14, s[8:11], s30 offen offset:128 nt lds
MM v[108:111], a[140:143], v[252:255], v[108:111]
v_exp_f32 v51, v51
MM a[224:227], a[244:247], v[252:255], a[224:227]
CV v242, v48, v49
CV v243, v50, v51
MM v[60:63], a[80:83], a[48:51], v[36:39]
v_exp_f32 v52, v52
MM v[64:67], a[84:87], a[48:51], v[36:39]
v_exp_f32 v53, v53
MM v[60:63], a[88:91], a[52:55], v[60:63]
v_exp_f32 v54, v54
MM v[64:67], a[92:95], a[52:55], v[64:67]
v_exp_f32 v55, v55
MM v[60:63], a[96:99], a[56:59], v[60:63]
CV v244, v52, v53
CV v245, v54, v55
MM v[64:67], a[100:103], a[56:59], v[64:67]
v_exp_f32 v56, v56
MM v[60:63], a[104:107], a[60:63], v[60:63]
v_exp_f32 v57, v57
MM v[64:67], a[108:111], a[60:63], v[64:67]
v_exp_f32 v58, v58
MM v[112:115], a[112:115], v[240:243], v[112:115]
v_exp_f32 v59, v59
MM v[116:119], a[116:119], v[240:243], v[116:119]
CV v246, v56, v57
CV v247, v58, v59
MM v[120:123], a[120:123], v[240:243], v[120:123]
v_exp_f32 v60, v60
MM v[124:127], a[124:127], v[240:243], v[124:127]
v_exp_f32 v61, v61
MM v[128:131], a[128:131], v[240:243], v[128:131]
v_exp_f32 v62, v62
MM v[132:135], a[132:135], v[240:243], v[132:135]
v_exp_f32 v63, v63
MM v[136:139], a[136:139], v[240:243], v[136:139]
CV v248, v60, v61
CV v249, v62, v63
MM v[140:143], a[140:143], v[240:243], v[140:143]
v_exp_f32 v64, v64
MM a[228:231], a[244:247], v[240:243], a[228:231]
s_waitcnt vmcnt(16)
s_barrier
s_add_u32 m0, s28, 0x18000
MM v[68:71], a[80:83], a[64:67], v[40:43]
s_add_u32 s30, s42, 0xe000
s_and_b32 s30, s30, 0x1ffff
s_waitcnt vmcnt(4)
MM v[72:75], a[84:87], a[64:67], v[40:43]
buffer_load_dwordx4 v13, s[4:7], s30 offen nt lds
MM v[68:71], a[88:91], a[68:71], v[68:71]
s_add_u32 m0, s28, 0x18f80
ds_read_b64 a[80:81], v5 offset:0
ds_read_b64 a[82:83], v6 offset:0
MM v[72:75], a[92:95], a[68:71], v[72:75]
buffer_load_dwordx4 v13, s[4:7], s30 offen offset:128 nt lds
MM v[68:71], a[96:99], a[72:75], v[68:71]
ds_read_b64 a[84:85], v5 offset:2048
ds_read_b64 a[86:87], v6 offset:2048
MM v[72:75], a[100:103], a[72:75], v[72:75]
v_add_u32 v7, 0xffff0000, v7
v_add_u32 v8, 0xffff0000, v8
MM v[68:71], a[104:107], a[76:79], v[68:71]
ds_read_b64 a[88:89], v7 offset:0
ds_read_b64 a[90:91], v8 offset:0
MM v[72:75], a[108:111], a[76:79], v[72:75]
v_exp_f32 v65, v65
MM v[144:147], a[112:115], v[244:247], v[144:147]
ds_read_b64 a[92:93], v7 offset:2048
ds_read_b64 a[94:95], v8 offset:2048
MM v[148:151], a[116:119], v[244:247], v[148:151]
v_exp_f32 v66, v66
MM v[152:155], a[120:123], v[244:247], v[152:155]
ds_read_b64 a[96:97], v5 offset:4096
ds_read_b64 a[98:99], v6 offset:4096
MM v[156:159], a[124:127], v[244:247], v[156:159]
v_exp_f32 v67, v67
MM v[160:163], a[128:131], v[244:247], v[160:163]
ds_read_b64 a[100:101], v5 offset:6144
ds_read_b64 a[102:103], v6 offset:6144
MM v[164:167], a[132:135], v[244:247], v[164:167]
CV v250, v64, v65
CV v251, v66, v67
MM v[168:171], a[136:139], v[244:247], v[168:171]
ds_read_b64 a[104:105], v7 offset:4096
ds_read_b64 a[106:107], v8 offset:4096
MM v[172:175], a[140:143], v[244:247], v[172:175]
v_exp_f32 v68, v68
MM a[232:235], a[244:247], v[244:247], a[232:235]
s_waitcnt lgkmcnt(6)
ds_read_b64 a[108:109], v7 offset:6144
ds_read_b64 a[110:111], v8 offset:6144
MM v[44:47], a[80:83], a[0:3], v[24:27]
v_exp_f32 v69, v69
MM v[48:51], a[84:87], a[0:3], v[24:27]
v_exp_f32 v70, v70
MM v[44:47], a[88:91], a[4:7], v[44:47]
v_exp_f32 v71, v71
MM v[48:51], a[92:95], a[4:7], v[48:51]
s_waitcnt lgkmcnt(4)
s_add_u32 m0, s28, 0x18800
s_add_u32 s30, s42, 0xf000
MM v[44:47], a[96:99], a[8:11], v[44:47]
s_and_b32 s30, s30, 0x1ffff
s_waitcnt vmcnt(4)
CV v252, v68, v69
MM v[48:51], a[100:103], a[8:11], v[48:51]
s_waitcnt lgkmcnt(2)
buffer_load_dwordx4 v13, s[4:7], s30 offen nt lds
MM v[44:47], a[104:107], a[12:15], v[44:47]
s_waitcnt lgkmcnt(0)
s_add_u32 m0, s28, 0x19780
CV v253, v70, v71
MM v[48:51], a[108:111], a[12:15], v[48:51]
buffer_load_dwordx4 v13, s[4:7], s30 offen offset:128 nt lds
MM v[176:179], a[112:115], v[248:251], v[176:179]
v_exp_f32 v72, v72
MM v[180:183], a[116:119], v[248:251], v[180:183]
v_exp_f32 v73, v73
MM v[184:187], a[120:123], v[248:251], v[184:187]
v_exp_f32 v74, v74
MM v[188:191], a[124:127], v[248:251], v[188:191]
v_exp_f32 v75, v75
MM v[192:195], a[128:131], v[248:251], v[192:195]
CV v254, v72, v73
CV v255, v74, v75
MM v[196:199], a[132:135], v[248:251], v[196:199]
v_exp_f32 v44, v44
MM v[200:203], a[136:139], v[248:251], v[200:203]
v_exp_f32 v45, v45
MM v[204:207], a[140:143], v[248:251], v[204:207]
v_exp_f32 v46, v46
MM a[236:239], a[244:247], v[248:251], a[236:239]
v_exp_f32 v47, v47
MM v[52:55], a[80:83], a[16:19], v[28:31]
CV v240, v44, v45
CV v241, v46, v47
MM v[56:59], a[84:87], a[16:19], v[28:31]
v_exp_f32 v48, v48
MM v[52:55], a[88:91], a[20:23], v[52:55]
v_exp_f32 v49, v49
MM v[56:59], a[92:95], a[20:23], v[56:59]
v_exp_f32 v50, v50
MM v[52:55], a[96:99], a[24:27], v[52:55]
v_exp_f32 v51, v51
MM v[56:59], a[100:103], a[24:27], v[56:59]
CV v242, v48, v49
CV v243, v50, v51
MM v[52:55], a[104:107], a[28:31], v[52:55]
v_add_u32 v1, 0xffff0000, v1
v_add_u32 v2, 0xffff0000, v2
MM v[56:59], a[108:111], a[28:31], v[56:59]
s_add_u32 m0, s28, 0x1c000
s_add_u32 s30, s42, 0xe000
s_and_b32 s30, s30, 0x1ffff
MM v[208:211], a[112:115], v[252:255], v[208:211]
s_waitcnt vmcnt(4)
buffer_load_dwordx4 v14, s[8:11], s30 offen nt lds
MM v[212:215], a[116:119], v[252:255], v[212:215]
s_add_u32 m0, s28, 0x1cf80
TR a[112:113], v1 offset:16384
TR a[114:115], v1 offset:18432
MM v[216:219], a[120:123], v[252:255], v[216:219]
buffer_load_dwordx4 v14, s[8:11], s30 offen offset:128 nt lds
MM v[220:223], a[124:127], v[252:255], v[220:223]
TR a[116:117], v2 offset:16384
TR a[118:119], v2 offset:18432
MM v[224:227], a[128:131], v[252:255], v[224:227]
v_add_u32 v3, 0xffff0000, v3
v_add_u32 v4, 0xffff0000, v4
MM v[228:231], a[132:135], v[252:255], v[228:231]
TR a[120:121], v3 offset:16384
TR a[122:123], v3 offset:18432
MM v[232:235], a[136:139], v[252:255], v[232:235]
v_exp_f32 v52, v52
MM v[236:239], a[140:143], v[252:255], v[236:239]
TR a[124:125], v4 offset:16384
TR a[126:127], v4 offset:18432
MM a[240:243], a[244:247], v[252:255], a[240:243]
v_exp_f32 v53, v53
MM v[60:63], a[80:83], a[32:35], v[32:35]
TR a[128:129], v1 offset:20480
TR a[130:131], v1 offset:22528
MM v[64:67], a[84:87], a[32:35], v[32:35]
v_exp_f32 v54, v54
MM v[60:63], a[88:91], a[36:39], v[60:63]
TR a[132:133], v2 offset:20480
TR a[134:135], v2 offset:22528
MM v[64:67], a[92:95], a[36:39], v[64:67]
v_exp_f32 v55, v55
MM v[60:63], a[96:99], a[40:43], v[60:63]
TR a[136:137], v3 offset:20480
TR a[138:139], v3 offset:22528
MM v[64:67], a[100:103], a[40:43], v[64:67]
CV v244, v52, v53
CV v245, v54, v55
MM v[60:63], a[104:107], a[44:47], v[60:63]
TR a[140:141], v4 offset:20480
TR a[142:143], v4 offset:22528
MM v[64:67], a[108:111], a[44:47], v[64:67]
s_waitcnt lgkmcnt(8)
v_exp_f32 v56, v56
MM v[80:83], a[112:115], v[240:243], v[80:83]
v_exp_f32 v57, v57
MM v[84:87], a[116:119], v[240:243], v[84:87]
v_exp_f32 v58, v58
MM v[88:91], a[120:123], v[240:243], v[88:91]
s_add_u32 m0, s28, 0x1c800
s_add_u32 s30, s42, 0xf000
s_and_b32 s30, s30, 0x1ffff
MM v[92:95], a[124:127], v[240:243], v[92:95]
s_waitcnt lgkmcnt(4)
s_waitcnt vmcnt(4)
MM v[96:99], a[128:131], v[240:243], v[96:99]
buffer_load_dwordx4 v14, s[8:11], s30 offen nt lds
MM v[100:103], a[132:135], v[240:243], v[100:103]
s_waitcnt lgkmcnt(2)
s_add_u32 m0, s28, 0x1d780
MM v[104:107], a[136:139], v[240:243], v[104:107]
s_waitcnt lgkmcnt(0)
buffer_load_dwordx4 v14, s[8:11], s30 offen offset:128 nt lds
MM v[108:111], a[140:143], v[240:243], v[108:111]
v_exp_f32 v59, v59
MM a[224:227], a[244:247], v[240:243], a[224:227]
CV v246, v56, v57
CV v247, v58, v59
MM v[68:71], a[80:83], a[48:51], v[36:39]
v_exp_f32 v60, v60
MM v[72:75], a[84:87], a[48:51], v[36:39]
v_exp_f32 v61, v61
MM v[68:71], a[88:91], a[52:55], v[68:71]
v_exp_f32 v62, v62
MM v[72:75], a[92:95], a[52:55], v[72:75]
v_exp_f32 v63, v63
MM v[68:71], a[96:99], a[56:59], v[68:71]
CV v248, v60, v61
CV v249, v62, v63
MM v[72:75], a[100:103], a[56:59], v[72:75]
v_exp_f32 v64, v64
MM v[68:71], a[104:107], a[60:63], v[68:71]
v_exp_f32 v65, v65
MM v[72:75], a[108:111], a[60:63], v[72:75]
v_exp_f32 v66, v66
MM v[112:115], a[112:115], v[244:247], v[112:115]
v_exp_f32 v67, v67
MM v[116:119], a[116:119], v[244:247], v[116:119]
CV v250, v64, v65
CV v251, v66, v67
MM v[120:123], a[120:123], v[244:247], v[120:123]
v_exp_f32 v68, v68
MM v[124:127], a[124:127], v[244:247], v[124:127]
v_exp_f32 v69, v69
MM v[128:131], a[128:131], v[244:247], v[128:131]
v_exp_f32 v70, v70
MM v[132:135], a[132:135], v[244:247], v[132:135]
v_exp_f32 v71, v71
MM v[136:139], a[136:139], v[244:247], v[136:139]
CV v252, v68, v69
CV v253, v70, v71
MM v[140:143], a[140:143], v[244:247], v[140:143]
v_exp_f32 v72, v72
MM a[228:231], a[244:247], v[244:247], a[228:231]
s_waitcnt vmcnt(16)
s_barrier
s_add_u32 m0, s28, 0x0
MM v[44:47], a[80:83], a[64:67], v[40:43]
s_add_u32 s30, s42, 0x10000
s_and_b32 s30, s30, 0x1ffff
s_add_u32 s30, s30, s97
MM v[48:51], a[84:87], a[64:67], v[40:43]
s_waitcnt vmcnt(4)
buffer_load_dwordx4 v13, s[4:7], s30 offen nt lds
MM v[44:47], a[88:91], a[68:71], v[44:47]
s_add_u32 m0, s28, 0xf80
ds_read_b64 a[80:81], v5 offset:32768
ds_read_b64 a[82:83], v6 offset:32768
MM v[48:51], a[92:95], a[68:71], v[48:51]
buffer_load_dwordx4 v13, s[4:7], s30 offen offset:128 nt lds
MM v[44:47], a[96:99], a[72:75], v[44:47]
ds_read_b64 a[84:85], v5 offset:34816
ds_read_b64 a[86:87], v6 offset:34816
MM v[48:51], a[100:103], a[72:75], v[48:51]
v_exp_f32 v73, v73
MM v[44:47], a[104:107], a[76:79], v[44:47]
ds_read_b64 a[88:89], v7 offset:32768
ds_read_b64 a[90:91], v8 offset:32768
MM v[48:51], a[108:111], a[76:79], v[48:51]
v_exp_f32 v74, v74
MM v[144:147], a[112:115], v[248:251], v[144:147]
ds_read_b64 a[92:93], v7 offset:34816
ds_read_b64 a[94:95], v8 offset:34816
MM v[148:151], a[116:119], v[248:251], v[148:151]
v_exp_f32 v75, v75
MM v[152:155], a[120:123], v[248:251], v[152:155]
ds_read_b64 a[96:97], v5 offset:36864
ds_read_b64 a[98:99], v6 offset:36864
MM v[156:159], a[124:127], v[248:251], v[156:159]
CV v254, v72, v73
CV v255, v74, v75
MM v[160:163], a[128:131], v[248:251], v[160:163]
ds_read_b64 a[100:101], v5 offset:38912
ds_read_b64 a[102:103], v6 offset:38912
MM v[164:167], a[132:135], v[248:251], v[164:167]
v_exp_f32 v44, v44
MM v[168:171], a[136:139], v[248:251], v[168:171]
ds_read_b64 a[104:105], v7 offset:36864
ds_read_b64 a[106:107], v8 offset:36864
MM v[172:175], a[140:143], v[248:251], v[172:175]
v_exp_f32 v45, v45
MM a[232:235], a[244:247], v[248:251], a[232:235]
s_waitcnt lgkmcnt(6)
ds_read_b64 a[108:109], v7 offset:38912
ds_read_b64 a[110:111], v8 offset:38912
MM v[52:55], a[80:83], a[0:3], v[24:27]
v_exp_f32 v46, v46
MM v[56:59], a[84:87], a[0:3], v[24:27]
v_exp_f32 v47, v47
MM v[52:55], a[88:91], a[4:7], v[52:55]
CV v240, v44, v45
CV v241, v46, v47
MM v[56:59], a[92:95], a[4:7], v[56:59]
s_waitcnt lgkmcnt(4)
s_add_u32 m0, s28, 0x800
s_add_u32 s30, s42, 0x11000
MM v[52:55], a[96:99], a[8:11], v[52:55]
s_and_b32 s30, s30, 0x1ffff
s_add_u32 s30, s30, s97
s_waitcnt vmcnt(4)
MM v[56:59], a[100:103], a[8:11], v[56:59]
s_waitcnt lgkmcnt(2)
buffer_load_dwordx4 v13, s[4:7], s30 offen nt lds
MM v[52:55], a[104:107], a[12:15], v[52:55]
s_waitcnt lgkmcnt(0)
s_add_u32 m0, s28, 0x1780
MM v[56:59], a[108:111], a[12:15], v[56:59]
buffer_load_dwordx4 v13, s[4:7], s30 offen offset:128 nt lds
MM v[176:179], a[112:115], v[252:255], v[176:179]
v_exp_f32 v48, v48
MM v[180:183], a[116:119], v[252:255], v[180:183]
v_exp_f32 v49, v49
MM v[184:187], a[120:123], v[252:255], v[184:187]
v_exp_f32 v50, v50
MM v[188:191], a[124:127], v[252:255], v[188:191]
v_exp_f32 v51, v51
MM v[192:195], a[128:131], v[252:255], v[192:195]
CV v242, v48, v49
CV v243, v50, v51
MM v[196:199], a[132:135], v[252:255], v[196:199]
v_exp_f32 v52, v52
MM v[200:203], a[136:139], v[252:255], v[200:203]
v_exp_f32 v53, v53
MM v[204:207], a[140:143], v[252:255], v[204:207]
v_exp_f32 v54, v54
MM a[236:239], a[244:247], v[252:255], a[236:239]
v_exp_f32 v55, v55
MM v[60:63], a[80:83], a[16:19], v[28:31]
CV v244, v52, v53
CV v245, v54, v55
MM v[64:67], a[84:87], a[16:19], v[28:31]
v_exp_f32 v56, v56
MM v[60:63], a[88:91], a[20:23], v[60:63]
v_exp_f32 v57, v57
MM v[64:67], a[92:95], a[20:23], v[64:67]
v_exp_f32 v58, v58
MM v[60:63], a[96:99], a[24:27], v[60:63]
v_exp_f32 v59, v59
MM v[64:67], a[100:103], a[24:27], v[64:67]
CV v246, v56, v57
CV v247, v58, v59
MM v[60:63], a[104:107], a[28:31], v[60:63]
MM v[64:67], a[108:111], a[28:31], v[64:67]
s_add_u32 m0, s28, 0x4000
s_add_u32 s30, s42, 0x10000
s_and_b32 s30, s30, 0x1ffff
MM v[208:211], a[112:115], v[240:243], v[208:211]
s_add_u32 s30, s30, s97
s_waitcnt vmcnt(4)
TR a[112:113], v1 offset:49152
MM v[212:215], a[116:119], v[240:243], v[212:215]
buffer_load_dwordx4 v14, s[8:11], s30 offen nt lds
MM v[216:219], a[120:123], v[240:243], v[216:219]
s_add_u32 m0, s28, 0x4f80
TR a[114:115], v1 offset:51200
TR a[116:117], v2 offset:49152
MM v[220:223], a[124:127], v[240:243], v[220:223]
buffer_load_dwordx4 v14, s[8:11], s30 offen offset:128 nt lds
MM v[224:227], a[128:131], v[240:243], v[224:227]
TR a[118:119], v2 offset:51200
TR a[120:121], v3 offset:49152
MM v[228:231], a[132:135], v[240:243], v[228:231]
v_exp_f32 v60, v60
MM v[232:235], a[136:139], v[240:243], v[232:235]
TR a[122:123], v3 offset:51200
TR a[124:125], v4 offset:49152
MM v[236:239], a[140:143], v[240:243], v[236:239]
v_exp_f32 v61, v61
MM a[240:243], a[244:247], v[240:243], a[240:243]
TR a[126:127], v4 offset:51200
TR a[128:129], v1 offset:53248
MM v[68:71], a[80:83], a[32:35], v[32:35]
v_exp_f32 v62, v62
MM v[72:75], a[84:87], a[32:35], v[32:35]
TR a[130:131], v1 offset:55296
TR a[132:133], v2 offset:53248
MM v[68:71], a[88:91], a[36:39], v[68:71]
v_exp_f32 v63, v63
MM v[72:75], a[92:95], a[36:39], v[72:75]
TR a[134:135], v2 offset:55296
TR a[136:137], v3 offset:53248
MM v[68:71], a[96:99], a[40:43], v[68:71]
CV v248, v60, v61
CV v249, v62, v63
MM v[72:75], a[100:103], a[40:43], v[72:75]
TR a[138:139], v3 offset:55296
TR a[140:141], v4 offset:53248
MM v[68:71], a[104:107], a[44:47], v[68:71]
v_exp_f32 v64, v64
MM v[72:75], a[108:111], a[44:47], v[72:75]
s_waitcnt lgkmcnt(7)
TR a[142:143], v4 offset:55296
MM v[80:83], a[112:115], v[244:247], v[80:83]
v_exp_f32 v65, v65
MM v[84:87], a[116:119], v[244:247], v[84:87]
v_exp_f32 v66, v66
MM v[88:91], a[120:123], v[244:247], v[88:91]
v_exp_f32 v67, v67
MM v[92:95], a[124:127], v[244:247], v[92:95]
s_waitcnt lgkmcnt(4)
s_add_u32 m0, s28, 0x4800
s_add_u32 s30, s42, 0x11000
MM v[96:99], a[128:131], v[244:247], v[96:99]
s_and_b32 s30, s30, 0x1ffff
s_add_u32 s30, s30, s97
s_waitcnt vmcnt(4)
MM v[100:103], a[132:135], v[244:247], v[100:103]
s_waitcnt lgkmcnt(2)
buffer_load_dwordx4 v14, s[8:11], s30 offen nt lds
MM v[104:107], a[136:139], v[244:247], v[104:107]
s_waitcnt lgkmcnt(0)
s_add_u32 m0, s28, 0x5780
CV v250, v64, v65
MM v[108:111], a[140:143], v[244:247], v[108:111]
buffer_load_dwordx4 v14, s[8:11], s30 offen offset:128 nt lds
MM a[224:227], a[244:247], v[244:247], a[224:227]
CV v251, v66, v67
MM v[44:47], a[80:83], a[48:51], v[36:39]
v_exp_f32 v68, v68
MM v[48:51], a[84:87], a[48:51], v[36:39]
v_exp_f32 v69, v69
MM v[44:47], a[88:91], a[52:55], v[44:47]
v_exp_f32 v70, v70
MM v[48:51], a[92:95], a[52:55], v[48:51]
v_exp_f32 v71, v71
MM v[44:47], a[96:99], a[56:59], v[44:47]
CV v252, v68, v69
CV v253, v70, v71
MM v[48:51], a[100:103], a[56:59], v[48:51]
v_exp_f32 v72, v72
MM v[44:47], a[104:107], a[60:63], v[44:47]
v_exp_f32 v73, v73
MM v[48:51], a[108:111], a[60:63], v[48:51]
v_exp_f32 v74, v74
MM v[112:115], a[112:115], v[248:251], v[112:115]
v_exp_f32 v75, v75
MM v[116:119], a[116:119], v[248:251], v[116:119]
CV v254, v72, v73
CV v255, v74, v75
MM v[120:123], a[120:123], v[248:251], v[120:123]
v_exp_f32 v44, v44
MM v[124:127], a[124:127], v[248:251], v[124:127]
v_exp_f32 v45, v45
MM v[128:131], a[128:131], v[248:251], v[128:131]
v_exp_f32 v46, v46
MM v[132:135], a[132:135], v[248:251], v[132:135]
v_exp_f32 v47, v47
MM v[136:139], a[136:139], v[248:251], v[136:139]
CV v240, v44, v45
CV v241, v46, v47
MM v[140:143], a[140:143], v[248:251], v[140:143]
v_exp_f32 v48, v48
MM a[228:231], a[244:247], v[248:251], a[228:231]
s_sub_u32 s96, s96, 1
s_cmp_lg_u32 s96, 0
s_cbranch_scc1 L_ZA1
s_waitcnt vmcnt(16)
s_barrier
v_add_u32 v5, 0x10000, v5
MM v[52:55], a[80:83], a[64:67], v[40:43]
s_mov_b32 s41, 0x0
s_add_u32 m0, s28, 0x20000
s_add_u32 s30, s31, 0x20000
MM v[56:59], a[84:87], a[64:67], v[40:43]
buffer_load_dwordx4 v17, s[20:23], s30 offen lds
MM v[52:55], a[88:91], a[68:71], v[52:55]
ds_read_b64 a[80:81], v5 offset:0
v_add_u32 v6, 0x10000, v6
MM v[56:59], a[92:95], a[68:71], v[56:59]
s_add_u32 m0, s28, 0x21000
s_add_u32 s30, s31, 0x28000
ds_read_b64 a[82:83], v6 offset:0
MM v[52:55], a[96:99], a[72:75], v[52:55]
buffer_load_dwordx4 v17, s[20:23], s30 offen lds
MM v[56:59], a[100:103], a[72:75], v[56:59]
ds_read_b64 a[84:85], v5 offset:2048
ds_read_b64 a[86:87], v6 offset:2048
MM v[52:55], a[104:107], a[76:79], v[52:55]
s_add_u32 m0, s28, 0x20800
s_add_u32 s30, s31, 0x24000
v_add_u32 v7, 0x10000, v7
MM v[56:59], a[108:111], a[76:79], v[56:59]
buffer_load_dwordx4 v17, s[20:23], s30 offen lds
MM v[144:147], a[112:115], v[252:255], v[144:147]
ds_read_b64 a[88:89], v7 offset:0
v_add_u32 v8, 0x10000, v8
MM v[148:151], a[116:119], v[252:255], v[148:151]
s_add_u32 m0, s28, 0x21800
s_add_u32 s30, s31, 0x2c000
ds_read_b64 a[90:91], v8 offset:0
MM v[152:155], a[120:123], v[252:255], v[152:155]
buffer_load_dwordx4 v17, s[20:23], s30 offen lds
MM v[156:159], a[124:127], v[252:255], v[156:159]
ds_read_b64 a[92:93], v7 offset:2048
ds_read_b64 a[94:95], v8 offset:2048
MM v[160:163], a[128:131], v[252:255], v[160:163]
s_add_u32 m0, s28, 0x24000
s_add_u32 s30, s31, 0x30000
v_add_u32 v1, 0x10000, v1
MM v[164:167], a[132:135], v[252:255], v[164:167]
ds_read_b64 a[96:97], v5 offset:4096
ds_read_b64 a[98:99], v6 offset:4096
MM v[168:171], a[136:139], v[252:255], v[168:171]
buffer_load_dwordx4 v17, s[20:23], s30 offen lds
MM v[172:175], a[140:143], v[252:255], v[172:175]
ds_read_b64 a[100:101], v5 offset:6144
ds_read_b64 a[102:103], v6 offset:6144
MM a[232:235], a[244:247], v[252:255], a[232:235]
s_waitcnt lgkmcnt(8)
s_add_u32 m0, s28, 0x25000
s_add_u32 s30, s31, 0x38000
ds_read_b64 a[104:105], v7 offset:4096
ds_read_b64 a[106:107], v8 offset:4096
MM v[60:63], a[80:83], a[0:3], v[24:27]
ds_read_b64 a[108:109], v7 offset:6144
ds_read_b64 a[110:111], v8 offset:6144
MM v[64:67], a[84:87], a[0:3], v[24:27]
s_waitcnt lgkmcnt(10)
buffer_load_dwordx4 v17, s[20:23], s30 offen lds
MM v[60:63], a[88:91], a[4:7], v[60:63]
s_waitcnt lgkmcnt(8)
v_exp_f32 v49, v49
v_exp_f32 v50, v50
v_exp_f32 v51, v51
buffer_load_dword v22, v23, s[20:23], s41 offen
MM v[64:67], a[92:95], a[4:7], v[64:67]
s_waitcnt lgkmcnt(6)
s_add_u32 m0, s28, 0x24800
s_add_u32 s30, s31, 0x34000
MM v[60:63], a[96:99], a[8:11], v[60:63]
s_waitcnt lgkmcnt(4)
buffer_load_dwordx4 v17, s[20:23], s30 offen lds
MM v[64:67], a[100:103], a[8:11], v[64:67]
s_waitcnt lgkmcnt(2)
CV v242, v48, v49
CV v243, v50, v51
MM v[60:63], a[104:107], a[12:15], v[60:63]
s_waitcnt lgkmcnt(0)
s_add_u32 m0, s28, 0x25800
s_add_u32 s30, s31, 0x3c000
MM v[64:67], a[108:111], a[12:15], v[64:67]
buffer_load_dwordx4 v17, s[20:23], s30 offen lds
MM v[176:179], a[112:115], v[240:243], v[176:179]
v_exp_f32 v52, v52
MM v[180:183], a[116:119], v[240:243], v[180:183]
v_exp_f32 v53, v53
MM v[184:187], a[120:123], v[240:243], v[184:187]
v_exp_f32 v54, v54
MM v[188:191], a[124:127], v[240:243], v[188:191]
v_exp_f32 v55, v55
MM v[192:195], a[128:131], v[240:243], v[192:195]
CV v244, v52, v53
CV v245, v54, v55
MM v[196:199], a[132:135], v[240:243], v[196:199]
v_exp_f32 v56, v56
MM v[200:203], a[136:139], v[240:243], v[200:203]
v_exp_f32 v57, v57
MM v[204:207], a[140:143], v[240:243], v[204:207]
v_exp_f32 v58, v58
MM a[236:239], a[244:247], v[240:243], a[236:239]
v_exp_f32 v59, v59
MM v[68:71], a[80:83], a[16:19], v[28:31]
CV v246, v56, v57
CV v247, v58, v59
MM v[72:75], a[84:87], a[16:19], v[28:31]
v_exp_f32 v60, v60
MM v[68:71], a[88:91], a[20:23], v[68:71]
v_exp_f32 v61, v61
MM v[72:75], a[92:95], a[20:23], v[72:75]
v_exp_f32 v62, v62
MM v[68:71], a[96:99], a[24:27], v[68:71]
v_exp_f32 v63, v63
MM v[72:75], a[100:103], a[24:27], v[72:75]
CV v248, v60, v61
CV v249, v62, v63
MM v[68:71], a[104:107], a[28:31], v[68:71]
v_exp_f32 v64, v64
MM v[72:75], a[108:111], a[28:31], v[72:75]
v_exp_f32 v65, v65
MM v[208:211], a[112:115], v[244:247], v[208:211]
TR a[112:113], v1 offset:16384
TR a[114:115], v1 offset:18432
MM v[212:215], a[116:119], v[244:247], v[212:215]
v_add_u32 v2, 0x10000, v2
v_add_u32 v3, 0x10000, v3
MM v[216:219], a[120:123], v[244:247], v[216:219]
TR a[116:117], v2 offset:16384
TR a[118:119], v2 offset:18432
MM v[220:223], a[124:127], v[244:247], v[220:223]
v_exp_f32 v66, v66
MM v[224:227], a[128:131], v[244:247], v[224:227]
v_exp_f32 v67, v67
MM v[228:231], a[132:135], v[244:247], v[228:231]
TR a[120:121], v3 offset:16384
TR a[122:123], v3 offset:18432
MM v[232:235], a[136:139], v[244:247], v[232:235]
v_add_u32 v4, 0x10000, v4
CV v250, v64, v65
MM v[236:239], a[140:143], v[244:247], v[236:239]
TR a[124:125], v4 offset:16384
TR a[126:127], v4 offset:18432
MM a[240:243], a[244:247], v[244:247], a[240:243]
CV v251, v66, v67
MM v[44:47], a[80:83], a[32:35], v[32:35]
TR a[128:129], v1 offset:20480
TR a[130:131], v1 offset:22528
MM v[48:51], a[84:87], a[32:35], v[32:35]
v_exp_f32 v68, v68
MM v[44:47], a[88:91], a[36:39], v[44:47]
TR a[132:133], v2 offset:20480
TR a[134:135], v2 offset:22528
MM v[48:51], a[92:95], a[36:39], v[48:51]
v_exp_f32 v69, v69
MM v[44:47], a[96:99], a[40:43], v[44:47]
TR a[136:137], v3 offset:20480
TR a[138:139], v3 offset:22528
MM v[48:51], a[100:103], a[40:43], v[48:51]
v_exp_f32 v70, v70
MM v[44:47], a[104:107], a[44:47], v[44:47]
TR a[140:141], v4 offset:20480
TR a[142:143], v4 offset:22528
MM v[48:51], a[108:111], a[44:47], v[48:51]
s_waitcnt lgkmcnt(8)
v_exp_f32 v71, v71
MM v[80:83], a[112:115], v[248:251], v[80:83]
CV v252, v68, v69
CV v253, v70, v71
MM v[84:87], a[116:119], v[248:251], v[84:87]
v_exp_f32 v72, v72
MM v[88:91], a[120:123], v[248:251], v[88:91]
v_exp_f32 v73, v73
MM v[92:95], a[124:127], v[248:251], v[92:95]
s_waitcnt lgkmcnt(4)
v_exp_f32 v74, v74
MM v[96:99], a[128:131], v[248:251], v[96:99]
v_exp_f32 v75, v75
MM v[100:103], a[132:135], v[248:251], v[100:103]
s_waitcnt lgkmcnt(2)
CV v254, v72, v73
CV v255, v74, v75
MM v[104:107], a[136:139], v[248:251], v[104:107]
s_waitcnt lgkmcnt(0)
v_exp_f32 v44, v44
MM v[108:111], a[140:143], v[248:251], v[108:111]
v_exp_f32 v45, v45
MM a[224:227], a[244:247], v[248:251], a[224:227]
v_exp_f32 v46, v46
MM v[52:55], a[80:83], a[48:51], v[36:39]
v_exp_f32 v47, v47
MM v[56:59], a[84:87], a[48:51], v[36:39]
CV v240, v44, v45
CV v241, v46, v47
MM v[52:55], a[88:91], a[52:55], v[52:55]
v_exp_f32 v48, v48
MM v[56:59], a[92:95], a[52:55], v[56:59]
v_exp_f32 v49, v49
MM v[52:55], a[96:99], a[56:59], v[52:55]
v_exp_f32 v50, v50
MM v[56:59], a[100:103], a[56:59], v[56:59]
v_exp_f32 v51, v51
MM v[52:55], a[104:107], a[60:63], v[52:55]
CV v242, v48, v49
CV v243, v50, v51
MM v[56:59], a[108:111], a[60:63], v[56:59]
MM v[112:115], a[112:115], v[252:255], v[112:115]
MM v[116:119], a[116:119], v[252:255], v[116:119]
MM v[120:123], a[120:123], v[252:255], v[120:123]
MM v[124:127], a[124:127], v[252:255], v[124:127]
MM v[128:131], a[128:131], v[252:255], v[128:131]
v_exp_f32 v52, v52
MM v[132:135], a[132:135], v[252:255], v[132:135]
v_exp_f32 v53, v53
MM v[136:139], a[136:139], v[252:255], v[136:139]
v_exp_f32 v54, v54
MM v[140:143], a[140:143], v[252:255], v[140:143]
v_exp_f32 v55, v55
MM a[228:231], a[244:247], v[252:255], a[228:231]
s_waitcnt vmcnt(17)
s_barrier
CV v244, v52, v53
MM v[60:63], a[80:83], a[64:67], v[40:43]
ds_read_b64 a[80:81], v5 offset:32768
ds_read_b64 a[82:83], v6 offset:32768
MM v[64:67], a[84:87], a[64:67], v[40:43]
CV v245, v54, v55
MM v[60:63], a[88:91], a[68:71], v[60:63]
ds_read_b64 a[84:85], v5 offset:34816
ds_read_b64 a[86:87], v6 offset:34816
MM v[64:67], a[92:95], a[68:71], v[64:67]
v_exp_f32 v56, v56
MM v[60:63], a[96:99], a[72:75], v[60:63]
ds_read_b64 a[88:89], v7 offset:32768
ds_read_b64 a[90:91], v8 offset:32768
MM v[64:67], a[100:103], a[72:75], v[64:67]
v_exp_f32 v57, v57
MM v[60:63], a[104:107], a[76:79], v[60:63]
ds_read_b64 a[92:93], v7 offset:34816
ds_read_b64 a[94:95], v8 offset:34816
MM v[64:67], a[108:111], a[76:79], v[64:67]
v_exp_f32 v58, v58
MM v[144:147], a[112:115], v[240:243], v[144:147]
ds_read_b64 a[96:97], v5 offset:36864
ds_read_b64 a[98:99], v6 offset:36864
MM v[148:151], a[116:119], v[240:243], v[148:151]
v_exp_f32 v59, v59
MM v[152:155], a[120:123], v[240:243], v[152:155]
ds_read_b64 a[100:101], v5 offset:38912
ds_read_b64 a[102:103], v6 offset:38912
MM v[156:159], a[124:127], v[240:243], v[156:159]
CV v246, v56, v57
CV v247, v58, v59
MM v[160:163], a[128:131], v[240:243], v[160:163]
ds_read_b64 a[104:105], v7 offset:36864
ds_read_b64 a[106:107], v8 offset:36864
MM v[164:167], a[132:135], v[240:243], v[164:167]
v_exp_f32 v60, v60
MM v[168:171], a[136:139], v[240:243], v[168:171]
ds_read_b64 a[108:109], v7 offset:38912
ds_read_b64 a[110:111], v8 offset:38912
MM v[172:175], a[140:143], v[240:243], v[172:175]
v_exp_f32 v61, v61
MM a[232:235], a[244:247], v[240:243], a[232:235]
s_waitcnt lgkmcnt(8)
v_exp_f32 v62, v62
MM v[68:71], a[80:83], a[0:3], v[24:27]
v_exp_f32 v63, v63
MM v[72:75], a[84:87], a[0:3], v[24:27]
CV v248, v60, v61
CV v249, v62, v63
MM v[68:71], a[88:91], a[4:7], v[68:71]
v_exp_f32 v64, v64
MM v[72:75], a[92:95], a[4:7], v[72:75]
s_waitcnt lgkmcnt(2)
v_exp_f32 v65, v65
MM v[68:71], a[96:99], a[8:11], v[68:71]
v_exp_f32 v66, v66
MM v[72:75], a[100:103], a[8:11], v[72:75]
v_exp_f32 v67, v67
MM v[68:71], a[104:107], a[12:15], v[68:71]
s_waitcnt lgkmcnt(0)
CV v250, v64, v65
CV v251, v66, v67
MM v[72:75], a[108:111], a[12:15], v[72:75]
MM v[176:179], a[112:115], v[244:247], v[176:179]
MM v[180:183], a[116:119], v[244:247], v[180:183]
MM v[184:187], a[120:123], v[244:247], v[184:187]
MM v[188:191], a[124:127], v[244:247], v[188:191]
v_exp_f32 v68, v68
MM v[192:195], a[128:131], v[244:247], v[192:195]
v_exp_f32 v69, v69
MM v[196:199], a[132:135], v[244:247], v[196:199]
v_exp_f32 v70, v70
MM v[200:203], a[136:139], v[244:247], v[200:203]
v_exp_f32 v71, v71
MM v[204:207], a[140:143], v[244:247], v[204:207]
CV v252, v68, v69
CV v253, v70, v71
MM a[236:239], a[244:247], v[244:247], a[236:239]
v_exp_f32 v72, v72
MM v[44:47], a[80:83], a[16:19], v[28:31]
v_exp_f32 v73, v73
MM v[48:51], a[84:87], a[16:19], v[28:31]
v_exp_f32 v74, v74
MM v[44:47], a[88:91], a[20:23], v[44:47]
v_exp_f32 v75, v75
MM v[48:51], a[92:95], a[20:23], v[48:51]
CV v254, v72, v73
CV v255, v74, v75
MM v[44:47], a[96:99], a[24:27], v[44:47]
MM v[48:51], a[100:103], a[24:27], v[48:51]
MM v[44:47], a[104:107], a[28:31], v[44:47]
MM v[48:51], a[108:111], a[28:31], v[48:51]
MM v[208:211], a[112:115], v[248:251], v[208:211]
TR a[112:113], v1 offset:49152
TR a[114:115], v1 offset:51200
MM v[212:215], a[116:119], v[248:251], v[212:215]
MM v[216:219], a[120:123], v[248:251], v[216:219]
TR a[116:117], v2 offset:49152
TR a[118:119], v2 offset:51200
MM v[220:223], a[124:127], v[248:251], v[220:223]
v_exp_f32 v44, v44
MM v[224:227], a[128:131], v[248:251], v[224:227]
TR a[120:121], v3 offset:49152
TR a[122:123], v3 offset:51200
MM v[228:231], a[132:135], v[248:251], v[228:231]
v_exp_f32 v45, v45
MM v[232:235], a[136:139], v[248:251], v[232:235]
TR a[124:125], v4 offset:49152
TR a[126:127], v4 offset:51200
MM v[236:239], a[140:143], v[248:251], v[236:239]
v_exp_f32 v46, v46
MM a[240:243], a[244:247], v[248:251], a[240:243]
TR a[128:129], v1 offset:53248
TR a[130:131], v1 offset:55296
MM v[52:55], a[80:83], a[32:35], v[32:35]
v_exp_f32 v47, v47
MM v[56:59], a[84:87], a[32:35], v[32:35]
TR a[132:133], v2 offset:53248
TR a[134:135], v2 offset:55296
MM v[52:55], a[88:91], a[36:39], v[52:55]
CV v240, v44, v45
CV v241, v46, v47
MM v[56:59], a[92:95], a[36:39], v[56:59]
TR a[136:137], v3 offset:53248
TR a[138:139], v3 offset:55296
MM v[52:55], a[96:99], a[40:43], v[52:55]
v_exp_f32 v48, v48
MM v[56:59], a[100:103], a[40:43], v[56:59]
TR a[140:141], v4 offset:53248
TR a[142:143], v4 offset:55296
MM v[52:55], a[104:107], a[44:47], v[52:55]
v_exp_f32 v49, v49
MM v[56:59], a[108:111], a[44:47], v[56:59]
s_waitcnt lgkmcnt(8)
v_exp_f32 v50, v50
MM v[80:83], a[112:115], v[252:255], v[80:83]
v_exp_f32 v51, v51
MM v[84:87], a[116:119], v[252:255], v[84:87]
CV v242, v48, v49
CV v243, v50, v51
MM v[88:91], a[120:123], v[252:255], v[88:91]
v_exp_f32 v52, v52
MM v[92:95], a[124:127], v[252:255], v[92:95]
s_waitcnt lgkmcnt(2)
v_exp_f32 v53, v53
MM v[96:99], a[128:131], v[252:255], v[96:99]
v_exp_f32 v54, v54
MM v[100:103], a[132:135], v[252:255], v[100:103]
v_exp_f32 v55, v55
MM v[104:107], a[136:139], v[252:255], v[104:107]
s_waitcnt lgkmcnt(0)
CV v244, v52, v53
CV v245, v54, v55
MM v[108:111], a[140:143], v[252:255], v[108:111]
v_exp_f32 v56, v56
MM a[224:227], a[244:247], v[252:255], a[224:227]
v_exp_f32 v57, v57
MM v[60:63], a[80:83], a[48:51], v[36:39]
v_exp_f32 v58, v58
MM v[64:67], a[84:87], a[48:51], v[36:39]
v_exp_f32 v59, v59
MM v[60:63], a[88:91], a[52:55], v[60:63]
CV v246, v56, v57
CV v247, v58, v59
MM v[64:67], a[92:95], a[52:55], v[64:67]
MM v[60:63], a[96:99], a[56:59], v[60:63]
MM v[64:67], a[100:103], a[56:59], v[64:67]
MM v[60:63], a[104:107], a[60:63], v[60:63]
MM v[64:67], a[108:111], a[60:63], v[64:67]
MM v[112:115], a[112:115], v[240:243], v[112:115]
MM v[116:119], a[116:119], v[240:243], v[116:119]
MM v[120:123], a[120:123], v[240:243], v[120:123]
MM v[124:127], a[124:127], v[240:243], v[124:127]
MM v[128:131], a[128:131], v[240:243], v[128:131]
MM v[132:135], a[132:135], v[240:243], v[132:135]
MM v[136:139], a[136:139], v[240:243], v[136:139]
v_exp_f32 v60, v60
MM v[140:143], a[140:143], v[240:243], v[140:143]
v_exp_f32 v61, v61
MM a[228:231], a[244:247], v[240:243], a[228:231]
v_exp_f32 v62, v62
MM v[68:71], a[80:83], a[64:67], v[40:43]
v_exp_f32 v63, v63
MM v[72:75], a[84:87], a[64:67], v[40:43]
CV v248, v60, v61
CV v249, v62, v63
MM v[68:71], a[88:91], a[68:71], v[68:71]
v_exp_f32 v64, v64
MM v[72:75], a[92:95], a[68:71], v[72:75]
v_exp_f32 v65, v65
MM v[68:71], a[96:99], a[72:75], v[68:71]
v_exp_f32 v66, v66
MM v[72:75], a[100:103], a[72:75], v[72:75]
v_exp_f32 v67, v67
MM v[68:71], a[104:107], a[76:79], v[68:71]
CV v250, v64, v65
CV v251, v66, v67
MM v[72:75], a[108:111], a[76:79], v[72:75]
MM v[144:147], a[112:115], v[244:247], v[144:147]
MM v[148:151], a[116:119], v[244:247], v[148:151]
MM v[152:155], a[120:123], v[244:247], v[152:155]
MM v[156:159], a[124:127], v[244:247], v[156:159]
MM v[160:163], a[128:131], v[244:247], v[160:163]
v_exp_f32 v68, v68
MM v[164:167], a[132:135], v[244:247], v[164:167]
v_exp_f32 v69, v69
MM v[168:171], a[136:139], v[244:247], v[168:171]
v_exp_f32 v70, v70
MM v[172:175], a[140:143], v[244:247], v[172:175]
v_exp_f32 v71, v71
MM a[232:235], a[244:247], v[244:247], a[232:235]
CV v252, v68, v69
CV v253, v70, v71
MM v[176:179], a[112:115], v[248:251], v[176:179]
v_exp_f32 v72, v72
MM v[180:183], a[116:119], v[248:251], v[180:183]
v_exp_f32 v73, v73
MM v[184:187], a[120:123], v[248:251], v[184:187]
v_exp_f32 v74, v74
MM v[188:191], a[124:127], v[248:251], v[188:191]
v_exp_f32 v75, v75
MM v[192:195], a[128:131], v[248:251], v[192:195]
CV v254, v72, v73
CV v255, v74, v75
MM v[196:199], a[132:135], v[248:251], v[196:199]
MM v[200:203], a[136:139], v[248:251], v[200:203]
MM v[204:207], a[140:143], v[248:251], v[204:207]
MM a[236:239], a[244:247], v[248:251], a[236:239]
MM v[208:211], a[112:115], v[252:255], v[208:211]
MM v[212:215], a[116:119], v[252:255], v[212:215]
MM v[216:219], a[120:123], v[252:255], v[216:219]
MM v[220:223], a[124:127], v[252:255], v[220:223]
MM v[224:227], a[128:131], v[252:255], v[224:227]
MM v[228:231], a[132:135], v[252:255], v[228:231]
MM v[232:235], a[136:139], v[252:255], v[232:235]
MM v[236:239], a[140:143], v[252:255], v[236:239]
MM a[240:243], a[244:247], v[252:255], a[240:243]
v_accvgpr_read_b32 v44, a224
v_accvgpr_read_b32 v46, a228
v_accvgpr_read_b32 v48, a232
v_accvgpr_read_b32 v50, a236
s_nop 3
v_accvgpr_read_b32 v52, a240
v_subrev_u32 v56, 0x2b800000, v44
v_subrev_u32 v57, 0x2b800000, v46
v_subrev_u32 v58, 0x2b800000, v48
v_subrev_u32 v59, 0x2b800000, v50
v_subrev_u32 v60, 0x2b800000, v52
v_max3_u32 v56, v56, v57, v58
v_max3_u32 v56, v56, v59, v60
v_cmp_lt_u32 vcc, 0x28000000, v56
v_rcp_f32 v44, v44
v_rcp_f32 v46, v46
v_rcp_f32 v48, v48
v_rcp_f32 v50, v50
v_rcp_f32 v52, v52
s_cmp_lg_u64 vcc, 0
s_cselect_b32 s40, 1, 0
v_mov_b32 v57, s40
s_lshl_b32 s40, s33, 2
v_add_u32 v58, 0x8000, v79
v_add_u32 v59, s40, v58
ds_write_b32 v59, v57
v_pk_mul_f32 v[80:81], v[80:81], v[44:45] op_sel_hi:[1,0]
v_pk_mul_f32 v[82:83], v[82:83], v[44:45] op_sel_hi:[1,0]
v_pk_mul_f32 v[84:85], v[84:85], v[44:45] op_sel_hi:[1,0]
v_pk_mul_f32 v[86:87], v[86:87], v[44:45] op_sel_hi:[1,0]
CV v80, v80, v81
CV v81, v82, v83
CV v82, v84, v85
CV v83, v86, v87
v_pk_mul_f32 v[88:89], v[88:89], v[44:45] op_sel_hi:[1,0]
v_pk_mul_f32 v[90:91], v[90:91], v[44:45] op_sel_hi:[1,0]
v_pk_mul_f32 v[92:93], v[92:93], v[44:45] op_sel_hi:[1,0]
v_pk_mul_f32 v[94:95], v[94:95], v[44:45] op_sel_hi:[1,0]
CV v84, v88, v89
CV v85, v90, v91
CV v86, v92, v93
CV v87, v94, v95
s_waitcnt lgkmcnt(0)
s_barrier
ds_read_b128 v[60:63], v58
v_pk_mul_f32 v[96:97], v[96:97], v[44:45] op_sel_hi:[1,0]
v_pk_mul_f32 v[98:99], v[98:99], v[44:45] op_sel_hi:[1,0]
v_pk_mul_f32 v[100:101], v[100:101], v[44:45] op_sel_hi:[1,0]
v_pk_mul_f32 v[102:103], v[102:103], v[44:45] op_sel_hi:[1,0]
CV v88, v96, v97
CV v89, v98, v99
CV v90, v100, v101
CV v91, v102, v103
v_pk_mul_f32 v[104:105], v[104:105], v[44:45] op_sel_hi:[1,0]
v_pk_mul_f32 v[106:107], v[106:107], v[44:45] op_sel_hi:[1,0]
v_pk_mul_f32 v[108:109], v[108:109], v[44:45] op_sel_hi:[1,0]
v_pk_mul_f32 v[110:111], v[110:111], v[44:45] op_sel_hi:[1,0]
CV v92, v104, v105
CV v93, v106, v107
CV v94, v108, v109
CV v95, v110, v111
v_pk_mul_f32 v[112:113], v[112:113], v[46:47] op_sel_hi:[1,0]
v_pk_mul_f32 v[114:115], v[114:115], v[46:47] op_sel_hi:[1,0]
v_pk_mul_f32 v[116:117], v[116:117], v[46:47] op_sel_hi:[1,0]
v_pk_mul_f32 v[118:119], v[118:119], v[46:47] op_sel_hi:[1,0]
CV v96, v112, v113
CV v97, v114, v115
CV v98, v116, v117
CV v99, v118, v119
v_pk_mul_f32 v[120:121], v[120:121], v[46:47] op_sel_hi:[1,0]
v_pk_mul_f32 v[122:123], v[122:123], v[46:47] op_sel_hi:[1,0]
v_pk_mul_f32 v[124:125], v[124:125], v[46:47] op_sel_hi:[1,0]
v_pk_mul_f32 v[126:127], v[126:127], v[46:47] op_sel_hi:[1,0]
s_waitcnt lgkmcnt(0)
v_or3_b32 v60, v60, v61, v62
v_or_b32 v60, v60, v63
CV v100, v120, v121
CV v101, v122, v123
v_readfirstlane_b32 s40, v60
CV v102, v124, v125
CV v103, v126, v127
v_pk_mul_f32 v[128:129], v[128:129], v[46:47] op_sel_hi:[1,0]
v_pk_mul_f32 v[130:131], v[130:131], v[46:47] op_sel_hi:[1,0]
s_or_b32 s40, s40, s36
s_cbranch_scc1 L_ZFB1
L_ZRet1:
s_waitcnt vmcnt(5)
s_barrier
s_mov_b32 s49, 0x0
s_mov_b32 s40, 0x0
s_mov_b32 s73, 0x300
v_pk_mul_f32 v[132:133], v[132:133], v[46:47] op_sel_hi:[1,0]
v_pk_mul_f32 v[134:135], v[134:135], v[46:47] op_sel_hi:[1,0]
s_add_u32 m0, s28, 0x18000
s_add_u32 s30, s31, 0x0
v_add_u32 v1, 0x8000, v1
CV v104, v128, v129
CV v105, v130, v131
CV v106, v132, v133
buffer_load_dwordx4 v17, s[20:23], s30 offen lds
CV v107, v134, v135
s_add_u32 m0, s28, 0x19000
s_add_u32 s30, s31, 0x8000
TR v[64:65], v1 offset:32768
v_pk_mul_f32 v[136:137], v[136:137], v[46:47] op_sel_hi:[1,0]
v_pk_mul_f32 v[138:139], v[138:139], v[46:47] op_sel_hi:[1,0]
v_pk_mul_f32 v[140:141], v[140:141], v[46:47] op_sel_hi:[1,0]
buffer_load_dwordx4 v17, s[20:23], s30 offen lds
v_pk_mul_f32 v[142:143], v[142:143], v[46:47] op_sel_hi:[1,0]
s_add_u32 m0, s28, 0x18800
s_add_u32 s30, s31, 0x4000
TR v[66:67], v1 offset:34816
CV v108, v136, v137
CV v109, v138, v139
CV v110, v140, v141
buffer_load_dwordx4 v17, s[20:23], s30 offen lds
CV v111, v142, v143
s_add_u32 m0, s28, 0x19800
s_add_u32 s30, s31, 0xc000
v_add_u32 v2, 0x8000, v2
v_pk_mul_f32 v[144:145], v[144:145], v[48:49] op_sel_hi:[1,0]
v_pk_mul_f32 v[146:147], v[146:147], v[48:49] op_sel_hi:[1,0]
v_pk_mul_f32 v[148:149], v[148:149], v[48:49] op_sel_hi:[1,0]
buffer_load_dwordx4 v17, s[20:23], s30 offen lds
v_pk_mul_f32 v[150:151], v[150:151], v[48:49] op_sel_hi:[1,0]
s_add_u32 m0, s28, 0x1c000
s_add_u32 s30, s31, 0x10000
TR v[68:69], v2 offset:32768
CV v112, v144, v145
CV v113, v146, v147
CV v114, v148, v149
buffer_load_dwordx4 v17, s[20:23], s30 offen lds
CV v115, v150, v151
s_add_u32 m0, s28, 0x1d000
s_add_u32 s30, s31, 0x18000
TR v[70:71], v2 offset:34816
v_pk_mul_f32 v[152:153], v[152:153], v[48:49] op_sel_hi:[1,0]
v_pk_mul_f32 v[154:155], v[154:155], v[48:49] op_sel_hi:[1,0]
v_pk_mul_f32 v[156:157], v[156:157], v[48:49] op_sel_hi:[1,0]
buffer_load_dwordx4 v17, s[20:23], s30 offen lds
v_pk_mul_f32 v[158:159], v[158:159], v[48:49] op_sel_hi:[1,0]
s_add_u32 m0, s28, 0x1c800
s_add_u32 s30, s31, 0x14000
v_add_u32 v3, 0x8000, v3
CV v116, v152, v153
CV v117, v154, v155
CV v118, v156, v157
buffer_load_dwordx4 v17, s[20:23], s30 offen lds
CV v119, v158, v159
s_add_u32 m0, s28, 0x1d800
s_add_u32 s30, s31, 0x1c000
TR v[72:73], v3 offset:32768
v_pk_mul_f32 v[160:161], v[160:161], v[48:49] op_sel_hi:[1,0]
v_pk_mul_f32 v[162:163], v[162:163], v[48:49] op_sel_hi:[1,0]
v_pk_mul_f32 v[164:165], v[164:165], v[48:49] op_sel_hi:[1,0]
buffer_load_dwordx4 v17, s[20:23], s30 offen lds
v_pk_mul_f32 v[166:167], v[166:167], v[48:49] op_sel_hi:[1,0]
TR v[74:75], v3 offset:34816
v_add_u32 v4, 0x8000, v4
CV v120, v160, v161
CV v121, v162, v163
CV v122, v164, v165
CV v123, v166, v167
TR v[76:77], v4 offset:32768
TR v[78:79], v4 offset:34816
v_pk_mul_f32 v[168:169], v[168:169], v[48:49] op_sel_hi:[1,0]
v_pk_mul_f32 v[170:171], v[170:171], v[48:49] op_sel_hi:[1,0]
v_pk_mul_f32 v[172:173], v[172:173], v[48:49] op_sel_hi:[1,0]
v_pk_mul_f32 v[174:175], v[174:175], v[48:49] op_sel_hi:[1,0]
CV v124, v168, v169
CV v125, v170, v171
CV v126, v172, v173
CV v127, v174, v175
v_pk_mul_f32 v[176:177], v[176:177], v[50:51] op_sel_hi:[1,0]
v_pk_mul_f32 v[178:179], v[178:179], v[50:51] op_sel_hi:[1,0]
v_pk_mul_f32 v[180:181], v[180:181], v[50:51] op_sel_hi:[1,0]
v_pk_mul_f32 v[182:183], v[182:183], v[50:51] op_sel_hi:[1,0]
CV v128, v176, v177
CV v129, v178, v179
CV v130, v180, v181
CV v131, v182, v183
v_pk_mul_f32 v[184:185], v[184:185], v[50:51] op_sel_hi:[1,0]
v_pk_mul_f32 v[186:187], v[186:187], v[50:51] op_sel_hi:[1,0]
v_pk_mul_f32 v[188:189], v[188:189], v[50:51] op_sel_hi:[1,0]
v_pk_mul_f32 v[190:191], v[190:191], v[50:51] op_sel_hi:[1,0]
CV v132, v184, v185
CV v133, v186, v187
CV v134, v188, v189
CV v135, v190, v191
v_pk_mul_f32 v[192:193], v[192:193], v[50:51] op_sel_hi:[1,0]
v_pk_mul_f32 v[194:195], v[194:195], v[50:51] op_sel_hi:[1,0]
v_pk_mul_f32 v[196:197], v[196:197], v[50:51] op_sel_hi:[1,0]
v_pk_mul_f32 v[198:199], v[198:199], v[50:51] op_sel_hi:[1,0]
CV v136, v192, v193
CV v137, v194, v195
CV v138, v196, v197
CV v139, v198, v199
v_pk_mul_f32 v[200:201], v[200:201], v[50:51] op_sel_hi:[1,0]
v_pk_mul_f32 v[202:203], v[202:203], v[50:51] op_sel_hi:[1,0]
v_pk_mul_f32 v[204:205], v[204:205], v[50:51] op_sel_hi:[1,0]
v_pk_mul_f32 v[206:207], v[206:207], v[50:51] op_sel_hi:[1,0]
CV v140, v200, v201
CV v141, v202, v203
CV v142, v204, v205
CV v143, v206, v207
v_pk_mul_f32 v[208:209], v[208:209], v[52:53] op_sel_hi:[1,0]
v_pk_mul_f32 v[210:211], v[210:211], v[52:53] op_sel_hi:[1,0]
v_pk_mul_f32 v[212:213], v[212:213], v[52:53] op_sel_hi:[1,0]
v_pk_mul_f32 v[214:215], v[214:215], v[52:53] op_sel_hi:[1,0]
CV v144, v208, v209
CV v145, v210, v211
CV v146, v212, v213
CV v147, v214, v215
v_pk_mul_f32 v[216:217], v[216:217], v[52:53] op_sel_hi:[1,0]
v_pk_mul_f32 v[218:219], v[218:219], v[52:53] op_sel_hi:[1,0]
v_pk_mul_f32 v[220:221], v[220:221], v[52:53] op_sel_hi:[1,0]
v_pk_mul_f32 v[222:223], v[222:223], v[52:53] op_sel_hi:[1,0]
CV v148, v216, v217
CV v149, v218, v219
CV v150, v220, v221
CV v151, v222, v223
v_pk_mul_f32 v[224:225], v[224:225], v[52:53] op_sel_hi:[1,0]
v_pk_mul_f32 v[226:227], v[226:227], v[52:53] op_sel_hi:[1,0]
v_pk_mul_f32 v[228:229], v[228:229], v[52:53] op_sel_hi:[1,0]
v_pk_mul_f32 v[230:231], v[230:231], v[52:53] op_sel_hi:[1,0]
CV v152, v224, v225
CV v153, v226, v227
CV v154, v228, v229
CV v155, v230, v231
v_pk_mul_f32 v[232:233], v[232:233], v[52:53] op_sel_hi:[1,0]
v_pk_mul_f32 v[234:235], v[234:235], v[52:53] op_sel_hi:[1,0]
v_pk_mul_f32 v[236:237], v[236:237], v[52:53] op_sel_hi:[1,0]
v_pk_mul_f32 v[238:239], v[238:239], v[52:53] op_sel_hi:[1,0]
CV v156, v232, v233
CV v157, v234, v235
CV v158, v236, v237
CV v159, v238, v239
s_mov_b32 s44, s86
s_mov_b32 s45, s87
s_mov_b32 s46, 4
s_mov_b32 s47, 0x20000
v_mov_b32 v5, 0
buffer_load_dword v6, v5, s[44:47], 0 offen sc1
s_waitcnt lgkmcnt(0)
MM v[160:163], v[64:67], v[80:83], 0
TR v[240:241], v1 offset:36864
TR v[242:243], v1 offset:38912
MM v[164:167], v[68:71], v[80:83], 0
ds_write_b128 v18, v[80:83] offset:0
MM v[168:171], v[72:75], v[80:83], 0
TR v[244:245], v2 offset:36864
TR v[246:247], v2 offset:38912
MM v[172:175], v[76:79], v[80:83], 0
ds_write_b128 v18, v[84:87] offset:1024
MM v[176:179], v[64:67], v[96:99], 0
TR v[248:249], v3 offset:36864
TR v[250:251], v3 offset:38912
MM v[180:183], v[68:71], v[96:99], 0
ds_write_b128 v18, v[88:91] offset:2048
MM v[184:187], v[72:75], v[96:99], 0
TR v[252:253], v4 offset:36864
TR v[254:255], v4 offset:38912
MM v[188:191], v[76:79], v[96:99], 0
ds_write_b128 v18, v[92:95] offset:3072
MM v[192:195], v[64:67], v[112:115], 0
ds_write_b128 v18, v[96:99] offset:4096
MM v[196:199], v[68:71], v[112:115], 0
ds_write_b128 v18, v[100:103] offset:5120
MM v[200:203], v[72:75], v[112:115], 0
ds_write_b128 v18, v[104:107] offset:6144
MM v[204:207], v[76:79], v[112:115], 0
ds_write_b128 v18, v[108:111] offset:7168
MM v[208:211], v[64:67], v[128:131], 0
ds_write_b128 v18, v[112:115] offset:8192
MM v[212:215], v[68:71], v[128:131], 0
ds_write_b128 v18, v[116:119] offset:9216
MM v[216:219], v[72:75], v[128:131], 0
ds_write_b128 v18, v[120:123] offset:10240
MM v[220:223], v[76:79], v[128:131], 0
ds_write_b128 v18, v[124:127] offset:11264
MM v[224:227], v[64:67], v[144:147], 0
ds_write_b128 v18, v[128:131] offset:12288
MM v[228:231], v[68:71], v[144:147], 0
ds_write_b128 v18, v[132:135] offset:13312
MM v[232:235], v[72:75], v[144:147], 0
ds_write_b128 v18, v[136:139] offset:14336
MM v[236:239], v[76:79], v[144:147], 0
s_waitcnt lgkmcnt(12)
ds_write_b128 v18, v[140:143] offset:15360
MM v[160:163], v[240:243], v[84:87], v[160:163]
s_waitcnt vmcnt(9)
s_barrier
s_mov_b32 s41, 0x80
MM v[164:167], v[244:247], v[84:87], v[164:167]
s_add_u32 m0, s28, 0x20000
s_add_u32 s30, s32, 0x20000
TR v[64:65], v1 offset:49152
MM v[168:171], v[248:251], v[84:87], v[168:171]
buffer_load_dwordx4 v17, s[20:23], s30 offen lds
MM v[172:175], v[252:255], v[84:87], v[172:175]
TR v[66:67], v1 offset:51200
TR v[68:69], v2 offset:49152
MM v[176:179], v[240:243], v[100:103], v[176:179]
s_add_u32 m0, s28, 0x21000
s_add_u32 s30, s32, 0x28000
MM v[180:183], v[244:247], v[100:103], v[180:183]
buffer_load_dwordx4 v17, s[20:23], s30 offen lds
MM v[184:187], v[248:251], v[100:103], v[184:187]
TR v[70:71], v2 offset:51200
TR v[72:73], v3 offset:49152
MM v[188:191], v[252:255], v[100:103], v[188:191]
s_add_u32 m0, s28, 0x20800
s_add_u32 s30, s32, 0x24000
MM v[192:195], v[240:243], v[116:119], v[192:195]
buffer_load_dwordx4 v17, s[20:23], s30 offen lds
MM v[196:199], v[244:247], v[116:119], v[196:199]
TR v[74:75], v3 offset:51200
TR v[76:77], v4 offset:49152
MM v[200:203], v[248:251], v[116:119], v[200:203]
s_add_u32 m0, s28, 0x21800
s_add_u32 s30, s32, 0x2c000
MM v[204:207], v[252:255], v[116:119], v[204:207]
TR v[78:79], v4 offset:51200
MM v[208:211], v[240:243], v[132:135], v[208:211]
buffer_load_dwordx4 v17, s[20:23], s30 offen lds
MM v[212:215], v[244:247], v[132:135], v[212:215]
buffer_load_dword v22, v23, s[20:23], s41 offen
MM v[216:219], v[248:251], v[132:135], v[216:219]
ds_write_b128 v18, v[144:147] offset:16384
MM v[220:223], v[252:255], v[132:135], v[220:223]
ds_write_b128 v18, v[148:151] offset:17408
MM v[224:227], v[240:243], v[148:151], v[224:227]
ds_write_b128 v18, v[152:155] offset:18432
MM v[228:231], v[244:247], v[148:151], v[228:231]
ds_write_b128 v18, v[156:159] offset:19456
MM v[232:235], v[248:251], v[148:151], v[232:235]
MM v[236:239], v[252:255], v[148:151], v[236:239]
s_waitcnt lgkmcnt(4)
MM v[160:163], v[64:67], v[88:91], v[160:163]
TR v[240:241], v1 offset:53248
TR v[242:243], v1 offset:55296
MM v[164:167], v[68:71], v[88:91], v[164:167]
MM v[168:171], v[72:75], v[88:91], v[168:171]
TR v[244:245], v2 offset:53248
TR v[246:247], v2 offset:55296
MM v[172:175], v[76:79], v[88:91], v[172:175]
MM v[176:179], v[64:67], v[104:107], v[176:179]
TR v[248:249], v3 offset:53248
TR v[250:251], v3 offset:55296
MM v[180:183], v[68:71], v[104:107], v[180:183]
MM v[184:187], v[72:75], v[104:107], v[184:187]
TR v[252:253], v4 offset:53248
TR v[254:255], v4 offset:55296
MM v[188:191], v[76:79], v[104:107], v[188:191]
MM v[192:195], v[64:67], v[120:123], v[192:195]
MM v[196:199], v[68:71], v[120:123], v[196:199]
MM v[200:203], v[72:75], v[120:123], v[200:203]
MM v[204:207], v[76:79], v[120:123], v[204:207]
MM v[208:211], v[64:67], v[136:139], v[208:211]
MM v[212:215], v[68:71], v[136:139], v[212:215]
MM v[216:219], v[72:75], v[136:139], v[216:219]
MM v[220:223], v[76:79], v[136:139], v[220:223]
MM v[224:227], v[64:67], v[152:155], v[224:227]
MM v[228:231], v[68:71], v[152:155], v[228:231]
MM v[232:235], v[72:75], v[152:155], v[232:235]
MM v[236:239], v[76:79], v[152:155], v[236:239]
s_waitcnt lgkmcnt(0)
MM v[160:163], v[240:243], v[92:95], v[160:163]
s_waitcnt vmcnt(10)
s_barrier
s_add_u32 m0, s28, 0x24000
MM v[164:167], v[244:247], v[92:95], v[164:167]
s_add_u32 s30, s32, 0x30000
buffer_load_dwordx4 v17, s[20:23], s30 offen lds
MM v[168:171], v[248:251], v[92:95], v[168:171]
TR v[64:65], v1 offset:0
TR v[66:67], v1 offset:2048
MM v[172:175], v[252:255], v[92:95], v[172:175]
s_add_u32 m0, s28, 0x25000
s_add_u32 s30, s32, 0x38000
MM v[176:179], v[240:243], v[108:111], v[176:179]
s_barrier
buffer_load_dwordx4 v17, s[20:23], s30 offen lds
MM v[180:183], v[244:247], v[108:111], v[180:183]
TR v[68:69], v2 offset:0
TR v[70:71], v2 offset:2048
MM v[184:187], v[248:251], v[108:111], v[184:187]
s_add_u32 m0, s28, 0x24800
s_add_u32 s30, s32, 0x34000
MM v[188:191], v[252:255], v[108:111], v[188:191]
buffer_load_dwordx4 v17, s[20:23], s30 offen lds
MM v[192:195], v[240:243], v[124:127], v[192:195]
TR v[72:73], v3 offset:0
TR v[74:75], v3 offset:2048
MM v[196:199], v[244:247], v[124:127], v[196:199]
s_add_u32 m0, s28, 0x25800
s_add_u32 s30, s32, 0x3c000
MM v[200:203], v[248:251], v[124:127], v[200:203]
buffer_load_dwordx4 v17, s[20:23], s30 offen lds
MM v[204:207], v[252:255], v[124:127], v[204:207]
TR v[76:77], v4 offset:0
TR v[78:79], v4 offset:2048
MM v[208:211], v[240:243], v[140:143], v[208:211]
MM v[212:215], v[244:247], v[140:143], v[212:215]
ds_read_b128 a[0:3], v19 offset:0
ds_read_b128 a[16:19], v19 offset:4096
MM v[216:219], v[248:251], v[140:143], v[216:219]
MM v[220:223], v[252:255], v[140:143], v[220:223]
ds_read_b128 a[32:35], v19 offset:8192
ds_read_b128 a[48:51], v19 offset:12288
MM v[224:227], v[240:243], v[156:159], v[224:227]
MM v[228:231], v[244:247], v[156:159], v[228:231]
ds_read_b128 a[64:67], v19 offset:16384
ds_read_b128 a[4:7], v19 offset:1024
MM v[232:235], v[248:251], v[156:159], v[232:235]
MM v[236:239], v[252:255], v[156:159], v[236:239]
s_waitcnt lgkmcnt(6)
ds_read_b128 a[20:23], v19 offset:5120
ds_read_b128 a[36:39], v19 offset:9216
MM v[160:163], v[64:67], a[144:147], v[160:163]
MM v[164:167], v[68:71], a[144:147], v[164:167]
TR v[240:241], v1 offset:4096
TR v[242:243], v1 offset:6144
MM v[168:171], v[72:75], a[144:147], v[168:171]
MM v[172:175], v[76:79], a[144:147], v[172:175]
TR v[244:245], v2 offset:4096
TR v[246:247], v2 offset:6144
MM v[176:179], v[64:67], a[160:163], v[176:179]
MM v[180:183], v[68:71], a[160:163], v[180:183]
TR v[248:249], v3 offset:4096
TR v[250:251], v3 offset:6144
MM v[184:187], v[72:75], a[160:163], v[184:187]
MM v[188:191], v[76:79], a[160:163], v[188:191]
TR v[252:253], v4 offset:4096
TR v[254:255], v4 offset:6144
MM v[192:195], v[64:67], a[176:179], v[192:195]
MM v[196:199], v[68:71], a[176:179], v[196:199]
ds_read_b128 a[52:55], v19 offset:13312
ds_read_b128 a[68:71], v19 offset:17408
MM v[200:203], v[72:75], a[176:179], v[200:203]
MM v[204:207], v[76:79], a[176:179], v[204:207]
ds_read_b128 a[8:11], v19 offset:2048
ds_read_b128 a[24:27], v19 offset:6144
MM v[208:211], v[64:67], a[192:195], v[208:211]
MM v[212:215], v[68:71], a[192:195], v[212:215]
ds_read_b128 a[40:43], v19 offset:10240
ds_read_b128 a[56:59], v19 offset:14336
MM v[216:219], v[72:75], a[192:195], v[216:219]
MM v[220:223], v[76:79], a[192:195], v[220:223]
ds_read_b128 a[72:75], v19 offset:18432
ds_read_b128 a[12:15], v19 offset:3072
MM v[224:227], v[64:67], a[208:211], v[224:227]
MM v[228:231], v[68:71], a[208:211], v[228:231]
ds_read_b128 a[28:31], v19 offset:7168
ds_read_b128 a[44:47], v19 offset:11264
MM v[232:235], v[72:75], a[208:211], v[232:235]
ds_read_b128 a[60:63], v19 offset:15360
ds_read_b128 a[76:79], v19 offset:19456
MM v[236:239], v[76:79], a[208:211], v[236:239]
s_waitcnt lgkmcnt(12)
MM v[160:163], v[240:243], a[148:151], v[160:163]
s_waitcnt vmcnt(10)
s_barrier
s_add_u32 m0, s28, 0x18000
MM v[164:167], v[244:247], a[148:151], v[164:167]
s_add_u32 s30, s32, 0x0
buffer_load_dwordx4 v17, s[20:23], s30 offen lds
MM v[168:171], v[248:251], a[148:151], v[168:171]
TR v[64:65], v1 offset:16384
TR v[66:67], v1 offset:18432
MM v[172:175], v[252:255], a[148:151], v[172:175]
s_add_u32 m0, s28, 0x19000
s_add_u32 s30, s32, 0x8000
MM v[176:179], v[240:243], a[164:167], v[176:179]
s_waitcnt lgkmcnt(2)
s_barrier
TR v[68:69], v2 offset:16384
MM v[180:183], v[244:247], a[164:167], v[180:183]
buffer_load_dwordx4 v17, s[20:23], s30 offen lds
MM v[184:187], v[248:251], a[164:167], v[184:187]
TR v[70:71], v2 offset:18432
TR v[72:73], v3 offset:16384
MM v[188:191], v[252:255], a[164:167], v[188:191]
s_add_u32 m0, s28, 0x18800
s_add_u32 s30, s32, 0x4000
MM v[192:195], v[240:243], a[180:183], v[192:195]
buffer_load_dwordx4 v17, s[20:23], s30 offen lds
MM v[196:199], v[244:247], a[180:183], v[196:199]
TR v[74:75], v3 offset:18432
TR v[76:77], v4 offset:16384
MM v[200:203], v[248:251], a[180:183], v[200:203]
s_add_u32 m0, s28, 0x19800
s_add_u32 s30, s32, 0xc000
MM v[204:207], v[252:255], a[180:183], v[204:207]
TR v[78:79], v4 offset:18432
MM v[208:211], v[240:243], a[196:199], v[208:211]
buffer_load_dwordx4 v17, s[20:23], s30 offen lds
MM v[212:215], v[244:247], a[196:199], v[212:215]
ds_write_b128 v18, a[144:147] offset:0
MM v[216:219], v[248:251], a[196:199], v[216:219]
ds_write_b128 v18, a[148:151] offset:1024
MM v[220:223], v[252:255], a[196:199], v[220:223]
ds_write_b128 v18, a[152:155] offset:2048
MM v[224:227], v[240:243], a[212:215], v[224:227]
ds_write_b128 v18, a[156:159] offset:3072
MM v[228:231], v[244:247], a[212:215], v[228:231]
ds_write_b128 v18, a[160:163] offset:4096
MM v[232:235], v[248:251], a[212:215], v[232:235]
ds_write_b128 v18, a[164:167] offset:5120
MM v[236:239], v[252:255], a[212:215], v[236:239]
s_waitcnt lgkmcnt(6)
ds_write_b128 v18, a[168:171] offset:6144
MM v[160:163], v[64:67], a[152:155], v[160:163]
TR v[240:241], v1 offset:20480
TR v[242:243], v1 offset:22528
MM v[164:167], v[68:71], a[152:155], v[164:167]
ds_write_b128 v18, a[172:175] offset:7168
MM v[168:171], v[72:75], a[152:155], v[168:171]
TR v[244:245], v2 offset:20480
TR v[246:247], v2 offset:22528
MM v[172:175], v[76:79], a[152:155], v[172:175]
ds_write_b128 v18, a[176:179] offset:8192
MM v[176:179], v[64:67], a[168:171], v[176:179]
TR v[248:249], v3 offset:20480
TR v[250:251], v3 offset:22528
MM v[180:183], v[68:71], a[168:171], v[180:183]
ds_write_b128 v18, a[180:183] offset:9216
MM v[184:187], v[72:75], a[168:171], v[184:187]
TR v[252:253], v4 offset:20480
TR v[254:255], v4 offset:22528
MM v[188:191], v[76:79], a[168:171], v[188:191]
ds_write_b128 v18, a[184:187] offset:10240
MM v[192:195], v[64:67], a[184:187], v[192:195]
ds_write_b128 v18, a[188:191] offset:11264
MM v[196:199], v[68:71], a[184:187], v[196:199]
ds_write_b128 v18, a[192:195] offset:12288
MM v[200:203], v[72:75], a[184:187], v[200:203]
ds_write_b128 v18, a[196:199] offset:13312
MM v[204:207], v[76:79], a[184:187], v[204:207]
ds_write_b128 v18, a[200:203] offset:14336
MM v[208:211], v[64:67], a[200:203], v[208:211]
ds_write_b128 v18, a[204:207] offset:15360
MM v[212:215], v[68:71], a[200:203], v[212:215]
ds_write_b128 v18, a[208:211] offset:16384
MM v[216:219], v[72:75], a[200:203], v[216:219]
ds_write_b128 v18, a[212:215] offset:17408
MM v[220:223], v[76:79], a[200:203], v[220:223]
ds_write_b128 v18, a[216:219] offset:18432
MM v[224:227], v[64:67], a[216:219], v[224:227]
ds_write_b128 v18, a[220:223] offset:19456
MM v[228:231], v[68:71], a[216:219], v[228:231]
MM v[232:235], v[72:75], a[216:219], v[232:235]
MM v[236:239], v[76:79], a[216:219], v[236:239]
s_waitcnt lgkmcnt(10)
MM v[160:163], v[240:243], a[156:159], v[160:163]
s_waitcnt vmcnt(9)
s_barrier
s_add_u32 m0, s28, 0x1c000
MM v[164:167], v[244:247], a[156:159], v[164:167]
s_add_u32 s30, s32, 0x10000
buffer_load_dwordx4 v17, s[20:23], s30 offen lds
MM v[168:171], v[248:251], a[156:159], v[168:171]
TR v[64:65], v1 offset:32768
TR v[66:67], v1 offset:34816
MM v[172:175], v[252:255], a[156:159], v[172:175]
s_add_u32 m0, s28, 0x1d000
s_add_u32 s30, s32, 0x18000
MM v[176:179], v[240:243], a[172:175], v[176:179]
buffer_load_dwordx4 v17, s[20:23], s30 offen lds
MM v[180:183], v[244:247], a[172:175], v[180:183]
TR v[68:69], v2 offset:32768
TR v[70:71], v2 offset:34816
MM v[184:187], v[248:251], a[172:175], v[184:187]
s_add_u32 m0, s28, 0x1c800
s_add_u32 s30, s32, 0x14000
MM v[188:191], v[252:255], a[172:175], v[188:191]
buffer_load_dwordx4 v17, s[20:23], s30 offen lds
MM v[192:195], v[240:243], a[188:191], v[192:195]
TR v[72:73], v3 offset:32768
TR v[74:75], v3 offset:34816
MM v[196:199], v[244:247], a[188:191], v[196:199]
s_add_u32 m0, s28, 0x1d800
s_add_u32 s30, s32, 0x1c000
MM v[200:203], v[248:251], a[188:191], v[200:203]
buffer_load_dwordx4 v17, s[20:23], s30 offen lds
MM v[204:207], v[252:255], a[188:191], v[204:207]
TR v[76:77], v4 offset:32768
TR v[78:79], v4 offset:34816
MM v[208:211], v[240:243], a[204:207], v[208:211]
MM v[212:215], v[244:247], a[204:207], v[212:215]
MM v[216:219], v[248:251], a[204:207], v[216:219]
MM v[220:223], v[252:255], a[204:207], v[220:223]
MM v[224:227], v[240:243], a[220:223], v[224:227]
MM v[228:231], v[244:247], a[220:223], v[228:231]
MM v[232:235], v[248:251], a[220:223], v[232:235]
MM v[236:239], v[252:255], a[220:223], v[236:239]
s_waitcnt lgkmcnt(0)
MM v[160:163], v[64:67], a[0:3], v[160:163]
TR v[240:241], v1 offset:36864
TR v[242:243], v1 offset:38912
MM v[164:167], v[68:71], a[0:3], v[164:167]
MM v[168:171], v[72:75], a[0:3], v[168:171]
TR v[244:245], v2 offset:36864
TR v[246:247], v2 offset:38912
MM v[172:175], v[76:79], a[0:3], v[172:175]
MM v[176:179], v[64:67], a[16:19], v[176:179]
TR v[248:249], v3 offset:36864
TR v[250:251], v3 offset:38912
MM v[180:183], v[68:71], a[16:19], v[180:183]
MM v[184:187], v[72:75], a[16:19], v[184:187]
TR v[252:253], v4 offset:36864
TR v[254:255], v4 offset:38912
MM v[188:191], v[76:79], a[16:19], v[188:191]
MM v[192:195], v[64:67], a[32:35], v[192:195]
MM v[196:199], v[68:71], a[32:35], v[196:199]
MM v[200:203], v[72:75], a[32:35], v[200:203]
s_cmp_lg_u32 s33, 0
s_cbranch_scc1 L_Zhso
v_readfirstlane_b32 s37, v6
s_nop 3
s_cmp_ge_u32 s37, 8
s_cbranch_scc1 L_Zhso
s_mov_b32 s40, 0x8000
L_Zhs:
buffer_load_dword v6, v5, s[44:47], 0 offen sc1
s_waitcnt vmcnt(0)
v_readfirstlane_b32 s37, v6
s_nop 3
s_sub_u32 s40, s40, 1
s_cbranch_scc1 L_Zhso
s_cmp_lt_u32 s37, 8
s_cbranch_scc1 L_Zhs
L_Zhso:
v_mov_b32 v6, 1
MM v[204:207], v[76:79], a[32:35], v[204:207]
MM v[208:211], v[64:67], a[48:51], v[208:211]
MM v[212:215], v[68:71], a[48:51], v[212:215]
MM v[216:219], v[72:75], a[48:51], v[216:219]
MM v[220:223], v[76:79], a[48:51], v[220:223]
MM v[224:227], v[64:67], a[64:67], v[224:227]
MM v[228:231], v[68:71], a[64:67], v[228:231]
MM v[232:235], v[72:75], a[64:67], v[232:235]
MM v[236:239], v[76:79], a[64:67], v[236:239]
s_waitcnt lgkmcnt(0)
MM v[160:163], v[240:243], a[4:7], v[160:163]
s_waitcnt vmcnt(8)
s_barrier
s_add_u32 m0, s28, 0x20000
MM v[164:167], v[244:247], a[4:7], v[164:167]
s_add_u32 s30, s31, 0x20080
buffer_load_dwordx4 v17, s[20:23], s30 offen lds
MM v[168:171], v[248:251], a[4:7], v[168:171]
TR v[64:65], v1 offset:49152
TR v[66:67], v1 offset:51200
MM v[172:175], v[252:255], a[4:7], v[172:175]
s_add_u32 m0, s28, 0x21000
s_add_u32 s30, s31, 0x28080
MM v[176:179], v[240:243], a[20:23], v[176:179]
s_barrier
buffer_load_dwordx4 v17, s[20:23], s30 offen lds
MM v[180:183], v[244:247], a[20:23], v[180:183]
TR v[68:69], v2 offset:49152
TR v[70:71], v2 offset:51200
MM v[184:187], v[248:251], a[20:23], v[184:187]
s_add_u32 m0, s28, 0x20800
s_add_u32 s30, s31, 0x24080
MM v[188:191], v[252:255], a[20:23], v[188:191]
buffer_load_dwordx4 v17, s[20:23], s30 offen lds
MM v[192:195], v[240:243], a[36:39], v[192:195]
TR v[72:73], v3 offset:49152
TR v[74:75], v3 offset:51200
MM v[196:199], v[244:247], a[36:39], v[196:199]
s_add_u32 m0, s28, 0x21800
s_add_u32 s30, s31, 0x2c080
MM v[200:203], v[248:251], a[36:39], v[200:203]
buffer_load_dwordx4 v17, s[20:23], s30 offen lds
MM v[204:207], v[252:255], a[36:39], v[204:207]
TR v[76:77], v4 offset:49152
TR v[78:79], v4 offset:51200
MM v[208:211], v[240:243], a[52:55], v[208:211]
MM v[212:215], v[244:247], a[52:55], v[212:215]
ds_read_b128 a[80:83], v19 offset:0
ds_read_b128 a[96:99], v19 offset:4096
MM v[216:219], v[248:251], a[52:55], v[216:219]
MM v[220:223], v[252:255], a[52:55], v[220:223]
ds_read_b128 a[112:115], v19 offset:8192
ds_read_b128 a[128:131], v19 offset:12288
MM v[224:227], v[240:243], a[68:71], v[224:227]
MM v[228:231], v[244:247], a[68:71], v[228:231]
ds_read_b128 a[224:227], v19 offset:16384
ds_read_b128 a[84:87], v19 offset:1024
MM v[232:235], v[248:251], a[68:71], v[232:235]
MM v[236:239], v[252:255], a[68:71], v[236:239]
s_waitcnt lgkmcnt(6)
ds_read_b128 a[100:103], v19 offset:5120
ds_read_b128 a[116:119], v19 offset:9216
MM v[160:163], v[64:67], a[8:11], v[160:163]
MM v[164:167], v[68:71], a[8:11], v[164:167]
TR v[240:241], v1 offset:53248
TR v[242:243], v1 offset:55296
MM v[168:171], v[72:75], a[8:11], v[168:171]
MM v[172:175], v[76:79], a[8:11], v[172:175]
TR v[244:245], v2 offset:53248
TR v[246:247], v2 offset:55296
MM v[176:179], v[64:67], a[24:27], v[176:179]
MM v[180:183], v[68:71], a[24:27], v[180:183]
TR v[248:249], v3 offset:53248
TR v[250:251], v3 offset:55296
MM v[184:187], v[72:75], a[24:27], v[184:187]
MM v[188:191], v[76:79], a[24:27], v[188:191]
TR v[252:253], v4 offset:53248
TR v[254:255], v4 offset:55296
MM v[192:195], v[64:67], a[40:43], v[192:195]
MM v[196:199], v[68:71], a[40:43], v[196:199]
ds_read_b128 a[132:135], v19 offset:13312
ds_read_b128 a[228:231], v19 offset:17408
MM v[200:203], v[72:75], a[40:43], v[200:203]
MM v[204:207], v[76:79], a[40:43], v[204:207]
ds_read_b128 a[88:91], v19 offset:2048
ds_read_b128 a[104:107], v19 offset:6144
MM v[208:211], v[64:67], a[56:59], v[208:211]
MM v[212:215], v[68:71], a[56:59], v[212:215]
ds_read_b128 a[120:123], v19 offset:10240
ds_read_b128 a[136:139], v19 offset:14336
MM v[216:219], v[72:75], a[56:59], v[216:219]
MM v[220:223], v[76:79], a[56:59], v[220:223]
ds_read_b128 a[232:235], v19 offset:18432
ds_read_b128 a[92:95], v19 offset:3072
MM v[224:227], v[64:67], a[72:75], v[224:227]
ds_read_b128 a[108:111], v19 offset:7168
ds_read_b128 a[124:127], v19 offset:11264
ds_read_b128 a[140:143], v19 offset:15360
ds_read_b128 a[236:239], v19 offset:19456
MM v[228:231], v[68:71], a[72:75], v[228:231]
MM v[232:235], v[72:75], a[72:75], v[232:235]
MM v[236:239], v[76:79], a[72:75], v[236:239]
s_waitcnt lgkmcnt(12)
MM v[160:163], v[240:243], a[12:15], v[160:163]
s_waitcnt vmcnt(8)
s_barrier
s_add_u32 m0, s28, 0x24000
MM v[164:167], v[244:247], a[12:15], v[164:167]
s_add_u32 s30, s31, 0x30080
buffer_load_dwordx4 v17, s[20:23], s30 offen lds
MM v[168:171], v[248:251], a[12:15], v[168:171]
TR v[64:65], v1 offset:0
TR v[66:67], v1 offset:2048
MM v[172:175], v[252:255], a[12:15], v[172:175]
s_add_u32 m0, s28, 0x25000
s_add_u32 s30, s31, 0x38080
MM v[176:179], v[240:243], a[28:31], v[176:179]
buffer_load_dwordx4 v17, s[20:23], s30 offen lds
MM v[180:183], v[244:247], a[28:31], v[180:183]
TR v[68:69], v2 offset:0
TR v[70:71], v2 offset:2048
MM v[184:187], v[248:251], a[28:31], v[184:187]
s_add_u32 m0, s28, 0x24800
s_add_u32 s30, s31, 0x34080
MM v[188:191], v[252:255], a[28:31], v[188:191]
buffer_load_dwordx4 v17, s[20:23], s30 offen lds
MM v[192:195], v[240:243], a[44:47], v[192:195]
TR v[72:73], v3 offset:0
TR v[74:75], v3 offset:2048
MM v[196:199], v[244:247], a[44:47], v[196:199]
s_add_u32 m0, s28, 0x25800
s_add_u32 s30, s31, 0x3c080
MM v[200:203], v[248:251], a[44:47], v[200:203]
buffer_load_dwordx4 v17, s[20:23], s30 offen lds
MM v[204:207], v[252:255], a[44:47], v[204:207]
TR v[76:77], v4 offset:0
TR v[78:79], v4 offset:2048
MM v[208:211], v[240:243], a[60:63], v[208:211]
MM v[212:215], v[244:247], a[60:63], v[212:215]
MM v[216:219], v[248:251], a[60:63], v[216:219]
MM v[220:223], v[252:255], a[60:63], v[220:223]
MM v[224:227], v[240:243], a[76:79], v[224:227]
MM v[228:231], v[244:247], a[76:79], v[228:231]
s_waitcnt lgkmcnt(8)
MM v[232:235], v[248:251], a[76:79], v[232:235]
MM v[236:239], v[252:255], a[76:79], v[236:239]
s_mov_b32 s96, 3
L_ZP:
s_add_u32 s31, s31, 0x80
s_add_u32 s32, s32, 0x80
s_add_u32 s49, s49, 0x2800
s_add_u32 s40, s40, 0x80
s_add_u32 s73, s73, 0x80
s_and_b32 s73, s73, 0x3ff
s_waitcnt lgkmcnt(0)
MM v[160:163], v[64:67], a[80:83], v[160:163]
TR v[240:241], v1 offset:4096
TR v[242:243], v1 offset:6144
MM v[164:167], v[68:71], a[80:83], v[164:167]
MM v[168:171], v[72:75], a[80:83], v[168:171]
TR v[244:245], v2 offset:4096
TR v[246:247], v2 offset:6144
MM v[172:175], v[76:79], a[80:83], v[172:175]
MM v[176:179], v[64:67], a[96:99], v[176:179]
TR v[248:249], v3 offset:4096
TR v[250:251], v3 offset:6144
MM v[180:183], v[68:71], a[96:99], v[180:183]
MM v[184:187], v[72:75], a[96:99], v[184:187]
TR v[252:253], v4 offset:4096
TR v[254:255], v4 offset:6144
MM v[188:191], v[76:79], a[96:99], v[188:191]
MM v[192:195], v[64:67], a[112:115], v[192:195]
MM v[196:199], v[68:71], a[112:115], v[196:199]
MM v[200:203], v[72:75], a[112:115], v[200:203]
MM v[204:207], v[76:79], a[112:115], v[204:207]
MM v[208:211], v[64:67], a[128:131], v[208:211]
MM v[212:215], v[68:71], a[128:131], v[212:215]
MM v[216:219], v[72:75], a[128:131], v[216:219]
MM v[220:223], v[76:79], a[128:131], v[220:223]
MM v[224:227], v[64:67], a[224:227], v[224:227]
MM v[228:231], v[68:71], a[224:227], v[228:231]
MM v[232:235], v[72:75], a[224:227], v[232:235]
MM v[236:239], v[76:79], a[224:227], v[236:239]
s_waitcnt lgkmcnt(0)
MM v[160:163], v[240:243], a[84:87], v[160:163]
s_waitcnt vmcnt(8)
s_barrier
s_add_u32 m0, s28, 0x18000
MM v[164:167], v[244:247], a[84:87], v[164:167]
s_add_u32 s30, s31, 0x0
buffer_load_dwordx4 v17, s[20:23], s30 offen lds
MM v[168:171], v[248:251], a[84:87], v[168:171]
TR v[64:65], v1 offset:16384
TR v[66:67], v1 offset:18432
MM v[172:175], v[252:255], a[84:87], v[172:175]
s_add_u32 m0, s28, 0x19000
s_add_u32 s30, s31, 0x8000
MM v[176:179], v[240:243], a[100:103], v[176:179]
buffer_load_dwordx4 v17, s[20:23], s30 offen lds
MM v[180:183], v[244:247], a[100:103], v[180:183]
TR v[68:69], v2 offset:16384
TR v[70:71], v2 offset:18432
MM v[184:187], v[248:251], a[100:103], v[184:187]
s_add_u32 m0, s28, 0x18800
s_add_u32 s30, s31, 0x4000
MM v[188:191], v[252:255], a[100:103], v[188:191]
buffer_load_dwordx4 v17, s[20:23], s30 offen lds
MM v[192:195], v[240:243], a[116:119], v[192:195]
TR v[72:73], v3 offset:16384
TR v[74:75], v3 offset:18432
MM v[196:199], v[244:247], a[116:119], v[196:199]
s_add_u32 m0, s28, 0x19800
s_add_u32 s30, s31, 0xc000
MM v[200:203], v[248:251], a[116:119], v[200:203]
buffer_load_dwordx4 v17, s[20:23], s30 offen lds
MM v[204:207], v[252:255], a[116:119], v[204:207]
TR v[76:77], v4 offset:16384
TR v[78:79], v4 offset:18432
MM v[208:211], v[240:243], a[132:135], v[208:211]
MM v[212:215], v[244:247], a[132:135], v[212:215]
MM v[216:219], v[248:251], a[132:135], v[216:219]
MM v[220:223], v[252:255], a[132:135], v[220:223]
MM v[224:227], v[240:243], a[228:231], v[224:227]
MM v[228:231], v[244:247], a[228:231], v[228:231]
MM v[232:235], v[248:251], a[228:231], v[232:235]
MM v[236:239], v[252:255], a[228:231], v[236:239]
s_waitcnt lgkmcnt(0)
MM v[160:163], v[64:67], a[88:91], v[160:163]
TR v[240:241], v1 offset:20480
TR v[242:243], v1 offset:22528
MM v[164:167], v[68:71], a[88:91], v[164:167]
MM v[168:171], v[72:75], a[88:91], v[168:171]
TR v[244:245], v2 offset:20480
TR v[246:247], v2 offset:22528
MM v[172:175], v[76:79], a[88:91], v[172:175]
MM v[176:179], v[64:67], a[104:107], v[176:179]
TR v[248:249], v3 offset:20480
TR v[250:251], v3 offset:22528
MM v[180:183], v[68:71], a[104:107], v[180:183]
MM v[184:187], v[72:75], a[104:107], v[184:187]
TR v[252:253], v4 offset:20480
TR v[254:255], v4 offset:22528
MM v[188:191], v[76:79], a[104:107], v[188:191]
MM v[192:195], v[64:67], a[120:123], v[192:195]
MM v[196:199], v[68:71], a[120:123], v[196:199]
MM v[200:203], v[72:75], a[120:123], v[200:203]
MM v[204:207], v[76:79], a[120:123], v[204:207]
MM v[208:211], v[64:67], a[136:139], v[208:211]
MM v[212:215], v[68:71], a[136:139], v[212:215]
MM v[216:219], v[72:75], a[136:139], v[216:219]
MM v[220:223], v[76:79], a[136:139], v[220:223]
MM v[224:227], v[64:67], a[232:235], v[224:227]
MM v[228:231], v[68:71], a[232:235], v[228:231]
MM v[232:235], v[72:75], a[232:235], v[232:235]
MM v[236:239], v[76:79], a[232:235], v[236:239]
s_waitcnt lgkmcnt(0)
MM v[160:163], v[240:243], a[92:95], v[160:163]
s_waitcnt vmcnt(8)
s_barrier
s_add_u32 s41, s40, 0x80
MM v[164:167], v[244:247], a[92:95], v[164:167]
s_add_u32 m0, s28, 0x1c000
s_add_u32 s30, s31, 0x10000
TR v[64:65], v1 offset:32768
MM v[168:171], v[248:251], a[92:95], v[168:171]
s_waitcnt vmcnt(8)
s_barrier
s_cmp_lg_u32 s33, 0
s_cbranch_scc1 L_ZsgL
s_mov_b64 exec, 1
buffer_atomic_add v6, v5, s[80:83], s73 offen
s_mov_b64 exec, -1
L_ZsgL:
MM v[172:175], v[252:255], a[92:95], v[172:175]
buffer_load_dwordx4 v17, s[20:23], s30 offen lds
MM v[176:179], v[240:243], a[108:111], v[176:179]
TR v[66:67], v1 offset:34816
TR v[68:69], v2 offset:32768
MM v[180:183], v[244:247], a[108:111], v[180:183]
s_add_u32 m0, s28, 0x1d000
s_add_u32 s30, s31, 0x18000
CV v24, v160, v161
MM v[184:187], v[248:251], a[108:111], v[184:187]
buffer_load_dwordx4 v17, s[20:23], s30 offen lds
MM v[188:191], v[252:255], a[108:111], v[188:191]
TR v[70:71], v2 offset:34816
TR v[72:73], v3 offset:32768
MM v[192:195], v[240:243], a[124:127], v[192:195]
s_add_u32 m0, s28, 0x1c800
s_add_u32 s30, s31, 0x14000
CV v25, v162, v163
MM v[196:199], v[244:247], a[124:127], v[196:199]
buffer_load_dwordx4 v17, s[20:23], s30 offen lds
MM v[200:203], v[248:251], a[124:127], v[200:203]
TR v[74:75], v3 offset:34816
TR v[76:77], v4 offset:32768
MM v[204:207], v[252:255], a[124:127], v[204:207]
s_add_u32 m0, s28, 0x1d800
s_add_u32 s30, s31, 0x1c000
TR v[78:79], v4 offset:34816
MM v[208:211], v[240:243], a[140:143], v[208:211]
buffer_load_dwordx4 v17, s[20:23], s30 offen lds
MM v[212:215], v[244:247], a[140:143], v[212:215]
CV v26, v164, v165
CV v27, v166, v167
MM v[216:219], v[248:251], a[140:143], v[216:219]
CV v28, v168, v169
CV v29, v170, v171
MM v[220:223], v[252:255], a[140:143], v[220:223]
CV v30, v172, v173
CV v31, v174, v175
MM v[224:227], v[240:243], a[236:239], v[224:227]
buffer_load_dword v22, v23, s[20:23], s41 offen
MM v[228:231], v[244:247], a[236:239], v[228:231]
CV v32, v176, v177
CV v33, v178, v179
MM v[232:235], v[248:251], a[236:239], v[232:235]
CV v34, v180, v181
CV v35, v182, v183
MM v[236:239], v[252:255], a[236:239], v[236:239]
s_waitcnt lgkmcnt(0)
CV v36, v184, v185
CV v37, v186, v187
MM v[160:163], v[64:67], v[80:83], 0
TR v[240:241], v1 offset:36864
CV v38, v188, v189
MM v[164:167], v[68:71], v[80:83], 0
TR v[242:243], v1 offset:38912
CV v39, v190, v191
MM v[168:171], v[72:75], v[80:83], 0
TR v[244:245], v2 offset:36864
CV v40, v192, v193
MM v[172:175], v[76:79], v[80:83], 0
TR v[246:247], v2 offset:38912
CV v41, v194, v195
MM v[176:179], v[64:67], v[96:99], 0
TR v[248:249], v3 offset:36864
CV v42, v196, v197
MM v[180:183], v[68:71], v[96:99], 0
TR v[250:251], v3 offset:38912
CV v43, v198, v199
MM v[184:187], v[72:75], v[96:99], 0
TR v[252:253], v4 offset:36864
CV v44, v200, v201
MM v[188:191], v[76:79], v[96:99], 0
TR v[254:255], v4 offset:38912
CV v45, v202, v203
MM v[192:195], v[64:67], v[112:115], 0
CV v46, v204, v205
CV v47, v206, v207
MM v[196:199], v[68:71], v[112:115], 0
CV v48, v208, v209
CV v49, v210, v211
MM v[200:203], v[72:75], v[112:115], 0
CV v50, v212, v213
CV v51, v214, v215
MM v[204:207], v[76:79], v[112:115], 0
CV v52, v216, v217
CV v53, v218, v219
MM v[208:211], v[64:67], v[128:131], 0
CV v54, v220, v221
CV v55, v222, v223
MM v[212:215], v[68:71], v[128:131], 0
CV v56, v224, v225
CV v57, v226, v227
MM v[216:219], v[72:75], v[128:131], 0
CV v58, v228, v229
CV v59, v230, v231
MM v[220:223], v[76:79], v[128:131], 0
CV v60, v232, v233
CV v61, v234, v235
MM v[224:227], v[64:67], v[144:147], 0
CV v62, v236, v237
CV v63, v238, v239
MM v[228:231], v[68:71], v[144:147], 0
MM v[232:235], v[72:75], v[144:147], 0
MM v[236:239], v[76:79], v[144:147], 0
s_waitcnt lgkmcnt(0)
MM v[160:163], v[240:243], v[84:87], v[160:163]
s_waitcnt vmcnt(9)
s_barrier
s_add_u32 s37, s49, 0xffffd800
MM v[164:167], v[244:247], v[84:87], v[164:167]
s_add_u32 m0, s28, 0x20000
s_add_u32 s30, s32, 0x20000
TR v[64:65], v1 offset:49152
MM v[168:171], v[248:251], v[84:87], v[168:171]
buffer_load_dwordx4 v17, s[20:23], s30 offen lds
MM v[172:175], v[252:255], v[84:87], v[172:175]
TR v[66:67], v1 offset:51200
TR v[68:69], v2 offset:49152
MM v[176:179], v[240:243], v[100:103], v[176:179]
s_add_u32 m0, s28, 0x21000
s_add_u32 s30, s32, 0x28000
MM v[180:183], v[244:247], v[100:103], v[180:183]
buffer_load_dwordx4 v17, s[20:23], s30 offen lds
MM v[184:187], v[248:251], v[100:103], v[184:187]
TR v[70:71], v2 offset:51200
TR v[72:73], v3 offset:49152
MM v[188:191], v[252:255], v[100:103], v[188:191]
s_add_u32 m0, s28, 0x20800
s_add_u32 s30, s32, 0x24000
MM v[192:195], v[240:243], v[116:119], v[192:195]
buffer_load_dwordx4 v17, s[20:23], s30 offen lds
MM v[196:199], v[244:247], v[116:119], v[196:199]
TR v[74:75], v3 offset:51200
TR v[76:77], v4 offset:49152
MM v[200:203], v[248:251], v[116:119], v[200:203]
s_add_u32 m0, s28, 0x21800
s_add_u32 s30, s32, 0x2c000
MM v[204:207], v[252:255], v[116:119], v[204:207]
TR v[78:79], v4 offset:51200
MM v[208:211], v[240:243], v[132:135], v[208:211]
buffer_store_dwordx4 v[24:27], v20, s[24:27], s37 offen sc1
MM v[212:215], v[244:247], v[132:135], v[212:215]
buffer_load_dwordx4 v17, s[20:23], s30 offen lds
MM v[216:219], v[248:251], v[132:135], v[216:219]
MM v[220:223], v[252:255], v[132:135], v[220:223]
MM v[224:227], v[240:243], v[148:151], v[224:227]
MM v[228:231], v[244:247], v[148:151], v[228:231]
MM v[232:235], v[248:251], v[148:151], v[232:235]
s_add_u32 s37, s49, 0xffffdc00
buffer_store_dwordx4 v[28:31], v20, s[24:27], s37 offen sc1
MM v[236:239], v[252:255], v[148:151], v[236:239]
s_waitcnt lgkmcnt(0)
MM v[160:163], v[64:67], v[88:91], v[160:163]
TR v[240:241], v1 offset:53248
TR v[242:243], v1 offset:55296
MM v[164:167], v[68:71], v[88:91], v[164:167]
MM v[168:171], v[72:75], v[88:91], v[168:171]
TR v[244:245], v2 offset:53248
TR v[246:247], v2 offset:55296
MM v[172:175], v[76:79], v[88:91], v[172:175]
MM v[176:179], v[64:67], v[104:107], v[176:179]
TR v[248:249], v3 offset:53248
TR v[250:251], v3 offset:55296
MM v[180:183], v[68:71], v[104:107], v[180:183]
MM v[184:187], v[72:75], v[104:107], v[184:187]
TR v[252:253], v4 offset:53248
TR v[254:255], v4 offset:55296
MM v[188:191], v[76:79], v[104:107], v[188:191]
MM v[192:195], v[64:67], v[120:123], v[192:195]
MM v[196:199], v[68:71], v[120:123], v[196:199]
MM v[200:203], v[72:75], v[120:123], v[200:203]
MM v[204:207], v[76:79], v[120:123], v[204:207]
MM v[208:211], v[64:67], v[136:139], v[208:211]
MM v[212:215], v[68:71], v[136:139], v[212:215]
MM v[216:219], v[72:75], v[136:139], v[216:219]
MM v[220:223], v[76:79], v[136:139], v[220:223]
MM v[224:227], v[64:67], v[152:155], v[224:227]
s_add_u32 s37, s49, 0xffffe000
buffer_store_dwordx4 v[32:35], v20, s[24:27], s37 offen sc1
MM v[228:231], v[68:71], v[152:155], v[228:231]
MM v[232:235], v[72:75], v[152:155], v[232:235]
MM v[236:239], v[76:79], v[152:155], v[236:239]
s_waitcnt lgkmcnt(0)
MM v[160:163], v[240:243], v[92:95], v[160:163]
s_waitcnt vmcnt(12)
s_barrier
s_add_u32 m0, s28, 0x24000
MM v[164:167], v[244:247], v[92:95], v[164:167]
s_add_u32 s30, s32, 0x30000
buffer_load_dwordx4 v17, s[20:23], s30 offen lds
MM v[168:171], v[248:251], v[92:95], v[168:171]
TR v[64:65], v1 offset:0
TR v[66:67], v1 offset:2048
MM v[172:175], v[252:255], v[92:95], v[172:175]
s_add_u32 m0, s28, 0x25000
s_add_u32 s30, s32, 0x38000
MM v[176:179], v[240:243], v[108:111], v[176:179]
buffer_load_dwordx4 v17, s[20:23], s30 offen lds
MM v[180:183], v[244:247], v[108:111], v[180:183]
TR v[68:69], v2 offset:0
TR v[70:71], v2 offset:2048
MM v[184:187], v[248:251], v[108:111], v[184:187]
s_add_u32 m0, s28, 0x24800
s_add_u32 s30, s32, 0x34000
MM v[188:191], v[252:255], v[108:111], v[188:191]
buffer_load_dwordx4 v17, s[20:23], s30 offen lds
MM v[192:195], v[240:243], v[124:127], v[192:195]
TR v[72:73], v3 offset:0
TR v[74:75], v3 offset:2048
MM v[196:199], v[244:247], v[124:127], v[196:199]
s_add_u32 m0, s28, 0x25800
s_add_u32 s30, s32, 0x3c000
MM v[200:203], v[248:251], v[124:127], v[200:203]
buffer_load_dwordx4 v17, s[20:23], s30 offen lds
MM v[204:207], v[252:255], v[124:127], v[204:207]
TR v[76:77], v4 offset:0
TR v[78:79], v4 offset:2048
MM v[208:211], v[240:243], v[140:143], v[208:211]
MM v[212:215], v[244:247], v[140:143], v[212:215]
MM v[216:219], v[248:251], v[140:143], v[216:219]
s_add_u32 s37, s49, 0xffffe400
buffer_store_dwordx4 v[36:39], v20, s[24:27], s37 offen sc1
MM v[220:223], v[252:255], v[140:143], v[220:223]
MM v[224:227], v[240:243], v[156:159], v[224:227]
MM v[228:231], v[244:247], v[156:159], v[228:231]
MM v[232:235], v[248:251], v[156:159], v[232:235]
MM v[236:239], v[252:255], v[156:159], v[236:239]
s_waitcnt lgkmcnt(0)
MM v[160:163], v[64:67], a[144:147], v[160:163]
TR v[240:241], v1 offset:4096
TR v[242:243], v1 offset:6144
MM v[164:167], v[68:71], a[144:147], v[164:167]
MM v[168:171], v[72:75], a[144:147], v[168:171]
TR v[244:245], v2 offset:4096
TR v[246:247], v2 offset:6144
MM v[172:175], v[76:79], a[144:147], v[172:175]
MM v[176:179], v[64:67], a[160:163], v[176:179]
TR v[248:249], v3 offset:4096
TR v[250:251], v3 offset:6144
MM v[180:183], v[68:71], a[160:163], v[180:183]
MM v[184:187], v[72:75], a[160:163], v[184:187]
TR v[252:253], v4 offset:4096
TR v[254:255], v4 offset:6144
MM v[188:191], v[76:79], a[160:163], v[188:191]
MM v[192:195], v[64:67], a[176:179], v[192:195]
MM v[196:199], v[68:71], a[176:179], v[196:199]
MM v[200:203], v[72:75], a[176:179], v[200:203]
MM v[204:207], v[76:79], a[176:179], v[204:207]
MM v[208:211], v[64:67], a[192:195], v[208:211]
s_add_u32 s37, s49, 0xffffe800
buffer_store_dwordx4 v[40:43], v20, s[24:27], s37 offen sc1
MM v[212:215], v[68:71], a[192:195], v[212:215]
MM v[216:219], v[72:75], a[192:195], v[216:219]
MM v[220:223], v[76:79], a[192:195], v[220:223]
MM v[224:227], v[64:67], a[208:211], v[224:227]
MM v[228:231], v[68:71], a[208:211], v[228:231]
MM v[232:235], v[72:75], a[208:211], v[232:235]
MM v[236:239], v[76:79], a[208:211], v[236:239]
s_waitcnt lgkmcnt(0)
MM v[160:163], v[240:243], a[148:151], v[160:163]
s_waitcnt vmcnt(14)
s_barrier
s_add_u32 m0, s28, 0x18000
MM v[164:167], v[244:247], a[148:151], v[164:167]
s_add_u32 s30, s32, 0x0
buffer_load_dwordx4 v17, s[20:23], s30 offen lds
MM v[168:171], v[248:251], a[148:151], v[168:171]
TR v[64:65], v1 offset:16384
TR v[66:67], v1 offset:18432
MM v[172:175], v[252:255], a[148:151], v[172:175]
s_add_u32 m0, s28, 0x19000
s_add_u32 s30, s32, 0x8000
MM v[176:179], v[240:243], a[164:167], v[176:179]
buffer_load_dwordx4 v17, s[20:23], s30 offen lds
MM v[180:183], v[244:247], a[164:167], v[180:183]
TR v[68:69], v2 offset:16384
TR v[70:71], v2 offset:18432
MM v[184:187], v[248:251], a[164:167], v[184:187]
s_add_u32 m0, s28, 0x18800
s_add_u32 s30, s32, 0x4000
MM v[188:191], v[252:255], a[164:167], v[188:191]
buffer_load_dwordx4 v17, s[20:23], s30 offen lds
MM v[192:195], v[240:243], a[180:183], v[192:195]
TR v[72:73], v3 offset:16384
TR v[74:75], v3 offset:18432
MM v[196:199], v[244:247], a[180:183], v[196:199]
s_add_u32 m0, s28, 0x19800
s_add_u32 s30, s32, 0xc000
MM v[200:203], v[248:251], a[180:183], v[200:203]
s_add_u32 s37, s49, 0xffffec00
buffer_load_dwordx4 v17, s[20:23], s30 offen lds
MM v[204:207], v[252:255], a[180:183], v[204:207]
TR v[76:77], v4 offset:16384
TR v[78:79], v4 offset:18432
MM v[208:211], v[240:243], a[196:199], v[208:211]
buffer_store_dwordx4 v[44:47], v20, s[24:27], s37 offen sc1
MM v[212:215], v[244:247], a[196:199], v[212:215]
MM v[216:219], v[248:251], a[196:199], v[216:219]
MM v[220:223], v[252:255], a[196:199], v[220:223]
MM v[224:227], v[240:243], a[212:215], v[224:227]
MM v[228:231], v[244:247], a[212:215], v[228:231]
MM v[232:235], v[248:251], a[212:215], v[232:235]
MM v[236:239], v[252:255], a[212:215], v[236:239]
s_waitcnt lgkmcnt(0)
MM v[160:163], v[64:67], a[152:155], v[160:163]
TR v[240:241], v1 offset:20480
TR v[242:243], v1 offset:22528
MM v[164:167], v[68:71], a[152:155], v[164:167]
MM v[168:171], v[72:75], a[152:155], v[168:171]
TR v[244:245], v2 offset:20480
TR v[246:247], v2 offset:22528
MM v[172:175], v[76:79], a[152:155], v[172:175]
MM v[176:179], v[64:67], a[168:171], v[176:179]
TR v[248:249], v3 offset:20480
TR v[250:251], v3 offset:22528
MM v[180:183], v[68:71], a[168:171], v[180:183]
MM v[184:187], v[72:75], a[168:171], v[184:187]
TR v[252:253], v4 offset:20480
TR v[254:255], v4 offset:22528
MM v[188:191], v[76:79], a[168:171], v[188:191]
MM v[192:195], v[64:67], a[184:187], v[192:195]
s_add_u32 s37, s49, 0xfffff000
buffer_store_dwordx4 v[48:51], v20, s[24:27], s37 offen sc1
MM v[196:199], v[68:71], a[184:187], v[196:199]
MM v[200:203], v[72:75], a[184:187], v[200:203]
MM v[204:207], v[76:79], a[184:187], v[204:207]
MM v[208:211], v[64:67], a[200:203], v[208:211]
MM v[212:215], v[68:71], a[200:203], v[212:215]
MM v[216:219], v[72:75], a[200:203], v[216:219]
MM v[220:223], v[76:79], a[200:203], v[220:223]
MM v[224:227], v[64:67], a[216:219], v[224:227]
MM v[228:231], v[68:71], a[216:219], v[228:231]
MM v[232:235], v[72:75], a[216:219], v[232:235]
MM v[236:239], v[76:79], a[216:219], v[236:239]
s_waitcnt lgkmcnt(0)
MM v[160:163], v[240:243], a[156:159], v[160:163]
s_waitcnt vmcnt(14)
s_barrier
s_add_u32 m0, s28, 0x1c000
MM v[164:167], v[244:247], a[156:159], v[164:167]
s_add_u32 s30, s32, 0x10000
buffer_load_dwordx4 v17, s[20:23], s30 offen lds
MM v[168:171], v[248:251], a[156:159], v[168:171]
TR v[64:65], v1 offset:32768
TR v[66:67], v1 offset:34816
MM v[172:175], v[252:255], a[156:159], v[172:175]
s_add_u32 m0, s28, 0x1d000
s_add_u32 s30, s32, 0x18000
MM v[176:179], v[240:243], a[172:175], v[176:179]
buffer_load_dwordx4 v17, s[20:23], s30 offen lds
MM v[180:183], v[244:247], a[172:175], v[180:183]
TR v[68:69], v2 offset:32768
TR v[70:71], v2 offset:34816
MM v[184:187], v[248:251], a[172:175], v[184:187]
s_add_u32 m0, s28, 0x1c800
s_add_u32 s30, s32, 0x14000
s_add_u32 s37, s49, 0xfffff400
MM v[188:191], v[252:255], a[172:175], v[188:191]
buffer_load_dwordx4 v17, s[20:23], s30 offen lds
MM v[192:195], v[240:243], a[188:191], v[192:195]
TR v[72:73], v3 offset:32768
TR v[74:75], v3 offset:34816
MM v[196:199], v[244:247], a[188:191], v[196:199]
s_add_u32 m0, s28, 0x1d800
s_add_u32 s30, s32, 0x1c000
MM v[200:203], v[248:251], a[188:191], v[200:203]
buffer_load_dwordx4 v17, s[20:23], s30 offen lds
MM v[204:207], v[252:255], a[188:191], v[204:207]
TR v[76:77], v4 offset:32768
TR v[78:79], v4 offset:34816
MM v[208:211], v[240:243], a[204:207], v[208:211]
buffer_store_dwordx4 v[52:55], v20, s[24:27], s37 offen sc1
MM v[212:215], v[244:247], a[204:207], v[212:215]
MM v[216:219], v[248:251], a[204:207], v[216:219]
MM v[220:223], v[252:255], a[204:207], v[220:223]
MM v[224:227], v[240:243], a[220:223], v[224:227]
MM v[228:231], v[244:247], a[220:223], v[228:231]
MM v[232:235], v[248:251], a[220:223], v[232:235]
MM v[236:239], v[252:255], a[220:223], v[236:239]
s_waitcnt lgkmcnt(0)
MM v[160:163], v[64:67], a[0:3], v[160:163]
TR v[240:241], v1 offset:36864
TR v[242:243], v1 offset:38912
MM v[164:167], v[68:71], a[0:3], v[164:167]
MM v[168:171], v[72:75], a[0:3], v[168:171]
TR v[244:245], v2 offset:36864
TR v[246:247], v2 offset:38912
MM v[172:175], v[76:79], a[0:3], v[172:175]
MM v[176:179], v[64:67], a[16:19], v[176:179]
s_add_u32 s37, s49, 0xfffff800
TR v[248:249], v3 offset:36864
TR v[250:251], v3 offset:38912
MM v[180:183], v[68:71], a[16:19], v[180:183]
buffer_store_dwordx4 v[56:59], v20, s[24:27], s37 offen sc1
MM v[184:187], v[72:75], a[16:19], v[184:187]
TR v[252:253], v4 offset:36864
TR v[254:255], v4 offset:38912
MM v[188:191], v[76:79], a[16:19], v[188:191]
MM v[192:195], v[64:67], a[32:35], v[192:195]
MM v[196:199], v[68:71], a[32:35], v[196:199]
MM v[200:203], v[72:75], a[32:35], v[200:203]
MM v[204:207], v[76:79], a[32:35], v[204:207]
MM v[208:211], v[64:67], a[48:51], v[208:211]
MM v[212:215], v[68:71], a[48:51], v[212:215]
MM v[216:219], v[72:75], a[48:51], v[216:219]
MM v[220:223], v[76:79], a[48:51], v[220:223]
MM v[224:227], v[64:67], a[64:67], v[224:227]
MM v[228:231], v[68:71], a[64:67], v[228:231]
MM v[232:235], v[72:75], a[64:67], v[232:235]
MM v[236:239], v[76:79], a[64:67], v[236:239]
s_waitcnt lgkmcnt(0)
MM v[160:163], v[240:243], a[4:7], v[160:163]
s_waitcnt vmcnt(14)
s_barrier
s_add_u32 m0, s28, 0x20000
MM v[164:167], v[244:247], a[4:7], v[164:167]
s_add_u32 s30, s31, 0x20080
buffer_load_dwordx4 v17, s[20:23], s30 offen lds
MM v[168:171], v[248:251], a[4:7], v[168:171]
s_add_u32 s37, s49, 0xfffffc00
TR v[64:65], v1 offset:49152
TR v[66:67], v1 offset:51200
MM v[172:175], v[252:255], a[4:7], v[172:175]
s_add_u32 m0, s28, 0x21000
s_add_u32 s30, s31, 0x28080
MM v[176:179], v[240:243], a[20:23], v[176:179]
buffer_load_dwordx4 v17, s[20:23], s30 offen lds
MM v[180:183], v[244:247], a[20:23], v[180:183]
TR v[68:69], v2 offset:49152
TR v[70:71], v2 offset:51200
MM v[184:187], v[248:251], a[20:23], v[184:187]
s_add_u32 m0, s28, 0x20800
s_add_u32 s30, s31, 0x24080
MM v[188:191], v[252:255], a[20:23], v[188:191]
buffer_load_dwordx4 v17, s[20:23], s30 offen lds
MM v[192:195], v[240:243], a[36:39], v[192:195]
TR v[72:73], v3 offset:49152
TR v[74:75], v3 offset:51200
MM v[196:199], v[244:247], a[36:39], v[196:199]
s_add_u32 m0, s28, 0x21800
s_add_u32 s30, s31, 0x2c080
MM v[200:203], v[248:251], a[36:39], v[200:203]
buffer_load_dwordx4 v17, s[20:23], s30 offen lds
MM v[204:207], v[252:255], a[36:39], v[204:207]
TR v[76:77], v4 offset:49152
TR v[78:79], v4 offset:51200
MM v[208:211], v[240:243], a[52:55], v[208:211]
buffer_store_dwordx4 v[60:63], v20, s[24:27], s37 offen sc1
MM v[212:215], v[244:247], a[52:55], v[212:215]
MM v[216:219], v[248:251], a[52:55], v[216:219]
MM v[220:223], v[252:255], a[52:55], v[220:223]
MM v[224:227], v[240:243], a[68:71], v[224:227]
MM v[228:231], v[244:247], a[68:71], v[228:231]
MM v[232:235], v[248:251], a[68:71], v[232:235]
MM v[236:239], v[252:255], a[68:71], v[236:239]
s_waitcnt lgkmcnt(0)
MM v[160:163], v[64:67], a[8:11], v[160:163]
TR v[240:241], v1 offset:53248
TR v[242:243], v1 offset:55296
MM v[164:167], v[68:71], a[8:11], v[164:167]
MM v[168:171], v[72:75], a[8:11], v[168:171]
TR v[244:245], v2 offset:53248
TR v[246:247], v2 offset:55296
MM v[172:175], v[76:79], a[8:11], v[172:175]
MM v[176:179], v[64:67], a[24:27], v[176:179]
TR v[248:249], v3 offset:53248
TR v[250:251], v3 offset:55296
MM v[180:183], v[68:71], a[24:27], v[180:183]
MM v[184:187], v[72:75], a[24:27], v[184:187]
TR v[252:253], v4 offset:53248
TR v[254:255], v4 offset:55296
MM v[188:191], v[76:79], a[24:27], v[188:191]
MM v[192:195], v[64:67], a[40:43], v[192:195]
MM v[196:199], v[68:71], a[40:43], v[196:199]
MM v[200:203], v[72:75], a[40:43], v[200:203]
MM v[204:207], v[76:79], a[40:43], v[204:207]
MM v[208:211], v[64:67], a[56:59], v[208:211]
MM v[212:215], v[68:71], a[56:59], v[212:215]
MM v[216:219], v[72:75], a[56:59], v[216:219]
MM v[220:223], v[76:79], a[56:59], v[220:223]
MM v[224:227], v[64:67], a[72:75], v[224:227]
MM v[228:231], v[68:71], a[72:75], v[228:231]
MM v[232:235], v[72:75], a[72:75], v[232:235]
MM v[236:239], v[76:79], a[72:75], v[236:239]
s_waitcnt lgkmcnt(0)
MM v[160:163], v[240:243], a[12:15], v[160:163]
s_waitcnt vmcnt(13)
s_barrier
s_add_u32 m0, s28, 0x24000
MM v[164:167], v[244:247], a[12:15], v[164:167]
s_add_u32 s30, s31, 0x30080
buffer_load_dwordx4 v17, s[20:23], s30 offen lds
MM v[168:171], v[248:251], a[12:15], v[168:171]
TR v[64:65], v1 offset:0
TR v[66:67], v1 offset:2048
MM v[172:175], v[252:255], a[12:15], v[172:175]
s_add_u32 m0, s28, 0x25000
s_add_u32 s30, s31, 0x38080
MM v[176:179], v[240:243], a[28:31], v[176:179]
buffer_load_dwordx4 v17, s[20:23], s30 offen lds
MM v[180:183], v[244:247], a[28:31], v[180:183]
TR v[68:69], v2 offset:0
TR v[70:71], v2 offset:2048
MM v[184:187], v[248:251], a[28:31], v[184:187]
s_add_u32 m0, s28, 0x24800
s_add_u32 s30, s31, 0x34080
MM v[188:191], v[252:255], a[28:31], v[188:191]
buffer_load_dwordx4 v17, s[20:23], s30 offen lds
MM v[192:195], v[240:243], a[44:47], v[192:195]
TR v[72:73], v3 offset:0
TR v[74:75], v3 offset:2048
MM v[196:199], v[244:247], a[44:47], v[196:199]
s_add_u32 m0, s28, 0x25800
s_add_u32 s30, s31, 0x3c080
MM v[200:203], v[248:251], a[44:47], v[200:203]
buffer_load_dwordx4 v17, s[20:23], s30 offen lds
MM v[204:207], v[252:255], a[44:47], v[204:207]
TR v[76:77], v4 offset:0
TR v[78:79], v4 offset:2048
MM v[208:211], v[240:243], a[60:63], v[208:211]
MM v[212:215], v[244:247], a[60:63], v[212:215]
MM v[216:219], v[248:251], a[60:63], v[216:219]
MM v[220:223], v[252:255], a[60:63], v[220:223]
MM v[224:227], v[240:243], a[76:79], v[224:227]
MM v[228:231], v[244:247], a[76:79], v[228:231]
MM v[232:235], v[248:251], a[76:79], v[232:235]
MM v[236:239], v[252:255], a[76:79], v[236:239]
s_sub_u32 s96, s96, 1
s_cmp_lg_u32 s96, 0
s_cbranch_scc1 L_ZP
s_add_u32 s73, s73, 0x80
s_and_b32 s73, s73, 0x3ff
s_waitcnt lgkmcnt(0)
MM v[160:163], v[64:67], a[80:83], v[160:163]
TR v[240:241], v1 offset:4096
TR v[242:243], v1 offset:6144
MM v[164:167], v[68:71], a[80:83], v[164:167]
MM v[168:171], v[72:75], a[80:83], v[168:171]
TR v[244:245], v2 offset:4096
TR v[246:247], v2 offset:6144
MM v[172:175], v[76:79], a[80:83], v[172:175]
MM v[176:179], v[64:67], a[96:99], v[176:179]
TR v[248:249], v3 offset:4096
TR v[250:251], v3 offset:6144
MM v[180:183], v[68:71], a[96:99], v[180:183]
MM v[184:187], v[72:75], a[96:99], v[184:187]
TR v[252:253], v4 offset:4096
TR v[254:255], v4 offset:6144
MM v[188:191], v[76:79], a[96:99], v[188:191]
MM v[192:195], v[64:67], a[112:115], v[192:195]
MM v[196:199], v[68:71], a[112:115], v[196:199]
MM v[200:203], v[72:75], a[112:115], v[200:203]
MM v[204:207], v[76:79], a[112:115], v[204:207]
MM v[208:211], v[64:67], a[128:131], v[208:211]
MM v[212:215], v[68:71], a[128:131], v[212:215]
MM v[216:219], v[72:75], a[128:131], v[216:219]
MM v[220:223], v[76:79], a[128:131], v[220:223]
MM v[224:227], v[64:67], a[224:227], v[224:227]
MM v[228:231], v[68:71], a[224:227], v[228:231]
MM v[232:235], v[72:75], a[224:227], v[232:235]
MM v[236:239], v[76:79], a[224:227], v[236:239]
s_waitcnt lgkmcnt(0)
MM v[160:163], v[240:243], a[84:87], v[160:163]
s_waitcnt vmcnt(11)
s_barrier
TR v[64:65], v1 offset:16384
MM v[164:167], v[244:247], a[84:87], v[164:167]
TR v[66:67], v1 offset:18432
MM v[168:171], v[248:251], a[84:87], v[168:171]
TR v[68:69], v2 offset:16384
MM v[172:175], v[252:255], a[84:87], v[172:175]
TR v[70:71], v2 offset:18432
MM v[176:179], v[240:243], a[100:103], v[176:179]
TR v[72:73], v3 offset:16384
MM v[180:183], v[244:247], a[100:103], v[180:183]
TR v[74:75], v3 offset:18432
MM v[184:187], v[248:251], a[100:103], v[184:187]
TR v[76:77], v4 offset:16384
MM v[188:191], v[252:255], a[100:103], v[188:191]
TR v[78:79], v4 offset:18432
MM v[192:195], v[240:243], a[116:119], v[192:195]
MM v[196:199], v[244:247], a[116:119], v[196:199]
MM v[200:203], v[248:251], a[116:119], v[200:203]
s_waitcnt vmcnt(4)
s_barrier
s_cmp_lg_u32 s33, 0
s_cbranch_scc1 L_ZsgT
s_mov_b64 exec, 1
buffer_atomic_add v6, v5, s[80:83], s73 offen
s_mov_b64 exec, -1
L_ZsgT:
MM v[204:207], v[252:255], a[116:119], v[204:207]
MM v[208:211], v[240:243], a[132:135], v[208:211]
MM v[212:215], v[244:247], a[132:135], v[212:215]
MM v[216:219], v[248:251], a[132:135], v[216:219]
MM v[220:223], v[252:255], a[132:135], v[220:223]
MM v[224:227], v[240:243], a[228:231], v[224:227]
MM v[228:231], v[244:247], a[228:231], v[228:231]
MM v[232:235], v[248:251], a[228:231], v[232:235]
MM v[236:239], v[252:255], a[228:231], v[236:239]
s_waitcnt lgkmcnt(0)
MM v[160:163], v[64:67], a[88:91], v[160:163]
TR v[240:241], v1 offset:20480
TR v[242:243], v1 offset:22528
MM v[164:167], v[68:71], a[88:91], v[164:167]
MM v[168:171], v[72:75], a[88:91], v[168:171]
TR v[244:245], v2 offset:20480
TR v[246:247], v2 offset:22528
MM v[172:175], v[76:79], a[88:91], v[172:175]
MM v[176:179], v[64:67], a[104:107], v[176:179]
TR v[248:249], v3 offset:20480
TR v[250:251], v3 offset:22528
MM v[180:183], v[68:71], a[104:107], v[180:183]
MM v[184:187], v[72:75], a[104:107], v[184:187]
TR v[252:253], v4 offset:20480
TR v[254:255], v4 offset:22528
MM v[188:191], v[76:79], a[104:107], v[188:191]
MM v[192:195], v[64:67], a[120:123], v[192:195]
MM v[196:199], v[68:71], a[120:123], v[196:199]
MM v[200:203], v[72:75], a[120:123], v[200:203]
MM v[204:207], v[76:79], a[120:123], v[204:207]
MM v[208:211], v[64:67], a[136:139], v[208:211]
MM v[212:215], v[68:71], a[136:139], v[212:215]
MM v[216:219], v[72:75], a[136:139], v[216:219]
MM v[220:223], v[76:79], a[136:139], v[220:223]
MM v[224:227], v[64:67], a[232:235], v[224:227]
MM v[228:231], v[68:71], a[232:235], v[228:231]
MM v[232:235], v[72:75], a[232:235], v[232:235]
MM v[236:239], v[76:79], a[232:235], v[236:239]
s_waitcnt lgkmcnt(0)
MM v[160:163], v[240:243], a[92:95], v[160:163]
MM v[164:167], v[244:247], a[92:95], v[164:167]
MM v[168:171], v[248:251], a[92:95], v[168:171]
MM v[172:175], v[252:255], a[92:95], v[172:175]
MM v[176:179], v[240:243], a[108:111], v[176:179]
MM v[180:183], v[244:247], a[108:111], v[180:183]
MM v[184:187], v[248:251], a[108:111], v[184:187]
MM v[188:191], v[252:255], a[108:111], v[188:191]
MM v[192:195], v[240:243], a[124:127], v[192:195]
MM v[196:199], v[244:247], a[124:127], v[196:199]
MM v[200:203], v[248:251], a[124:127], v[200:203]
MM v[204:207], v[252:255], a[124:127], v[204:207]
MM v[208:211], v[240:243], a[140:143], v[208:211]
MM v[212:215], v[244:247], a[140:143], v[212:215]
MM v[216:219], v[248:251], a[140:143], v[216:219]
MM v[220:223], v[252:255], a[140:143], v[220:223]
MM v[224:227], v[240:243], a[236:239], v[224:227]
MM v[228:231], v[244:247], a[236:239], v[228:231]
MM v[232:235], v[248:251], a[236:239], v[232:235]
MM v[236:239], v[252:255], a[236:239], v[236:239]
s_min_u32 s72, s33, 2
s_lshl_b32 s72, s72, 7
buffer_load_dword v7, v5, s[80:83], s72 offen sc1
CV v24, v160, v161
CV v25, v162, v163
CV v26, v164, v165
CV v27, v166, v167
s_add_u32 s37, s49, 0x0
buffer_store_dwordx4 v[24:27], v20, s[24:27], s37 offen sc1
CV v28, v168, v169
CV v29, v170, v171
CV v30, v172, v173
CV v31, v174, v175
s_add_u32 s37, s49, 0x400
buffer_store_dwordx4 v[28:31], v20, s[24:27], s37 offen sc1
CV v32, v176, v177
CV v33, v178, v179
CV v34, v180, v181
CV v35, v182, v183
s_add_u32 s37, s49, 0x800
buffer_store_dwordx4 v[32:35], v20, s[24:27], s37 offen sc1
CV v36, v184, v185
CV v37, v186, v187
CV v38, v188, v189
CV v39, v190, v191
s_add_u32 s37, s49, 0xc00
buffer_store_dwordx4 v[36:39], v20, s[24:27], s37 offen sc1
CV v40, v192, v193
CV v41, v194, v195
CV v42, v196, v197
CV v43, v198, v199
s_add_u32 s37, s49, 0x1000
buffer_store_dwordx4 v[40:43], v20, s[24:27], s37 offen sc1
CV v44, v200, v201
CV v45, v202, v203
CV v46, v204, v205
CV v47, v206, v207
s_add_u32 s37, s49, 0x1400
buffer_store_dwordx4 v[44:47], v20, s[24:27], s37 offen sc1
CV v48, v208, v209
CV v49, v210, v211
CV v50, v212, v213
CV v51, v214, v215
s_add_u32 s37, s49, 0x1800
buffer_store_dwordx4 v[48:51], v20, s[24:27], s37 offen sc1
CV v52, v216, v217
CV v53, v218, v219
CV v54, v220, v221
CV v55, v222, v223
s_add_u32 s37, s49, 0x1c00
buffer_store_dwordx4 v[52:55], v20, s[24:27], s37 offen sc1
CV v56, v224, v225
CV v57, v226, v227
CV v58, v228, v229
CV v59, v230, v231
s_add_u32 s37, s49, 0x2000
buffer_store_dwordx4 v[56:59], v20, s[24:27], s37 offen sc1
CV v60, v232, v233
CV v61, v234, v235
CV v62, v236, v237
CV v63, v238, v239
s_add_u32 s37, s49, 0x2400
buffer_store_dwordx4 v[60:63], v20, s[24:27], s37 offen sc1
s_cmp_eq_u32 s33, 3
s_cselect_b32 s40, 0, s33
s_cselect_b32 s41, 4, 0
s_mul_i32 s37, s40, 10240
s_mul_i32 s43, s41, 2048
s_add_i32 s37, s37, s43
s_add_i32 s8, s37, s74
s_mul_i32 s37, s40, 128
s_mul_i32 s43, s41, 32768
s_add_i32 s37, s37, s43
s_add_i32 s13, s37, s75
s_cmp_eq_u32 s33, 3
s_cselect_b32 s40, 1, s33
s_cselect_b32 s41, 4, 1
s_mul_i32 s37, s40, 10240
s_mul_i32 s43, s41, 2048
s_add_i32 s37, s37, s43
s_add_i32 s9, s37, s74
s_mul_i32 s37, s40, 128
s_mul_i32 s43, s41, 32768
s_add_i32 s37, s37, s43
s_add_i32 s14, s37, s75
s_cmp_eq_u32 s33, 3
s_cselect_b32 s40, 2, s33
s_cselect_b32 s41, 4, 2
s_mul_i32 s37, s40, 10240
s_mul_i32 s43, s41, 2048
s_add_i32 s37, s37, s43
s_add_i32 s10, s37, s74
s_mul_i32 s37, s40, 128
s_mul_i32 s43, s41, 32768
s_add_i32 s37, s37, s43
s_add_i32 s15, s37, s75
s_cmp_eq_u32 s33, 3
s_cselect_b32 s40, 3, s33
s_cselect_b32 s41, 3, 3
s_mul_i32 s37, s40, 10240
s_mul_i32 s43, s41, 2048
s_add_i32 s37, s37, s43
s_add_i32 s11, s37, s74
s_mul_i32 s37, s40, 128
s_mul_i32 s43, s41, 32768
s_add_i32 s37, s37, s43
s_add_i32 s16, s37, s75
s_cmp_eq_u32 s33, 3
s_mov_b32 s40, 3
s_cselect_b32 s41, 4, s33
s_mul_i32 s37, s40, 10240
s_mul_i32 s43, s41, 2048
s_add_i32 s37, s37, s43
s_add_i32 s12, s37, s74
s_mul_i32 s37, s40, 128
s_mul_i32 s43, s41, 32768
s_add_i32 s37, s37, s43
s_add_i32 s17, s37, s75
v_accvgpr_read_b32 v1, a252
v_readfirstlane_b32 s41, v0
v_readfirstlane_b32 s43, v1
v_bfe_u32 v2, v20, 4, 4
v_lshlrev_b32 v2, 11, v2
v_lshrrev_b32 v3, 8, v20
v_lshl_add_u32 v2, v3, 4, v2
s_mov_b32 s4, s84
s_mov_b32 s5, s85
s_mov_b32 s6, 5242880
s_mov_b32 s7, 0x20000
s_mov_b32 s46, 0xffff0000
s_mov_b32 s73, 0x180
s_waitcnt vmcnt(10)
v_readfirstlane_b32 s37, v7
s_nop 3
s_sub_u32 s37, s37, s41
s_cmp_lt_u32 s37, 8
s_cbranch_scc1 L_Zrslow
s_add_u32 s37, s8, 0x0
buffer_load_dwordx4 v[80:83], v20, s[76:79], s37 offen sc1
s_add_u32 s37, s8, 0x28000
buffer_load_dwordx4 v[84:87], v20, s[76:79], s37 offen sc1
s_add_u32 s37, s8, 0x50000
buffer_load_dwordx4 v[88:91], v20, s[76:79], s37 offen sc1
s_add_u32 s37, s8, 0x78000
buffer_load_dwordx4 v[92:95], v20, s[76:79], s37 offen sc1
s_add_u32 s37, s8, 0xa0000
buffer_load_dwordx4 v[96:99], v20, s[76:79], s37 offen sc1
s_add_u32 s37, s8, 0xc8000
buffer_load_dwordx4 v[100:103], v20, s[76:79], s37 offen sc1
s_add_u32 s37, s8, 0xf0000
buffer_load_dwordx4 v[104:107], v20, s[76:79], s37 offen sc1
s_add_u32 s37, s8, 0x118000
buffer_load_dwordx4 v[108:111], v20, s[76:79], s37 offen sc1
s_add_u32 s37, s9, 0x0
buffer_load_dwordx4 v[112:115], v20, s[76:79], s37 offen sc1
s_add_u32 s37, s9, 0x28000
buffer_load_dwordx4 v[116:119], v20, s[76:79], s37 offen sc1
s_waitcnt vmcnt(10)
s_barrier
s_cmp_lg_u32 s33, 0
s_cbranch_scc1 L_ZsgE1
s_mov_b64 exec, 1
buffer_atomic_add v6, v5, s[80:83], s73 offen
s_mov_b64 exec, -1
L_ZsgE1:
s_branch L_Zrest
L_Zrslow:
s_waitcnt vmcnt(0)
s_barrier
s_cmp_lg_u32 s33, 0
s_cbranch_scc1 L_ZsgE2
s_mov_b64 exec, 1
buffer_atomic_add v6, v5, s[80:83], s73 offen
s_mov_b64 exec, -1
L_ZsgE2:
s_mov_b32 s40, 0x8000
L_ZrA:
buffer_load_dword v25, v5, s[80:83], s72 offen sc1
s_waitcnt vmcnt(0)
v_readfirstlane_b32 s37, v25
s_nop 3
s_sub_u32 s40, s40, 1
s_cbranch_scc1 L_ZrAo
s_sub_u32 s37, s37, s41
s_cmp_lt_u32 s37, 8
s_cbranch_scc1 L_ZrA
L_ZrAo:
s_add_u32 s37, s8, 0x0
buffer_load_dwordx4 v[80:83], v20, s[76:79], s37 offen sc1
s_add_u32 s37, s8, 0x28000
buffer_load_dwordx4 v[84:87], v20, s[76:79], s37 offen sc1
s_add_u32 s37, s8, 0x50000
buffer_load_dwordx4 v[88:91], v20, s[76:79], s37 offen sc1
s_add_u32 s37, s8, 0x78000
buffer_load_dwordx4 v[92:95], v20, s[76:79], s37 offen sc1
s_add_u32 s37, s8, 0xa0000
buffer_load_dwordx4 v[96:99], v20, s[76:79], s37 offen sc1
s_add_u32 s37, s8, 0xc8000
buffer_load_dwordx4 v[100:103], v20, s[76:79], s37 offen sc1
s_add_u32 s37, s8, 0xf0000
buffer_load_dwordx4 v[104:107], v20, s[76:79], s37 offen sc1
s_add_u32 s37, s8, 0x118000
buffer_load_dwordx4 v[108:111], v20, s[76:79], s37 offen sc1
s_add_u32 s37, s9, 0x0
buffer_load_dwordx4 v[112:115], v20, s[76:79], s37 offen sc1
s_add_u32 s37, s9, 0x28000
buffer_load_dwordx4 v[116:119], v20, s[76:79], s37 offen sc1
L_Zrest:
s_add_u32 s37, s9, 0x50000
buffer_load_dwordx4 v[120:123], v20, s[76:79], s37 offen sc1
s_add_u32 s37, s9, 0x78000
buffer_load_dwordx4 v[124:127], v20, s[76:79], s37 offen sc1
s_add_u32 s37, s9, 0xa0000
buffer_load_dwordx4 v[128:131], v20, s[76:79], s37 offen sc1
s_add_u32 s37, s9, 0xc8000
buffer_load_dwordx4 v[132:135], v20, s[76:79], s37 offen sc1
s_add_u32 s37, s9, 0xf0000
buffer_load_dwordx4 v[136:139], v20, s[76:79], s37 offen sc1
s_add_u32 s37, s9, 0x118000
buffer_load_dwordx4 v[140:143], v20, s[76:79], s37 offen sc1
s_add_u32 s37, s10, 0x0
buffer_load_dwordx4 v[144:147], v20, s[76:79], s37 offen sc1
s_add_u32 s37, s10, 0x28000
buffer_load_dwordx4 v[148:151], v20, s[76:79], s37 offen sc1
s_add_u32 s37, s10, 0x50000
buffer_load_dwordx4 v[152:155], v20, s[76:79], s37 offen sc1
s_add_u32 s37, s10, 0x78000
buffer_load_dwordx4 v[156:159], v20, s[76:79], s37 offen sc1
s_add_u32 s37, s10, 0xa0000
buffer_load_dwordx4 v[160:163], v20, s[76:79], s37 offen sc1
s_add_u32 s37, s10, 0xc8000
buffer_load_dwordx4 v[164:167], v20, s[76:79], s37 offen sc1
s_add_u32 s37, s10, 0xf0000
buffer_load_dwordx4 v[168:171], v20, s[76:79], s37 offen sc1
s_add_u32 s37, s10, 0x118000
buffer_load_dwordx4 v[172:175], v20, s[76:79], s37 offen sc1
s_cmp_eq_u32 s33, 3
s_cbranch_scc1 L_Zrw3
s_add_u32 s37, s11, 0x0
buffer_load_dwordx4 v[176:179], v20, s[76:79], s37 offen sc1
s_add_u32 s37, s11, 0x28000
buffer_load_dwordx4 v[180:183], v20, s[76:79], s37 offen sc1
s_add_u32 s37, s11, 0x50000
buffer_load_dwordx4 v[184:187], v20, s[76:79], s37 offen sc1
s_add_u32 s37, s11, 0x78000
buffer_load_dwordx4 v[188:191], v20, s[76:79], s37 offen sc1
s_add_u32 s37, s11, 0xa0000
buffer_load_dwordx4 v[192:195], v20, s[76:79], s37 offen sc1
s_add_u32 s37, s11, 0xc8000
buffer_load_dwordx4 v[196:199], v20, s[76:79], s37 offen sc1
s_add_u32 s37, s11, 0xf0000
buffer_load_dwordx4 v[200:203], v20, s[76:79], s37 offen sc1
s_add_u32 s37, s11, 0x118000
buffer_load_dwordx4 v[204:207], v20, s[76:79], s37 offen sc1
L_Zrw3:
buffer_load_dword v62, v5, s[80:83], s73 offen sc1
s_waitcnt vmcnt(24)
v_lshlrev_b32 v24, 16, v80
v_and_b32 v25, s46, v80
v_lshlrev_b32 v26, 16, v81
v_and_b32 v27, s46, v81
v_lshlrev_b32 v28, 16, v82
v_and_b32 v29, s46, v82
v_lshlrev_b32 v30, 16, v83
v_and_b32 v31, s46, v83
s_waitcnt vmcnt(23)
v_lshlrev_b32 v60, 16, v84
v_and_b32 v61, s46, v84
v_pk_add_f32 v[24:25], v[24:25], v[60:61]
v_lshlrev_b32 v60, 16, v85
v_and_b32 v61, s46, v85
v_pk_add_f32 v[26:27], v[26:27], v[60:61]
v_lshlrev_b32 v60, 16, v86
v_and_b32 v61, s46, v86
v_pk_add_f32 v[28:29], v[28:29], v[60:61]
v_lshlrev_b32 v60, 16, v87
v_and_b32 v61, s46, v87
v_pk_add_f32 v[30:31], v[30:31], v[60:61]
s_waitcnt vmcnt(22)
v_lshlrev_b32 v60, 16, v88
v_and_b32 v61, s46, v88
v_pk_add_f32 v[24:25], v[24:25], v[60:61]
v_lshlrev_b32 v60, 16, v89
v_and_b32 v61, s46, v89
v_pk_add_f32 v[26:27], v[26:27], v[60:61]
v_lshlrev_b32 v60, 16, v90
v_and_b32 v61, s46, v90
v_pk_add_f32 v[28:29], v[28:29], v[60:61]
v_lshlrev_b32 v60, 16, v91
v_and_b32 v61, s46, v91
v_pk_add_f32 v[30:31], v[30:31], v[60:61]
s_waitcnt vmcnt(21)
v_lshlrev_b32 v60, 16, v92
v_and_b32 v61, s46, v92
v_pk_add_f32 v[24:25], v[24:25], v[60:61]
v_lshlrev_b32 v60, 16, v93
v_and_b32 v61, s46, v93
v_pk_add_f32 v[26:27], v[26:27], v[60:61]
v_lshlrev_b32 v60, 16, v94
v_and_b32 v61, s46, v94
v_pk_add_f32 v[28:29], v[28:29], v[60:61]
v_lshlrev_b32 v60, 16, v95
v_and_b32 v61, s46, v95
v_pk_add_f32 v[30:31], v[30:31], v[60:61]
s_waitcnt vmcnt(20)
v_lshlrev_b32 v60, 16, v96
v_and_b32 v61, s46, v96
v_pk_add_f32 v[24:25], v[24:25], v[60:61]
v_lshlrev_b32 v60, 16, v97
v_and_b32 v61, s46, v97
v_pk_add_f32 v[26:27], v[26:27], v[60:61]
v_lshlrev_b32 v60, 16, v98
v_and_b32 v61, s46, v98
v_pk_add_f32 v[28:29], v[28:29], v[60:61]
v_lshlrev_b32 v60, 16, v99
v_and_b32 v61, s46, v99
v_pk_add_f32 v[30:31], v[30:31], v[60:61]
s_waitcnt vmcnt(19)
v_lshlrev_b32 v60, 16, v100
v_and_b32 v61, s46, v100
v_pk_add_f32 v[24:25], v[24:25], v[60:61]
v_lshlrev_b32 v60, 16, v101
v_and_b32 v61, s46, v101
v_pk_add_f32 v[26:27], v[26:27], v[60:61]
v_lshlrev_b32 v60, 16, v102
v_and_b32 v61, s46, v102
v_pk_add_f32 v[28:29], v[28:29], v[60:61]
v_lshlrev_b32 v60, 16, v103
v_and_b32 v61, s46, v103
v_pk_add_f32 v[30:31], v[30:31], v[60:61]
s_waitcnt vmcnt(18)
v_lshlrev_b32 v60, 16, v104
v_and_b32 v61, s46, v104
v_pk_add_f32 v[24:25], v[24:25], v[60:61]
v_lshlrev_b32 v60, 16, v105
v_and_b32 v61, s46, v105
v_pk_add_f32 v[26:27], v[26:27], v[60:61]
v_lshlrev_b32 v60, 16, v106
v_and_b32 v61, s46, v106
v_pk_add_f32 v[28:29], v[28:29], v[60:61]
v_lshlrev_b32 v60, 16, v107
v_and_b32 v61, s46, v107
v_pk_add_f32 v[30:31], v[30:31], v[60:61]
s_waitcnt vmcnt(17)
v_lshlrev_b32 v60, 16, v108
v_and_b32 v61, s46, v108
v_pk_add_f32 v[24:25], v[24:25], v[60:61]
v_lshlrev_b32 v60, 16, v109
v_and_b32 v61, s46, v109
v_pk_add_f32 v[26:27], v[26:27], v[60:61]
v_lshlrev_b32 v60, 16, v110
v_and_b32 v61, s46, v110
v_pk_add_f32 v[28:29], v[28:29], v[60:61]
v_lshlrev_b32 v60, 16, v111
v_and_b32 v61, s46, v111
v_pk_add_f32 v[30:31], v[30:31], v[60:61]
CV v32, v24, v25
CV v33, v26, v27
CV v34, v28, v29
CV v35, v30, v31
s_nop 0
v_permlane32_swap_b32 v32, v34
v_permlane32_swap_b32 v33, v35
s_nop 0
v_permlane16_swap_b32 v32, v34
v_permlane16_swap_b32 v33, v35
buffer_store_dwordx4 v[32:35], v2, s[4:7], s13 offen
s_waitcnt vmcnt(17)
v_lshlrev_b32 v40, 16, v112
v_and_b32 v41, s46, v112
v_lshlrev_b32 v42, 16, v113
v_and_b32 v43, s46, v113
v_lshlrev_b32 v44, 16, v114
v_and_b32 v45, s46, v114
v_lshlrev_b32 v46, 16, v115
v_and_b32 v47, s46, v115
s_waitcnt vmcnt(16)
v_lshlrev_b32 v60, 16, v116
v_and_b32 v61, s46, v116
v_pk_add_f32 v[40:41], v[40:41], v[60:61]
v_lshlrev_b32 v60, 16, v117
v_and_b32 v61, s46, v117
v_pk_add_f32 v[42:43], v[42:43], v[60:61]
v_lshlrev_b32 v60, 16, v118
v_and_b32 v61, s46, v118
v_pk_add_f32 v[44:45], v[44:45], v[60:61]
v_lshlrev_b32 v60, 16, v119
v_and_b32 v61, s46, v119
v_pk_add_f32 v[46:47], v[46:47], v[60:61]
s_waitcnt vmcnt(15)
v_lshlrev_b32 v60, 16, v120
v_and_b32 v61, s46, v120
v_pk_add_f32 v[40:41], v[40:41], v[60:61]
v_lshlrev_b32 v60, 16, v121
v_and_b32 v61, s46, v121
v_pk_add_f32 v[42:43], v[42:43], v[60:61]
v_lshlrev_b32 v60, 16, v122
v_and_b32 v61, s46, v122
v_pk_add_f32 v[44:45], v[44:45], v[60:61]
v_lshlrev_b32 v60, 16, v123
v_and_b32 v61, s46, v123
v_pk_add_f32 v[46:47], v[46:47], v[60:61]
s_waitcnt vmcnt(14)
v_lshlrev_b32 v60, 16, v124
v_and_b32 v61, s46, v124
v_pk_add_f32 v[40:41], v[40:41], v[60:61]
v_lshlrev_b32 v60, 16, v125
v_and_b32 v61, s46, v125
v_pk_add_f32 v[42:43], v[42:43], v[60:61]
v_lshlrev_b32 v60, 16, v126
v_and_b32 v61, s46, v126
v_pk_add_f32 v[44:45], v[44:45], v[60:61]
v_lshlrev_b32 v60, 16, v127
v_and_b32 v61, s46, v127
v_pk_add_f32 v[46:47], v[46:47], v[60:61]
s_waitcnt vmcnt(13)
v_lshlrev_b32 v60, 16, v128
v_and_b32 v61, s46, v128
v_pk_add_f32 v[40:41], v[40:41], v[60:61]
v_lshlrev_b32 v60, 16, v129
v_and_b32 v61, s46, v129
v_pk_add_f32 v[42:43], v[42:43], v[60:61]
v_lshlrev_b32 v60, 16, v130
v_and_b32 v61, s46, v130
v_pk_add_f32 v[44:45], v[44:45], v[60:61]
v_lshlrev_b32 v60, 16, v131
v_and_b32 v61, s46, v131
v_pk_add_f32 v[46:47], v[46:47], v[60:61]
s_waitcnt vmcnt(12)
v_lshlrev_b32 v60, 16, v132
v_and_b32 v61, s46, v132
v_pk_add_f32 v[40:41], v[40:41], v[60:61]
v_lshlrev_b32 v60, 16, v133
v_and_b32 v61, s46, v133
v_pk_add_f32 v[42:43], v[42:43], v[60:61]
v_lshlrev_b32 v60, 16, v134
v_and_b32 v61, s46, v134
v_pk_add_f32 v[44:45], v[44:45], v[60:61]
v_lshlrev_b32 v60, 16, v135
v_and_b32 v61, s46, v135
v_pk_add_f32 v[46:47], v[46:47], v[60:61]
s_waitcnt vmcnt(11)
v_lshlrev_b32 v60, 16, v136
v_and_b32 v61, s46, v136
v_pk_add_f32 v[40:41], v[40:41], v[60:61]
v_lshlrev_b32 v60, 16, v137
v_and_b32 v61, s46, v137
v_pk_add_f32 v[42:43], v[42:43], v[60:61]
v_lshlrev_b32 v60, 16, v138
v_and_b32 v61, s46, v138
v_pk_add_f32 v[44:45], v[44:45], v[60:61]
v_lshlrev_b32 v60, 16, v139
v_and_b32 v61, s46, v139
v_pk_add_f32 v[46:47], v[46:47], v[60:61]
s_waitcnt vmcnt(10)
v_lshlrev_b32 v60, 16, v140
v_and_b32 v61, s46, v140
v_pk_add_f32 v[40:41], v[40:41], v[60:61]
v_lshlrev_b32 v60, 16, v141
v_and_b32 v61, s46, v141
v_pk_add_f32 v[42:43], v[42:43], v[60:61]
v_lshlrev_b32 v60, 16, v142
v_and_b32 v61, s46, v142
v_pk_add_f32 v[44:45], v[44:45], v[60:61]
v_lshlrev_b32 v60, 16, v143
v_and_b32 v61, s46, v143
v_pk_add_f32 v[46:47], v[46:47], v[60:61]
CV v48, v40, v41
CV v49, v42, v43
CV v50, v44, v45
CV v51, v46, v47
s_nop 0
v_permlane32_swap_b32 v48, v50
v_permlane32_swap_b32 v49, v51
s_nop 0
v_permlane16_swap_b32 v48, v50
v_permlane16_swap_b32 v49, v51
buffer_store_dwordx4 v[48:51], v2, s[4:7], s14 offen
s_waitcnt vmcnt(2)
v_readfirstlane_b32 s37, v62
s_nop 3
s_sub_u32 s37, s37, s43
s_cmp_ge_u32 s37, 8
s_cbranch_scc1 L_ZrBo
s_mov_b32 s40, 0x8000
L_ZrB:
buffer_load_dword v62, v5, s[80:83], s73 offen sc1
s_waitcnt vmcnt(0)
v_readfirstlane_b32 s37, v62
s_nop 3
s_sub_u32 s40, s40, 1
s_cbranch_scc1 L_ZrBo
s_sub_u32 s37, s37, s43
s_cmp_lt_u32 s37, 8
s_cbranch_scc1 L_ZrB
L_ZrBo:
s_cmp_lg_u32 s33, 3
s_cbranch_scc1 L_Zrn3
s_add_u32 s37, s11, 0x0
buffer_load_dwordx4 v[176:179], v20, s[76:79], s37 offen sc1
s_add_u32 s37, s11, 0x28000
buffer_load_dwordx4 v[180:183], v20, s[76:79], s37 offen sc1
s_add_u32 s37, s11, 0x50000
buffer_load_dwordx4 v[184:187], v20, s[76:79], s37 offen sc1
s_add_u32 s37, s11, 0x78000
buffer_load_dwordx4 v[188:191], v20, s[76:79], s37 offen sc1
s_add_u32 s37, s11, 0xa0000
buffer_load_dwordx4 v[192:195], v20, s[76:79], s37 offen sc1
s_add_u32 s37, s11, 0xc8000
buffer_load_dwordx4 v[196:199], v20, s[76:79], s37 offen sc1
s_add_u32 s37, s11, 0xf0000
buffer_load_dwordx4 v[200:203], v20, s[76:79], s37 offen sc1
s_add_u32 s37, s11, 0x118000
buffer_load_dwordx4 v[204:207], v20, s[76:79], s37 offen sc1
L_Zrn3:
s_add_u32 s37, s12, 0x0
buffer_load_dwordx4 v[208:211], v20, s[76:79], s37 offen sc1
s_add_u32 s37, s12, 0x28000
buffer_load_dwordx4 v[212:215], v20, s[76:79], s37 offen sc1
s_add_u32 s37, s12, 0x50000
buffer_load_dwordx4 v[216:219], v20, s[76:79], s37 offen sc1
s_add_u32 s37, s12, 0x78000
buffer_load_dwordx4 v[220:223], v20, s[76:79], s37 offen sc1
s_add_u32 s37, s12, 0xa0000
buffer_load_dwordx4 v[224:227], v20, s[76:79], s37 offen sc1
s_add_u32 s37, s12, 0xc8000
buffer_load_dwordx4 v[228:231], v20, s[76:79], s37 offen sc1
s_add_u32 s37, s12, 0xf0000
buffer_load_dwordx4 v[232:235], v20, s[76:79], s37 offen sc1
s_add_u32 s37, s12, 0x118000
buffer_load_dwordx4 v[236:239], v20, s[76:79], s37 offen sc1
v_lshlrev_b32 v24, 16, v144
v_and_b32 v25, s46, v144
v_lshlrev_b32 v26, 16, v145
v_and_b32 v27, s46, v145
v_lshlrev_b32 v28, 16, v146
v_and_b32 v29, s46, v146
v_lshlrev_b32 v30, 16, v147
v_and_b32 v31, s46, v147
v_lshlrev_b32 v60, 16, v148
v_and_b32 v61, s46, v148
v_pk_add_f32 v[24:25], v[24:25], v[60:61]
v_lshlrev_b32 v60, 16, v149
v_and_b32 v61, s46, v149
v_pk_add_f32 v[26:27], v[26:27], v[60:61]
v_lshlrev_b32 v60, 16, v150
v_and_b32 v61, s46, v150
v_pk_add_f32 v[28:29], v[28:29], v[60:61]
v_lshlrev_b32 v60, 16, v151
v_and_b32 v61, s46, v151
v_pk_add_f32 v[30:31], v[30:31], v[60:61]
v_lshlrev_b32 v60, 16, v152
v_and_b32 v61, s46, v152
v_pk_add_f32 v[24:25], v[24:25], v[60:61]
v_lshlrev_b32 v60, 16, v153
v_and_b32 v61, s46, v153
v_pk_add_f32 v[26:27], v[26:27], v[60:61]
v_lshlrev_b32 v60, 16, v154
v_and_b32 v61, s46, v154
v_pk_add_f32 v[28:29], v[28:29], v[60:61]
v_lshlrev_b32 v60, 16, v155
v_and_b32 v61, s46, v155
v_pk_add_f32 v[30:31], v[30:31], v[60:61]
v_lshlrev_b32 v60, 16, v156
v_and_b32 v61, s46, v156
v_pk_add_f32 v[24:25], v[24:25], v[60:61]
v_lshlrev_b32 v60, 16, v157
v_and_b32 v61, s46, v157
v_pk_add_f32 v[26:27], v[26:27], v[60:61]
v_lshlrev_b32 v60, 16, v158
v_and_b32 v61, s46, v158
v_pk_add_f32 v[28:29], v[28:29], v[60:61]
v_lshlrev_b32 v60, 16, v159
v_and_b32 v61, s46, v159
v_pk_add_f32 v[30:31], v[30:31], v[60:61]
v_lshlrev_b32 v60, 16, v160
v_and_b32 v61, s46, v160
v_pk_add_f32 v[24:25], v[24:25], v[60:61]
v_lshlrev_b32 v60, 16, v161
v_and_b32 v61, s46, v161
v_pk_add_f32 v[26:27], v[26:27], v[60:61]
v_lshlrev_b32 v60, 16, v162
v_and_b32 v61, s46, v162
v_pk_add_f32 v[28:29], v[28:29], v[60:61]
v_lshlrev_b32 v60, 16, v163
v_and_b32 v61, s46, v163
v_pk_add_f32 v[30:31], v[30:31], v[60:61]
v_lshlrev_b32 v60, 16, v164
v_and_b32 v61, s46, v164
v_pk_add_f32 v[24:25], v[24:25], v[60:61]
v_lshlrev_b32 v60, 16, v165
v_and_b32 v61, s46, v165
v_pk_add_f32 v[26:27], v[26:27], v[60:61]
v_lshlrev_b32 v60, 16, v166
v_and_b32 v61, s46, v166
v_pk_add_f32 v[28:29], v[28:29], v[60:61]
v_lshlrev_b32 v60, 16, v167
v_and_b32 v61, s46, v167
v_pk_add_f32 v[30:31], v[30:31], v[60:61]
v_lshlrev_b32 v60, 16, v168
v_and_b32 v61, s46, v168
v_pk_add_f32 v[24:25], v[24:25], v[60:61]
v_lshlrev_b32 v60, 16, v169
v_and_b32 v61, s46, v169
v_pk_add_f32 v[26:27], v[26:27], v[60:61]
v_lshlrev_b32 v60, 16, v170
v_and_b32 v61, s46, v170
v_pk_add_f32 v[28:29], v[28:29], v[60:61]
v_lshlrev_b32 v60, 16, v171
v_and_b32 v61, s46, v171
v_pk_add_f32 v[30:31], v[30:31], v[60:61]
v_lshlrev_b32 v60, 16, v172
v_and_b32 v61, s46, v172
v_pk_add_f32 v[24:25], v[24:25], v[60:61]
v_lshlrev_b32 v60, 16, v173
v_and_b32 v61, s46, v173
v_pk_add_f32 v[26:27], v[26:27], v[60:61]
v_lshlrev_b32 v60, 16, v174
v_and_b32 v61, s46, v174
v_pk_add_f32 v[28:29], v[28:29], v[60:61]
v_lshlrev_b32 v60, 16, v175
v_and_b32 v61, s46, v175
v_pk_add_f32 v[30:31], v[30:31], v[60:61]
CV v32, v24, v25
CV v33, v26, v27
CV v34, v28, v29
CV v35, v30, v31
s_nop 0
v_permlane32_swap_b32 v32, v34
v_permlane32_swap_b32 v33, v35
s_nop 0
v_permlane16_swap_b32 v32, v34
v_permlane16_swap_b32 v33, v35
buffer_store_dwordx4 v[32:35], v2, s[4:7], s15 offen
s_waitcnt vmcnt(9)
v_lshlrev_b32 v40, 16, v176
v_and_b32 v41, s46, v176
v_lshlrev_b32 v42, 16, v177
v_and_b32 v43, s46, v177
v_lshlrev_b32 v44, 16, v178
v_and_b32 v45, s46, v178
v_lshlrev_b32 v46, 16, v179
v_and_b32 v47, s46, v179
v_lshlrev_b32 v60, 16, v180
v_and_b32 v61, s46, v180
v_pk_add_f32 v[40:41], v[40:41], v[60:61]
v_lshlrev_b32 v60, 16, v181
v_and_b32 v61, s46, v181
v_pk_add_f32 v[42:43], v[42:43], v[60:61]
v_lshlrev_b32 v60, 16, v182
v_and_b32 v61, s46, v182
v_pk_add_f32 v[44:45], v[44:45], v[60:61]
v_lshlrev_b32 v60, 16, v183
v_and_b32 v61, s46, v183
v_pk_add_f32 v[46:47], v[46:47], v[60:61]
v_lshlrev_b32 v60, 16, v184
v_and_b32 v61, s46, v184
v_pk_add_f32 v[40:41], v[40:41], v[60:61]
v_lshlrev_b32 v60, 16, v185
v_and_b32 v61, s46, v185
v_pk_add_f32 v[42:43], v[42:43], v[60:61]
v_lshlrev_b32 v60, 16, v186
v_and_b32 v61, s46, v186
v_pk_add_f32 v[44:45], v[44:45], v[60:61]
v_lshlrev_b32 v60, 16, v187
v_and_b32 v61, s46, v187
v_pk_add_f32 v[46:47], v[46:47], v[60:61]
v_lshlrev_b32 v60, 16, v188
v_and_b32 v61, s46, v188
v_pk_add_f32 v[40:41], v[40:41], v[60:61]
v_lshlrev_b32 v60, 16, v189
v_and_b32 v61, s46, v189
v_pk_add_f32 v[42:43], v[42:43], v[60:61]
v_lshlrev_b32 v60, 16, v190
v_and_b32 v61, s46, v190
v_pk_add_f32 v[44:45], v[44:45], v[60:61]
v_lshlrev_b32 v60, 16, v191
v_and_b32 v61, s46, v191
v_pk_add_f32 v[46:47], v[46:47], v[60:61]
v_lshlrev_b32 v60, 16, v192
v_and_b32 v61, s46, v192
v_pk_add_f32 v[40:41], v[40:41], v[60:61]
v_lshlrev_b32 v60, 16, v193
v_and_b32 v61, s46, v193
v_pk_add_f32 v[42:43], v[42:43], v[60:61]
v_lshlrev_b32 v60, 16, v194
v_and_b32 v61, s46, v194
v_pk_add_f32 v[44:45], v[44:45], v[60:61]
v_lshlrev_b32 v60, 16, v195
v_and_b32 v61, s46, v195
v_pk_add_f32 v[46:47], v[46:47], v[60:61]
v_lshlrev_b32 v60, 16, v196
v_and_b32 v61, s46, v196
v_pk_add_f32 v[40:41], v[40:41], v[60:61]
v_lshlrev_b32 v60, 16, v197
v_and_b32 v61, s46, v197
v_pk_add_f32 v[42:43], v[42:43], v[60:61]
v_lshlrev_b32 v60, 16, v198
v_and_b32 v61, s46, v198
v_pk_add_f32 v[44:45], v[44:45], v[60:61]
v_lshlrev_b32 v60, 16, v199
v_and_b32 v61, s46, v199
v_pk_add_f32 v[46:47], v[46:47], v[60:61]
v_lshlrev_b32 v60, 16, v200
v_and_b32 v61, s46, v200
v_pk_add_f32 v[40:41], v[40:41], v[60:61]
v_lshlrev_b32 v60, 16, v201
v_and_b32 v61, s46, v201
v_pk_add_f32 v[42:43], v[42:43], v[60:61]
v_lshlrev_b32 v60, 16, v202
v_and_b32 v61, s46, v202
v_pk_add_f32 v[44:45], v[44:45], v[60:61]
v_lshlrev_b32 v60, 16, v203
v_and_b32 v61, s46, v203
v_pk_add_f32 v[46:47], v[46:47], v[60:61]
v_lshlrev_b32 v60, 16, v204
v_and_b32 v61, s46, v204
v_pk_add_f32 v[40:41], v[40:41], v[60:61]
v_lshlrev_b32 v60, 16, v205
v_and_b32 v61, s46, v205
v_pk_add_f32 v[42:43], v[42:43], v[60:61]
v_lshlrev_b32 v60, 16, v206
v_and_b32 v61, s46, v206
v_pk_add_f32 v[44:45], v[44:45], v[60:61]
v_lshlrev_b32 v60, 16, v207
v_and_b32 v61, s46, v207
v_pk_add_f32 v[46:47], v[46:47], v[60:61]
CV v48, v40, v41
CV v49, v42, v43
CV v50, v44, v45
CV v51, v46, v47
s_nop 0
v_permlane32_swap_b32 v48, v50
v_permlane32_swap_b32 v49, v51
s_nop 0
v_permlane16_swap_b32 v48, v50
v_permlane16_swap_b32 v49, v51
buffer_store_dwordx4 v[48:51], v2, s[4:7], s16 offen
s_waitcnt vmcnt(9)
v_lshlrev_b32 v24, 16, v208
v_and_b32 v25, s46, v208
v_lshlrev_b32 v26, 16, v209
v_and_b32 v27, s46, v209
v_lshlrev_b32 v28, 16, v210
v_and_b32 v29, s46, v210
v_lshlrev_b32 v30, 16, v211
v_and_b32 v31, s46, v211
s_waitcnt vmcnt(8)
v_lshlrev_b32 v60, 16, v212
v_and_b32 v61, s46, v212
v_pk_add_f32 v[24:25], v[24:25], v[60:61]
v_lshlrev_b32 v60, 16, v213
v_and_b32 v61, s46, v213
v_pk_add_f32 v[26:27], v[26:27], v[60:61]
v_lshlrev_b32 v60, 16, v214
v_and_b32 v61, s46, v214
v_pk_add_f32 v[28:29], v[28:29], v[60:61]
v_lshlrev_b32 v60, 16, v215
v_and_b32 v61, s46, v215
v_pk_add_f32 v[30:31], v[30:31], v[60:61]
s_waitcnt vmcnt(7)
v_lshlrev_b32 v60, 16, v216
v_and_b32 v61, s46, v216
v_pk_add_f32 v[24:25], v[24:25], v[60:61]
v_lshlrev_b32 v60, 16, v217
v_and_b32 v61, s46, v217
v_pk_add_f32 v[26:27], v[26:27], v[60:61]
v_lshlrev_b32 v60, 16, v218
v_and_b32 v61, s46, v218
v_pk_add_f32 v[28:29], v[28:29], v[60:61]
v_lshlrev_b32 v60, 16, v219
v_and_b32 v61, s46, v219
v_pk_add_f32 v[30:31], v[30:31], v[60:61]
s_waitcnt vmcnt(6)
v_lshlrev_b32 v60, 16, v220
v_and_b32 v61, s46, v220
v_pk_add_f32 v[24:25], v[24:25], v[60:61]
v_lshlrev_b32 v60, 16, v221
v_and_b32 v61, s46, v221
v_pk_add_f32 v[26:27], v[26:27], v[60:61]
v_lshlrev_b32 v60, 16, v222
v_and_b32 v61, s46, v222
v_pk_add_f32 v[28:29], v[28:29], v[60:61]
v_lshlrev_b32 v60, 16, v223
v_and_b32 v61, s46, v223
v_pk_add_f32 v[30:31], v[30:31], v[60:61]
s_waitcnt vmcnt(5)
v_lshlrev_b32 v60, 16, v224
v_and_b32 v61, s46, v224
v_pk_add_f32 v[24:25], v[24:25], v[60:61]
v_lshlrev_b32 v60, 16, v225
v_and_b32 v61, s46, v225
v_pk_add_f32 v[26:27], v[26:27], v[60:61]
v_lshlrev_b32 v60, 16, v226
v_and_b32 v61, s46, v226
v_pk_add_f32 v[28:29], v[28:29], v[60:61]
v_lshlrev_b32 v60, 16, v227
v_and_b32 v61, s46, v227
v_pk_add_f32 v[30:31], v[30:31], v[60:61]
s_waitcnt vmcnt(4)
v_lshlrev_b32 v60, 16, v228
v_and_b32 v61, s46, v228
v_pk_add_f32 v[24:25], v[24:25], v[60:61]
v_lshlrev_b32 v60, 16, v229
v_and_b32 v61, s46, v229
v_pk_add_f32 v[26:27], v[26:27], v[60:61]
v_lshlrev_b32 v60, 16, v230
v_and_b32 v61, s46, v230
v_pk_add_f32 v[28:29], v[28:29], v[60:61]
v_lshlrev_b32 v60, 16, v231
v_and_b32 v61, s46, v231
v_pk_add_f32 v[30:31], v[30:31], v[60:61]
s_waitcnt vmcnt(3)
v_lshlrev_b32 v60, 16, v232
v_and_b32 v61, s46, v232
v_pk_add_f32 v[24:25], v[24:25], v[60:61]
v_lshlrev_b32 v60, 16, v233
v_and_b32 v61, s46, v233
v_pk_add_f32 v[26:27], v[26:27], v[60:61]
v_lshlrev_b32 v60, 16, v234
v_and_b32 v61, s46, v234
v_pk_add_f32 v[28:29], v[28:29], v[60:61]
v_lshlrev_b32 v60, 16, v235
v_and_b32 v61, s46, v235
v_pk_add_f32 v[30:31], v[30:31], v[60:61]
s_waitcnt vmcnt(2)
v_lshlrev_b32 v60, 16, v236
v_and_b32 v61, s46, v236
v_pk_add_f32 v[24:25], v[24:25], v[60:61]
v_lshlrev_b32 v60, 16, v237
v_and_b32 v61, s46, v237
v_pk_add_f32 v[26:27], v[26:27], v[60:61]
v_lshlrev_b32 v60, 16, v238
v_and_b32 v61, s46, v238
v_pk_add_f32 v[28:29], v[28:29], v[60:61]
v_lshlrev_b32 v60, 16, v239
v_and_b32 v61, s46, v239
v_pk_add_f32 v[30:31], v[30:31], v[60:61]
CV v32, v24, v25
CV v33, v26, v27
CV v34, v28, v29
CV v35, v30, v31
s_nop 0
v_permlane32_swap_b32 v32, v34
v_permlane32_swap_b32 v33, v35
s_nop 0
v_permlane16_swap_b32 v32, v34
v_permlane16_swap_b32 v33, v35
buffer_store_dwordx4 v[32:35], v2, s[4:7], s17 offen
s_endpgm
L_Zend:
L_ZFB0:
s_cmp_eq_u32 s36, 0
s_cbranch_scc1 L_ZFBgo0
v_mov_b32 v24, 0
v_mov_b32 v25, 0
v_mov_b32 v26, 0
v_mov_b32 v27, 0
v_mov_b32 v28, 0
v_mov_b32 v29, 0
v_mov_b32 v30, 0
v_mov_b32 v31, 0
v_mov_b32 v32, 0
v_mov_b32 v33, 0
v_mov_b32 v34, 0
v_mov_b32 v35, 0
v_mov_b32 v36, 0
v_mov_b32 v37, 0
v_mov_b32 v38, 0
v_mov_b32 v39, 0
v_mov_b32 v40, 0
v_mov_b32 v41, 0
v_mov_b32 v42, 0
v_mov_b32 v43, 0
s_mov_b32 s36, 0
s_branch L_ZRet0
L_ZFBgo0:
s_waitcnt vmcnt(0) lgkmcnt(0)
s_barrier
v_bfe_u32 v124, v20, 4, 4
v_lshlrev_b32 v124, 8, v124
v_lshrrev_b32 v125, 8, v20
v_lshl_add_u32 v124, v125, 3, v124
v_mov_b32 v116, 0xff800000
v_mov_b32 v117, 0xff800000
v_mov_b32 v118, 0xff800000
v_mov_b32 v119, 0xff800000
v_mov_b32 v120, 0xff800000
s_mov_b32 s40, 0
s_mov_b32 s96, 32
L_ZFBloop0:
buffer_load_dwordx2 v[80:81], v124, s[4:7], s40 offen offset:0
buffer_load_dwordx2 v[82:83], v124, s[4:7], s40 offen offset:32
buffer_load_dwordx2 v[84:85], v124, s[4:7], s40 offen offset:64
buffer_load_dwordx2 v[86:87], v124, s[4:7], s40 offen offset:96
buffer_load_dwordx2 v[88:89], v124, s[4:7], s40 offen offset:128
buffer_load_dwordx2 v[90:91], v124, s[4:7], s40 offen offset:160
buffer_load_dwordx2 v[92:93], v124, s[4:7], s40 offen offset:192
buffer_load_dwordx2 v[94:95], v124, s[4:7], s40 offen offset:224
s_waitcnt vmcnt(6)
MM v[96:99], v[80:83], a[0:3], 0
s_waitcnt vmcnt(4)
MM v[96:99], v[84:87], a[4:7], v[96:99]
s_waitcnt vmcnt(2)
MM v[96:99], v[88:91], a[8:11], v[96:99]
s_waitcnt vmcnt(0)
MM v[96:99], v[92:95], a[12:15], v[96:99]
MM v[100:103], v[80:83], a[16:19], 0
MM v[100:103], v[84:87], a[20:23], v[100:103]
MM v[100:103], v[88:91], a[24:27], v[100:103]
MM v[100:103], v[92:95], a[28:31], v[100:103]
MM v[104:107], v[80:83], a[32:35], 0
MM v[104:107], v[84:87], a[36:39], v[104:107]
MM v[104:107], v[88:91], a[40:43], v[104:107]
MM v[104:107], v[92:95], a[44:47], v[104:107]
MM v[108:111], v[80:83], a[48:51], 0
MM v[108:111], v[84:87], a[52:55], v[108:111]
MM v[108:111], v[88:91], a[56:59], v[108:111]
MM v[108:111], v[92:95], a[60:63], v[108:111]
MM v[112:115], v[80:83], a[64:67], 0
MM v[112:115], v[84:87], a[68:71], v[112:115]
MM v[112:115], v[88:91], a[72:75], v[112:115]
MM v[112:115], v[92:95], a[76:79], v[112:115]
v_max3_f32 v116, v116, v96, v97
v_max3_f32 v116, v116, v98, v99
v_max3_f32 v117, v117, v100, v101
v_max3_f32 v117, v117, v102, v103
v_max3_f32 v118, v118, v104, v105
v_max3_f32 v118, v118, v106, v107
v_max3_f32 v119, v119, v108, v109
v_max3_f32 v119, v119, v110, v111
v_max3_f32 v120, v120, v112, v113
v_max3_f32 v120, v120, v114, v115
s_add_u32 s40, s40, 4096
s_sub_u32 s96, s96, 1
s_cmp_lg_u32 s96, 0
s_nop 7
s_cbranch_scc1 L_ZFBloop0
v_lshrrev_b32 v124, 2, v20
v_xor_b32 v124, 64, v124
ds_bpermute_b32 v96, v124, v116
ds_bpermute_b32 v97, v124, v117
ds_bpermute_b32 v98, v124, v118
ds_bpermute_b32 v99, v124, v119
ds_bpermute_b32 v100, v124, v120
s_waitcnt lgkmcnt(4)
v_max_f32 v116, v116, v96
s_waitcnt lgkmcnt(3)
v_max_f32 v117, v117, v97
s_waitcnt lgkmcnt(2)
v_max_f32 v118, v118, v98
s_waitcnt lgkmcnt(1)
v_max_f32 v119, v119, v99
s_waitcnt lgkmcnt(0)
v_max_f32 v120, v120, v100
v_lshrrev_b32 v124, 2, v20
v_xor_b32 v124, 128, v124
ds_bpermute_b32 v96, v124, v116
ds_bpermute_b32 v97, v124, v117
ds_bpermute_b32 v98, v124, v118
ds_bpermute_b32 v99, v124, v119
ds_bpermute_b32 v100, v124, v120
s_waitcnt lgkmcnt(4)
v_max_f32 v116, v116, v96
s_waitcnt lgkmcnt(3)
v_max_f32 v117, v117, v97
s_waitcnt lgkmcnt(2)
v_max_f32 v118, v118, v98
s_waitcnt lgkmcnt(1)
v_max_f32 v119, v119, v99
s_waitcnt lgkmcnt(0)
v_max_f32 v120, v120, v100
v_sub_f32 v24, 0, v116
v_sub_f32 v25, 0, v116
v_sub_f32 v26, 0, v116
v_sub_f32 v27, 0, v116
v_sub_f32 v28, 0, v117
v_sub_f32 v29, 0, v117
v_sub_f32 v30, 0, v117
v_sub_f32 v31, 0, v117
v_sub_f32 v32, 0, v118
v_sub_f32 v33, 0, v118
v_sub_f32 v34, 0, v118
v_sub_f32 v35, 0, v118
v_sub_f32 v36, 0, v119
v_sub_f32 v37, 0, v119
v_sub_f32 v38, 0, v119
v_sub_f32 v39, 0, v119
v_sub_f32 v40, 0, v120
v_sub_f32 v41, 0, v120
v_sub_f32 v42, 0, v120
v_sub_f32 v43, 0, v120
s_add_u32 s42, s98, 0x0
v_add_u32 v1, 0xffff0000, v1
v_add_u32 v2, 0xffff0000, v2
v_add_u32 v3, 0xffff0000, v3
v_add_u32 v4, 0xffff0000, v4
v_add_u32 v5, 0xffff0000, v5
v_add_u32 v6, 0xffff0000, v6
v_add_u32 v7, 0xffff0000, v7
v_add_u32 v8, 0xffff0000, v8
s_add_u32 m0, s28, 0x0
s_add_u32 s30, s98, 0x0
s_and_b32 s30, s30, 0x1ffff
buffer_load_dwordx4 v13, s[4:7], s30 offen nt lds
s_add_u32 m0, s28, 0xf80
s_add_u32 s30, s98, 0x0
s_and_b32 s30, s30, 0x1ffff
buffer_load_dwordx4 v13, s[4:7], s30 offen offset:128 nt lds
s_add_u32 m0, s28, 0x800
s_add_u32 s30, s98, 0x1000
s_and_b32 s30, s30, 0x1ffff
buffer_load_dwordx4 v13, s[4:7], s30 offen nt lds
s_add_u32 m0, s28, 0x1780
s_add_u32 s30, s98, 0x1000
s_and_b32 s30, s30, 0x1ffff
buffer_load_dwordx4 v13, s[4:7], s30 offen offset:128 nt lds
s_add_u32 m0, s28, 0x8000
s_add_u32 s30, s98, 0x2000
s_and_b32 s30, s30, 0x1ffff
buffer_load_dwordx4 v13, s[4:7], s30 offen nt lds
s_add_u32 m0, s28, 0x8f80
s_add_u32 s30, s98, 0x2000
s_and_b32 s30, s30, 0x1ffff
buffer_load_dwordx4 v13, s[4:7], s30 offen offset:128 nt lds
s_add_u32 m0, s28, 0x8800
s_add_u32 s30, s98, 0x3000
s_and_b32 s30, s30, 0x1ffff
buffer_load_dwordx4 v13, s[4:7], s30 offen nt lds
s_add_u32 m0, s28, 0x9780
s_add_u32 s30, s98, 0x3000
s_and_b32 s30, s30, 0x1ffff
buffer_load_dwordx4 v13, s[4:7], s30 offen offset:128 nt lds
s_add_u32 m0, s28, 0x10000
s_add_u32 s30, s98, 0x4000
s_and_b32 s30, s30, 0x1ffff
buffer_load_dwordx4 v13, s[4:7], s30 offen nt lds
s_add_u32 m0, s28, 0x10f80
s_add_u32 s30, s98, 0x4000
s_and_b32 s30, s30, 0x1ffff
buffer_load_dwordx4 v13, s[4:7], s30 offen offset:128 nt lds
s_add_u32 m0, s28, 0x10800
s_add_u32 s30, s98, 0x5000
s_and_b32 s30, s30, 0x1ffff
buffer_load_dwordx4 v13, s[4:7], s30 offen nt lds
s_add_u32 m0, s28, 0x11780
s_add_u32 s30, s98, 0x5000
s_and_b32 s30, s30, 0x1ffff
buffer_load_dwordx4 v13, s[4:7], s30 offen offset:128 nt lds
s_add_u32 m0, s28, 0x18000
s_add_u32 s30, s98, 0x6000
s_and_b32 s30, s30, 0x1ffff
buffer_load_dwordx4 v13, s[4:7], s30 offen nt lds
s_add_u32 m0, s28, 0x18f80
s_add_u32 s30, s98, 0x6000
s_and_b32 s30, s30, 0x1ffff
buffer_load_dwordx4 v13, s[4:7], s30 offen offset:128 nt lds
s_add_u32 m0, s28, 0x18800
s_add_u32 s30, s98, 0x7000
s_and_b32 s30, s30, 0x1ffff
buffer_load_dwordx4 v13, s[4:7], s30 offen nt lds
s_add_u32 m0, s28, 0x19780
s_add_u32 s30, s98, 0x7000
s_and_b32 s30, s30, 0x1ffff
buffer_load_dwordx4 v13, s[4:7], s30 offen offset:128 nt lds
s_add_u32 m0, s28, 0x4000
s_add_u32 s30, s98, 0x0
s_and_b32 s30, s30, 0x1ffff
buffer_load_dwordx4 v14, s[8:11], s30 offen nt lds
s_add_u32 m0, s28, 0x4f80
s_add_u32 s30, s98, 0x0
s_and_b32 s30, s30, 0x1ffff
buffer_load_dwordx4 v14, s[8:11], s30 offen offset:128 nt lds
s_add_u32 m0, s28, 0x4800
s_add_u32 s30, s98, 0x1000
s_and_b32 s30, s30, 0x1ffff
buffer_load_dwordx4 v14, s[8:11], s30 offen nt lds
s_add_u32 m0, s28, 0x5780
s_add_u32 s30, s98, 0x1000
s_and_b32 s30, s30, 0x1ffff
buffer_load_dwordx4 v14, s[8:11], s30 offen offset:128 nt lds
s_add_u32 m0, s28, 0xc000
s_add_u32 s30, s98, 0x2000
s_and_b32 s30, s30, 0x1ffff
buffer_load_dwordx4 v14, s[8:11], s30 offen nt lds
s_add_u32 m0, s28, 0xcf80
s_add_u32 s30, s98, 0x2000
s_and_b32 s30, s30, 0x1ffff
buffer_load_dwordx4 v14, s[8:11], s30 offen offset:128 nt lds
s_add_u32 m0, s28, 0xc800
s_add_u32 s30, s98, 0x3000
s_and_b32 s30, s30, 0x1ffff
buffer_load_dwordx4 v14, s[8:11], s30 offen nt lds
s_add_u32 m0, s28, 0xd780
s_add_u32 s30, s98, 0x3000
s_and_b32 s30, s30, 0x1ffff
buffer_load_dwordx4 v14, s[8:11], s30 offen offset:128 nt lds
s_add_u32 m0, s28, 0x14000
s_add_u32 s30, s98, 0x4000
s_and_b32 s30, s30, 0x1ffff
buffer_load_dwordx4 v14, s[8:11], s30 offen nt lds
s_add_u32 m0, s28, 0x14f80
s_add_u32 s30, s98, 0x4000
s_and_b32 s30, s30, 0x1ffff
buffer_load_dwordx4 v14, s[8:11], s30 offen offset:128 nt lds
s_add_u32 m0, s28, 0x14800
s_add_u32 s30, s98, 0x5000
s_and_b32 s30, s30, 0x1ffff
buffer_load_dwordx4 v14, s[8:11], s30 offen nt lds
s_add_u32 m0, s28, 0x15780
s_add_u32 s30, s98, 0x5000
s_and_b32 s30, s30, 0x1ffff
buffer_load_dwordx4 v14, s[8:11], s30 offen offset:128 nt lds
s_add_u32 m0, s28, 0x1c000
s_add_u32 s30, s98, 0x6000
s_and_b32 s30, s30, 0x1ffff
buffer_load_dwordx4 v14, s[8:11], s30 offen nt lds
s_add_u32 m0, s28, 0x1cf80
s_add_u32 s30, s98, 0x6000
s_and_b32 s30, s30, 0x1ffff
buffer_load_dwordx4 v14, s[8:11], s30 offen offset:128 nt lds
s_add_u32 m0, s28, 0x1c800
s_add_u32 s30, s98, 0x7000
s_and_b32 s30, s30, 0x1ffff
buffer_load_dwordx4 v14, s[8:11], s30 offen nt lds
s_add_u32 m0, s28, 0x1d780
s_add_u32 s30, s98, 0x7000
s_and_b32 s30, s30, 0x1ffff
buffer_load_dwordx4 v14, s[8:11], s30 offen offset:128 nt lds
s_waitcnt vmcnt(0)
s_barrier
ds_read_b64 a[80:81], v5 offset:0
ds_read_b64 a[82:83], v6 offset:0
ds_read_b64 a[84:85], v5 offset:2048
ds_read_b64 a[86:87], v6 offset:2048
ds_read_b64 a[88:89], v7 offset:0
ds_read_b64 a[90:91], v8 offset:0
ds_read_b64 a[92:93], v7 offset:2048
ds_read_b64 a[94:95], v8 offset:2048
ds_read_b64 a[96:97], v5 offset:4096
ds_read_b64 a[98:99], v6 offset:4096
ds_read_b64 a[100:101], v5 offset:6144
ds_read_b64 a[102:103], v6 offset:6144
ds_read_b64 a[104:105], v7 offset:4096
ds_read_b64 a[106:107], v8 offset:4096
ds_read_b64 a[108:109], v7 offset:6144
ds_read_b64 a[110:111], v8 offset:6144
TR a[112:113], v1 offset:16384
TR a[114:115], v1 offset:18432
TR a[116:117], v2 offset:16384
TR a[118:119], v2 offset:18432
TR a[120:121], v3 offset:16384
TR a[122:123], v3 offset:18432
TR a[124:125], v4 offset:16384
TR a[126:127], v4 offset:18432
TR a[128:129], v1 offset:20480
TR a[130:131], v1 offset:22528
TR a[132:133], v2 offset:20480
TR a[134:135], v2 offset:22528
TR a[136:137], v3 offset:20480
TR a[138:139], v3 offset:22528
TR a[140:141], v4 offset:20480
TR a[142:143], v4 offset:22528
s_waitcnt lgkmcnt(0)
s_mov_b32 s36, 1
s_branch L_ZAent0
L_ZFB1:
s_cmp_eq_u32 s36, 0
s_cbranch_scc1 L_ZFBgo1
v_mov_b32 v24, 0
v_mov_b32 v25, 0
v_mov_b32 v26, 0
v_mov_b32 v27, 0
v_mov_b32 v28, 0
v_mov_b32 v29, 0
v_mov_b32 v30, 0
v_mov_b32 v31, 0
v_mov_b32 v32, 0
v_mov_b32 v33, 0
v_mov_b32 v34, 0
v_mov_b32 v35, 0
v_mov_b32 v36, 0
v_mov_b32 v37, 0
v_mov_b32 v38, 0
v_mov_b32 v39, 0
v_mov_b32 v40, 0
v_mov_b32 v41, 0
v_mov_b32 v42, 0
v_mov_b32 v43, 0
s_mov_b32 s36, 0
s_branch L_ZRet1
L_ZFBgo1:
s_waitcnt vmcnt(0) lgkmcnt(0)
s_barrier
v_bfe_u32 v124, v20, 4, 4
v_lshlrev_b32 v124, 8, v124
v_lshrrev_b32 v125, 8, v20
v_lshl_add_u32 v124, v125, 3, v124
v_mov_b32 v116, 0xff800000
v_mov_b32 v117, 0xff800000
v_mov_b32 v118, 0xff800000
v_mov_b32 v119, 0xff800000
v_mov_b32 v120, 0xff800000
s_mov_b32 s40, 0
s_mov_b32 s96, 32
L_ZFBloop1:
buffer_load_dwordx2 v[80:81], v124, s[4:7], s40 offen offset:0
buffer_load_dwordx2 v[82:83], v124, s[4:7], s40 offen offset:32
buffer_load_dwordx2 v[84:85], v124, s[4:7], s40 offen offset:64
buffer_load_dwordx2 v[86:87], v124, s[4:7], s40 offen offset:96
buffer_load_dwordx2 v[88:89], v124, s[4:7], s40 offen offset:128
buffer_load_dwordx2 v[90:91], v124, s[4:7], s40 offen offset:160
buffer_load_dwordx2 v[92:93], v124, s[4:7], s40 offen offset:192
buffer_load_dwordx2 v[94:95], v124, s[4:7], s40 offen offset:224
s_waitcnt vmcnt(6)
MM v[96:99], v[80:83], a[0:3], 0
s_waitcnt vmcnt(4)
MM v[96:99], v[84:87], a[4:7], v[96:99]
s_waitcnt vmcnt(2)
MM v[96:99], v[88:91], a[8:11], v[96:99]
s_waitcnt vmcnt(0)
MM v[96:99], v[92:95], a[12:15], v[96:99]
MM v[100:103], v[80:83], a[16:19], 0
MM v[100:103], v[84:87], a[20:23], v[100:103]
MM v[100:103], v[88:91], a[24:27], v[100:103]
MM v[100:103], v[92:95], a[28:31], v[100:103]
MM v[104:107], v[80:83], a[32:35], 0
MM v[104:107], v[84:87], a[36:39], v[104:107]
MM v[104:107], v[88:91], a[40:43], v[104:107]
MM v[104:107], v[92:95], a[44:47], v[104:107]
MM v[108:111], v[80:83], a[48:51], 0
MM v[108:111], v[84:87], a[52:55], v[108:111]
MM v[108:111], v[88:91], a[56:59], v[108:111]
MM v[108:111], v[92:95], a[60:63], v[108:111]
MM v[112:115], v[80:83], a[64:67], 0
MM v[112:115], v[84:87], a[68:71], v[112:115]
MM v[112:115], v[88:91], a[72:75], v[112:115]
MM v[112:115], v[92:95], a[76:79], v[112:115]
v_max3_f32 v116, v116, v96, v97
v_max3_f32 v116, v116, v98, v99
v_max3_f32 v117, v117, v100, v101
v_max3_f32 v117, v117, v102, v103
v_max3_f32 v118, v118, v104, v105
v_max3_f32 v118, v118, v106, v107
v_max3_f32 v119, v119, v108, v109
v_max3_f32 v119, v119, v110, v111
v_max3_f32 v120, v120, v112, v113
v_max3_f32 v120, v120, v114, v115
s_add_u32 s40, s40, 4096
s_sub_u32 s96, s96, 1
s_cmp_lg_u32 s96, 0
s_nop 7
s_cbranch_scc1 L_ZFBloop1
v_lshrrev_b32 v124, 2, v20
v_xor_b32 v124, 64, v124
ds_bpermute_b32 v96, v124, v116
ds_bpermute_b32 v97, v124, v117
ds_bpermute_b32 v98, v124, v118
ds_bpermute_b32 v99, v124, v119
ds_bpermute_b32 v100, v124, v120
s_waitcnt lgkmcnt(4)
v_max_f32 v116, v116, v96
s_waitcnt lgkmcnt(3)
v_max_f32 v117, v117, v97
s_waitcnt lgkmcnt(2)
v_max_f32 v118, v118, v98
s_waitcnt lgkmcnt(1)
v_max_f32 v119, v119, v99
s_waitcnt lgkmcnt(0)
v_max_f32 v120, v120, v100
v_lshrrev_b32 v124, 2, v20
v_xor_b32 v124, 128, v124
ds_bpermute_b32 v96, v124, v116
ds_bpermute_b32 v97, v124, v117
ds_bpermute_b32 v98, v124, v118
ds_bpermute_b32 v99, v124, v119
ds_bpermute_b32 v100, v124, v120
s_waitcnt lgkmcnt(4)
v_max_f32 v116, v116, v96
s_waitcnt lgkmcnt(3)
v_max_f32 v117, v117, v97
s_waitcnt lgkmcnt(2)
v_max_f32 v118, v118, v98
s_waitcnt lgkmcnt(1)
v_max_f32 v119, v119, v99
s_waitcnt lgkmcnt(0)
v_max_f32 v120, v120, v100
v_sub_f32 v24, 0, v116
v_sub_f32 v25, 0, v116
v_sub_f32 v26, 0, v116
v_sub_f32 v27, 0, v116
v_sub_f32 v28, 0, v117
v_sub_f32 v29, 0, v117
v_sub_f32 v30, 0, v117
v_sub_f32 v31, 0, v117
v_sub_f32 v32, 0, v118
v_sub_f32 v33, 0, v118
v_sub_f32 v34, 0, v118
v_sub_f32 v35, 0, v118
v_sub_f32 v36, 0, v119
v_sub_f32 v37, 0, v119
v_sub_f32 v38, 0, v119
v_sub_f32 v39, 0, v119
v_sub_f32 v40, 0, v120
v_sub_f32 v41, 0, v120
v_sub_f32 v42, 0, v120
v_sub_f32 v43, 0, v120
s_add_u32 s42, s98, 0x18000
v_add_u32 v1, 0xffff0000, v1
v_add_u32 v2, 0xffff0000, v2
v_add_u32 v3, 0xffff0000, v3
v_add_u32 v4, 0xffff0000, v4
v_add_u32 v5, 0xffff0000, v5
v_add_u32 v6, 0xffff0000, v6
v_add_u32 v7, 0xffff0000, v7
v_add_u32 v8, 0xffff0000, v8
s_add_u32 m0, s28, 0x0
s_add_u32 s30, s98, 0x0
s_and_b32 s30, s30, 0x1ffff
buffer_load_dwordx4 v13, s[4:7], s30 offen nt lds
s_add_u32 m0, s28, 0xf80
s_add_u32 s30, s98, 0x0
s_and_b32 s30, s30, 0x1ffff
buffer_load_dwordx4 v13, s[4:7], s30 offen offset:128 nt lds
s_add_u32 m0, s28, 0x800
s_add_u32 s30, s98, 0x1000
s_and_b32 s30, s30, 0x1ffff
buffer_load_dwordx4 v13, s[4:7], s30 offen nt lds
s_add_u32 m0, s28, 0x1780
s_add_u32 s30, s98, 0x1000
s_and_b32 s30, s30, 0x1ffff
buffer_load_dwordx4 v13, s[4:7], s30 offen offset:128 nt lds
s_add_u32 m0, s28, 0x8000
s_add_u32 s30, s98, 0x2000
s_and_b32 s30, s30, 0x1ffff
buffer_load_dwordx4 v13, s[4:7], s30 offen nt lds
s_add_u32 m0, s28, 0x8f80
s_add_u32 s30, s98, 0x2000
s_and_b32 s30, s30, 0x1ffff
buffer_load_dwordx4 v13, s[4:7], s30 offen offset:128 nt lds
s_add_u32 m0, s28, 0x8800
s_add_u32 s30, s98, 0x3000
s_and_b32 s30, s30, 0x1ffff
buffer_load_dwordx4 v13, s[4:7], s30 offen nt lds
s_add_u32 m0, s28, 0x9780
s_add_u32 s30, s98, 0x3000
s_and_b32 s30, s30, 0x1ffff
buffer_load_dwordx4 v13, s[4:7], s30 offen offset:128 nt lds
s_add_u32 m0, s28, 0x10000
s_add_u32 s30, s98, 0x4000
s_and_b32 s30, s30, 0x1ffff
buffer_load_dwordx4 v13, s[4:7], s30 offen nt lds
s_add_u32 m0, s28, 0x10f80
s_add_u32 s30, s98, 0x4000
s_and_b32 s30, s30, 0x1ffff
buffer_load_dwordx4 v13, s[4:7], s30 offen offset:128 nt lds
s_add_u32 m0, s28, 0x10800
s_add_u32 s30, s98, 0x5000
s_and_b32 s30, s30, 0x1ffff
buffer_load_dwordx4 v13, s[4:7], s30 offen nt lds
s_add_u32 m0, s28, 0x11780
s_add_u32 s30, s98, 0x5000
s_and_b32 s30, s30, 0x1ffff
buffer_load_dwordx4 v13, s[4:7], s30 offen offset:128 nt lds
s_add_u32 m0, s28, 0x18000
s_add_u32 s30, s98, 0x6000
s_and_b32 s30, s30, 0x1ffff
buffer_load_dwordx4 v13, s[4:7], s30 offen nt lds
s_add_u32 m0, s28, 0x18f80
s_add_u32 s30, s98, 0x6000
s_and_b32 s30, s30, 0x1ffff
buffer_load_dwordx4 v13, s[4:7], s30 offen offset:128 nt lds
s_add_u32 m0, s28, 0x18800
s_add_u32 s30, s98, 0x7000
s_and_b32 s30, s30, 0x1ffff
buffer_load_dwordx4 v13, s[4:7], s30 offen nt lds
s_add_u32 m0, s28, 0x19780
s_add_u32 s30, s98, 0x7000
s_and_b32 s30, s30, 0x1ffff
buffer_load_dwordx4 v13, s[4:7], s30 offen offset:128 nt lds
s_add_u32 m0, s28, 0x4000
s_add_u32 s30, s98, 0x0
s_and_b32 s30, s30, 0x1ffff
buffer_load_dwordx4 v14, s[8:11], s30 offen nt lds
s_add_u32 m0, s28, 0x4f80
s_add_u32 s30, s98, 0x0
s_and_b32 s30, s30, 0x1ffff
buffer_load_dwordx4 v14, s[8:11], s30 offen offset:128 nt lds
s_add_u32 m0, s28, 0x4800
s_add_u32 s30, s98, 0x1000
s_and_b32 s30, s30, 0x1ffff
buffer_load_dwordx4 v14, s[8:11], s30 offen nt lds
s_add_u32 m0, s28, 0x5780
s_add_u32 s30, s98, 0x1000
s_and_b32 s30, s30, 0x1ffff
buffer_load_dwordx4 v14, s[8:11], s30 offen offset:128 nt lds
s_add_u32 m0, s28, 0xc000
s_add_u32 s30, s98, 0x2000
s_and_b32 s30, s30, 0x1ffff
buffer_load_dwordx4 v14, s[8:11], s30 offen nt lds
s_add_u32 m0, s28, 0xcf80
s_add_u32 s30, s98, 0x2000
s_and_b32 s30, s30, 0x1ffff
buffer_load_dwordx4 v14, s[8:11], s30 offen offset:128 nt lds
s_add_u32 m0, s28, 0xc800
s_add_u32 s30, s98, 0x3000
s_and_b32 s30, s30, 0x1ffff
buffer_load_dwordx4 v14, s[8:11], s30 offen nt lds
s_add_u32 m0, s28, 0xd780
s_add_u32 s30, s98, 0x3000
s_and_b32 s30, s30, 0x1ffff
buffer_load_dwordx4 v14, s[8:11], s30 offen offset:128 nt lds
s_add_u32 m0, s28, 0x14000
s_add_u32 s30, s98, 0x4000
s_and_b32 s30, s30, 0x1ffff
buffer_load_dwordx4 v14, s[8:11], s30 offen nt lds
s_add_u32 m0, s28, 0x14f80
s_add_u32 s30, s98, 0x4000
s_and_b32 s30, s30, 0x1ffff
buffer_load_dwordx4 v14, s[8:11], s30 offen offset:128 nt lds
s_add_u32 m0, s28, 0x14800
s_add_u32 s30, s98, 0x5000
s_and_b32 s30, s30, 0x1ffff
buffer_load_dwordx4 v14, s[8:11], s30 offen nt lds
s_add_u32 m0, s28, 0x15780
s_add_u32 s30, s98, 0x5000
s_and_b32 s30, s30, 0x1ffff
buffer_load_dwordx4 v14, s[8:11], s30 offen offset:128 nt lds
s_add_u32 m0, s28, 0x1c000
s_add_u32 s30, s98, 0x6000
s_and_b32 s30, s30, 0x1ffff
buffer_load_dwordx4 v14, s[8:11], s30 offen nt lds
s_add_u32 m0, s28, 0x1cf80
s_add_u32 s30, s98, 0x6000
s_and_b32 s30, s30, 0x1ffff
buffer_load_dwordx4 v14, s[8:11], s30 offen offset:128 nt lds
s_add_u32 m0, s28, 0x1c800
s_add_u32 s30, s98, 0x7000
s_and_b32 s30, s30, 0x1ffff
buffer_load_dwordx4 v14, s[8:11], s30 offen nt lds
s_add_u32 m0, s28, 0x1d780
s_add_u32 s30, s98, 0x7000
s_and_b32 s30, s30, 0x1ffff
buffer_load_dwordx4 v14, s[8:11], s30 offen offset:128 nt lds
s_waitcnt vmcnt(0)
s_barrier
ds_read_b64 a[80:81], v5 offset:0
ds_read_b64 a[82:83], v6 offset:0
ds_read_b64 a[84:85], v5 offset:2048
ds_read_b64 a[86:87], v6 offset:2048
ds_read_b64 a[88:89], v7 offset:0
ds_read_b64 a[90:91], v8 offset:0
ds_read_b64 a[92:93], v7 offset:2048
ds_read_b64 a[94:95], v8 offset:2048
ds_read_b64 a[96:97], v5 offset:4096
ds_read_b64 a[98:99], v6 offset:4096
ds_read_b64 a[100:101], v5 offset:6144
ds_read_b64 a[102:103], v6 offset:6144
ds_read_b64 a[104:105], v7 offset:4096
ds_read_b64 a[106:107], v8 offset:4096
ds_read_b64 a[108:109], v7 offset:6144
ds_read_b64 a[110:111], v8 offset:6144
TR a[112:113], v1 offset:16384
TR a[114:115], v1 offset:18432
TR a[116:117], v2 offset:16384
TR a[118:119], v2 offset:18432
TR a[120:121], v3 offset:16384
TR a[122:123], v3 offset:18432
TR a[124:125], v4 offset:16384
TR a[126:127], v4 offset:18432
TR a[128:129], v1 offset:20480
TR a[130:131], v1 offset:22528
TR a[132:133], v2 offset:20480
TR a[134:135], v2 offset:22528
TR a[136:137], v3 offset:20480
TR a[138:139], v3 offset:22528
TR a[140:141], v4 offset:20480
TR a[142:143], v4 offset:22528
s_waitcnt lgkmcnt(0)
s_mov_b32 s36, 1
s_branch L_ZAent1
L_far1:
s_cmp_lg_u32 s33, 0
s_cbranch_scc1 L_Yann
s_mov_b32 s44, s86
s_mov_b32 s45, s87
s_mov_b32 s46, 4
s_mov_b32 s47, 0x20000
s_mov_b64 exec, 1
v_mov_b32 v45, 1
buffer_atomic_add v45, v78, s[44:47], 0 offen
s_mov_b64 exec, -1
L_Yann:
s_nop 4
s_waitcnt vmcnt(0) lgkmcnt(0)
s_barrier
s_mov_b32 s43, 0x0
s_mov_b32 s48, 0x0
MM v[84:87], a[116:119], a[20:23], v[84:87]
s_add_u32 m0, s29, 0x23000
s_add_u32 s30, s48, 0x0
TR a[80:81], v9 offset:32768
MM v[88:91], a[120:123], a[20:23], v[88:91]
buffer_load_dwordx4 v15, s[12:15], s30 offen lds
MM v[92:95], a[124:127], a[20:23], v[92:95]
TR a[82:83], v9 offset:33280
TR a[84:85], v10 offset:32768
MM v[96:99], a[128:131], a[20:23], v[96:99]
s_add_u32 m0, s29, 0x23800
s_add_u32 s30, s48, 0x4000
MM v[100:103], a[132:135], a[20:23], v[100:103]
buffer_load_dwordx4 v15, s[12:15], s30 offen lds
MM v[104:107], a[136:139], a[20:23], v[104:107]
TR a[86:87], v10 offset:33280
TR a[88:89], v11 offset:32768
MM v[108:111], a[140:143], a[20:23], v[108:111]
s_add_u32 m0, s29, 0x24000
s_add_u32 s30, s48, 0x8000
MM v[112:115], a[112:115], a[24:27], v[112:115]
buffer_load_dwordx4 v15, s[12:15], s30 offen lds
MM v[116:119], a[116:119], a[24:27], v[116:119]
TR a[90:91], v11 offset:33280
TR a[92:93], v12 offset:32768
MM v[120:123], a[120:123], a[24:27], v[120:123]
s_add_u32 m0, s29, 0x24800
s_add_u32 s30, s48, 0xc000
MM v[124:127], a[124:127], a[24:27], v[124:127]
buffer_load_dwordx4 v15, s[12:15], s30 offen lds
MM v[128:131], a[128:131], a[24:27], v[128:131]
TR a[94:95], v12 offset:33280
TR a[96:97], v9 offset:36864
MM v[132:135], a[132:135], a[24:27], v[132:135]
s_add_u32 m0, s29, 0x25000
s_add_u32 s30, s48, 0x10000
MM v[136:139], a[136:139], a[24:27], v[136:139]
buffer_load_dwordx4 v15, s[12:15], s30 offen lds
MM v[140:143], a[140:143], a[24:27], v[140:143]
TR a[98:99], v9 offset:37376
TR a[100:101], v10 offset:36864
MM v[144:147], a[112:115], a[28:31], v[144:147]
s_add_u32 m0, s28, 0xc000
s_add_u32 s30, s43, 0x100
MM v[148:151], a[116:119], a[28:31], v[148:151]
buffer_load_dwordx4 v16, s[16:19], s30 offen lds
MM v[152:155], a[120:123], a[28:31], v[152:155]
TR a[102:103], v10 offset:37376
TR a[104:105], v11 offset:36864
MM v[156:159], a[124:127], a[28:31], v[156:159]
s_add_u32 m0, s28, 0xcf80
MM v[160:163], a[128:131], a[28:31], v[160:163]
buffer_load_dwordx4 v16, s[16:19], s30 offen offset:128 lds
MM v[164:167], a[132:135], a[28:31], v[164:167]
TR a[106:107], v11 offset:37376
TR a[108:109], v12 offset:36864
MM v[168:171], a[136:139], a[28:31], v[168:171]
s_add_u32 m0, s28, 0xc800
s_add_u32 s30, s43, 0x20100
MM v[172:175], a[140:143], a[28:31], v[172:175]
buffer_load_dwordx4 v16, s[16:19], s30 offen lds
MM v[176:179], a[112:115], a[32:35], v[176:179]
TR a[110:111], v12 offset:37376
ds_read_b128 a[0:3], v76 offset:0
MM v[180:183], a[116:119], a[32:35], v[180:183]
s_add_u32 m0, s28, 0xd780
MM v[184:187], a[120:123], a[32:35], v[184:187]
buffer_load_dwordx4 v16, s[16:19], s30 offen offset:128 lds
MM v[188:191], a[124:127], a[32:35], v[188:191]
ds_read_b128 a[4:7], v76 offset:2048
ds_read_b128 a[8:11], v76 offset:4096
MM v[192:195], a[128:131], a[32:35], v[192:195]
s_add_u32 m0, s28, 0x10000
s_add_u32 s30, s43, 0x40100
MM v[196:199], a[132:135], a[32:35], v[196:199]
buffer_load_dwordx4 v16, s[16:19], s30 offen lds
MM v[200:203], a[136:139], a[32:35], v[200:203]
ds_read_b128 a[12:15], v76 offset:6144
ds_read_b128 a[16:19], v76 offset:8192
MM v[204:207], a[140:143], a[32:35], v[204:207]
s_add_u32 m0, s28, 0x10f80
MM v[208:211], a[112:115], a[36:39], v[208:211]
buffer_load_dwordx4 v16, s[16:19], s30 offen offset:128 lds
MM v[212:215], a[116:119], a[36:39], v[212:215]
MM v[216:219], a[120:123], a[36:39], v[216:219]
s_add_u32 m0, s28, 0x10800
s_add_u32 s30, s43, 0x60100
MM v[220:223], a[124:127], a[36:39], v[220:223]
buffer_load_dwordx4 v16, s[16:19], s30 offen lds
MM v[224:227], a[128:131], a[36:39], v[224:227]
MM v[228:231], a[132:135], a[36:39], v[228:231]
s_add_u32 m0, s28, 0x11780
MM v[232:235], a[136:139], a[36:39], v[232:235]
buffer_load_dwordx4 v16, s[16:19], s30 offen offset:128 lds
MM v[236:239], a[140:143], a[36:39], v[236:239]
s_waitcnt lgkmcnt(4)
MM v[80:83], a[80:83], a[0:3], v[80:83]
s_barrier
s_add_u32 m0, s28, 0x14000
s_add_u32 s30, s43, 0x80100
MM v[84:87], a[84:87], a[0:3], v[84:87]
buffer_load_dwordx4 v16, s[16:19], s30 offen lds
MM v[88:91], a[88:91], a[0:3], v[88:91]
TR a[112:113], v9 offset:49152
TR a[114:115], v9 offset:49664
MM v[92:95], a[92:95], a[0:3], v[92:95]
s_add_u32 m0, s28, 0x14f80
MM v[96:99], a[96:99], a[0:3], v[96:99]
buffer_load_dwordx4 v16, s[16:19], s30 offen offset:128 lds
MM v[100:103], a[100:103], a[0:3], v[100:103]
TR a[116:117], v10 offset:49152
TR a[118:119], v10 offset:49664
MM v[104:107], a[104:107], a[0:3], v[104:107]
s_add_u32 m0, s28, 0x14800
s_add_u32 s30, s43, 0xa0100
MM v[108:111], a[108:111], a[0:3], v[108:111]
s_waitcnt lgkmcnt(7)
buffer_load_dwordx4 v16, s[16:19], s30 offen lds
MM v[112:115], a[80:83], a[4:7], v[112:115]
TR a[120:121], v11 offset:49152
TR a[122:123], v11 offset:49664
MM v[116:119], a[84:87], a[4:7], v[116:119]
s_add_u32 m0, s28, 0x15780
MM v[120:123], a[88:91], a[4:7], v[120:123]
buffer_load_dwordx4 v16, s[16:19], s30 offen offset:128 lds
MM v[124:127], a[92:95], a[4:7], v[124:127]
TR a[124:125], v12 offset:49152
TR a[126:127], v12 offset:49664
MM v[128:131], a[96:99], a[4:7], v[128:131]
MM v[132:135], a[100:103], a[4:7], v[132:135]
TR a[128:129], v9 offset:53248
TR a[130:131], v9 offset:53760
MM v[136:139], a[104:107], a[4:7], v[136:139]
MM v[140:143], a[108:111], a[4:7], v[140:143]
s_waitcnt lgkmcnt(12)
TR a[132:133], v10 offset:53248
TR a[134:135], v10 offset:53760
MM v[144:147], a[80:83], a[8:11], v[144:147]
MM v[148:151], a[84:87], a[8:11], v[148:151]
TR a[136:137], v11 offset:53248
TR a[138:139], v11 offset:53760
MM v[152:155], a[88:91], a[8:11], v[152:155]
MM v[156:159], a[92:95], a[8:11], v[156:159]
TR a[140:141], v12 offset:53248
TR a[142:143], v12 offset:53760
MM v[160:163], a[96:99], a[8:11], v[160:163]
MM v[164:167], a[100:103], a[8:11], v[164:167]
ds_read_b128 a[20:23], v77 offset:0
ds_read_b128 a[24:27], v77 offset:2048
MM v[168:171], a[104:107], a[8:11], v[168:171]
MM v[172:175], a[108:111], a[8:11], v[172:175]
s_waitcnt lgkmcnt(15)
ds_read_b128 a[28:31], v77 offset:4096
ds_read_b128 a[32:35], v77 offset:6144
MM v[176:179], a[80:83], a[12:15], v[176:179]
MM v[180:183], a[84:87], a[12:15], v[180:183]
ds_read_b128 a[36:39], v77 offset:8192
MM v[184:187], a[88:91], a[12:15], v[184:187]
MM v[188:191], a[92:95], a[12:15], v[188:191]
MM v[192:195], a[96:99], a[12:15], v[192:195]
MM v[196:199], a[100:103], a[12:15], v[196:199]
MM v[200:203], a[104:107], a[12:15], v[200:203]
MM v[204:207], a[108:111], a[12:15], v[204:207]
MM v[208:211], a[80:83], a[16:19], v[208:211]
MM v[212:215], a[84:87], a[16:19], v[212:215]
MM v[216:219], a[88:91], a[16:19], v[216:219]
MM v[220:223], a[92:95], a[16:19], v[220:223]
MM v[224:227], a[96:99], a[16:19], v[224:227]
MM v[228:231], a[100:103], a[16:19], v[228:231]
MM v[232:235], a[104:107], a[16:19], v[232:235]
MM v[236:239], a[108:111], a[16:19], v[236:239]
s_waitcnt lgkmcnt(4)
MM v[80:83], a[112:115], a[20:23], v[80:83]
s_waitcnt lgkmcnt(0)
s_barrier
s_add_u32 m0, s29, 0x1df80
MM v[84:87], a[116:119], a[20:23], v[84:87]
s_add_u32 s30, s48, 0x0
buffer_load_dwordx4 v15, s[12:15], s30 offen offset:128 lds
MM v[88:91], a[120:123], a[20:23], v[88:91]
MM v[92:95], a[124:127], a[20:23], v[92:95]
s_add_u32 m0, s29, 0x1e780
s_add_u32 s30, s48, 0x4000
MM v[96:99], a[128:131], a[20:23], v[96:99]
buffer_load_dwordx4 v15, s[12:15], s30 offen offset:128 lds
MM v[100:103], a[132:135], a[20:23], v[100:103]
MM v[104:107], a[136:139], a[20:23], v[104:107]
s_add_u32 m0, s29, 0x1ef80
s_add_u32 s30, s48, 0x8000
MM v[108:111], a[140:143], a[20:23], v[108:111]
buffer_load_dwordx4 v15, s[12:15], s30 offen offset:128 lds
MM v[112:115], a[112:115], a[24:27], v[112:115]
MM v[116:119], a[116:119], a[24:27], v[116:119]
s_add_u32 m0, s29, 0x1f780
s_add_u32 s30, s48, 0xc000
MM v[120:123], a[120:123], a[24:27], v[120:123]
buffer_load_dwordx4 v15, s[12:15], s30 offen offset:128 lds
MM v[124:127], a[124:127], a[24:27], v[124:127]
MM v[128:131], a[128:131], a[24:27], v[128:131]
s_add_u32 m0, s29, 0x1ff80
s_add_u32 s30, s48, 0x10000
MM v[132:135], a[132:135], a[24:27], v[132:135]
buffer_load_dwordx4 v15, s[12:15], s30 offen offset:128 lds
MM v[136:139], a[136:139], a[24:27], v[136:139]
MM v[140:143], a[140:143], a[24:27], v[140:143]
s_add_u32 m0, s28, 0x18000
s_add_u32 s30, s43, 0xc0100
MM v[144:147], a[112:115], a[28:31], v[144:147]
buffer_load_dwordx4 v16, s[16:19], s30 offen lds
MM v[148:151], a[116:119], a[28:31], v[148:151]
MM v[152:155], a[120:123], a[28:31], v[152:155]
s_add_u32 m0, s28, 0x18f80
MM v[156:159], a[124:127], a[28:31], v[156:159]
buffer_load_dwordx4 v16, s[16:19], s30 offen offset:128 lds
MM v[160:163], a[128:131], a[28:31], v[160:163]
MM v[164:167], a[132:135], a[28:31], v[164:167]
s_add_u32 m0, s28, 0x18800
s_add_u32 s30, s43, 0xe0100
MM v[168:171], a[136:139], a[28:31], v[168:171]
buffer_load_dwordx4 v16, s[16:19], s30 offen lds
MM v[172:175], a[140:143], a[28:31], v[172:175]
MM v[176:179], a[112:115], a[32:35], v[176:179]
s_add_u32 m0, s28, 0x19780
MM v[180:183], a[116:119], a[32:35], v[180:183]
buffer_load_dwordx4 v16, s[16:19], s30 offen offset:128 lds
MM v[184:187], a[120:123], a[32:35], v[184:187]
MM v[188:191], a[124:127], a[32:35], v[188:191]
MM v[192:195], a[128:131], a[32:35], v[192:195]
MM v[196:199], a[132:135], a[32:35], v[196:199]
MM v[200:203], a[136:139], a[32:35], v[200:203]
MM v[204:207], a[140:143], a[32:35], v[204:207]
MM v[208:211], a[112:115], a[36:39], v[208:211]
MM v[212:215], a[116:119], a[36:39], v[212:215]
MM v[216:219], a[120:123], a[36:39], v[216:219]
MM v[220:223], a[124:127], a[36:39], v[220:223]
MM v[224:227], a[128:131], a[36:39], v[224:227]
MM v[228:231], a[132:135], a[36:39], v[228:231]
MM v[232:235], a[136:139], a[36:39], v[232:235]
MM v[236:239], a[140:143], a[36:39], v[236:239]
v_pk_mul_f32 v[80:81], v[80:81], s[38:39]
v_pk_mul_f32 v[82:83], v[82:83], s[38:39]
v_pk_mul_f32 v[84:85], v[84:85], s[38:39]
v_pk_mul_f32 v[86:87], v[86:87], s[38:39]
CV v80, v80, v81
CV v81, v82, v83
CV v82, v84, v85
CV v83, v86, v87
v_accvgpr_write_b32 a144, v80
v_accvgpr_write_b32 a145, v81
v_accvgpr_write_b32 a146, v82
v_accvgpr_write_b32 a147, v83
v_pk_mul_f32 v[88:89], v[88:89], s[38:39]
v_pk_mul_f32 v[90:91], v[90:91], s[38:39]
v_pk_mul_f32 v[92:93], v[92:93], s[38:39]
v_pk_mul_f32 v[94:95], v[94:95], s[38:39]
CV v88, v88, v89
CV v89, v90, v91
CV v90, v92, v93
CV v91, v94, v95
v_accvgpr_write_b32 a148, v88
v_accvgpr_write_b32 a149, v89
v_accvgpr_write_b32 a150, v90
v_accvgpr_write_b32 a151, v91
v_pk_mul_f32 v[96:97], v[96:97], s[38:39]
v_pk_mul_f32 v[98:99], v[98:99], s[38:39]
v_pk_mul_f32 v[100:101], v[100:101], s[38:39]
v_pk_mul_f32 v[102:103], v[102:103], s[38:39]
CV v96, v96, v97
CV v97, v98, v99
CV v98, v100, v101
CV v99, v102, v103
v_accvgpr_write_b32 a152, v96
v_accvgpr_write_b32 a153, v97
v_accvgpr_write_b32 a154, v98
v_accvgpr_write_b32 a155, v99
v_pk_mul_f32 v[104:105], v[104:105], s[38:39]
v_pk_mul_f32 v[106:107], v[106:107], s[38:39]
v_pk_mul_f32 v[108:109], v[108:109], s[38:39]
v_pk_mul_f32 v[110:111], v[110:111], s[38:39]
CV v104, v104, v105
CV v105, v106, v107
CV v106, v108, v109
CV v107, v110, v111
v_accvgpr_write_b32 a156, v104
v_accvgpr_write_b32 a157, v105
v_accvgpr_write_b32 a158, v106
v_accvgpr_write_b32 a159, v107
v_pk_mul_f32 v[112:113], v[112:113], s[38:39]
v_pk_mul_f32 v[114:115], v[114:115], s[38:39]
v_pk_mul_f32 v[116:117], v[116:117], s[38:39]
v_pk_mul_f32 v[118:119], v[118:119], s[38:39]
CV v112, v112, v113
CV v113, v114, v115
CV v114, v116, v117
CV v115, v118, v119
v_accvgpr_write_b32 a160, v112
v_accvgpr_write_b32 a161, v113
v_accvgpr_write_b32 a162, v114
v_accvgpr_write_b32 a163, v115
v_pk_mul_f32 v[120:121], v[120:121], s[38:39]
v_pk_mul_f32 v[122:123], v[122:123], s[38:39]
v_pk_mul_f32 v[124:125], v[124:125], s[38:39]
v_pk_mul_f32 v[126:127], v[126:127], s[38:39]
CV v120, v120, v121
CV v121, v122, v123
CV v122, v124, v125
CV v123, v126, v127
v_accvgpr_write_b32 a164, v120
v_accvgpr_write_b32 a165, v121
v_accvgpr_write_b32 a166, v122
v_accvgpr_write_b32 a167, v123
v_pk_mul_f32 v[128:129], v[128:129], s[38:39]
v_pk_mul_f32 v[130:131], v[130:131], s[38:39]
v_pk_mul_f32 v[132:133], v[132:133], s[38:39]
v_pk_mul_f32 v[134:135], v[134:135], s[38:39]
CV v128, v128, v129
CV v129, v130, v131
CV v130, v132, v133
CV v131, v134, v135
v_accvgpr_write_b32 a168, v128
v_accvgpr_write_b32 a169, v129
v_accvgpr_write_b32 a170, v130
v_accvgpr_write_b32 a171, v131
v_pk_mul_f32 v[136:137], v[136:137], s[38:39]
v_pk_mul_f32 v[138:139], v[138:139], s[38:39]
v_pk_mul_f32 v[140:141], v[140:141], s[38:39]
v_pk_mul_f32 v[142:143], v[142:143], s[38:39]
CV v136, v136, v137
CV v137, v138, v139
CV v138, v140, v141
CV v139, v142, v143
v_accvgpr_write_b32 a172, v136
v_accvgpr_write_b32 a173, v137
v_accvgpr_write_b32 a174, v138
v_accvgpr_write_b32 a175, v139
v_pk_mul_f32 v[144:145], v[144:145], s[38:39]
v_pk_mul_f32 v[146:147], v[146:147], s[38:39]
v_pk_mul_f32 v[148:149], v[148:149], s[38:39]
v_pk_mul_f32 v[150:151], v[150:151], s[38:39]
CV v144, v144, v145
CV v145, v146, v147
CV v146, v148, v149
CV v147, v150, v151
v_accvgpr_write_b32 a176, v144
v_accvgpr_write_b32 a177, v145
v_accvgpr_write_b32 a178, v146
v_accvgpr_write_b32 a179, v147
v_pk_mul_f32 v[152:153], v[152:153], s[38:39]
v_pk_mul_f32 v[154:155], v[154:155], s[38:39]
v_pk_mul_f32 v[156:157], v[156:157], s[38:39]
v_pk_mul_f32 v[158:159], v[158:159], s[38:39]
CV v152, v152, v153
CV v153, v154, v155
CV v154, v156, v157
CV v155, v158, v159
v_accvgpr_write_b32 a180, v152
v_accvgpr_write_b32 a181, v153
v_accvgpr_write_b32 a182, v154
v_accvgpr_write_b32 a183, v155
v_pk_mul_f32 v[160:161], v[160:161], s[38:39]
v_pk_mul_f32 v[162:163], v[162:163], s[38:39]
v_pk_mul_f32 v[164:165], v[164:165], s[38:39]
v_pk_mul_f32 v[166:167], v[166:167], s[38:39]
CV v160, v160, v161
CV v161, v162, v163
CV v162, v164, v165
CV v163, v166, v167
v_accvgpr_write_b32 a184, v160
v_accvgpr_write_b32 a185, v161
v_accvgpr_write_b32 a186, v162
v_accvgpr_write_b32 a187, v163
v_pk_mul_f32 v[168:169], v[168:169], s[38:39]
v_pk_mul_f32 v[170:171], v[170:171], s[38:39]
v_pk_mul_f32 v[172:173], v[172:173], s[38:39]
v_pk_mul_f32 v[174:175], v[174:175], s[38:39]
CV v168, v168, v169
CV v169, v170, v171
CV v170, v172, v173
CV v171, v174, v175
v_accvgpr_write_b32 a188, v168
s_waitcnt vmcnt(17)
s_barrier
v_accvgpr_write_b32 a189, v169
v_accvgpr_write_b32 a190, v170
v_accvgpr_write_b32 a191, v171
TR a[80:81], v9 offset:0
TR a[82:83], v9 offset:512
v_pk_mul_f32 v[176:177], v[176:177], s[38:39]
v_pk_mul_f32 v[178:179], v[178:179], s[38:39]
v_pk_mul_f32 v[180:181], v[180:181], s[38:39]
v_pk_mul_f32 v[182:183], v[182:183], s[38:39]
TR a[84:85], v10 offset:0
TR a[86:87], v10 offset:512
CV v176, v176, v177
CV v177, v178, v179
CV v178, v180, v181
CV v179, v182, v183
TR a[88:89], v11 offset:0
TR a[90:91], v11 offset:512
v_accvgpr_write_b32 a192, v176
v_accvgpr_write_b32 a193, v177
v_accvgpr_write_b32 a194, v178
v_accvgpr_write_b32 a195, v179
TR a[92:93], v12 offset:0
TR a[94:95], v12 offset:512
v_pk_mul_f32 v[184:185], v[184:185], s[38:39]
v_pk_mul_f32 v[186:187], v[186:187], s[38:39]
v_pk_mul_f32 v[188:189], v[188:189], s[38:39]
v_pk_mul_f32 v[190:191], v[190:191], s[38:39]
TR a[96:97], v9 offset:4096
TR a[98:99], v9 offset:4608
CV v184, v184, v185
CV v185, v186, v187
CV v186, v188, v189
CV v187, v190, v191
TR a[100:101], v10 offset:4096
TR a[102:103], v10 offset:4608
v_accvgpr_write_b32 a196, v184
v_accvgpr_write_b32 a197, v185
v_accvgpr_write_b32 a198, v186
v_accvgpr_write_b32 a199, v187
TR a[104:105], v11 offset:4096
TR a[106:107], v11 offset:4608
v_pk_mul_f32 v[192:193], v[192:193], s[38:39]
v_pk_mul_f32 v[194:195], v[194:195], s[38:39]
v_pk_mul_f32 v[196:197], v[196:197], s[38:39]
v_pk_mul_f32 v[198:199], v[198:199], s[38:39]
TR a[108:109], v12 offset:4096
TR a[110:111], v12 offset:4608
CV v192, v192, v193
CV v193, v194, v195
CV v194, v196, v197
CV v195, v198, v199
ds_read_b128 a[0:3], v76 offset:20480
ds_read_b128 a[4:7], v76 offset:22528
v_accvgpr_write_b32 a200, v192
v_accvgpr_write_b32 a201, v193
v_accvgpr_write_b32 a202, v194
v_accvgpr_write_b32 a203, v195
ds_read_b128 a[8:11], v76 offset:24576
ds_read_b128 a[12:15], v76 offset:26624
v_pk_mul_f32 v[200:201], v[200:201], s[38:39]
v_pk_mul_f32 v[202:203], v[202:203], s[38:39]
v_pk_mul_f32 v[204:205], v[204:205], s[38:39]
v_pk_mul_f32 v[206:207], v[206:207], s[38:39]
ds_read_b128 a[16:19], v76 offset:28672
CV v200, v200, v201
CV v201, v202, v203
CV v202, v204, v205
CV v203, v206, v207
v_accvgpr_write_b32 a204, v200
v_accvgpr_write_b32 a205, v201
v_accvgpr_write_b32 a206, v202
v_accvgpr_write_b32 a207, v203
v_pk_mul_f32 v[208:209], v[208:209], s[38:39]
v_pk_mul_f32 v[210:211], v[210:211], s[38:39]
v_pk_mul_f32 v[212:213], v[212:213], s[38:39]
v_pk_mul_f32 v[214:215], v[214:215], s[38:39]
CV v208, v208, v209
CV v209, v210, v211
CV v210, v212, v213
CV v211, v214, v215
v_accvgpr_write_b32 a208, v208
v_accvgpr_write_b32 a209, v209
v_accvgpr_write_b32 a210, v210
v_accvgpr_write_b32 a211, v211
v_pk_mul_f32 v[216:217], v[216:217], s[38:39]
v_pk_mul_f32 v[218:219], v[218:219], s[38:39]
v_pk_mul_f32 v[220:221], v[220:221], s[38:39]
v_pk_mul_f32 v[222:223], v[222:223], s[38:39]
CV v216, v216, v217
CV v217, v218, v219
CV v218, v220, v221
CV v219, v222, v223
v_accvgpr_write_b32 a212, v216
v_accvgpr_write_b32 a213, v217
v_accvgpr_write_b32 a214, v218
v_accvgpr_write_b32 a215, v219
v_pk_mul_f32 v[224:225], v[224:225], s[38:39]
v_pk_mul_f32 v[226:227], v[226:227], s[38:39]
v_pk_mul_f32 v[228:229], v[228:229], s[38:39]
v_pk_mul_f32 v[230:231], v[230:231], s[38:39]
CV v224, v224, v225
CV v225, v226, v227
CV v226, v228, v229
CV v227, v230, v231
v_accvgpr_write_b32 a216, v224
v_accvgpr_write_b32 a217, v225
v_accvgpr_write_b32 a218, v226
v_accvgpr_write_b32 a219, v227
v_pk_mul_f32 v[232:233], v[232:233], s[38:39]
v_pk_mul_f32 v[234:235], v[234:235], s[38:39]
v_pk_mul_f32 v[236:237], v[236:237], s[38:39]
v_pk_mul_f32 v[238:239], v[238:239], s[38:39]
CV v232, v232, v233
CV v233, v234, v235
CV v234, v236, v237
CV v235, v238, v239
v_accvgpr_write_b32 a220, v232
v_accvgpr_write_b32 a221, v233
v_accvgpr_write_b32 a222, v234
v_accvgpr_write_b32 a223, v235
s_waitcnt lgkmcnt(4)
MM v[80:83], a[80:83], a[0:3], 0
s_waitcnt vmcnt(13)
s_barrier
s_add_u32 m0, s28, 0xc000
MM v[84:87], a[84:87], a[0:3], 0
s_add_u32 s30, s43, 0x100100
buffer_load_dwordx4 v16, s[16:19], s30 offen lds
MM v[88:91], a[88:91], a[0:3], 0
TR a[112:113], v9 offset:16384
TR a[114:115], v9 offset:16896
MM v[92:95], a[92:95], a[0:3], 0
s_add_u32 m0, s28, 0xcf80
MM v[96:99], a[96:99], a[0:3], 0
buffer_load_dwordx4 v16, s[16:19], s30 offen offset:128 lds
MM v[100:103], a[100:103], a[0:3], 0
TR a[116:117], v10 offset:16384
TR a[118:119], v10 offset:16896
MM v[104:107], a[104:107], a[0:3], 0
s_add_u32 m0, s28, 0xc800
s_add_u32 s30, s43, 0x120100
MM v[108:111], a[108:111], a[0:3], 0
s_waitcnt lgkmcnt(7)
buffer_load_dwordx4 v16, s[16:19], s30 offen lds
MM v[112:115], a[80:83], a[4:7], 0
TR a[120:121], v11 offset:16384
TR a[122:123], v11 offset:16896
MM v[116:119], a[84:87], a[4:7], 0
s_add_u32 m0, s28, 0xd780
MM v[120:123], a[88:91], a[4:7], 0
buffer_load_dwordx4 v16, s[16:19], s30 offen offset:128 lds
MM v[124:127], a[92:95], a[4:7], 0
TR a[124:125], v12 offset:16384
TR a[126:127], v12 offset:16896
MM v[128:131], a[96:99], a[4:7], 0
MM v[132:135], a[100:103], a[4:7], 0
TR a[128:129], v9 offset:20480
TR a[130:131], v9 offset:20992
MM v[136:139], a[104:107], a[4:7], 0
MM v[140:143], a[108:111], a[4:7], 0
s_waitcnt lgkmcnt(12)
TR a[132:133], v10 offset:20480
TR a[134:135], v10 offset:20992
MM v[144:147], a[80:83], a[8:11], 0
MM v[148:151], a[84:87], a[8:11], 0
TR a[136:137], v11 offset:20480
TR a[138:139], v11 offset:20992
MM v[152:155], a[88:91], a[8:11], 0
MM v[156:159], a[92:95], a[8:11], 0
TR a[140:141], v12 offset:20480
TR a[142:143], v12 offset:20992
MM v[160:163], a[96:99], a[8:11], 0
MM v[164:167], a[100:103], a[8:11], 0
ds_read_b128 a[20:23], v77 offset:20480
ds_read_b128 a[24:27], v77 offset:22528
MM v[168:171], a[104:107], a[8:11], 0
MM v[172:175], a[108:111], a[8:11], 0
s_waitcnt lgkmcnt(15)
ds_read_b128 a[28:31], v77 offset:24576
ds_read_b128 a[32:35], v77 offset:26624
MM v[176:179], a[80:83], a[12:15], 0
MM v[180:183], a[84:87], a[12:15], 0
ds_read_b128 a[36:39], v77 offset:28672
MM v[184:187], a[88:91], a[12:15], 0
MM v[188:191], a[92:95], a[12:15], 0
MM v[192:195], a[96:99], a[12:15], 0
MM v[196:199], a[100:103], a[12:15], 0
MM v[200:203], a[104:107], a[12:15], 0
MM v[204:207], a[108:111], a[12:15], 0
MM v[208:211], a[80:83], a[16:19], 0
MM v[212:215], a[84:87], a[16:19], 0
MM v[216:219], a[88:91], a[16:19], 0
MM v[220:223], a[92:95], a[16:19], 0
MM v[224:227], a[96:99], a[16:19], 0
MM v[228:231], a[100:103], a[16:19], 0
MM v[232:235], a[104:107], a[16:19], 0
MM v[236:239], a[108:111], a[16:19], 0
s_mov_b32 s96, 3
L_YQ1:
s_add_u32 s43, s43, 0x100000
s_add_u32 s48, s48, 0x100
s_waitcnt lgkmcnt(4)
MM v[80:83], a[112:115], a[20:23], v[80:83]
s_waitcnt vmcnt(8) lgkmcnt(0)
s_barrier
s_add_u32 m0, s29, 0x23000
MM v[84:87], a[116:119], a[20:23], v[84:87]
s_add_u32 s30, s48, 0x0
buffer_load_dwordx4 v15, s[12:15], s30 offen lds
MM v[88:91], a[120:123], a[20:23], v[88:91]
TR a[80:81], v9 offset:32768
TR a[82:83], v9 offset:33280
MM v[92:95], a[124:127], a[20:23], v[92:95]
s_add_u32 m0, s29, 0x23800
s_add_u32 s30, s48, 0x4000
MM v[96:99], a[128:131], a[20:23], v[96:99]
buffer_load_dwordx4 v15, s[12:15], s30 offen lds
MM v[100:103], a[132:135], a[20:23], v[100:103]
TR a[84:85], v10 offset:32768
TR a[86:87], v10 offset:33280
MM v[104:107], a[136:139], a[20:23], v[104:107]
s_add_u32 m0, s29, 0x24000
s_add_u32 s30, s48, 0x8000
MM v[108:111], a[140:143], a[20:23], v[108:111]
buffer_load_dwordx4 v15, s[12:15], s30 offen lds
MM v[112:115], a[112:115], a[24:27], v[112:115]
TR a[88:89], v11 offset:32768
TR a[90:91], v11 offset:33280
MM v[116:119], a[116:119], a[24:27], v[116:119]
s_add_u32 m0, s29, 0x24800
s_add_u32 s30, s48, 0xc000
MM v[120:123], a[120:123], a[24:27], v[120:123]
buffer_load_dwordx4 v15, s[12:15], s30 offen lds
MM v[124:127], a[124:127], a[24:27], v[124:127]
TR a[92:93], v12 offset:32768
TR a[94:95], v12 offset:33280
MM v[128:131], a[128:131], a[24:27], v[128:131]
s_add_u32 m0, s29, 0x25000
s_add_u32 s30, s48, 0x10000
MM v[132:135], a[132:135], a[24:27], v[132:135]
buffer_load_dwordx4 v15, s[12:15], s30 offen lds
MM v[136:139], a[136:139], a[24:27], v[136:139]
TR a[96:97], v9 offset:36864
TR a[98:99], v9 offset:37376
MM v[140:143], a[140:143], a[24:27], v[140:143]
s_add_u32 m0, s28, 0x10000
s_add_u32 s30, s43, 0x40100
MM v[144:147], a[112:115], a[28:31], v[144:147]
buffer_load_dwordx4 v16, s[16:19], s30 offen lds
MM v[148:151], a[116:119], a[28:31], v[148:151]
TR a[100:101], v10 offset:36864
TR a[102:103], v10 offset:37376
MM v[152:155], a[120:123], a[28:31], v[152:155]
s_add_u32 m0, s28, 0x10f80
MM v[156:159], a[124:127], a[28:31], v[156:159]
buffer_load_dwordx4 v16, s[16:19], s30 offen offset:128 lds
MM v[160:163], a[128:131], a[28:31], v[160:163]
TR a[104:105], v11 offset:36864
TR a[106:107], v11 offset:37376
MM v[164:167], a[132:135], a[28:31], v[164:167]
s_add_u32 m0, s28, 0x10800
s_add_u32 s30, s43, 0x60100
MM v[168:171], a[136:139], a[28:31], v[168:171]
buffer_load_dwordx4 v16, s[16:19], s30 offen lds
MM v[172:175], a[140:143], a[28:31], v[172:175]
TR a[108:109], v12 offset:36864
TR a[110:111], v12 offset:37376
MM v[176:179], a[112:115], a[32:35], v[176:179]
s_add_u32 m0, s28, 0x11780
MM v[180:183], a[116:119], a[32:35], v[180:183]
buffer_load_dwordx4 v16, s[16:19], s30 offen offset:128 lds
MM v[184:187], a[120:123], a[32:35], v[184:187]
ds_read_b128 a[0:3], v76 offset:0
ds_read_b128 a[4:7], v76 offset:2048
MM v[188:191], a[124:127], a[32:35], v[188:191]
MM v[192:195], a[128:131], a[32:35], v[192:195]
ds_read_b128 a[8:11], v76 offset:4096
ds_read_b128 a[12:15], v76 offset:6144
MM v[196:199], a[132:135], a[32:35], v[196:199]
MM v[200:203], a[136:139], a[32:35], v[200:203]
ds_read_b128 a[16:19], v76 offset:8192
MM v[204:207], a[140:143], a[32:35], v[204:207]
MM v[208:211], a[112:115], a[36:39], v[208:211]
MM v[212:215], a[116:119], a[36:39], v[212:215]
MM v[216:219], a[120:123], a[36:39], v[216:219]
MM v[220:223], a[124:127], a[36:39], v[220:223]
MM v[224:227], a[128:131], a[36:39], v[224:227]
MM v[228:231], a[132:135], a[36:39], v[228:231]
MM v[232:235], a[136:139], a[36:39], v[232:235]
MM v[236:239], a[140:143], a[36:39], v[236:239]
s_waitcnt lgkmcnt(4)
MM v[80:83], a[80:83], a[0:3], v[80:83]
s_waitcnt vmcnt(13)
s_barrier
s_add_u32 m0, s28, 0x14000
MM v[84:87], a[84:87], a[0:3], v[84:87]
s_add_u32 s30, s43, 0x80100
buffer_load_dwordx4 v16, s[16:19], s30 offen lds
MM v[88:91], a[88:91], a[0:3], v[88:91]
TR a[112:113], v9 offset:49152
TR a[114:115], v9 offset:49664
MM v[92:95], a[92:95], a[0:3], v[92:95]
s_add_u32 m0, s28, 0x14f80
MM v[96:99], a[96:99], a[0:3], v[96:99]
buffer_load_dwordx4 v16, s[16:19], s30 offen offset:128 lds
MM v[100:103], a[100:103], a[0:3], v[100:103]
TR a[116:117], v10 offset:49152
TR a[118:119], v10 offset:49664
MM v[104:107], a[104:107], a[0:3], v[104:107]
s_add_u32 m0, s28, 0x14800
s_add_u32 s30, s43, 0xa0100
MM v[108:111], a[108:111], a[0:3], v[108:111]
s_waitcnt lgkmcnt(7)
buffer_load_dwordx4 v16, s[16:19], s30 offen lds
MM v[112:115], a[80:83], a[4:7], v[112:115]
TR a[120:121], v11 offset:49152
TR a[122:123], v11 offset:49664
MM v[116:119], a[84:87], a[4:7], v[116:119]
s_add_u32 m0, s28, 0x15780
MM v[120:123], a[88:91], a[4:7], v[120:123]
buffer_load_dwordx4 v16, s[16:19], s30 offen offset:128 lds
MM v[124:127], a[92:95], a[4:7], v[124:127]
TR a[124:125], v12 offset:49152
TR a[126:127], v12 offset:49664
MM v[128:131], a[96:99], a[4:7], v[128:131]
MM v[132:135], a[100:103], a[4:7], v[132:135]
TR a[128:129], v9 offset:53248
TR a[130:131], v9 offset:53760
MM v[136:139], a[104:107], a[4:7], v[136:139]
MM v[140:143], a[108:111], a[4:7], v[140:143]
s_waitcnt lgkmcnt(12)
TR a[132:133], v10 offset:53248
TR a[134:135], v10 offset:53760
MM v[144:147], a[80:83], a[8:11], v[144:147]
MM v[148:151], a[84:87], a[8:11], v[148:151]
TR a[136:137], v11 offset:53248
TR a[138:139], v11 offset:53760
MM v[152:155], a[88:91], a[8:11], v[152:155]
MM v[156:159], a[92:95], a[8:11], v[156:159]
TR a[140:141], v12 offset:53248
TR a[142:143], v12 offset:53760
MM v[160:163], a[96:99], a[8:11], v[160:163]
MM v[164:167], a[100:103], a[8:11], v[164:167]
ds_read_b128 a[20:23], v77 offset:0
ds_read_b128 a[24:27], v77 offset:2048
MM v[168:171], a[104:107], a[8:11], v[168:171]
MM v[172:175], a[108:111], a[8:11], v[172:175]
s_waitcnt lgkmcnt(15)
ds_read_b128 a[28:31], v77 offset:4096
ds_read_b128 a[32:35], v77 offset:6144
MM v[176:179], a[80:83], a[12:15], v[176:179]
MM v[180:183], a[84:87], a[12:15], v[180:183]
ds_read_b128 a[36:39], v77 offset:8192
MM v[184:187], a[88:91], a[12:15], v[184:187]
MM v[188:191], a[92:95], a[12:15], v[188:191]
MM v[192:195], a[96:99], a[12:15], v[192:195]
MM v[196:199], a[100:103], a[12:15], v[196:199]
MM v[200:203], a[104:107], a[12:15], v[200:203]
MM v[204:207], a[108:111], a[12:15], v[204:207]
MM v[208:211], a[80:83], a[16:19], v[208:211]
MM v[212:215], a[84:87], a[16:19], v[212:215]
MM v[216:219], a[88:91], a[16:19], v[216:219]
MM v[220:223], a[92:95], a[16:19], v[220:223]
MM v[224:227], a[96:99], a[16:19], v[224:227]
MM v[228:231], a[100:103], a[16:19], v[228:231]
MM v[232:235], a[104:107], a[16:19], v[232:235]
MM v[236:239], a[108:111], a[16:19], v[236:239]
s_waitcnt lgkmcnt(4)
MM v[80:83], a[112:115], a[20:23], v[80:83]
s_waitcnt vmcnt(8) lgkmcnt(0)
s_barrier
s_add_u32 m0, s29, 0x1df80
MM v[84:87], a[116:119], a[20:23], v[84:87]
s_add_u32 s30, s48, 0x0
buffer_load_dwordx4 v15, s[12:15], s30 offen offset:128 lds
MM v[88:91], a[120:123], a[20:23], v[88:91]
TR a[80:81], v9 offset:0
TR a[82:83], v9 offset:512
MM v[92:95], a[124:127], a[20:23], v[92:95]
s_add_u32 m0, s29, 0x1e780
s_add_u32 s30, s48, 0x4000
MM v[96:99], a[128:131], a[20:23], v[96:99]
buffer_load_dwordx4 v15, s[12:15], s30 offen offset:128 lds
MM v[100:103], a[132:135], a[20:23], v[100:103]
TR a[84:85], v10 offset:0
TR a[86:87], v10 offset:512
MM v[104:107], a[136:139], a[20:23], v[104:107]
s_add_u32 m0, s29, 0x1ef80
s_add_u32 s30, s48, 0x8000
MM v[108:111], a[140:143], a[20:23], v[108:111]
buffer_load_dwordx4 v15, s[12:15], s30 offen offset:128 lds
MM v[112:115], a[112:115], a[24:27], v[112:115]
TR a[88:89], v11 offset:0
TR a[90:91], v11 offset:512
MM v[116:119], a[116:119], a[24:27], v[116:119]
s_add_u32 m0, s29, 0x1f780
s_add_u32 s30, s48, 0xc000
MM v[120:123], a[120:123], a[24:27], v[120:123]
buffer_load_dwordx4 v15, s[12:15], s30 offen offset:128 lds
MM v[124:127], a[124:127], a[24:27], v[124:127]
TR a[92:93], v12 offset:0
TR a[94:95], v12 offset:512
MM v[128:131], a[128:131], a[24:27], v[128:131]
s_add_u32 m0, s29, 0x1ff80
s_add_u32 s30, s48, 0x10000
MM v[132:135], a[132:135], a[24:27], v[132:135]
buffer_load_dwordx4 v15, s[12:15], s30 offen offset:128 lds
MM v[136:139], a[136:139], a[24:27], v[136:139]
TR a[96:97], v9 offset:4096
TR a[98:99], v9 offset:4608
MM v[140:143], a[140:143], a[24:27], v[140:143]
s_add_u32 m0, s28, 0x18000
s_add_u32 s30, s43, 0xc0100
MM v[144:147], a[112:115], a[28:31], v[144:147]
buffer_load_dwordx4 v16, s[16:19], s30 offen lds
MM v[148:151], a[116:119], a[28:31], v[148:151]
TR a[100:101], v10 offset:4096
TR a[102:103], v10 offset:4608
MM v[152:155], a[120:123], a[28:31], v[152:155]
s_add_u32 m0, s28, 0x18f80
MM v[156:159], a[124:127], a[28:31], v[156:159]
buffer_load_dwordx4 v16, s[16:19], s30 offen offset:128 lds
MM v[160:163], a[128:131], a[28:31], v[160:163]
TR a[104:105], v11 offset:4096
TR a[106:107], v11 offset:4608
MM v[164:167], a[132:135], a[28:31], v[164:167]
s_add_u32 m0, s28, 0x18800
s_add_u32 s30, s43, 0xe0100
MM v[168:171], a[136:139], a[28:31], v[168:171]
buffer_load_dwordx4 v16, s[16:19], s30 offen lds
MM v[172:175], a[140:143], a[28:31], v[172:175]
TR a[108:109], v12 offset:4096
TR a[110:111], v12 offset:4608
MM v[176:179], a[112:115], a[32:35], v[176:179]
s_add_u32 m0, s28, 0x19780
MM v[180:183], a[116:119], a[32:35], v[180:183]
buffer_load_dwordx4 v16, s[16:19], s30 offen offset:128 lds
MM v[184:187], a[120:123], a[32:35], v[184:187]
ds_read_b128 a[0:3], v76 offset:20480
ds_read_b128 a[4:7], v76 offset:22528
MM v[188:191], a[124:127], a[32:35], v[188:191]
MM v[192:195], a[128:131], a[32:35], v[192:195]
ds_read_b128 a[8:11], v76 offset:24576
ds_read_b128 a[12:15], v76 offset:26624
MM v[196:199], a[132:135], a[32:35], v[196:199]
MM v[200:203], a[136:139], a[32:35], v[200:203]
ds_read_b128 a[16:19], v76 offset:28672
MM v[204:207], a[140:143], a[32:35], v[204:207]
MM v[208:211], a[112:115], a[36:39], v[208:211]
MM v[212:215], a[116:119], a[36:39], v[212:215]
MM v[216:219], a[120:123], a[36:39], v[216:219]
MM v[220:223], a[124:127], a[36:39], v[220:223]
MM v[224:227], a[128:131], a[36:39], v[224:227]
MM v[228:231], a[132:135], a[36:39], v[228:231]
MM v[232:235], a[136:139], a[36:39], v[232:235]
MM v[236:239], a[140:143], a[36:39], v[236:239]
s_waitcnt lgkmcnt(4)
MM v[80:83], a[80:83], a[0:3], v[80:83]
s_waitcnt vmcnt(13)
s_barrier
s_add_u32 m0, s28, 0xc000
MM v[84:87], a[84:87], a[0:3], v[84:87]
s_add_u32 s30, s43, 0x100100
buffer_load_dwordx4 v16, s[16:19], s30 offen lds
MM v[88:91], a[88:91], a[0:3], v[88:91]
TR a[112:113], v9 offset:16384
TR a[114:115], v9 offset:16896
MM v[92:95], a[92:95], a[0:3], v[92:95]
s_add_u32 m0, s28, 0xcf80
MM v[96:99], a[96:99], a[0:3], v[96:99]
buffer_load_dwordx4 v16, s[16:19], s30 offen offset:128 lds
MM v[100:103], a[100:103], a[0:3], v[100:103]
TR a[116:117], v10 offset:16384
TR a[118:119], v10 offset:16896
MM v[104:107], a[104:107], a[0:3], v[104:107]
s_add_u32 m0, s28, 0xc800
s_add_u32 s30, s43, 0x120100
MM v[108:111], a[108:111], a[0:3], v[108:111]
s_waitcnt lgkmcnt(7)
buffer_load_dwordx4 v16, s[16:19], s30 offen lds
MM v[112:115], a[80:83], a[4:7], v[112:115]
TR a[120:121], v11 offset:16384
TR a[122:123], v11 offset:16896
MM v[116:119], a[84:87], a[4:7], v[116:119]
s_add_u32 m0, s28, 0xd780
MM v[120:123], a[88:91], a[4:7], v[120:123]
buffer_load_dwordx4 v16, s[16:19], s30 offen offset:128 lds
MM v[124:127], a[92:95], a[4:7], v[124:127]
TR a[124:125], v12 offset:16384
TR a[126:127], v12 offset:16896
MM v[128:131], a[96:99], a[4:7], v[128:131]
MM v[132:135], a[100:103], a[4:7], v[132:135]
TR a[128:129], v9 offset:20480
TR a[130:131], v9 offset:20992
MM v[136:139], a[104:107], a[4:7], v[136:139]
MM v[140:143], a[108:111], a[4:7], v[140:143]
s_waitcnt lgkmcnt(12)
TR a[132:133], v10 offset:20480
TR a[134:135], v10 offset:20992
MM v[144:147], a[80:83], a[8:11], v[144:147]
MM v[148:151], a[84:87], a[8:11], v[148:151]
TR a[136:137], v11 offset:20480
TR a[138:139], v11 offset:20992
MM v[152:155], a[88:91], a[8:11], v[152:155]
MM v[156:159], a[92:95], a[8:11], v[156:159]
TR a[140:141], v12 offset:20480
TR a[142:143], v12 offset:20992
MM v[160:163], a[96:99], a[8:11], v[160:163]
MM v[164:167], a[100:103], a[8:11], v[164:167]
ds_read_b128 a[20:23], v77 offset:20480
ds_read_b128 a[24:27], v77 offset:22528
MM v[168:171], a[104:107], a[8:11], v[168:171]
MM v[172:175], a[108:111], a[8:11], v[172:175]
s_waitcnt lgkmcnt(15)
ds_read_b128 a[28:31], v77 offset:24576
ds_read_b128 a[32:35], v77 offset:26624
MM v[176:179], a[80:83], a[12:15], v[176:179]
MM v[180:183], a[84:87], a[12:15], v[180:183]
ds_read_b128 a[36:39], v77 offset:28672
MM v[184:187], a[88:91], a[12:15], v[184:187]
MM v[188:191], a[92:95], a[12:15], v[188:191]
MM v[192:195], a[96:99], a[12:15], v[192:195]
MM v[196:199], a[100:103], a[12:15], v[196:199]
MM v[200:203], a[104:107], a[12:15], v[200:203]
MM v[204:207], a[108:111], a[12:15], v[204:207]
MM v[208:211], a[80:83], a[16:19], v[208:211]
MM v[212:215], a[84:87], a[16:19], v[212:215]
MM v[216:219], a[88:91], a[16:19], v[216:219]
MM v[220:223], a[92:95], a[16:19], v[220:223]
MM v[224:227], a[96:99], a[16:19], v[224:227]
MM v[228:231], a[100:103], a[16:19], v[228:231]
MM v[232:235], a[104:107], a[16:19], v[232:235]
MM v[236:239], a[108:111], a[16:19], v[236:239]
s_sub_u32 s96, s96, 1
s_cmp_lg_u32 s96, 0
s_cbranch_scc1 L_YQ1
s_waitcnt lgkmcnt(4)
MM v[80:83], a[112:115], a[20:23], v[80:83]
s_waitcnt vmcnt(0) lgkmcnt(0)
s_barrier
s_add_u32 m0, s28, 0x10000
MM v[84:87], a[116:119], a[20:23], v[84:87]
s_add_u32 s30, s42, 0x4000
s_and_b32 s30, s30, 0x1ffff
TR a[80:81], v9 offset:32768
MM v[88:91], a[120:123], a[20:23], v[88:91]
buffer_load_dwordx4 v13, s[4:7], s30 offen nt lds
MM v[92:95], a[124:127], a[20:23], v[92:95]
s_add_u32 m0, s28, 0x10f80
TR a[82:83], v9 offset:33280
TR a[84:85], v10 offset:32768
MM v[96:99], a[128:131], a[20:23], v[96:99]
buffer_load_dwordx4 v13, s[4:7], s30 offen offset:128 nt lds
MM v[100:103], a[132:135], a[20:23], v[100:103]
TR a[86:87], v10 offset:33280
TR a[88:89], v11 offset:32768
MM v[104:107], a[136:139], a[20:23], v[104:107]
MM v[108:111], a[140:143], a[20:23], v[108:111]
s_add_u32 m0, s28, 0x10800
s_add_u32 s30, s42, 0x5000
s_and_b32 s30, s30, 0x1ffff
MM v[112:115], a[112:115], a[24:27], v[112:115]
buffer_load_dwordx4 v13, s[4:7], s30 offen nt lds
MM v[116:119], a[116:119], a[24:27], v[116:119]
s_add_u32 m0, s28, 0x11780
TR a[90:91], v11 offset:33280
TR a[92:93], v12 offset:32768
MM v[120:123], a[120:123], a[24:27], v[120:123]
buffer_load_dwordx4 v13, s[4:7], s30 offen offset:128 nt lds
MM v[124:127], a[124:127], a[24:27], v[124:127]
TR a[94:95], v12 offset:33280
TR a[96:97], v9 offset:36864
MM v[128:131], a[128:131], a[24:27], v[128:131]
MM v[132:135], a[132:135], a[24:27], v[132:135]
s_add_u32 m0, s28, 0xc000
s_add_u32 s30, s42, 0x2000
s_and_b32 s30, s30, 0x1ffff
MM v[136:139], a[136:139], a[24:27], v[136:139]
buffer_load_dwordx4 v14, s[8:11], s30 offen nt lds
MM v[140:143], a[140:143], a[24:27], v[140:143]
s_add_u32 m0, s28, 0xcf80
TR a[98:99], v9 offset:37376
TR a[100:101], v10 offset:36864
MM v[144:147], a[112:115], a[28:31], v[144:147]
buffer_load_dwordx4 v14, s[8:11], s30 offen offset:128 nt lds
MM v[148:151], a[116:119], a[28:31], v[148:151]
TR a[102:103], v10 offset:37376
TR a[104:105], v11 offset:36864
MM v[152:155], a[120:123], a[28:31], v[152:155]
MM v[156:159], a[124:127], a[28:31], v[156:159]
s_add_u32 m0, s28, 0xc800
s_add_u32 s30, s42, 0x3000
s_and_b32 s30, s30, 0x1ffff
MM v[160:163], a[128:131], a[28:31], v[160:163]
buffer_load_dwordx4 v14, s[8:11], s30 offen nt lds
MM v[164:167], a[132:135], a[28:31], v[164:167]
s_add_u32 m0, s28, 0xd780
TR a[106:107], v11 offset:37376
TR a[108:109], v12 offset:36864
MM v[168:171], a[136:139], a[28:31], v[168:171]
buffer_load_dwordx4 v14, s[8:11], s30 offen offset:128 nt lds
MM v[172:175], a[140:143], a[28:31], v[172:175]
TR a[110:111], v12 offset:37376
ds_read_b128 a[0:3], v76 offset:0
MM v[176:179], a[112:115], a[32:35], v[176:179]
MM v[180:183], a[116:119], a[32:35], v[180:183]
ds_read_b128 a[4:7], v76 offset:2048
ds_read_b128 a[8:11], v76 offset:4096
MM v[184:187], a[120:123], a[32:35], v[184:187]
MM v[188:191], a[124:127], a[32:35], v[188:191]
ds_read_b128 a[12:15], v76 offset:6144
ds_read_b128 a[16:19], v76 offset:8192
MM v[192:195], a[128:131], a[32:35], v[192:195]
MM v[196:199], a[132:135], a[32:35], v[196:199]
MM v[200:203], a[136:139], a[32:35], v[200:203]
MM v[204:207], a[140:143], a[32:35], v[204:207]
MM v[208:211], a[112:115], a[36:39], v[208:211]
MM v[212:215], a[116:119], a[36:39], v[212:215]
MM v[216:219], a[120:123], a[36:39], v[216:219]
MM v[220:223], a[124:127], a[36:39], v[220:223]
MM v[224:227], a[128:131], a[36:39], v[224:227]
MM v[228:231], a[132:135], a[36:39], v[228:231]
MM v[232:235], a[136:139], a[36:39], v[232:235]
MM v[236:239], a[140:143], a[36:39], v[236:239]
s_waitcnt lgkmcnt(4)
MM v[80:83], a[80:83], a[0:3], v[80:83]
s_barrier
s_add_u32 m0, s28, 0x14000
s_add_u32 s30, s42, 0x4000
MM v[84:87], a[84:87], a[0:3], v[84:87]
s_and_b32 s30, s30, 0x1ffff
buffer_load_dwordx4 v14, s[8:11], s30 offen nt lds
MM v[88:91], a[88:91], a[0:3], v[88:91]
s_add_u32 m0, s28, 0x14f80
TR a[112:113], v9 offset:49152
TR a[114:115], v9 offset:49664
MM v[92:95], a[92:95], a[0:3], v[92:95]
buffer_load_dwordx4 v14, s[8:11], s30 offen offset:128 nt lds
MM v[96:99], a[96:99], a[0:3], v[96:99]
TR a[116:117], v10 offset:49152
TR a[118:119], v10 offset:49664
MM v[100:103], a[100:103], a[0:3], v[100:103]
MM v[104:107], a[104:107], a[0:3], v[104:107]
s_add_u32 m0, s28, 0x14800
s_add_u32 s30, s42, 0x5000
s_and_b32 s30, s30, 0x1ffff
MM v[108:111], a[108:111], a[0:3], v[108:111]
s_waitcnt lgkmcnt(7)
buffer_load_dwordx4 v14, s[8:11], s30 offen nt lds
MM v[112:115], a[80:83], a[4:7], v[112:115]
s_add_u32 m0, s28, 0x15780
TR a[120:121], v11 offset:49152
TR a[122:123], v11 offset:49664
MM v[116:119], a[84:87], a[4:7], v[116:119]
buffer_load_dwordx4 v14, s[8:11], s30 offen offset:128 nt lds
MM v[120:123], a[88:91], a[4:7], v[120:123]
TR a[124:125], v12 offset:49152
TR a[126:127], v12 offset:49664
MM v[124:127], a[92:95], a[4:7], v[124:127]
MM v[128:131], a[96:99], a[4:7], v[128:131]
TR a[128:129], v9 offset:53248
TR a[130:131], v9 offset:53760
MM v[132:135], a[100:103], a[4:7], v[132:135]
MM v[136:139], a[104:107], a[4:7], v[136:139]
TR a[132:133], v10 offset:53248
TR a[134:135], v10 offset:53760
MM v[140:143], a[108:111], a[4:7], v[140:143]
s_waitcnt lgkmcnt(14)
MM v[144:147], a[80:83], a[8:11], v[144:147]
TR a[136:137], v11 offset:53248
TR a[138:139], v11 offset:53760
MM v[148:151], a[84:87], a[8:11], v[148:151]
MM v[152:155], a[88:91], a[8:11], v[152:155]
TR a[140:141], v12 offset:53248
TR a[142:143], v12 offset:53760
MM v[156:159], a[92:95], a[8:11], v[156:159]
MM v[160:163], a[96:99], a[8:11], v[160:163]
ds_read_b128 a[20:23], v77 offset:0
ds_read_b128 a[24:27], v77 offset:2048
MM v[164:167], a[100:103], a[8:11], v[164:167]
MM v[168:171], a[104:107], a[8:11], v[168:171]
ds_read_b128 a[28:31], v77 offset:4096
ds_read_b128 a[32:35], v77 offset:6144
MM v[172:175], a[108:111], a[8:11], v[172:175]
s_waitcnt lgkmcnt(15)
MM v[176:179], a[80:83], a[12:15], v[176:179]
ds_read_b128 a[36:39], v77 offset:8192
MM v[180:183], a[84:87], a[12:15], v[180:183]
MM v[184:187], a[88:91], a[12:15], v[184:187]
MM v[188:191], a[92:95], a[12:15], v[188:191]
MM v[192:195], a[96:99], a[12:15], v[192:195]
MM v[196:199], a[100:103], a[12:15], v[196:199]
MM v[200:203], a[104:107], a[12:15], v[200:203]
MM v[204:207], a[108:111], a[12:15], v[204:207]
MM v[208:211], a[80:83], a[16:19], v[208:211]
MM v[212:215], a[84:87], a[16:19], v[212:215]
MM v[216:219], a[88:91], a[16:19], v[216:219]
MM v[220:223], a[92:95], a[16:19], v[220:223]
MM v[224:227], a[96:99], a[16:19], v[224:227]
MM v[228:231], a[100:103], a[16:19], v[228:231]
MM v[232:235], a[104:107], a[16:19], v[232:235]
MM v[236:239], a[108:111], a[16:19], v[236:239]
s_waitcnt lgkmcnt(4)
MM v[80:83], a[112:115], a[20:23], v[80:83]
s_waitcnt lgkmcnt(0)
s_barrier
s_add_u32 m0, s28, 0x18000
MM v[84:87], a[116:119], a[20:23], v[84:87]
s_add_u32 s30, s42, 0x6000
s_and_b32 s30, s30, 0x1ffff
MM v[88:91], a[120:123], a[20:23], v[88:91]
buffer_load_dwordx4 v13, s[4:7], s30 offen nt lds
MM v[92:95], a[124:127], a[20:23], v[92:95]
s_add_u32 m0, s28, 0x18f80
MM v[96:99], a[128:131], a[20:23], v[96:99]
buffer_load_dwordx4 v13, s[4:7], s30 offen offset:128 nt lds
MM v[100:103], a[132:135], a[20:23], v[100:103]
MM v[104:107], a[136:139], a[20:23], v[104:107]
MM v[108:111], a[140:143], a[20:23], v[108:111]
s_add_u32 m0, s28, 0x18800
s_add_u32 s30, s42, 0x7000
s_and_b32 s30, s30, 0x1ffff
MM v[112:115], a[112:115], a[24:27], v[112:115]
buffer_load_dwordx4 v13, s[4:7], s30 offen nt lds
MM v[116:119], a[116:119], a[24:27], v[116:119]
s_add_u32 m0, s28, 0x19780
MM v[120:123], a[120:123], a[24:27], v[120:123]
buffer_load_dwordx4 v13, s[4:7], s30 offen offset:128 nt lds
MM v[124:127], a[124:127], a[24:27], v[124:127]
MM v[128:131], a[128:131], a[24:27], v[128:131]
MM v[132:135], a[132:135], a[24:27], v[132:135]
s_add_u32 m0, s28, 0x1c000
s_add_u32 s30, s42, 0x6000
s_and_b32 s30, s30, 0x1ffff
MM v[136:139], a[136:139], a[24:27], v[136:139]
buffer_load_dwordx4 v14, s[8:11], s30 offen nt lds
MM v[140:143], a[140:143], a[24:27], v[140:143]
s_add_u32 m0, s28, 0x1cf80
MM v[144:147], a[112:115], a[28:31], v[144:147]
buffer_load_dwordx4 v14, s[8:11], s30 offen offset:128 nt lds
MM v[148:151], a[116:119], a[28:31], v[148:151]
MM v[152:155], a[120:123], a[28:31], v[152:155]
MM v[156:159], a[124:127], a[28:31], v[156:159]
s_add_u32 m0, s28, 0x1c800
s_add_u32 s30, s42, 0x7000
s_and_b32 s30, s30, 0x1ffff
MM v[160:163], a[128:131], a[28:31], v[160:163]
buffer_load_dwordx4 v14, s[8:11], s30 offen nt lds
MM v[164:167], a[132:135], a[28:31], v[164:167]
s_add_u32 m0, s28, 0x1d780
MM v[168:171], a[136:139], a[28:31], v[168:171]
buffer_load_dwordx4 v14, s[8:11], s30 offen offset:128 nt lds
MM v[172:175], a[140:143], a[28:31], v[172:175]
MM v[176:179], a[112:115], a[32:35], v[176:179]
MM v[180:183], a[116:119], a[32:35], v[180:183]
MM v[184:187], a[120:123], a[32:35], v[184:187]
MM v[188:191], a[124:127], a[32:35], v[188:191]
MM v[192:195], a[128:131], a[32:35], v[192:195]
MM v[196:199], a[132:135], a[32:35], v[196:199]
MM v[200:203], a[136:139], a[32:35], v[200:203]
MM v[204:207], a[140:143], a[32:35], v[204:207]
MM v[208:211], a[112:115], a[36:39], v[208:211]
MM v[212:215], a[116:119], a[36:39], v[212:215]
MM v[216:219], a[120:123], a[36:39], v[216:219]
MM v[220:223], a[124:127], a[36:39], v[220:223]
MM v[224:227], a[128:131], a[36:39], v[224:227]
MM v[228:231], a[132:135], a[36:39], v[228:231]
MM v[232:235], a[136:139], a[36:39], v[232:235]
MM v[236:239], a[140:143], a[36:39], v[236:239]
v_pk_mul_f32 v[80:81], v[80:81], s[38:39]
s_mov_b32 s43, 0x0
s_mov_b32 s48, 0x0
v_pk_mul_f32 v[82:83], v[82:83], s[38:39]
v_pk_mul_f32 v[84:85], v[84:85], s[38:39]
v_pk_mul_f32 v[86:87], v[86:87], s[38:39]
CV v80, v80, v81
CV v81, v82, v83
CV v82, v84, v85
CV v83, v86, v87
v_accvgpr_write_b32 a0, v80
v_accvgpr_write_b32 a1, v81
v_accvgpr_write_b32 a2, v82
v_accvgpr_write_b32 a3, v83
v_pk_mul_f32 v[88:89], v[88:89], s[38:39]
v_pk_mul_f32 v[90:91], v[90:91], s[38:39]
v_pk_mul_f32 v[92:93], v[92:93], s[38:39]
v_pk_mul_f32 v[94:95], v[94:95], s[38:39]
CV v88, v88, v89
CV v89, v90, v91
CV v90, v92, v93
CV v91, v94, v95
v_accvgpr_write_b32 a4, v88
v_accvgpr_write_b32 a5, v89
v_accvgpr_write_b32 a6, v90
v_accvgpr_write_b32 a7, v91
v_pk_mul_f32 v[96:97], v[96:97], s[38:39]
v_pk_mul_f32 v[98:99], v[98:99], s[38:39]
v_pk_mul_f32 v[100:101], v[100:101], s[38:39]
v_pk_mul_f32 v[102:103], v[102:103], s[38:39]
CV v96, v96, v97
CV v97, v98, v99
CV v98, v100, v101
CV v99, v102, v103
v_accvgpr_write_b32 a8, v96
v_accvgpr_write_b32 a9, v97
v_accvgpr_write_b32 a10, v98
v_accvgpr_write_b32 a11, v99
v_pk_mul_f32 v[104:105], v[104:105], s[38:39]
v_pk_mul_f32 v[106:107], v[106:107], s[38:39]
v_pk_mul_f32 v[108:109], v[108:109], s[38:39]
v_pk_mul_f32 v[110:111], v[110:111], s[38:39]
CV v104, v104, v105
CV v105, v106, v107
CV v106, v108, v109
CV v107, v110, v111
v_accvgpr_write_b32 a12, v104
v_accvgpr_write_b32 a13, v105
v_accvgpr_write_b32 a14, v106
v_accvgpr_write_b32 a15, v107
v_pk_mul_f32 v[112:113], v[112:113], s[38:39]
v_pk_mul_f32 v[114:115], v[114:115], s[38:39]
v_pk_mul_f32 v[116:117], v[116:117], s[38:39]
v_pk_mul_f32 v[118:119], v[118:119], s[38:39]
CV v112, v112, v113
CV v113, v114, v115
CV v114, v116, v117
CV v115, v118, v119
v_accvgpr_write_b32 a16, v112
v_accvgpr_write_b32 a17, v113
v_accvgpr_write_b32 a18, v114
v_accvgpr_write_b32 a19, v115
v_pk_mul_f32 v[120:121], v[120:121], s[38:39]
v_pk_mul_f32 v[122:123], v[122:123], s[38:39]
v_pk_mul_f32 v[124:125], v[124:125], s[38:39]
v_pk_mul_f32 v[126:127], v[126:127], s[38:39]
CV v120, v120, v121
CV v121, v122, v123
CV v122, v124, v125
CV v123, v126, v127
v_accvgpr_write_b32 a20, v120
v_accvgpr_write_b32 a21, v121
v_accvgpr_write_b32 a22, v122
v_accvgpr_write_b32 a23, v123
v_pk_mul_f32 v[128:129], v[128:129], s[38:39]
v_pk_mul_f32 v[130:131], v[130:131], s[38:39]
v_pk_mul_f32 v[132:133], v[132:133], s[38:39]
v_pk_mul_f32 v[134:135], v[134:135], s[38:39]
CV v128, v128, v129
CV v129, v130, v131
CV v130, v132, v133
CV v131, v134, v135
v_accvgpr_write_b32 a24, v128
v_accvgpr_write_b32 a25, v129
v_accvgpr_write_b32 a26, v130
v_accvgpr_write_b32 a27, v131
v_pk_mul_f32 v[136:137], v[136:137], s[38:39]
v_pk_mul_f32 v[138:139], v[138:139], s[38:39]
v_pk_mul_f32 v[140:141], v[140:141], s[38:39]
v_pk_mul_f32 v[142:143], v[142:143], s[38:39]
CV v136, v136, v137
CV v137, v138, v139
CV v138, v140, v141
CV v139, v142, v143
v_accvgpr_write_b32 a28, v136
v_accvgpr_write_b32 a29, v137
v_accvgpr_write_b32 a30, v138
v_accvgpr_write_b32 a31, v139
v_pk_mul_f32 v[144:145], v[144:145], s[38:39]
v_pk_mul_f32 v[146:147], v[146:147], s[38:39]
v_pk_mul_f32 v[148:149], v[148:149], s[38:39]
v_pk_mul_f32 v[150:151], v[150:151], s[38:39]
CV v144, v144, v145
s_barrier
CV v145, v146, v147
CV v146, v148, v149
CV v147, v150, v151
TR a[112:113], v1 offset:16384
TR a[114:115], v1 offset:18432
v_accvgpr_write_b32 a32, v144
v_accvgpr_write_b32 a33, v145
v_accvgpr_write_b32 a34, v146
v_accvgpr_write_b32 a35, v147
TR a[116:117], v2 offset:16384
TR a[118:119], v2 offset:18432
v_pk_mul_f32 v[152:153], v[152:153], s[38:39]
v_pk_mul_f32 v[154:155], v[154:155], s[38:39]
v_pk_mul_f32 v[156:157], v[156:157], s[38:39]
v_pk_mul_f32 v[158:159], v[158:159], s[38:39]
TR a[120:121], v3 offset:16384
TR a[122:123], v3 offset:18432
CV v152, v152, v153
CV v153, v154, v155
CV v154, v156, v157
CV v155, v158, v159
TR a[124:125], v4 offset:16384
TR a[126:127], v4 offset:18432
v_accvgpr_write_b32 a36, v152
v_accvgpr_write_b32 a37, v153
v_accvgpr_write_b32 a38, v154
v_accvgpr_write_b32 a39, v155
TR a[128:129], v1 offset:20480
TR a[130:131], v1 offset:22528
v_pk_mul_f32 v[160:161], v[160:161], s[38:39]
v_pk_mul_f32 v[162:163], v[162:163], s[38:39]
v_pk_mul_f32 v[164:165], v[164:165], s[38:39]
v_pk_mul_f32 v[166:167], v[166:167], s[38:39]
TR a[132:133], v2 offset:20480
TR a[134:135], v2 offset:22528
CV v160, v160, v161
CV v161, v162, v163
CV v162, v164, v165
CV v163, v166, v167
TR a[136:137], v3 offset:20480
TR a[138:139], v3 offset:22528
v_accvgpr_write_b32 a40, v160
v_accvgpr_write_b32 a41, v161
v_accvgpr_write_b32 a42, v162
v_accvgpr_write_b32 a43, v163
TR a[140:141], v4 offset:20480
TR a[142:143], v4 offset:22528
v_pk_mul_f32 v[168:169], v[168:169], s[38:39]
v_pk_mul_f32 v[170:171], v[170:171], s[38:39]
v_pk_mul_f32 v[172:173], v[172:173], s[38:39]
v_pk_mul_f32 v[174:175], v[174:175], s[38:39]
ds_read_b64 a[80:81], v5 offset:0
ds_read_b64 a[82:83], v6 offset:0
CV v168, v168, v169
CV v169, v170, v171
CV v170, v172, v173
CV v171, v174, v175
ds_read_b64 a[84:85], v5 offset:2048
ds_read_b64 a[86:87], v6 offset:2048
v_accvgpr_write_b32 a44, v168
v_accvgpr_write_b32 a45, v169
v_accvgpr_write_b32 a46, v170
v_accvgpr_write_b32 a47, v171
ds_read_b64 a[88:89], v7 offset:0
ds_read_b64 a[90:91], v8 offset:0
v_pk_mul_f32 v[176:177], v[176:177], s[38:39]
v_pk_mul_f32 v[178:179], v[178:179], s[38:39]
v_pk_mul_f32 v[180:181], v[180:181], s[38:39]
v_pk_mul_f32 v[182:183], v[182:183], s[38:39]
ds_read_b64 a[92:93], v7 offset:2048
ds_read_b64 a[94:95], v8 offset:2048
CV v176, v176, v177
CV v177, v178, v179
CV v178, v180, v181
CV v179, v182, v183
ds_read_b64 a[96:97], v5 offset:4096
ds_read_b64 a[98:99], v6 offset:4096
v_accvgpr_write_b32 a48, v176
v_accvgpr_write_b32 a49, v177
v_accvgpr_write_b32 a50, v178
v_accvgpr_write_b32 a51, v179
ds_read_b64 a[100:101], v5 offset:6144
ds_read_b64 a[102:103], v6 offset:6144
v_pk_mul_f32 v[184:185], v[184:185], s[38:39]
v_pk_mul_f32 v[186:187], v[186:187], s[38:39]
v_pk_mul_f32 v[188:189], v[188:189], s[38:39]
v_pk_mul_f32 v[190:191], v[190:191], s[38:39]
ds_read_b64 a[104:105], v7 offset:4096
ds_read_b64 a[106:107], v8 offset:4096
CV v184, v184, v185
CV v185, v186, v187
CV v186, v188, v189
CV v187, v190, v191
ds_read_b64 a[108:109], v7 offset:6144
ds_read_b64 a[110:111], v8 offset:6144
v_accvgpr_write_b32 a52, v184
v_accvgpr_write_b32 a53, v185
v_accvgpr_write_b32 a54, v186
v_accvgpr_write_b32 a55, v187
v_pk_mul_f32 v[192:193], v[192:193], s[38:39]
v_pk_mul_f32 v[194:195], v[194:195], s[38:39]
v_pk_mul_f32 v[196:197], v[196:197], s[38:39]
v_pk_mul_f32 v[198:199], v[198:199], s[38:39]
CV v192, v192, v193
CV v193, v194, v195
CV v194, v196, v197
CV v195, v198, v199
v_accvgpr_write_b32 a56, v192
v_accvgpr_write_b32 a57, v193
v_accvgpr_write_b32 a58, v194
v_accvgpr_write_b32 a59, v195
v_pk_mul_f32 v[200:201], v[200:201], s[38:39]
v_pk_mul_f32 v[202:203], v[202:203], s[38:39]
v_pk_mul_f32 v[204:205], v[204:205], s[38:39]
v_pk_mul_f32 v[206:207], v[206:207], s[38:39]
CV v200, v200, v201
CV v201, v202, v203
CV v202, v204, v205
CV v203, v206, v207
v_accvgpr_write_b32 a60, v200
v_accvgpr_write_b32 a61, v201
v_accvgpr_write_b32 a62, v202
v_accvgpr_write_b32 a63, v203
v_pk_mul_f32 v[208:209], v[208:209], s[38:39]
v_pk_mul_f32 v[210:211], v[210:211], s[38:39]
v_pk_mul_f32 v[212:213], v[212:213], s[38:39]
v_pk_mul_f32 v[214:215], v[214:215], s[38:39]
CV v208, v208, v209
CV v209, v210, v211
CV v210, v212, v213
CV v211, v214, v215
v_accvgpr_write_b32 a64, v208
v_accvgpr_write_b32 a65, v209
v_accvgpr_write_b32 a66, v210
v_accvgpr_write_b32 a67, v211
v_pk_mul_f32 v[216:217], v[216:217], s[38:39]
v_pk_mul_f32 v[218:219], v[218:219], s[38:39]
v_pk_mul_f32 v[220:221], v[220:221], s[38:39]
v_pk_mul_f32 v[222:223], v[222:223], s[38:39]
CV v216, v216, v217
CV v217, v218, v219
CV v218, v220, v221
CV v219, v222, v223
v_accvgpr_write_b32 a68, v216
v_accvgpr_write_b32 a69, v217
v_accvgpr_write_b32 a70, v218
v_accvgpr_write_b32 a71, v219
v_pk_mul_f32 v[224:225], v[224:225], s[38:39]
v_pk_mul_f32 v[226:227], v[226:227], s[38:39]
v_pk_mul_f32 v[228:229], v[228:229], s[38:39]
v_pk_mul_f32 v[230:231], v[230:231], s[38:39]
CV v224, v224, v225
CV v225, v226, v227
CV v226, v228, v229
CV v227, v230, v231
v_accvgpr_write_b32 a72, v224
v_accvgpr_write_b32 a73, v225
v_accvgpr_write_b32 a74, v226
v_accvgpr_write_b32 a75, v227
v_pk_mul_f32 v[232:233], v[232:233], s[38:39]
v_pk_mul_f32 v[234:235], v[234:235], s[38:39]
v_pk_mul_f32 v[236:237], v[236:237], s[38:39]
v_pk_mul_f32 v[238:239], v[238:239], s[38:39]
CV v232, v232, v233
CV v233, v234, v235
CV v234, v236, v237
CV v235, v238, v239
v_accvgpr_write_b32 a76, v232
v_accvgpr_write_b32 a77, v233
v_accvgpr_write_b32 a78, v234
v_accvgpr_write_b32 a79, v235
L_YAent0:
s_mov_b32 s99, 0x0
s_waitcnt lgkmcnt(8)
MM v[44:47], a[80:83], a[144:147], v[24:27]
MM v[48:51], a[84:87], a[144:147], v[24:27]
MM v[44:47], a[88:91], a[148:151], v[44:47]
MM v[48:51], a[92:95], a[148:151], v[48:51]
s_waitcnt lgkmcnt(0)
MM v[44:47], a[96:99], a[152:155], v[44:47]
MM v[48:51], a[100:103], a[152:155], v[48:51]
MM v[44:47], a[104:107], a[156:159], v[44:47]
MM v[48:51], a[108:111], a[156:159], v[48:51]
MM v[52:55], a[80:83], a[160:163], v[28:31]
MM v[56:59], a[84:87], a[160:163], v[28:31]
MM v[52:55], a[88:91], a[164:167], v[52:55]
MM v[56:59], a[92:95], a[164:167], v[56:59]
MM v[52:55], a[96:99], a[168:171], v[52:55]
MM v[56:59], a[100:103], a[168:171], v[56:59]
MM v[52:55], a[104:107], a[172:175], v[52:55]
v_exp_f32 v44, v44
MM v[56:59], a[108:111], a[172:175], v[56:59]
v_exp_f32 v45, v45
MM v[60:63], a[80:83], a[176:179], v[32:35]
v_exp_f32 v46, v46
MM v[64:67], a[84:87], a[176:179], v[32:35]
v_exp_f32 v47, v47
MM v[60:63], a[88:91], a[180:183], v[60:63]
CV v240, v44, v45
CV v241, v46, v47
v_exp_f32 v48, v48
v_exp_f32 v49, v49
v_exp_f32 v50, v50
v_exp_f32 v51, v51
MM v[64:67], a[92:95], a[180:183], v[64:67]
CV v242, v48, v49
CV v243, v50, v51
MM v[60:63], a[96:99], a[184:187], v[60:63]
v_exp_f32 v52, v52
MM v[64:67], a[100:103], a[184:187], v[64:67]
v_exp_f32 v53, v53
MM v[60:63], a[104:107], a[188:191], v[60:63]
v_exp_f32 v54, v54
MM v[64:67], a[108:111], a[188:191], v[64:67]
v_exp_f32 v55, v55
MM v[80:83], a[112:115], v[240:243], 0
CV v244, v52, v53
CV v245, v54, v55
MM v[84:87], a[116:119], v[240:243], 0
v_exp_f32 v56, v56
MM v[88:91], a[120:123], v[240:243], 0
v_exp_f32 v57, v57
MM v[92:95], a[124:127], v[240:243], 0
v_exp_f32 v58, v58
MM v[96:99], a[128:131], v[240:243], 0
v_exp_f32 v59, v59
MM v[100:103], a[132:135], v[240:243], 0
CV v246, v56, v57
CV v247, v58, v59
MM v[104:107], a[136:139], v[240:243], 0
v_exp_f32 v60, v60
MM v[108:111], a[140:143], v[240:243], 0
v_exp_f32 v61, v61
MM a[224:227], a[244:247], v[240:243], 0
v_exp_f32 v62, v62
MM v[68:71], a[80:83], a[192:195], v[36:39]
v_exp_f32 v63, v63
MM v[72:75], a[84:87], a[192:195], v[36:39]
CV v248, v60, v61
CV v249, v62, v63
MM v[68:71], a[88:91], a[196:199], v[68:71]
v_exp_f32 v64, v64
MM v[72:75], a[92:95], a[196:199], v[72:75]
v_exp_f32 v65, v65
MM v[68:71], a[96:99], a[200:203], v[68:71]
v_exp_f32 v66, v66
MM v[72:75], a[100:103], a[200:203], v[72:75]
v_exp_f32 v67, v67
MM v[68:71], a[104:107], a[204:207], v[68:71]
CV v250, v64, v65
CV v251, v66, v67
MM v[72:75], a[108:111], a[204:207], v[72:75]
MM v[112:115], a[112:115], v[244:247], 0
MM v[116:119], a[116:119], v[244:247], 0
MM v[120:123], a[120:123], v[244:247], 0
MM v[124:127], a[124:127], v[244:247], 0
MM v[128:131], a[128:131], v[244:247], 0
v_exp_f32 v68, v68
MM v[132:135], a[132:135], v[244:247], 0
v_exp_f32 v69, v69
MM v[136:139], a[136:139], v[244:247], 0
v_exp_f32 v70, v70
MM v[140:143], a[140:143], v[244:247], 0
v_exp_f32 v71, v71
MM a[228:231], a[244:247], v[244:247], 0
s_waitcnt vmcnt(12)
s_barrier
s_add_u32 m0, s28, 0x0
MM v[44:47], a[80:83], a[208:211], v[40:43]
s_add_u32 s30, s42, 0x8000
s_and_b32 s30, s30, 0x1ffff
s_waitcnt vmcnt(4)
MM v[48:51], a[84:87], a[208:211], v[40:43]
buffer_load_dwordx4 v13, s[4:7], s30 offen nt lds
MM v[44:47], a[88:91], a[212:215], v[44:47]
s_add_u32 m0, s28, 0xf80
ds_read_b64 a[80:81], v5 offset:32768
ds_read_b64 a[82:83], v6 offset:32768
MM v[48:51], a[92:95], a[212:215], v[48:51]
buffer_load_dwordx4 v13, s[4:7], s30 offen offset:128 nt lds
MM v[44:47], a[96:99], a[216:219], v[44:47]
ds_read_b64 a[84:85], v5 offset:34816
ds_read_b64 a[86:87], v6 offset:34816
MM v[48:51], a[100:103], a[216:219], v[48:51]
CV v252, v68, v69
CV v253, v70, v71
MM v[44:47], a[104:107], a[220:223], v[44:47]
ds_read_b64 a[88:89], v7 offset:32768
ds_read_b64 a[90:91], v8 offset:32768
MM v[48:51], a[108:111], a[220:223], v[48:51]
v_exp_f32 v72, v72
MM v[144:147], a[112:115], v[248:251], 0
ds_read_b64 a[92:93], v7 offset:34816
ds_read_b64 a[94:95], v8 offset:34816
MM v[148:151], a[116:119], v[248:251], 0
v_exp_f32 v73, v73
MM v[152:155], a[120:123], v[248:251], 0
ds_read_b64 a[96:97], v5 offset:36864
ds_read_b64 a[98:99], v6 offset:36864
MM v[156:159], a[124:127], v[248:251], 0
v_exp_f32 v74, v74
MM v[160:163], a[128:131], v[248:251], 0
ds_read_b64 a[100:101], v5 offset:38912
ds_read_b64 a[102:103], v6 offset:38912
MM v[164:167], a[132:135], v[248:251], 0
v_exp_f32 v75, v75
MM v[168:171], a[136:139], v[248:251], 0
ds_read_b64 a[104:105], v7 offset:36864
ds_read_b64 a[106:107], v8 offset:36864
MM v[172:175], a[140:143], v[248:251], 0
CV v254, v72, v73
CV v255, v74, v75
MM a[232:235], a[244:247], v[248:251], 0
s_waitcnt lgkmcnt(6)
ds_read_b64 a[108:109], v7 offset:38912
ds_read_b64 a[110:111], v8 offset:38912
MM v[52:55], a[80:83], a[144:147], v[24:27]
v_exp_f32 v44, v44
MM v[56:59], a[84:87], a[144:147], v[24:27]
v_exp_f32 v45, v45
MM v[52:55], a[88:91], a[148:151], v[52:55]
v_exp_f32 v46, v46
MM v[56:59], a[92:95], a[148:151], v[56:59]
s_waitcnt lgkmcnt(4)
s_add_u32 m0, s28, 0x800
s_add_u32 s30, s42, 0x9000
MM v[52:55], a[96:99], a[152:155], v[52:55]
s_and_b32 s30, s30, 0x1ffff
s_waitcnt vmcnt(4)
MM v[56:59], a[100:103], a[152:155], v[56:59]
s_waitcnt lgkmcnt(2)
buffer_load_dwordx4 v13, s[4:7], s30 offen nt lds
MM v[52:55], a[104:107], a[156:159], v[52:55]
s_waitcnt lgkmcnt(0)
s_add_u32 m0, s28, 0x1780
MM v[56:59], a[108:111], a[156:159], v[56:59]
buffer_load_dwordx4 v13, s[4:7], s30 offen offset:128 nt lds
MM v[176:179], a[112:115], v[252:255], 0
v_exp_f32 v47, v47
MM v[180:183], a[116:119], v[252:255], 0
CV v240, v44, v45
CV v241, v46, v47
MM v[184:187], a[120:123], v[252:255], 0
v_exp_f32 v48, v48
MM v[188:191], a[124:127], v[252:255], 0
v_exp_f32 v49, v49
MM v[192:195], a[128:131], v[252:255], 0
v_exp_f32 v50, v50
MM v[196:199], a[132:135], v[252:255], 0
v_exp_f32 v51, v51
MM v[200:203], a[136:139], v[252:255], 0
CV v242, v48, v49
CV v243, v50, v51
MM v[204:207], a[140:143], v[252:255], 0
v_exp_f32 v52, v52
MM a[236:239], a[244:247], v[252:255], 0
v_exp_f32 v53, v53
MM v[60:63], a[80:83], a[160:163], v[28:31]
v_exp_f32 v54, v54
MM v[64:67], a[84:87], a[160:163], v[28:31]
v_exp_f32 v55, v55
MM v[60:63], a[88:91], a[164:167], v[60:63]
CV v244, v52, v53
CV v245, v54, v55
MM v[64:67], a[92:95], a[164:167], v[64:67]
v_exp_f32 v56, v56
MM v[60:63], a[96:99], a[168:171], v[60:63]
v_exp_f32 v57, v57
MM v[64:67], a[100:103], a[168:171], v[64:67]
v_exp_f32 v58, v58
MM v[60:63], a[104:107], a[172:175], v[60:63]
v_exp_f32 v59, v59
MM v[64:67], a[108:111], a[172:175], v[64:67]
s_add_u32 m0, s28, 0x4000
s_add_u32 s30, s42, 0x8000
s_and_b32 s30, s30, 0x1ffff
MM v[208:211], a[112:115], v[240:243], 0
s_waitcnt vmcnt(4)
buffer_load_dwordx4 v14, s[8:11], s30 offen nt lds
MM v[212:215], a[116:119], v[240:243], 0
s_add_u32 m0, s28, 0x4f80
TR a[112:113], v1 offset:49152
TR a[114:115], v1 offset:51200
MM v[216:219], a[120:123], v[240:243], 0
buffer_load_dwordx4 v14, s[8:11], s30 offen offset:128 nt lds
MM v[220:223], a[124:127], v[240:243], 0
TR a[116:117], v2 offset:49152
TR a[118:119], v2 offset:51200
MM v[224:227], a[128:131], v[240:243], 0
CV v246, v56, v57
CV v247, v58, v59
MM v[228:231], a[132:135], v[240:243], 0
TR a[120:121], v3 offset:49152
TR a[122:123], v3 offset:51200
MM v[232:235], a[136:139], v[240:243], 0
v_exp_f32 v60, v60
MM v[236:239], a[140:143], v[240:243], 0
TR a[124:125], v4 offset:49152
TR a[126:127], v4 offset:51200
MM a[240:243], a[244:247], v[240:243], 0
v_exp_f32 v61, v61
MM v[68:71], a[80:83], a[176:179], v[32:35]
TR a[128:129], v1 offset:53248
TR a[130:131], v1 offset:55296
MM v[72:75], a[84:87], a[176:179], v[32:35]
v_exp_f32 v62, v62
MM v[68:71], a[88:91], a[180:183], v[68:71]
TR a[132:133], v2 offset:53248
TR a[134:135], v2 offset:55296
MM v[72:75], a[92:95], a[180:183], v[72:75]
v_exp_f32 v63, v63
MM v[68:71], a[96:99], a[184:187], v[68:71]
TR a[136:137], v3 offset:53248
TR a[138:139], v3 offset:55296
MM v[72:75], a[100:103], a[184:187], v[72:75]
CV v248, v60, v61
CV v249, v62, v63
MM v[68:71], a[104:107], a[188:191], v[68:71]
TR a[140:141], v4 offset:53248
TR a[142:143], v4 offset:55296
MM v[72:75], a[108:111], a[188:191], v[72:75]
s_waitcnt lgkmcnt(8)
v_exp_f32 v64, v64
MM v[80:83], a[112:115], v[244:247], v[80:83]
v_exp_f32 v65, v65
MM v[84:87], a[116:119], v[244:247], v[84:87]
v_exp_f32 v66, v66
MM v[88:91], a[120:123], v[244:247], v[88:91]
s_add_u32 m0, s28, 0x4800
s_add_u32 s30, s42, 0x9000
s_and_b32 s30, s30, 0x1ffff
MM v[92:95], a[124:127], v[244:247], v[92:95]
s_waitcnt lgkmcnt(4)
s_waitcnt vmcnt(4)
MM v[96:99], a[128:131], v[244:247], v[96:99]
buffer_load_dwordx4 v14, s[8:11], s30 offen nt lds
MM v[100:103], a[132:135], v[244:247], v[100:103]
s_waitcnt lgkmcnt(2)
s_add_u32 m0, s28, 0x5780
MM v[104:107], a[136:139], v[244:247], v[104:107]
s_waitcnt lgkmcnt(0)
buffer_load_dwordx4 v14, s[8:11], s30 offen offset:128 nt lds
MM v[108:111], a[140:143], v[244:247], v[108:111]
v_exp_f32 v67, v67
MM a[224:227], a[244:247], v[244:247], a[224:227]
CV v250, v64, v65
CV v251, v66, v67
MM v[44:47], a[80:83], a[192:195], v[36:39]
v_exp_f32 v68, v68
MM v[48:51], a[84:87], a[192:195], v[36:39]
v_exp_f32 v69, v69
MM v[44:47], a[88:91], a[196:199], v[44:47]
v_exp_f32 v70, v70
MM v[48:51], a[92:95], a[196:199], v[48:51]
v_exp_f32 v71, v71
MM v[44:47], a[96:99], a[200:203], v[44:47]
CV v252, v68, v69
CV v253, v70, v71
MM v[48:51], a[100:103], a[200:203], v[48:51]
v_exp_f32 v72, v72
MM v[44:47], a[104:107], a[204:207], v[44:47]
v_exp_f32 v73, v73
MM v[48:51], a[108:111], a[204:207], v[48:51]
v_exp_f32 v74, v74
MM v[112:115], a[112:115], v[248:251], v[112:115]
v_exp_f32 v75, v75
MM v[116:119], a[116:119], v[248:251], v[116:119]
CV v254, v72, v73
CV v255, v74, v75
MM v[120:123], a[120:123], v[248:251], v[120:123]
v_exp_f32 v44, v44
MM v[124:127], a[124:127], v[248:251], v[124:127]
v_exp_f32 v45, v45
MM v[128:131], a[128:131], v[248:251], v[128:131]
v_exp_f32 v46, v46
MM v[132:135], a[132:135], v[248:251], v[132:135]
v_exp_f32 v47, v47
MM v[136:139], a[136:139], v[248:251], v[136:139]
CV v240, v44, v45
CV v241, v46, v47
MM v[140:143], a[140:143], v[248:251], v[140:143]
v_exp_f32 v48, v48
MM a[228:231], a[244:247], v[248:251], a[228:231]
s_mov_b32 s96, 3
L_YA0:
s_add_u32 s42, s42, 0x8000
s_add_u32 s99, s99, 0xc000
s_and_b32 s97, s99, 0x20000
s_waitcnt vmcnt(16)
s_barrier
MM v[52:55], a[80:83], a[208:211], v[40:43]
s_add_u32 m0, s28, 0x8000
s_add_u32 s30, s42, 0x2000
s_and_b32 s30, s30, 0x1ffff
MM v[56:59], a[84:87], a[208:211], v[40:43]
s_waitcnt vmcnt(4)
buffer_load_dwordx4 v13, s[4:7], s30 offen nt lds
MM v[52:55], a[88:91], a[212:215], v[52:55]
s_add_u32 m0, s28, 0x8f80
v_add_u32 v5, 0x10000, v5
v_add_u32 v6, 0x10000, v6
MM v[56:59], a[92:95], a[212:215], v[56:59]
buffer_load_dwordx4 v13, s[4:7], s30 offen offset:128 nt lds
MM v[52:55], a[96:99], a[216:219], v[52:55]
ds_read_b64 a[80:81], v5 offset:0
ds_read_b64 a[82:83], v6 offset:0
MM v[56:59], a[100:103], a[216:219], v[56:59]
v_exp_f32 v49, v49
MM v[52:55], a[104:107], a[220:223], v[52:55]
ds_read_b64 a[84:85], v5 offset:2048
ds_read_b64 a[86:87], v6 offset:2048
MM v[56:59], a[108:111], a[220:223], v[56:59]
v_add_u32 v7, 0x10000, v7
v_add_u32 v8, 0x10000, v8
MM v[144:147], a[112:115], v[252:255], v[144:147]
ds_read_b64 a[88:89], v7 offset:0
ds_read_b64 a[90:91], v8 offset:0
MM v[148:151], a[116:119], v[252:255], v[148:151]
v_exp_f32 v50, v50
MM v[152:155], a[120:123], v[252:255], v[152:155]
ds_read_b64 a[92:93], v7 offset:2048
ds_read_b64 a[94:95], v8 offset:2048
MM v[156:159], a[124:127], v[252:255], v[156:159]
v_exp_f32 v51, v51
MM v[160:163], a[128:131], v[252:255], v[160:163]
ds_read_b64 a[96:97], v5 offset:4096
ds_read_b64 a[98:99], v6 offset:4096
MM v[164:167], a[132:135], v[252:255], v[164:167]
CV v242, v48, v49
CV v243, v50, v51
MM v[168:171], a[136:139], v[252:255], v[168:171]
ds_read_b64 a[100:101], v5 offset:6144
ds_read_b64 a[102:103], v6 offset:6144
MM v[172:175], a[140:143], v[252:255], v[172:175]
ds_read_b64 a[104:105], v7 offset:4096
ds_read_b64 a[106:107], v8 offset:4096
MM a[232:235], a[244:247], v[252:255], a[232:235]
s_waitcnt lgkmcnt(8)
ds_read_b64 a[108:109], v7 offset:6144
ds_read_b64 a[110:111], v8 offset:6144
MM v[60:63], a[80:83], a[144:147], v[24:27]
v_exp_f32 v52, v52
MM v[64:67], a[84:87], a[144:147], v[24:27]
v_exp_f32 v53, v53
MM v[60:63], a[88:91], a[148:151], v[60:63]
s_waitcnt lgkmcnt(8)
v_exp_f32 v54, v54
MM v[64:67], a[92:95], a[148:151], v[64:67]
s_waitcnt lgkmcnt(6)
s_add_u32 m0, s28, 0x8800
s_add_u32 s30, s42, 0x3000
MM v[60:63], a[96:99], a[152:155], v[60:63]
s_waitcnt lgkmcnt(4)
s_and_b32 s30, s30, 0x1ffff
s_waitcnt vmcnt(4)
MM v[64:67], a[100:103], a[152:155], v[64:67]
s_waitcnt lgkmcnt(2)
buffer_load_dwordx4 v13, s[4:7], s30 offen nt lds
MM v[60:63], a[104:107], a[156:159], v[60:63]
s_waitcnt lgkmcnt(0)
s_add_u32 m0, s28, 0x9780
v_add_u32 v1, 0x10000, v1
MM v[64:67], a[108:111], a[156:159], v[64:67]
buffer_load_dwordx4 v13, s[4:7], s30 offen offset:128 nt lds
MM v[176:179], a[112:115], v[240:243], v[176:179]
v_exp_f32 v55, v55
MM v[180:183], a[116:119], v[240:243], v[180:183]
CV v244, v52, v53
CV v245, v54, v55
MM v[184:187], a[120:123], v[240:243], v[184:187]
v_exp_f32 v56, v56
MM v[188:191], a[124:127], v[240:243], v[188:191]
v_exp_f32 v57, v57
MM v[192:195], a[128:131], v[240:243], v[192:195]
v_exp_f32 v58, v58
MM v[196:199], a[132:135], v[240:243], v[196:199]
v_exp_f32 v59, v59
MM v[200:203], a[136:139], v[240:243], v[200:203]
CV v246, v56, v57
CV v247, v58, v59
MM v[204:207], a[140:143], v[240:243], v[204:207]
v_exp_f32 v60, v60
MM a[236:239], a[244:247], v[240:243], a[236:239]
v_exp_f32 v61, v61
MM v[68:71], a[80:83], a[160:163], v[28:31]
v_exp_f32 v62, v62
MM v[72:75], a[84:87], a[160:163], v[28:31]
v_exp_f32 v63, v63
MM v[68:71], a[88:91], a[164:167], v[68:71]
CV v248, v60, v61
CV v249, v62, v63
MM v[72:75], a[92:95], a[164:167], v[72:75]
v_exp_f32 v64, v64
MM v[68:71], a[96:99], a[168:171], v[68:71]
v_exp_f32 v65, v65
MM v[72:75], a[100:103], a[168:171], v[72:75]
v_exp_f32 v66, v66
MM v[68:71], a[104:107], a[172:175], v[68:71]
v_exp_f32 v67, v67
MM v[72:75], a[108:111], a[172:175], v[72:75]
s_add_u32 m0, s28, 0xc000
s_add_u32 s30, s42, 0x2000
s_and_b32 s30, s30, 0x1ffff
MM v[208:211], a[112:115], v[244:247], v[208:211]
s_waitcnt vmcnt(4)
buffer_load_dwordx4 v14, s[8:11], s30 offen nt lds
MM v[212:215], a[116:119], v[244:247], v[212:215]
s_add_u32 m0, s28, 0xcf80
TR a[112:113], v1 offset:16384
TR a[114:115], v1 offset:18432
MM v[216:219], a[120:123], v[244:247], v[216:219]
buffer_load_dwordx4 v14, s[8:11], s30 offen offset:128 nt lds
MM v[220:223], a[124:127], v[244:247], v[220:223]
CV v250, v64, v65
v_add_u32 v2, 0x10000, v2
MM v[224:227], a[128:131], v[244:247], v[224:227]
TR a[116:117], v2 offset:16384
TR a[118:119], v2 offset:18432
MM v[228:231], a[132:135], v[244:247], v[228:231]
CV v251, v66, v67
v_add_u32 v3, 0x10000, v3
MM v[232:235], a[136:139], v[244:247], v[232:235]
TR a[120:121], v3 offset:16384
TR a[122:123], v3 offset:18432
MM v[236:239], a[140:143], v[244:247], v[236:239]
v_add_u32 v4, 0x10000, v4
MM a[240:243], a[244:247], v[244:247], a[240:243]
TR a[124:125], v4 offset:16384
TR a[126:127], v4 offset:18432
MM v[44:47], a[80:83], a[176:179], v[32:35]
v_exp_f32 v68, v68
MM v[48:51], a[84:87], a[176:179], v[32:35]
TR a[128:129], v1 offset:20480
TR a[130:131], v1 offset:22528
MM v[44:47], a[88:91], a[180:183], v[44:47]
v_exp_f32 v69, v69
MM v[48:51], a[92:95], a[180:183], v[48:51]
TR a[132:133], v2 offset:20480
TR a[134:135], v2 offset:22528
MM v[44:47], a[96:99], a[184:187], v[44:47]
v_exp_f32 v70, v70
MM v[48:51], a[100:103], a[184:187], v[48:51]
TR a[136:137], v3 offset:20480
TR a[138:139], v3 offset:22528
MM v[44:47], a[104:107], a[188:191], v[44:47]
v_exp_f32 v71, v71
MM v[48:51], a[108:111], a[188:191], v[48:51]
s_waitcnt lgkmcnt(6)
TR a[140:141], v4 offset:20480
TR a[142:143], v4 offset:22528
MM v[80:83], a[112:115], v[248:251], v[80:83]
CV v252, v68, v69
CV v253, v70, v71
MM v[84:87], a[116:119], v[248:251], v[84:87]
v_exp_f32 v72, v72
MM v[88:91], a[120:123], v[248:251], v[88:91]
s_add_u32 m0, s28, 0xc800
s_add_u32 s30, s42, 0x3000
s_and_b32 s30, s30, 0x1ffff
MM v[92:95], a[124:127], v[248:251], v[92:95]
s_waitcnt lgkmcnt(4)
s_waitcnt vmcnt(4)
MM v[96:99], a[128:131], v[248:251], v[96:99]
buffer_load_dwordx4 v14, s[8:11], s30 offen nt lds
MM v[100:103], a[132:135], v[248:251], v[100:103]
s_waitcnt lgkmcnt(2)
s_add_u32 m0, s28, 0xd780
MM v[104:107], a[136:139], v[248:251], v[104:107]
s_waitcnt lgkmcnt(0)
buffer_load_dwordx4 v14, s[8:11], s30 offen offset:128 nt lds
MM v[108:111], a[140:143], v[248:251], v[108:111]
v_exp_f32 v73, v73
MM a[224:227], a[244:247], v[248:251], a[224:227]
v_exp_f32 v74, v74
MM v[52:55], a[80:83], a[192:195], v[36:39]
v_exp_f32 v75, v75
MM v[56:59], a[84:87], a[192:195], v[36:39]
CV v254, v72, v73
CV v255, v74, v75
MM v[52:55], a[88:91], a[196:199], v[52:55]
v_exp_f32 v44, v44
MM v[56:59], a[92:95], a[196:199], v[56:59]
v_exp_f32 v45, v45
MM v[52:55], a[96:99], a[200:203], v[52:55]
v_exp_f32 v46, v46
MM v[56:59], a[100:103], a[200:203], v[56:59]
v_exp_f32 v47, v47
MM v[52:55], a[104:107], a[204:207], v[52:55]
CV v240, v44, v45
CV v241, v46, v47
MM v[56:59], a[108:111], a[204:207], v[56:59]
v_exp_f32 v48, v48
MM v[112:115], a[112:115], v[252:255], v[112:115]
v_exp_f32 v49, v49
MM v[116:119], a[116:119], v[252:255], v[116:119]
v_exp_f32 v50, v50
MM v[120:123], a[120:123], v[252:255], v[120:123]
v_exp_f32 v51, v51
MM v[124:127], a[124:127], v[252:255], v[124:127]
CV v242, v48, v49
CV v243, v50, v51
MM v[128:131], a[128:131], v[252:255], v[128:131]
v_exp_f32 v52, v52
MM v[132:135], a[132:135], v[252:255], v[132:135]
v_exp_f32 v53, v53
MM v[136:139], a[136:139], v[252:255], v[136:139]
v_exp_f32 v54, v54
MM v[140:143], a[140:143], v[252:255], v[140:143]
v_exp_f32 v55, v55
MM a[228:231], a[244:247], v[252:255], a[228:231]
s_waitcnt vmcnt(16)
s_barrier
s_add_u32 m0, s28, 0x10000
MM v[60:63], a[80:83], a[208:211], v[40:43]
s_add_u32 s30, s42, 0x4000
s_and_b32 s30, s30, 0x1ffff
s_waitcnt vmcnt(4)
MM v[64:67], a[84:87], a[208:211], v[40:43]
buffer_load_dwordx4 v13, s[4:7], s30 offen nt lds
MM v[60:63], a[88:91], a[212:215], v[60:63]
s_add_u32 m0, s28, 0x10f80
ds_read_b64 a[80:81], v5 offset:32768
ds_read_b64 a[82:83], v6 offset:32768
MM v[64:67], a[92:95], a[212:215], v[64:67]
buffer_load_dwordx4 v13, s[4:7], s30 offen offset:128 nt lds
MM v[60:63], a[96:99], a[216:219], v[60:63]
ds_read_b64 a[84:85], v5 offset:34816
ds_read_b64 a[86:87], v6 offset:34816
MM v[64:67], a[100:103], a[216:219], v[64:67]
CV v244, v52, v53
CV v245, v54, v55
MM v[60:63], a[104:107], a[220:223], v[60:63]
ds_read_b64 a[88:89], v7 offset:32768
ds_read_b64 a[90:91], v8 offset:32768
MM v[64:67], a[108:111], a[220:223], v[64:67]
v_exp_f32 v56, v56
MM v[144:147], a[112:115], v[240:243], v[144:147]
ds_read_b64 a[92:93], v7 offset:34816
ds_read_b64 a[94:95], v8 offset:34816
MM v[148:151], a[116:119], v[240:243], v[148:151]
v_exp_f32 v57, v57
MM v[152:155], a[120:123], v[240:243], v[152:155]
ds_read_b64 a[96:97], v5 offset:36864
ds_read_b64 a[98:99], v6 offset:36864
MM v[156:159], a[124:127], v[240:243], v[156:159]
v_exp_f32 v58, v58
MM v[160:163], a[128:131], v[240:243], v[160:163]
ds_read_b64 a[100:101], v5 offset:38912
ds_read_b64 a[102:103], v6 offset:38912
MM v[164:167], a[132:135], v[240:243], v[164:167]
v_exp_f32 v59, v59
MM v[168:171], a[136:139], v[240:243], v[168:171]
ds_read_b64 a[104:105], v7 offset:36864
ds_read_b64 a[106:107], v8 offset:36864
MM v[172:175], a[140:143], v[240:243], v[172:175]
CV v246, v56, v57
CV v247, v58, v59
MM a[232:235], a[244:247], v[240:243], a[232:235]
s_waitcnt lgkmcnt(6)
ds_read_b64 a[108:109], v7 offset:38912
ds_read_b64 a[110:111], v8 offset:38912
MM v[68:71], a[80:83], a[144:147], v[24:27]
v_exp_f32 v60, v60
MM v[72:75], a[84:87], a[144:147], v[24:27]
v_exp_f32 v61, v61
MM v[68:71], a[88:91], a[148:151], v[68:71]
v_exp_f32 v62, v62
MM v[72:75], a[92:95], a[148:151], v[72:75]
s_waitcnt lgkmcnt(4)
s_add_u32 m0, s28, 0x10800
s_add_u32 s30, s42, 0x5000
MM v[68:71], a[96:99], a[152:155], v[68:71]
s_and_b32 s30, s30, 0x1ffff
s_waitcnt vmcnt(4)
MM v[72:75], a[100:103], a[152:155], v[72:75]
s_waitcnt lgkmcnt(2)
buffer_load_dwordx4 v13, s[4:7], s30 offen nt lds
MM v[68:71], a[104:107], a[156:159], v[68:71]
s_waitcnt lgkmcnt(0)
s_add_u32 m0, s28, 0x11780
MM v[72:75], a[108:111], a[156:159], v[72:75]
buffer_load_dwordx4 v13, s[4:7], s30 offen offset:128 nt lds
MM v[176:179], a[112:115], v[244:247], v[176:179]
v_exp_f32 v63, v63
MM v[180:183], a[116:119], v[244:247], v[180:183]
CV v248, v60, v61
CV v249, v62, v63
MM v[184:187], a[120:123], v[244:247], v[184:187]
v_exp_f32 v64, v64
MM v[188:191], a[124:127], v[244:247], v[188:191]
v_exp_f32 v65, v65
MM v[192:195], a[128:131], v[244:247], v[192:195]
v_exp_f32 v66, v66
MM v[196:199], a[132:135], v[244:247], v[196:199]
v_exp_f32 v67, v67
MM v[200:203], a[136:139], v[244:247], v[200:203]
CV v250, v64, v65
CV v251, v66, v67
MM v[204:207], a[140:143], v[244:247], v[204:207]
v_exp_f32 v68, v68
MM a[236:239], a[244:247], v[244:247], a[236:239]
v_exp_f32 v69, v69
MM v[44:47], a[80:83], a[160:163], v[28:31]
v_exp_f32 v70, v70
MM v[48:51], a[84:87], a[160:163], v[28:31]
v_exp_f32 v71, v71
MM v[44:47], a[88:91], a[164:167], v[44:47]
CV v252, v68, v69
CV v253, v70, v71
MM v[48:51], a[92:95], a[164:167], v[48:51]
v_exp_f32 v72, v72
MM v[44:47], a[96:99], a[168:171], v[44:47]
v_exp_f32 v73, v73
MM v[48:51], a[100:103], a[168:171], v[48:51]
v_exp_f32 v74, v74
MM v[44:47], a[104:107], a[172:175], v[44:47]
v_exp_f32 v75, v75
MM v[48:51], a[108:111], a[172:175], v[48:51]
s_add_u32 m0, s28, 0x14000
s_add_u32 s30, s42, 0x4000
s_and_b32 s30, s30, 0x1ffff
MM v[208:211], a[112:115], v[248:251], v[208:211]
s_waitcnt vmcnt(4)
buffer_load_dwordx4 v14, s[8:11], s30 offen nt lds
MM v[212:215], a[116:119], v[248:251], v[212:215]
s_add_u32 m0, s28, 0x14f80
TR a[112:113], v1 offset:49152
TR a[114:115], v1 offset:51200
MM v[216:219], a[120:123], v[248:251], v[216:219]
buffer_load_dwordx4 v14, s[8:11], s30 offen offset:128 nt lds
MM v[220:223], a[124:127], v[248:251], v[220:223]
TR a[116:117], v2 offset:49152
TR a[118:119], v2 offset:51200
MM v[224:227], a[128:131], v[248:251], v[224:227]
CV v254, v72, v73
CV v255, v74, v75
MM v[228:231], a[132:135], v[248:251], v[228:231]
TR a[120:121], v3 offset:49152
TR a[122:123], v3 offset:51200
MM v[232:235], a[136:139], v[248:251], v[232:235]
v_exp_f32 v44, v44
MM v[236:239], a[140:143], v[248:251], v[236:239]
TR a[124:125], v4 offset:49152
TR a[126:127], v4 offset:51200
MM a[240:243], a[244:247], v[248:251], a[240:243]
v_exp_f32 v45, v45
MM v[52:55], a[80:83], a[176:179], v[32:35]
TR a[128:129], v1 offset:53248
TR a[130:131], v1 offset:55296
MM v[56:59], a[84:87], a[176:179], v[32:35]
v_exp_f32 v46, v46
MM v[52:55], a[88:91], a[180:183], v[52:55]
TR a[132:133], v2 offset:53248
TR a[134:135], v2 offset:55296
MM v[56:59], a[92:95], a[180:183], v[56:59]
v_exp_f32 v47, v47
MM v[52:55], a[96:99], a[184:187], v[52:55]
TR a[136:137], v3 offset:53248
TR a[138:139], v3 offset:55296
MM v[56:59], a[100:103], a[184:187], v[56:59]
CV v240, v44, v45
CV v241, v46, v47
MM v[52:55], a[104:107], a[188:191], v[52:55]
TR a[140:141], v4 offset:53248
TR a[142:143], v4 offset:55296
MM v[56:59], a[108:111], a[188:191], v[56:59]
s_waitcnt lgkmcnt(8)
v_exp_f32 v48, v48
MM v[80:83], a[112:115], v[252:255], v[80:83]
v_exp_f32 v49, v49
MM v[84:87], a[116:119], v[252:255], v[84:87]
v_exp_f32 v50, v50
MM v[88:91], a[120:123], v[252:255], v[88:91]
s_add_u32 m0, s28, 0x14800
s_add_u32 s30, s42, 0x5000
s_and_b32 s30, s30, 0x1ffff
MM v[92:95], a[124:127], v[252:255], v[92:95]
s_waitcnt lgkmcnt(4)
s_waitcnt vmcnt(4)
v_add_u32 v5, 0xffff0000, v5
MM v[96:99], a[128:131], v[252:255], v[96:99]
buffer_load_dwordx4 v14, s[8:11], s30 offen nt lds
MM v[100:103], a[132:135], v[252:255], v[100:103]
s_waitcnt lgkmcnt(2)
s_add_u32 m0, s28, 0x15780
v_add_u32 v6, 0xffff0000, v6
MM v[104:107], a[136:139], v[252:255], v[104:107]
s_waitcnt lgkmcnt(0)
buffer_load_dwordx4 v14, s[8:11], s30 offen offset:128 nt lds
MM v[108:111], a[140:143], v[252:255], v[108:111]
v_exp_f32 v51, v51
MM a[224:227], a[244:247], v[252:255], a[224:227]
CV v242, v48, v49
CV v243, v50, v51
MM v[60:63], a[80:83], a[192:195], v[36:39]
v_exp_f32 v52, v52
MM v[64:67], a[84:87], a[192:195], v[36:39]
v_exp_f32 v53, v53
MM v[60:63], a[88:91], a[196:199], v[60:63]
v_exp_f32 v54, v54
MM v[64:67], a[92:95], a[196:199], v[64:67]
v_exp_f32 v55, v55
MM v[60:63], a[96:99], a[200:203], v[60:63]
CV v244, v52, v53
CV v245, v54, v55
MM v[64:67], a[100:103], a[200:203], v[64:67]
v_exp_f32 v56, v56
MM v[60:63], a[104:107], a[204:207], v[60:63]
v_exp_f32 v57, v57
MM v[64:67], a[108:111], a[204:207], v[64:67]
v_exp_f32 v58, v58
MM v[112:115], a[112:115], v[240:243], v[112:115]
v_exp_f32 v59, v59
MM v[116:119], a[116:119], v[240:243], v[116:119]
CV v246, v56, v57
CV v247, v58, v59
MM v[120:123], a[120:123], v[240:243], v[120:123]
v_exp_f32 v60, v60
MM v[124:127], a[124:127], v[240:243], v[124:127]
v_exp_f32 v61, v61
MM v[128:131], a[128:131], v[240:243], v[128:131]
v_exp_f32 v62, v62
MM v[132:135], a[132:135], v[240:243], v[132:135]
v_exp_f32 v63, v63
MM v[136:139], a[136:139], v[240:243], v[136:139]
CV v248, v60, v61
CV v249, v62, v63
MM v[140:143], a[140:143], v[240:243], v[140:143]
v_exp_f32 v64, v64
MM a[228:231], a[244:247], v[240:243], a[228:231]
s_waitcnt vmcnt(16)
s_barrier
s_add_u32 m0, s28, 0x18000
MM v[68:71], a[80:83], a[208:211], v[40:43]
s_add_u32 s30, s42, 0x6000
s_and_b32 s30, s30, 0x1ffff
s_waitcnt vmcnt(4)
MM v[72:75], a[84:87], a[208:211], v[40:43]
buffer_load_dwordx4 v13, s[4:7], s30 offen nt lds
MM v[68:71], a[88:91], a[212:215], v[68:71]
s_add_u32 m0, s28, 0x18f80
ds_read_b64 a[80:81], v5 offset:0
ds_read_b64 a[82:83], v6 offset:0
MM v[72:75], a[92:95], a[212:215], v[72:75]
buffer_load_dwordx4 v13, s[4:7], s30 offen offset:128 nt lds
MM v[68:71], a[96:99], a[216:219], v[68:71]
ds_read_b64 a[84:85], v5 offset:2048
ds_read_b64 a[86:87], v6 offset:2048
MM v[72:75], a[100:103], a[216:219], v[72:75]
v_add_u32 v7, 0xffff0000, v7
v_add_u32 v8, 0xffff0000, v8
MM v[68:71], a[104:107], a[220:223], v[68:71]
ds_read_b64 a[88:89], v7 offset:0
ds_read_b64 a[90:91], v8 offset:0
MM v[72:75], a[108:111], a[220:223], v[72:75]
v_exp_f32 v65, v65
MM v[144:147], a[112:115], v[244:247], v[144:147]
ds_read_b64 a[92:93], v7 offset:2048
ds_read_b64 a[94:95], v8 offset:2048
MM v[148:151], a[116:119], v[244:247], v[148:151]
v_exp_f32 v66, v66
MM v[152:155], a[120:123], v[244:247], v[152:155]
ds_read_b64 a[96:97], v5 offset:4096
ds_read_b64 a[98:99], v6 offset:4096
MM v[156:159], a[124:127], v[244:247], v[156:159]
v_exp_f32 v67, v67
MM v[160:163], a[128:131], v[244:247], v[160:163]
ds_read_b64 a[100:101], v5 offset:6144
ds_read_b64 a[102:103], v6 offset:6144
MM v[164:167], a[132:135], v[244:247], v[164:167]
CV v250, v64, v65
CV v251, v66, v67
MM v[168:171], a[136:139], v[244:247], v[168:171]
ds_read_b64 a[104:105], v7 offset:4096
ds_read_b64 a[106:107], v8 offset:4096
MM v[172:175], a[140:143], v[244:247], v[172:175]
v_exp_f32 v68, v68
MM a[232:235], a[244:247], v[244:247], a[232:235]
s_waitcnt lgkmcnt(6)
ds_read_b64 a[108:109], v7 offset:6144
ds_read_b64 a[110:111], v8 offset:6144
MM v[44:47], a[80:83], a[144:147], v[24:27]
v_exp_f32 v69, v69
MM v[48:51], a[84:87], a[144:147], v[24:27]
v_exp_f32 v70, v70
MM v[44:47], a[88:91], a[148:151], v[44:47]
v_exp_f32 v71, v71
MM v[48:51], a[92:95], a[148:151], v[48:51]
s_waitcnt lgkmcnt(4)
s_add_u32 m0, s28, 0x18800
s_add_u32 s30, s42, 0x7000
MM v[44:47], a[96:99], a[152:155], v[44:47]
s_and_b32 s30, s30, 0x1ffff
s_waitcnt vmcnt(4)
CV v252, v68, v69
MM v[48:51], a[100:103], a[152:155], v[48:51]
s_waitcnt lgkmcnt(2)
buffer_load_dwordx4 v13, s[4:7], s30 offen nt lds
MM v[44:47], a[104:107], a[156:159], v[44:47]
s_waitcnt lgkmcnt(0)
s_add_u32 m0, s28, 0x19780
CV v253, v70, v71
MM v[48:51], a[108:111], a[156:159], v[48:51]
buffer_load_dwordx4 v13, s[4:7], s30 offen offset:128 nt lds
MM v[176:179], a[112:115], v[248:251], v[176:179]
v_exp_f32 v72, v72
MM v[180:183], a[116:119], v[248:251], v[180:183]
v_exp_f32 v73, v73
MM v[184:187], a[120:123], v[248:251], v[184:187]
v_exp_f32 v74, v74
MM v[188:191], a[124:127], v[248:251], v[188:191]
v_exp_f32 v75, v75
MM v[192:195], a[128:131], v[248:251], v[192:195]
CV v254, v72, v73
CV v255, v74, v75
MM v[196:199], a[132:135], v[248:251], v[196:199]
v_exp_f32 v44, v44
MM v[200:203], a[136:139], v[248:251], v[200:203]
v_exp_f32 v45, v45
MM v[204:207], a[140:143], v[248:251], v[204:207]
v_exp_f32 v46, v46
MM a[236:239], a[244:247], v[248:251], a[236:239]
v_exp_f32 v47, v47
MM v[52:55], a[80:83], a[160:163], v[28:31]
CV v240, v44, v45
CV v241, v46, v47
MM v[56:59], a[84:87], a[160:163], v[28:31]
v_exp_f32 v48, v48
MM v[52:55], a[88:91], a[164:167], v[52:55]
v_exp_f32 v49, v49
MM v[56:59], a[92:95], a[164:167], v[56:59]
v_exp_f32 v50, v50
MM v[52:55], a[96:99], a[168:171], v[52:55]
v_exp_f32 v51, v51
MM v[56:59], a[100:103], a[168:171], v[56:59]
CV v242, v48, v49
CV v243, v50, v51
MM v[52:55], a[104:107], a[172:175], v[52:55]
v_add_u32 v1, 0xffff0000, v1
v_add_u32 v2, 0xffff0000, v2
MM v[56:59], a[108:111], a[172:175], v[56:59]
s_add_u32 m0, s28, 0x1c000
s_add_u32 s30, s42, 0x6000
s_and_b32 s30, s30, 0x1ffff
MM v[208:211], a[112:115], v[252:255], v[208:211]
s_waitcnt vmcnt(4)
buffer_load_dwordx4 v14, s[8:11], s30 offen nt lds
MM v[212:215], a[116:119], v[252:255], v[212:215]
s_add_u32 m0, s28, 0x1cf80
TR a[112:113], v1 offset:16384
TR a[114:115], v1 offset:18432
MM v[216:219], a[120:123], v[252:255], v[216:219]
buffer_load_dwordx4 v14, s[8:11], s30 offen offset:128 nt lds
MM v[220:223], a[124:127], v[252:255], v[220:223]
TR a[116:117], v2 offset:16384
TR a[118:119], v2 offset:18432
MM v[224:227], a[128:131], v[252:255], v[224:227]
v_add_u32 v3, 0xffff0000, v3
v_add_u32 v4, 0xffff0000, v4
MM v[228:231], a[132:135], v[252:255], v[228:231]
TR a[120:121], v3 offset:16384
TR a[122:123], v3 offset:18432
MM v[232:235], a[136:139], v[252:255], v[232:235]
v_exp_f32 v52, v52
MM v[236:239], a[140:143], v[252:255], v[236:239]
TR a[124:125], v4 offset:16384
TR a[126:127], v4 offset:18432
MM a[240:243], a[244:247], v[252:255], a[240:243]
v_exp_f32 v53, v53
MM v[60:63], a[80:83], a[176:179], v[32:35]
TR a[128:129], v1 offset:20480
TR a[130:131], v1 offset:22528
MM v[64:67], a[84:87], a[176:179], v[32:35]
v_exp_f32 v54, v54
MM v[60:63], a[88:91], a[180:183], v[60:63]
TR a[132:133], v2 offset:20480
TR a[134:135], v2 offset:22528
MM v[64:67], a[92:95], a[180:183], v[64:67]
v_exp_f32 v55, v55
MM v[60:63], a[96:99], a[184:187], v[60:63]
TR a[136:137], v3 offset:20480
TR a[138:139], v3 offset:22528
MM v[64:67], a[100:103], a[184:187], v[64:67]
CV v244, v52, v53
CV v245, v54, v55
MM v[60:63], a[104:107], a[188:191], v[60:63]
TR a[140:141], v4 offset:20480
TR a[142:143], v4 offset:22528
MM v[64:67], a[108:111], a[188:191], v[64:67]
s_waitcnt lgkmcnt(8)
v_exp_f32 v56, v56
MM v[80:83], a[112:115], v[240:243], v[80:83]
v_exp_f32 v57, v57
MM v[84:87], a[116:119], v[240:243], v[84:87]
v_exp_f32 v58, v58
MM v[88:91], a[120:123], v[240:243], v[88:91]
s_add_u32 m0, s28, 0x1c800
s_add_u32 s30, s42, 0x7000
s_and_b32 s30, s30, 0x1ffff
MM v[92:95], a[124:127], v[240:243], v[92:95]
s_waitcnt lgkmcnt(4)
s_waitcnt vmcnt(4)
MM v[96:99], a[128:131], v[240:243], v[96:99]
buffer_load_dwordx4 v14, s[8:11], s30 offen nt lds
MM v[100:103], a[132:135], v[240:243], v[100:103]
s_waitcnt lgkmcnt(2)
s_add_u32 m0, s28, 0x1d780
MM v[104:107], a[136:139], v[240:243], v[104:107]
s_waitcnt lgkmcnt(0)
buffer_load_dwordx4 v14, s[8:11], s30 offen offset:128 nt lds
MM v[108:111], a[140:143], v[240:243], v[108:111]
v_exp_f32 v59, v59
MM a[224:227], a[244:247], v[240:243], a[224:227]
CV v246, v56, v57
CV v247, v58, v59
MM v[68:71], a[80:83], a[192:195], v[36:39]
v_exp_f32 v60, v60
MM v[72:75], a[84:87], a[192:195], v[36:39]
v_exp_f32 v61, v61
MM v[68:71], a[88:91], a[196:199], v[68:71]
v_exp_f32 v62, v62
MM v[72:75], a[92:95], a[196:199], v[72:75]
v_exp_f32 v63, v63
MM v[68:71], a[96:99], a[200:203], v[68:71]
CV v248, v60, v61
CV v249, v62, v63
MM v[72:75], a[100:103], a[200:203], v[72:75]
v_exp_f32 v64, v64
MM v[68:71], a[104:107], a[204:207], v[68:71]
v_exp_f32 v65, v65
MM v[72:75], a[108:111], a[204:207], v[72:75]
v_exp_f32 v66, v66
MM v[112:115], a[112:115], v[244:247], v[112:115]
v_exp_f32 v67, v67
MM v[116:119], a[116:119], v[244:247], v[116:119]
CV v250, v64, v65
CV v251, v66, v67
MM v[120:123], a[120:123], v[244:247], v[120:123]
v_exp_f32 v68, v68
MM v[124:127], a[124:127], v[244:247], v[124:127]
v_exp_f32 v69, v69
MM v[128:131], a[128:131], v[244:247], v[128:131]
v_exp_f32 v70, v70
MM v[132:135], a[132:135], v[244:247], v[132:135]
v_exp_f32 v71, v71
MM v[136:139], a[136:139], v[244:247], v[136:139]
CV v252, v68, v69
CV v253, v70, v71
MM v[140:143], a[140:143], v[244:247], v[140:143]
v_exp_f32 v72, v72
MM a[228:231], a[244:247], v[244:247], a[228:231]
s_waitcnt vmcnt(16)
s_barrier
s_add_u32 m0, s28, 0x0
MM v[44:47], a[80:83], a[208:211], v[40:43]
s_add_u32 s30, s42, 0x8000
s_and_b32 s30, s30, 0x1ffff
s_add_u32 s30, s30, s97
MM v[48:51], a[84:87], a[208:211], v[40:43]
s_waitcnt vmcnt(4)
buffer_load_dwordx4 v13, s[4:7], s30 offen nt lds
MM v[44:47], a[88:91], a[212:215], v[44:47]
s_add_u32 m0, s28, 0xf80
ds_read_b64 a[80:81], v5 offset:32768
ds_read_b64 a[82:83], v6 offset:32768
MM v[48:51], a[92:95], a[212:215], v[48:51]
buffer_load_dwordx4 v13, s[4:7], s30 offen offset:128 nt lds
MM v[44:47], a[96:99], a[216:219], v[44:47]
ds_read_b64 a[84:85], v5 offset:34816
ds_read_b64 a[86:87], v6 offset:34816
MM v[48:51], a[100:103], a[216:219], v[48:51]
v_exp_f32 v73, v73
MM v[44:47], a[104:107], a[220:223], v[44:47]
ds_read_b64 a[88:89], v7 offset:32768
ds_read_b64 a[90:91], v8 offset:32768
MM v[48:51], a[108:111], a[220:223], v[48:51]
v_exp_f32 v74, v74
MM v[144:147], a[112:115], v[248:251], v[144:147]
ds_read_b64 a[92:93], v7 offset:34816
ds_read_b64 a[94:95], v8 offset:34816
MM v[148:151], a[116:119], v[248:251], v[148:151]
v_exp_f32 v75, v75
MM v[152:155], a[120:123], v[248:251], v[152:155]
ds_read_b64 a[96:97], v5 offset:36864
ds_read_b64 a[98:99], v6 offset:36864
MM v[156:159], a[124:127], v[248:251], v[156:159]
CV v254, v72, v73
CV v255, v74, v75
MM v[160:163], a[128:131], v[248:251], v[160:163]
ds_read_b64 a[100:101], v5 offset:38912
ds_read_b64 a[102:103], v6 offset:38912
MM v[164:167], a[132:135], v[248:251], v[164:167]
v_exp_f32 v44, v44
MM v[168:171], a[136:139], v[248:251], v[168:171]
ds_read_b64 a[104:105], v7 offset:36864
ds_read_b64 a[106:107], v8 offset:36864
MM v[172:175], a[140:143], v[248:251], v[172:175]
v_exp_f32 v45, v45
MM a[232:235], a[244:247], v[248:251], a[232:235]
s_waitcnt lgkmcnt(6)
ds_read_b64 a[108:109], v7 offset:38912
ds_read_b64 a[110:111], v8 offset:38912
MM v[52:55], a[80:83], a[144:147], v[24:27]
v_exp_f32 v46, v46
MM v[56:59], a[84:87], a[144:147], v[24:27]
v_exp_f32 v47, v47
MM v[52:55], a[88:91], a[148:151], v[52:55]
CV v240, v44, v45
CV v241, v46, v47
MM v[56:59], a[92:95], a[148:151], v[56:59]
s_waitcnt lgkmcnt(4)
s_add_u32 m0, s28, 0x800
s_add_u32 s30, s42, 0x9000
MM v[52:55], a[96:99], a[152:155], v[52:55]
s_and_b32 s30, s30, 0x1ffff
s_add_u32 s30, s30, s97
s_waitcnt vmcnt(4)
MM v[56:59], a[100:103], a[152:155], v[56:59]
s_waitcnt lgkmcnt(2)
buffer_load_dwordx4 v13, s[4:7], s30 offen nt lds
MM v[52:55], a[104:107], a[156:159], v[52:55]
s_waitcnt lgkmcnt(0)
s_add_u32 m0, s28, 0x1780
MM v[56:59], a[108:111], a[156:159], v[56:59]
buffer_load_dwordx4 v13, s[4:7], s30 offen offset:128 nt lds
MM v[176:179], a[112:115], v[252:255], v[176:179]
v_exp_f32 v48, v48
MM v[180:183], a[116:119], v[252:255], v[180:183]
v_exp_f32 v49, v49
MM v[184:187], a[120:123], v[252:255], v[184:187]
v_exp_f32 v50, v50
MM v[188:191], a[124:127], v[252:255], v[188:191]
v_exp_f32 v51, v51
MM v[192:195], a[128:131], v[252:255], v[192:195]
CV v242, v48, v49
CV v243, v50, v51
MM v[196:199], a[132:135], v[252:255], v[196:199]
v_exp_f32 v52, v52
MM v[200:203], a[136:139], v[252:255], v[200:203]
v_exp_f32 v53, v53
MM v[204:207], a[140:143], v[252:255], v[204:207]
v_exp_f32 v54, v54
MM a[236:239], a[244:247], v[252:255], a[236:239]
v_exp_f32 v55, v55
MM v[60:63], a[80:83], a[160:163], v[28:31]
CV v244, v52, v53
CV v245, v54, v55
MM v[64:67], a[84:87], a[160:163], v[28:31]
v_exp_f32 v56, v56
MM v[60:63], a[88:91], a[164:167], v[60:63]
v_exp_f32 v57, v57
MM v[64:67], a[92:95], a[164:167], v[64:67]
v_exp_f32 v58, v58
MM v[60:63], a[96:99], a[168:171], v[60:63]
v_exp_f32 v59, v59
MM v[64:67], a[100:103], a[168:171], v[64:67]
CV v246, v56, v57
CV v247, v58, v59
MM v[60:63], a[104:107], a[172:175], v[60:63]
MM v[64:67], a[108:111], a[172:175], v[64:67]
s_add_u32 m0, s28, 0x4000
s_add_u32 s30, s42, 0x8000
s_and_b32 s30, s30, 0x1ffff
MM v[208:211], a[112:115], v[240:243], v[208:211]
s_add_u32 s30, s30, s97
s_waitcnt vmcnt(4)
TR a[112:113], v1 offset:49152
MM v[212:215], a[116:119], v[240:243], v[212:215]
buffer_load_dwordx4 v14, s[8:11], s30 offen nt lds
MM v[216:219], a[120:123], v[240:243], v[216:219]
s_add_u32 m0, s28, 0x4f80
TR a[114:115], v1 offset:51200
TR a[116:117], v2 offset:49152
MM v[220:223], a[124:127], v[240:243], v[220:223]
buffer_load_dwordx4 v14, s[8:11], s30 offen offset:128 nt lds
MM v[224:227], a[128:131], v[240:243], v[224:227]
TR a[118:119], v2 offset:51200
TR a[120:121], v3 offset:49152
MM v[228:231], a[132:135], v[240:243], v[228:231]
v_exp_f32 v60, v60
MM v[232:235], a[136:139], v[240:243], v[232:235]
TR a[122:123], v3 offset:51200
TR a[124:125], v4 offset:49152
MM v[236:239], a[140:143], v[240:243], v[236:239]
v_exp_f32 v61, v61
MM a[240:243], a[244:247], v[240:243], a[240:243]
TR a[126:127], v4 offset:51200
TR a[128:129], v1 offset:53248
MM v[68:71], a[80:83], a[176:179], v[32:35]
v_exp_f32 v62, v62
MM v[72:75], a[84:87], a[176:179], v[32:35]
TR a[130:131], v1 offset:55296
TR a[132:133], v2 offset:53248
MM v[68:71], a[88:91], a[180:183], v[68:71]
v_exp_f32 v63, v63
MM v[72:75], a[92:95], a[180:183], v[72:75]
TR a[134:135], v2 offset:55296
TR a[136:137], v3 offset:53248
MM v[68:71], a[96:99], a[184:187], v[68:71]
CV v248, v60, v61
CV v249, v62, v63
MM v[72:75], a[100:103], a[184:187], v[72:75]
TR a[138:139], v3 offset:55296
TR a[140:141], v4 offset:53248
MM v[68:71], a[104:107], a[188:191], v[68:71]
v_exp_f32 v64, v64
MM v[72:75], a[108:111], a[188:191], v[72:75]
s_waitcnt lgkmcnt(7)
TR a[142:143], v4 offset:55296
MM v[80:83], a[112:115], v[244:247], v[80:83]
v_exp_f32 v65, v65
MM v[84:87], a[116:119], v[244:247], v[84:87]
v_exp_f32 v66, v66
MM v[88:91], a[120:123], v[244:247], v[88:91]
v_exp_f32 v67, v67
MM v[92:95], a[124:127], v[244:247], v[92:95]
s_waitcnt lgkmcnt(4)
s_add_u32 m0, s28, 0x4800
s_add_u32 s30, s42, 0x9000
MM v[96:99], a[128:131], v[244:247], v[96:99]
s_and_b32 s30, s30, 0x1ffff
s_add_u32 s30, s30, s97
s_waitcnt vmcnt(4)
MM v[100:103], a[132:135], v[244:247], v[100:103]
s_waitcnt lgkmcnt(2)
buffer_load_dwordx4 v14, s[8:11], s30 offen nt lds
MM v[104:107], a[136:139], v[244:247], v[104:107]
s_waitcnt lgkmcnt(0)
s_add_u32 m0, s28, 0x5780
CV v250, v64, v65
MM v[108:111], a[140:143], v[244:247], v[108:111]
buffer_load_dwordx4 v14, s[8:11], s30 offen offset:128 nt lds
MM a[224:227], a[244:247], v[244:247], a[224:227]
CV v251, v66, v67
MM v[44:47], a[80:83], a[192:195], v[36:39]
v_exp_f32 v68, v68
MM v[48:51], a[84:87], a[192:195], v[36:39]
v_exp_f32 v69, v69
MM v[44:47], a[88:91], a[196:199], v[44:47]
v_exp_f32 v70, v70
MM v[48:51], a[92:95], a[196:199], v[48:51]
v_exp_f32 v71, v71
MM v[44:47], a[96:99], a[200:203], v[44:47]
CV v252, v68, v69
CV v253, v70, v71
MM v[48:51], a[100:103], a[200:203], v[48:51]
v_exp_f32 v72, v72
MM v[44:47], a[104:107], a[204:207], v[44:47]
v_exp_f32 v73, v73
MM v[48:51], a[108:111], a[204:207], v[48:51]
v_exp_f32 v74, v74
MM v[112:115], a[112:115], v[248:251], v[112:115]
v_exp_f32 v75, v75
MM v[116:119], a[116:119], v[248:251], v[116:119]
CV v254, v72, v73
CV v255, v74, v75
MM v[120:123], a[120:123], v[248:251], v[120:123]
v_exp_f32 v44, v44
MM v[124:127], a[124:127], v[248:251], v[124:127]
v_exp_f32 v45, v45
MM v[128:131], a[128:131], v[248:251], v[128:131]
v_exp_f32 v46, v46
MM v[132:135], a[132:135], v[248:251], v[132:135]
v_exp_f32 v47, v47
MM v[136:139], a[136:139], v[248:251], v[136:139]
CV v240, v44, v45
CV v241, v46, v47
MM v[140:143], a[140:143], v[248:251], v[140:143]
v_exp_f32 v48, v48
MM a[228:231], a[244:247], v[248:251], a[228:231]
s_sub_u32 s96, s96, 1
s_cmp_lg_u32 s96, 0
s_cbranch_scc1 L_YA0
s_waitcnt vmcnt(16)
s_barrier
s_add_u32 m0, s28, 0x8000
MM v[52:55], a[80:83], a[208:211], v[40:43]
s_add_u32 s30, s42, 0xa000
s_and_b32 s30, s30, 0x1ffff
s_add_u32 s30, s30, 0x20000
MM v[56:59], a[84:87], a[208:211], v[40:43]
buffer_load_dwordx4 v13, s[4:7], s30 offen nt lds
MM v[52:55], a[88:91], a[212:215], v[52:55]
s_add_u32 m0, s28, 0x8f80
v_add_u32 v5, 0x10000, v5
v_add_u32 v6, 0x10000, v6
MM v[56:59], a[92:95], a[212:215], v[56:59]
buffer_load_dwordx4 v13, s[4:7], s30 offen offset:128 nt lds
MM v[52:55], a[96:99], a[216:219], v[52:55]
ds_read_b64 a[80:81], v5 offset:0
ds_read_b64 a[82:83], v6 offset:0
MM v[56:59], a[100:103], a[216:219], v[56:59]
v_exp_f32 v49, v49
MM v[52:55], a[104:107], a[220:223], v[52:55]
ds_read_b64 a[84:85], v5 offset:2048
ds_read_b64 a[86:87], v6 offset:2048
MM v[56:59], a[108:111], a[220:223], v[56:59]
v_add_u32 v7, 0x10000, v7
v_add_u32 v8, 0x10000, v8
MM v[144:147], a[112:115], v[252:255], v[144:147]
ds_read_b64 a[88:89], v7 offset:0
ds_read_b64 a[90:91], v8 offset:0
MM v[148:151], a[116:119], v[252:255], v[148:151]
v_exp_f32 v50, v50
MM v[152:155], a[120:123], v[252:255], v[152:155]
ds_read_b64 a[92:93], v7 offset:2048
ds_read_b64 a[94:95], v8 offset:2048
MM v[156:159], a[124:127], v[252:255], v[156:159]
v_exp_f32 v51, v51
MM v[160:163], a[128:131], v[252:255], v[160:163]
ds_read_b64 a[96:97], v5 offset:4096
ds_read_b64 a[98:99], v6 offset:4096
MM v[164:167], a[132:135], v[252:255], v[164:167]
CV v242, v48, v49
CV v243, v50, v51
MM v[168:171], a[136:139], v[252:255], v[168:171]
ds_read_b64 a[100:101], v5 offset:6144
ds_read_b64 a[102:103], v6 offset:6144
MM v[172:175], a[140:143], v[252:255], v[172:175]
ds_read_b64 a[104:105], v7 offset:4096
ds_read_b64 a[106:107], v8 offset:4096
MM a[232:235], a[244:247], v[252:255], a[232:235]
s_waitcnt lgkmcnt(8)
ds_read_b64 a[108:109], v7 offset:6144
ds_read_b64 a[110:111], v8 offset:6144
MM v[60:63], a[80:83], a[144:147], v[24:27]
v_exp_f32 v52, v52
MM v[64:67], a[84:87], a[144:147], v[24:27]
v_exp_f32 v53, v53
MM v[60:63], a[88:91], a[148:151], v[60:63]
s_waitcnt lgkmcnt(8)
v_exp_f32 v54, v54
MM v[64:67], a[92:95], a[148:151], v[64:67]
s_waitcnt lgkmcnt(6)
s_add_u32 m0, s28, 0x8800
s_add_u32 s30, s42, 0xb000
MM v[60:63], a[96:99], a[152:155], v[60:63]
s_waitcnt lgkmcnt(4)
s_and_b32 s30, s30, 0x1ffff
s_add_u32 s30, s30, 0x20000
MM v[64:67], a[100:103], a[152:155], v[64:67]
s_waitcnt lgkmcnt(2)
buffer_load_dwordx4 v13, s[4:7], s30 offen nt lds
MM v[60:63], a[104:107], a[156:159], v[60:63]
s_waitcnt lgkmcnt(0)
s_add_u32 m0, s28, 0x9780
v_add_u32 v1, 0x10000, v1
MM v[64:67], a[108:111], a[156:159], v[64:67]
buffer_load_dwordx4 v13, s[4:7], s30 offen offset:128 nt lds
MM v[176:179], a[112:115], v[240:243], v[176:179]
v_exp_f32 v55, v55
MM v[180:183], a[116:119], v[240:243], v[180:183]
CV v244, v52, v53
CV v245, v54, v55
MM v[184:187], a[120:123], v[240:243], v[184:187]
v_exp_f32 v56, v56
MM v[188:191], a[124:127], v[240:243], v[188:191]
v_exp_f32 v57, v57
MM v[192:195], a[128:131], v[240:243], v[192:195]
v_exp_f32 v58, v58
MM v[196:199], a[132:135], v[240:243], v[196:199]
v_exp_f32 v59, v59
MM v[200:203], a[136:139], v[240:243], v[200:203]
CV v246, v56, v57
CV v247, v58, v59
MM v[204:207], a[140:143], v[240:243], v[204:207]
v_exp_f32 v60, v60
MM a[236:239], a[244:247], v[240:243], a[236:239]
v_exp_f32 v61, v61
MM v[68:71], a[80:83], a[160:163], v[28:31]
v_exp_f32 v62, v62
MM v[72:75], a[84:87], a[160:163], v[28:31]
v_exp_f32 v63, v63
MM v[68:71], a[88:91], a[164:167], v[68:71]
CV v248, v60, v61
CV v249, v62, v63
MM v[72:75], a[92:95], a[164:167], v[72:75]
v_exp_f32 v64, v64
MM v[68:71], a[96:99], a[168:171], v[68:71]
v_exp_f32 v65, v65
MM v[72:75], a[100:103], a[168:171], v[72:75]
v_exp_f32 v66, v66
MM v[68:71], a[104:107], a[172:175], v[68:71]
v_exp_f32 v67, v67
MM v[72:75], a[108:111], a[172:175], v[72:75]
s_add_u32 m0, s28, 0xc000
s_add_u32 s30, s42, 0xa000
s_and_b32 s30, s30, 0x1ffff
MM v[208:211], a[112:115], v[244:247], v[208:211]
s_add_u32 s30, s30, 0x20000
buffer_load_dwordx4 v14, s[8:11], s30 offen nt lds
MM v[212:215], a[116:119], v[244:247], v[212:215]
s_add_u32 m0, s28, 0xcf80
TR a[112:113], v1 offset:16384
TR a[114:115], v1 offset:18432
MM v[216:219], a[120:123], v[244:247], v[216:219]
buffer_load_dwordx4 v14, s[8:11], s30 offen offset:128 nt lds
MM v[220:223], a[124:127], v[244:247], v[220:223]
v_add_u32 v2, 0x10000, v2
CV v250, v64, v65
MM v[224:227], a[128:131], v[244:247], v[224:227]
TR a[116:117], v2 offset:16384
TR a[118:119], v2 offset:18432
MM v[228:231], a[132:135], v[244:247], v[228:231]
v_add_u32 v3, 0x10000, v3
CV v251, v66, v67
MM v[232:235], a[136:139], v[244:247], v[232:235]
TR a[120:121], v3 offset:16384
TR a[122:123], v3 offset:18432
MM v[236:239], a[140:143], v[244:247], v[236:239]
v_add_u32 v4, 0x10000, v4
MM a[240:243], a[244:247], v[244:247], a[240:243]
TR a[124:125], v4 offset:16384
TR a[126:127], v4 offset:18432
MM v[44:47], a[80:83], a[176:179], v[32:35]
v_exp_f32 v68, v68
MM v[48:51], a[84:87], a[176:179], v[32:35]
TR a[128:129], v1 offset:20480
TR a[130:131], v1 offset:22528
MM v[44:47], a[88:91], a[180:183], v[44:47]
v_exp_f32 v69, v69
MM v[48:51], a[92:95], a[180:183], v[48:51]
TR a[132:133], v2 offset:20480
TR a[134:135], v2 offset:22528
MM v[44:47], a[96:99], a[184:187], v[44:47]
v_exp_f32 v70, v70
MM v[48:51], a[100:103], a[184:187], v[48:51]
TR a[136:137], v3 offset:20480
TR a[138:139], v3 offset:22528
MM v[44:47], a[104:107], a[188:191], v[44:47]
v_exp_f32 v71, v71
MM v[48:51], a[108:111], a[188:191], v[48:51]
s_waitcnt lgkmcnt(6)
TR a[140:141], v4 offset:20480
TR a[142:143], v4 offset:22528
MM v[80:83], a[112:115], v[248:251], v[80:83]
CV v252, v68, v69
CV v253, v70, v71
MM v[84:87], a[116:119], v[248:251], v[84:87]
v_exp_f32 v72, v72
MM v[88:91], a[120:123], v[248:251], v[88:91]
s_add_u32 m0, s28, 0xc800
s_add_u32 s30, s42, 0xb000
s_and_b32 s30, s30, 0x1ffff
MM v[92:95], a[124:127], v[248:251], v[92:95]
s_waitcnt lgkmcnt(4)
s_add_u32 s30, s30, 0x20000
MM v[96:99], a[128:131], v[248:251], v[96:99]
buffer_load_dwordx4 v14, s[8:11], s30 offen nt lds
MM v[100:103], a[132:135], v[248:251], v[100:103]
s_waitcnt lgkmcnt(2)
s_add_u32 m0, s28, 0xd780
MM v[104:107], a[136:139], v[248:251], v[104:107]
s_waitcnt lgkmcnt(0)
buffer_load_dwordx4 v14, s[8:11], s30 offen offset:128 nt lds
MM v[108:111], a[140:143], v[248:251], v[108:111]
v_exp_f32 v73, v73
MM a[224:227], a[244:247], v[248:251], a[224:227]
v_exp_f32 v74, v74
MM v[52:55], a[80:83], a[192:195], v[36:39]
v_exp_f32 v75, v75
MM v[56:59], a[84:87], a[192:195], v[36:39]
CV v254, v72, v73
CV v255, v74, v75
MM v[52:55], a[88:91], a[196:199], v[52:55]
v_exp_f32 v44, v44
MM v[56:59], a[92:95], a[196:199], v[56:59]
v_exp_f32 v45, v45
MM v[52:55], a[96:99], a[200:203], v[52:55]
v_exp_f32 v46, v46
MM v[56:59], a[100:103], a[200:203], v[56:59]
v_exp_f32 v47, v47
MM v[52:55], a[104:107], a[204:207], v[52:55]
CV v240, v44, v45
CV v241, v46, v47
MM v[56:59], a[108:111], a[204:207], v[56:59]
v_exp_f32 v48, v48
MM v[112:115], a[112:115], v[252:255], v[112:115]
v_exp_f32 v49, v49
MM v[116:119], a[116:119], v[252:255], v[116:119]
v_exp_f32 v50, v50
MM v[120:123], a[120:123], v[252:255], v[120:123]
v_exp_f32 v51, v51
MM v[124:127], a[124:127], v[252:255], v[124:127]
CV v242, v48, v49
CV v243, v50, v51
MM v[128:131], a[128:131], v[252:255], v[128:131]
v_exp_f32 v52, v52
MM v[132:135], a[132:135], v[252:255], v[132:135]
v_exp_f32 v53, v53
MM v[136:139], a[136:139], v[252:255], v[136:139]
v_exp_f32 v54, v54
MM v[140:143], a[140:143], v[252:255], v[140:143]
v_exp_f32 v55, v55
MM a[228:231], a[244:247], v[252:255], a[228:231]
s_waitcnt vmcnt(16)
s_barrier
s_add_u32 m0, s28, 0x10000
MM v[60:63], a[80:83], a[208:211], v[40:43]
s_add_u32 s30, s42, 0xc000
s_and_b32 s30, s30, 0x1ffff
s_add_u32 s30, s30, 0x20000
MM v[64:67], a[84:87], a[208:211], v[40:43]
buffer_load_dwordx4 v13, s[4:7], s30 offen nt lds
MM v[60:63], a[88:91], a[212:215], v[60:63]
s_add_u32 m0, s28, 0x10f80
ds_read_b64 a[80:81], v5 offset:32768
ds_read_b64 a[82:83], v6 offset:32768
MM v[64:67], a[92:95], a[212:215], v[64:67]
buffer_load_dwordx4 v13, s[4:7], s30 offen offset:128 nt lds
MM v[60:63], a[96:99], a[216:219], v[60:63]
ds_read_b64 a[84:85], v5 offset:34816
ds_read_b64 a[86:87], v6 offset:34816
MM v[64:67], a[100:103], a[216:219], v[64:67]
CV v244, v52, v53
CV v245, v54, v55
MM v[60:63], a[104:107], a[220:223], v[60:63]
ds_read_b64 a[88:89], v7 offset:32768
ds_read_b64 a[90:91], v8 offset:32768
MM v[64:67], a[108:111], a[220:223], v[64:67]
v_exp_f32 v56, v56
MM v[144:147], a[112:115], v[240:243], v[144:147]
ds_read_b64 a[92:93], v7 offset:34816
ds_read_b64 a[94:95], v8 offset:34816
MM v[148:151], a[116:119], v[240:243], v[148:151]
v_exp_f32 v57, v57
MM v[152:155], a[120:123], v[240:243], v[152:155]
ds_read_b64 a[96:97], v5 offset:36864
ds_read_b64 a[98:99], v6 offset:36864
MM v[156:159], a[124:127], v[240:243], v[156:159]
v_exp_f32 v58, v58
MM v[160:163], a[128:131], v[240:243], v[160:163]
ds_read_b64 a[100:101], v5 offset:38912
ds_read_b64 a[102:103], v6 offset:38912
MM v[164:167], a[132:135], v[240:243], v[164:167]
v_exp_f32 v59, v59
MM v[168:171], a[136:139], v[240:243], v[168:171]
ds_read_b64 a[104:105], v7 offset:36864
ds_read_b64 a[106:107], v8 offset:36864
MM v[172:175], a[140:143], v[240:243], v[172:175]
CV v246, v56, v57
CV v247, v58, v59
MM a[232:235], a[244:247], v[240:243], a[232:235]
s_waitcnt lgkmcnt(6)
ds_read_b64 a[108:109], v7 offset:38912
ds_read_b64 a[110:111], v8 offset:38912
MM v[68:71], a[80:83], a[144:147], v[24:27]
v_exp_f32 v60, v60
MM v[72:75], a[84:87], a[144:147], v[24:27]
v_exp_f32 v61, v61
MM v[68:71], a[88:91], a[148:151], v[68:71]
v_exp_f32 v62, v62
MM v[72:75], a[92:95], a[148:151], v[72:75]
s_waitcnt lgkmcnt(4)
s_add_u32 m0, s28, 0x10800
s_add_u32 s30, s42, 0xd000
MM v[68:71], a[96:99], a[152:155], v[68:71]
s_and_b32 s30, s30, 0x1ffff
s_add_u32 s30, s30, 0x20000
MM v[72:75], a[100:103], a[152:155], v[72:75]
s_waitcnt lgkmcnt(2)
buffer_load_dwordx4 v13, s[4:7], s30 offen nt lds
MM v[68:71], a[104:107], a[156:159], v[68:71]
s_waitcnt lgkmcnt(0)
s_add_u32 m0, s28, 0x11780
MM v[72:75], a[108:111], a[156:159], v[72:75]
buffer_load_dwordx4 v13, s[4:7], s30 offen offset:128 nt lds
MM v[176:179], a[112:115], v[244:247], v[176:179]
v_exp_f32 v63, v63
MM v[180:183], a[116:119], v[244:247], v[180:183]
CV v248, v60, v61
CV v249, v62, v63
MM v[184:187], a[120:123], v[244:247], v[184:187]
v_exp_f32 v64, v64
MM v[188:191], a[124:127], v[244:247], v[188:191]
v_exp_f32 v65, v65
MM v[192:195], a[128:131], v[244:247], v[192:195]
v_exp_f32 v66, v66
MM v[196:199], a[132:135], v[244:247], v[196:199]
v_exp_f32 v67, v67
MM v[200:203], a[136:139], v[244:247], v[200:203]
CV v250, v64, v65
CV v251, v66, v67
MM v[204:207], a[140:143], v[244:247], v[204:207]
v_exp_f32 v68, v68
MM a[236:239], a[244:247], v[244:247], a[236:239]
v_exp_f32 v69, v69
MM v[44:47], a[80:83], a[160:163], v[28:31]
v_exp_f32 v70, v70
MM v[48:51], a[84:87], a[160:163], v[28:31]
v_exp_f32 v71, v71
MM v[44:47], a[88:91], a[164:167], v[44:47]
CV v252, v68, v69
CV v253, v70, v71
MM v[48:51], a[92:95], a[164:167], v[48:51]
v_exp_f32 v72, v72
MM v[44:47], a[96:99], a[168:171], v[44:47]
v_exp_f32 v73, v73
MM v[48:51], a[100:103], a[168:171], v[48:51]
v_exp_f32 v74, v74
MM v[44:47], a[104:107], a[172:175], v[44:47]
v_exp_f32 v75, v75
MM v[48:51], a[108:111], a[172:175], v[48:51]
s_add_u32 m0, s28, 0x14000
s_add_u32 s30, s42, 0xc000
s_and_b32 s30, s30, 0x1ffff
MM v[208:211], a[112:115], v[248:251], v[208:211]
s_add_u32 s30, s30, 0x20000
buffer_load_dwordx4 v14, s[8:11], s30 offen nt lds
MM v[212:215], a[116:119], v[248:251], v[212:215]
s_add_u32 m0, s28, 0x14f80
TR a[112:113], v1 offset:49152
TR a[114:115], v1 offset:51200
MM v[216:219], a[120:123], v[248:251], v[216:219]
buffer_load_dwordx4 v14, s[8:11], s30 offen offset:128 nt lds
MM v[220:223], a[124:127], v[248:251], v[220:223]
TR a[116:117], v2 offset:49152
TR a[118:119], v2 offset:51200
MM v[224:227], a[128:131], v[248:251], v[224:227]
CV v254, v72, v73
CV v255, v74, v75
MM v[228:231], a[132:135], v[248:251], v[228:231]
TR a[120:121], v3 offset:49152
TR a[122:123], v3 offset:51200
MM v[232:235], a[136:139], v[248:251], v[232:235]
v_exp_f32 v44, v44
MM v[236:239], a[140:143], v[248:251], v[236:239]
TR a[124:125], v4 offset:49152
TR a[126:127], v4 offset:51200
MM a[240:243], a[244:247], v[248:251], a[240:243]
v_exp_f32 v45, v45
MM v[52:55], a[80:83], a[176:179], v[32:35]
TR a[128:129], v1 offset:53248
TR a[130:131], v1 offset:55296
MM v[56:59], a[84:87], a[176:179], v[32:35]
v_exp_f32 v46, v46
MM v[52:55], a[88:91], a[180:183], v[52:55]
TR a[132:133], v2 offset:53248
TR a[134:135], v2 offset:55296
MM v[56:59], a[92:95], a[180:183], v[56:59]
v_exp_f32 v47, v47
MM v[52:55], a[96:99], a[184:187], v[52:55]
TR a[136:137], v3 offset:53248
TR a[138:139], v3 offset:55296
MM v[56:59], a[100:103], a[184:187], v[56:59]
CV v240, v44, v45
CV v241, v46, v47
MM v[52:55], a[104:107], a[188:191], v[52:55]
TR a[140:141], v4 offset:53248
TR a[142:143], v4 offset:55296
MM v[56:59], a[108:111], a[188:191], v[56:59]
s_waitcnt lgkmcnt(8)
v_exp_f32 v48, v48
MM v[80:83], a[112:115], v[252:255], v[80:83]
v_exp_f32 v49, v49
MM v[84:87], a[116:119], v[252:255], v[84:87]
v_exp_f32 v50, v50
MM v[88:91], a[120:123], v[252:255], v[88:91]
s_add_u32 m0, s28, 0x14800
s_add_u32 s30, s42, 0xd000
s_and_b32 s30, s30, 0x1ffff
MM v[92:95], a[124:127], v[252:255], v[92:95]
s_waitcnt lgkmcnt(4)
s_add_u32 s30, s30, 0x20000
MM v[96:99], a[128:131], v[252:255], v[96:99]
buffer_load_dwordx4 v14, s[8:11], s30 offen nt lds
MM v[100:103], a[132:135], v[252:255], v[100:103]
s_waitcnt lgkmcnt(2)
s_add_u32 m0, s28, 0x15780
MM v[104:107], a[136:139], v[252:255], v[104:107]
s_waitcnt lgkmcnt(0)
buffer_load_dwordx4 v14, s[8:11], s30 offen offset:128 nt lds
MM v[108:111], a[140:143], v[252:255], v[108:111]
v_exp_f32 v51, v51
MM a[224:227], a[244:247], v[252:255], a[224:227]
CV v242, v48, v49
CV v243, v50, v51
MM v[60:63], a[80:83], a[192:195], v[36:39]
v_exp_f32 v52, v52
MM v[64:67], a[84:87], a[192:195], v[36:39]
v_exp_f32 v53, v53
MM v[60:63], a[88:91], a[196:199], v[60:63]
v_exp_f32 v54, v54
MM v[64:67], a[92:95], a[196:199], v[64:67]
v_exp_f32 v55, v55
MM v[60:63], a[96:99], a[200:203], v[60:63]
CV v244, v52, v53
CV v245, v54, v55
MM v[64:67], a[100:103], a[200:203], v[64:67]
v_exp_f32 v56, v56
MM v[60:63], a[104:107], a[204:207], v[60:63]
v_exp_f32 v57, v57
MM v[64:67], a[108:111], a[204:207], v[64:67]
v_exp_f32 v58, v58
MM v[112:115], a[112:115], v[240:243], v[112:115]
v_exp_f32 v59, v59
MM v[116:119], a[116:119], v[240:243], v[116:119]
CV v246, v56, v57
CV v247, v58, v59
MM v[120:123], a[120:123], v[240:243], v[120:123]
v_exp_f32 v60, v60
MM v[124:127], a[124:127], v[240:243], v[124:127]
v_exp_f32 v61, v61
MM v[128:131], a[128:131], v[240:243], v[128:131]
v_exp_f32 v62, v62
MM v[132:135], a[132:135], v[240:243], v[132:135]
v_exp_f32 v63, v63
MM v[136:139], a[136:139], v[240:243], v[136:139]
CV v248, v60, v61
CV v249, v62, v63
MM v[140:143], a[140:143], v[240:243], v[140:143]
v_exp_f32 v64, v64
MM a[228:231], a[244:247], v[240:243], a[228:231]
v_exp_f32 v65, v65
MM v[68:71], a[80:83], a[208:211], v[40:43]
v_exp_f32 v66, v66
MM v[72:75], a[84:87], a[208:211], v[40:43]
v_exp_f32 v67, v67
MM v[68:71], a[88:91], a[212:215], v[68:71]
CV v250, v64, v65
CV v251, v66, v67
MM v[72:75], a[92:95], a[212:215], v[72:75]
MM v[68:71], a[96:99], a[216:219], v[68:71]
MM v[72:75], a[100:103], a[216:219], v[72:75]
MM v[68:71], a[104:107], a[220:223], v[68:71]
MM v[72:75], a[108:111], a[220:223], v[72:75]
MM v[144:147], a[112:115], v[244:247], v[144:147]
MM v[148:151], a[116:119], v[244:247], v[148:151]
MM v[152:155], a[120:123], v[244:247], v[152:155]
MM v[156:159], a[124:127], v[244:247], v[156:159]
MM v[160:163], a[128:131], v[244:247], v[160:163]
MM v[164:167], a[132:135], v[244:247], v[164:167]
MM v[168:171], a[136:139], v[244:247], v[168:171]
v_exp_f32 v68, v68
MM v[172:175], a[140:143], v[244:247], v[172:175]
v_exp_f32 v69, v69
MM a[232:235], a[244:247], v[244:247], a[232:235]
v_exp_f32 v70, v70
MM v[176:179], a[112:115], v[248:251], v[176:179]
v_exp_f32 v71, v71
MM v[180:183], a[116:119], v[248:251], v[180:183]
CV v252, v68, v69
CV v253, v70, v71
MM v[184:187], a[120:123], v[248:251], v[184:187]
v_exp_f32 v72, v72
MM v[188:191], a[124:127], v[248:251], v[188:191]
v_exp_f32 v73, v73
v_exp_f32 v74, v74
v_exp_f32 v75, v75
MM v[192:195], a[128:131], v[248:251], v[192:195]
CV v254, v72, v73
CV v255, v74, v75
MM v[196:199], a[132:135], v[248:251], v[196:199]
MM v[200:203], a[136:139], v[248:251], v[200:203]
MM v[204:207], a[140:143], v[248:251], v[204:207]
MM a[236:239], a[244:247], v[248:251], a[236:239]
MM v[208:211], a[112:115], v[252:255], v[208:211]
MM v[212:215], a[116:119], v[252:255], v[212:215]
MM v[216:219], a[120:123], v[252:255], v[216:219]
MM v[220:223], a[124:127], v[252:255], v[220:223]
MM v[224:227], a[128:131], v[252:255], v[224:227]
MM v[228:231], a[132:135], v[252:255], v[228:231]
MM v[232:235], a[136:139], v[252:255], v[232:235]
MM v[236:239], a[140:143], v[252:255], v[236:239]
MM a[240:243], a[244:247], v[252:255], a[240:243]
v_accvgpr_read_b32 v44, a224
v_accvgpr_read_b32 v46, a228
v_accvgpr_read_b32 v48, a232
v_accvgpr_read_b32 v50, a236
s_nop 3
v_accvgpr_read_b32 v52, a240
v_subrev_u32 v56, 0x2b800000, v44
v_subrev_u32 v57, 0x2b800000, v46
v_subrev_u32 v58, 0x2b800000, v48
v_subrev_u32 v59, 0x2b800000, v50
v_subrev_u32 v60, 0x2b800000, v52
v_max3_u32 v56, v56, v57, v58
v_max3_u32 v56, v56, v59, v60
v_cmp_lt_u32 vcc, 0x28000000, v56
v_rcp_f32 v44, v44
v_rcp_f32 v46, v46
v_rcp_f32 v48, v48
v_rcp_f32 v50, v50
v_rcp_f32 v52, v52
s_cmp_lg_u64 vcc, 0
s_cselect_b32 s40, 1, 0
v_mov_b32 v57, s40
s_lshl_b32 s40, s33, 2
v_add_u32 v58, 0x20000, v79
v_add_u32 v59, s40, v58
ds_write_b32 v59, v57
v_pk_mul_f32 v[80:81], v[80:81], v[44:45] op_sel_hi:[1,0]
v_pk_mul_f32 v[82:83], v[82:83], v[44:45] op_sel_hi:[1,0]
v_pk_mul_f32 v[84:85], v[84:85], v[44:45] op_sel_hi:[1,0]
v_pk_mul_f32 v[86:87], v[86:87], v[44:45] op_sel_hi:[1,0]
CV v80, v80, v81
CV v81, v82, v83
CV v82, v84, v85
CV v83, v86, v87
v_pk_mul_f32 v[88:89], v[88:89], v[44:45] op_sel_hi:[1,0]
v_pk_mul_f32 v[90:91], v[90:91], v[44:45] op_sel_hi:[1,0]
v_pk_mul_f32 v[92:93], v[92:93], v[44:45] op_sel_hi:[1,0]
v_pk_mul_f32 v[94:95], v[94:95], v[44:45] op_sel_hi:[1,0]
CV v84, v88, v89
CV v85, v90, v91
CV v86, v92, v93
CV v87, v94, v95
s_waitcnt lgkmcnt(0)
s_barrier
ds_read_b128 v[60:63], v58
v_pk_mul_f32 v[96:97], v[96:97], v[44:45] op_sel_hi:[1,0]
v_pk_mul_f32 v[98:99], v[98:99], v[44:45] op_sel_hi:[1,0]
v_pk_mul_f32 v[100:101], v[100:101], v[44:45] op_sel_hi:[1,0]
v_pk_mul_f32 v[102:103], v[102:103], v[44:45] op_sel_hi:[1,0]
CV v88, v96, v97
CV v89, v98, v99
CV v90, v100, v101
CV v91, v102, v103
v_pk_mul_f32 v[104:105], v[104:105], v[44:45] op_sel_hi:[1,0]
v_pk_mul_f32 v[106:107], v[106:107], v[44:45] op_sel_hi:[1,0]
v_pk_mul_f32 v[108:109], v[108:109], v[44:45] op_sel_hi:[1,0]
v_pk_mul_f32 v[110:111], v[110:111], v[44:45] op_sel_hi:[1,0]
CV v92, v104, v105
CV v93, v106, v107
CV v94, v108, v109
CV v95, v110, v111
v_pk_mul_f32 v[112:113], v[112:113], v[46:47] op_sel_hi:[1,0]
v_pk_mul_f32 v[114:115], v[114:115], v[46:47] op_sel_hi:[1,0]
v_pk_mul_f32 v[116:117], v[116:117], v[46:47] op_sel_hi:[1,0]
v_pk_mul_f32 v[118:119], v[118:119], v[46:47] op_sel_hi:[1,0]
CV v96, v112, v113
CV v97, v114, v115
CV v98, v116, v117
CV v99, v118, v119
v_pk_mul_f32 v[120:121], v[120:121], v[46:47] op_sel_hi:[1,0]
v_pk_mul_f32 v[122:123], v[122:123], v[46:47] op_sel_hi:[1,0]
v_pk_mul_f32 v[124:125], v[124:125], v[46:47] op_sel_hi:[1,0]
v_pk_mul_f32 v[126:127], v[126:127], v[46:47] op_sel_hi:[1,0]
s_waitcnt lgkmcnt(0)
v_or3_b32 v60, v60, v61, v62
v_or_b32 v60, v60, v63
CV v100, v120, v121
CV v101, v122, v123
v_readfirstlane_b32 s40, v60
CV v102, v124, v125
CV v103, v126, v127
v_pk_mul_f32 v[128:129], v[128:129], v[46:47] op_sel_hi:[1,0]
v_pk_mul_f32 v[130:131], v[130:131], v[46:47] op_sel_hi:[1,0]
s_or_b32 s40, s40, s36
s_cbranch_scc1 L_YFB0
L_YRet0:
s_waitcnt vmcnt(16)
s_barrier
v_pk_mul_f32 v[132:133], v[132:133], v[46:47] op_sel_hi:[1,0]
v_pk_mul_f32 v[134:135], v[134:135], v[46:47] op_sel_hi:[1,0]
s_add_u32 m0, s28, 0x18000
s_add_u32 s30, s42, 0xe000
s_and_b32 s30, s30, 0x1ffff
CV v104, v128, v129
CV v105, v130, v131
CV v106, v132, v133
CV v107, v134, v135
s_add_u32 s30, s30, 0x20000
buffer_load_dwordx4 v13, s[4:7], s30 offen nt lds
v_pk_mul_f32 v[136:137], v[136:137], v[46:47] op_sel_hi:[1,0]
v_pk_mul_f32 v[138:139], v[138:139], v[46:47] op_sel_hi:[1,0]
v_pk_mul_f32 v[140:141], v[140:141], v[46:47] op_sel_hi:[1,0]
v_pk_mul_f32 v[142:143], v[142:143], v[46:47] op_sel_hi:[1,0]
s_add_u32 m0, s28, 0x18f80
v_add_u32 v1, 0xffff0000, v1
v_add_u32 v5, 0xffff0000, v5
CV v108, v136, v137
CV v109, v138, v139
CV v110, v140, v141
CV v111, v142, v143
buffer_load_dwordx4 v13, s[4:7], s30 offen offset:128 nt lds
v_pk_mul_f32 v[144:145], v[144:145], v[48:49] op_sel_hi:[1,0]
v_pk_mul_f32 v[146:147], v[146:147], v[48:49] op_sel_hi:[1,0]
v_pk_mul_f32 v[148:149], v[148:149], v[48:49] op_sel_hi:[1,0]
v_pk_mul_f32 v[150:151], v[150:151], v[48:49] op_sel_hi:[1,0]
TR a[112:113], v1 offset:16384
TR a[114:115], v1 offset:18432
CV v112, v144, v145
CV v113, v146, v147
CV v114, v148, v149
CV v115, v150, v151
ds_read_b64 a[80:81], v5 offset:0
v_add_u32 v2, 0xffff0000, v2
v_pk_mul_f32 v[152:153], v[152:153], v[48:49] op_sel_hi:[1,0]
v_pk_mul_f32 v[154:155], v[154:155], v[48:49] op_sel_hi:[1,0]
v_pk_mul_f32 v[156:157], v[156:157], v[48:49] op_sel_hi:[1,0]
v_pk_mul_f32 v[158:159], v[158:159], v[48:49] op_sel_hi:[1,0]
TR a[116:117], v2 offset:16384
TR a[118:119], v2 offset:18432
CV v116, v152, v153
CV v117, v154, v155
CV v118, v156, v157
CV v119, v158, v159
v_add_u32 v3, 0xffff0000, v3
v_add_u32 v6, 0xffff0000, v6
v_pk_mul_f32 v[160:161], v[160:161], v[48:49] op_sel_hi:[1,0]
v_pk_mul_f32 v[162:163], v[162:163], v[48:49] op_sel_hi:[1,0]
v_pk_mul_f32 v[164:165], v[164:165], v[48:49] op_sel_hi:[1,0]
v_pk_mul_f32 v[166:167], v[166:167], v[48:49] op_sel_hi:[1,0]
s_add_u32 m0, s28, 0x18800
s_add_u32 s30, s42, 0xf000
s_and_b32 s30, s30, 0x1ffff
CV v120, v160, v161
CV v121, v162, v163
CV v122, v164, v165
CV v123, v166, v167
s_add_u32 s30, s30, 0x20000
buffer_load_dwordx4 v13, s[4:7], s30 offen nt lds
v_pk_mul_f32 v[168:169], v[168:169], v[48:49] op_sel_hi:[1,0]
v_pk_mul_f32 v[170:171], v[170:171], v[48:49] op_sel_hi:[1,0]
v_pk_mul_f32 v[172:173], v[172:173], v[48:49] op_sel_hi:[1,0]
v_pk_mul_f32 v[174:175], v[174:175], v[48:49] op_sel_hi:[1,0]
s_add_u32 m0, s28, 0x19780
TR a[120:121], v3 offset:16384
TR a[122:123], v3 offset:18432
CV v124, v168, v169
CV v125, v170, v171
CV v126, v172, v173
CV v127, v174, v175
buffer_load_dwordx4 v13, s[4:7], s30 offen offset:128 nt lds
v_pk_mul_f32 v[176:177], v[176:177], v[50:51] op_sel_hi:[1,0]
v_pk_mul_f32 v[178:179], v[178:179], v[50:51] op_sel_hi:[1,0]
v_pk_mul_f32 v[180:181], v[180:181], v[50:51] op_sel_hi:[1,0]
v_pk_mul_f32 v[182:183], v[182:183], v[50:51] op_sel_hi:[1,0]
ds_read_b64 a[82:83], v6 offset:0
v_add_u32 v4, 0xffff0000, v4
CV v128, v176, v177
CV v129, v178, v179
CV v130, v180, v181
CV v131, v182, v183
TR a[124:125], v4 offset:16384
TR a[126:127], v4 offset:18432
v_pk_mul_f32 v[184:185], v[184:185], v[50:51] op_sel_hi:[1,0]
v_pk_mul_f32 v[186:187], v[186:187], v[50:51] op_sel_hi:[1,0]
v_pk_mul_f32 v[188:189], v[188:189], v[50:51] op_sel_hi:[1,0]
v_pk_mul_f32 v[190:191], v[190:191], v[50:51] op_sel_hi:[1,0]
TR a[128:129], v1 offset:20480
TR a[130:131], v1 offset:22528
CV v132, v184, v185
CV v133, v186, v187
CV v134, v188, v189
CV v135, v190, v191
TR a[132:133], v2 offset:20480
TR a[134:135], v2 offset:22528
v_pk_mul_f32 v[192:193], v[192:193], v[50:51] op_sel_hi:[1,0]
v_pk_mul_f32 v[194:195], v[194:195], v[50:51] op_sel_hi:[1,0]
v_pk_mul_f32 v[196:197], v[196:197], v[50:51] op_sel_hi:[1,0]
v_pk_mul_f32 v[198:199], v[198:199], v[50:51] op_sel_hi:[1,0]
s_add_u32 m0, s28, 0x1c000
s_add_u32 s30, s42, 0xe000
s_and_b32 s30, s30, 0x1ffff
CV v136, v192, v193
CV v137, v194, v195
CV v138, v196, v197
CV v139, v198, v199
s_add_u32 s30, s30, 0x20000
buffer_load_dwordx4 v14, s[8:11], s30 offen nt lds
v_pk_mul_f32 v[200:201], v[200:201], v[50:51] op_sel_hi:[1,0]
v_pk_mul_f32 v[202:203], v[202:203], v[50:51] op_sel_hi:[1,0]
v_pk_mul_f32 v[204:205], v[204:205], v[50:51] op_sel_hi:[1,0]
v_pk_mul_f32 v[206:207], v[206:207], v[50:51] op_sel_hi:[1,0]
s_add_u32 m0, s28, 0x1cf80
TR a[136:137], v3 offset:20480
TR a[138:139], v3 offset:22528
CV v140, v200, v201
CV v141, v202, v203
CV v142, v204, v205
CV v143, v206, v207
buffer_load_dwordx4 v14, s[8:11], s30 offen offset:128 nt lds
v_pk_mul_f32 v[208:209], v[208:209], v[52:53] op_sel_hi:[1,0]
v_pk_mul_f32 v[210:211], v[210:211], v[52:53] op_sel_hi:[1,0]
v_pk_mul_f32 v[212:213], v[212:213], v[52:53] op_sel_hi:[1,0]
v_pk_mul_f32 v[214:215], v[214:215], v[52:53] op_sel_hi:[1,0]
TR a[140:141], v4 offset:20480
TR a[142:143], v4 offset:22528
CV v144, v208, v209
CV v145, v210, v211
CV v146, v212, v213
CV v147, v214, v215
ds_read_b64 a[84:85], v5 offset:2048
ds_read_b64 a[86:87], v6 offset:2048
v_pk_mul_f32 v[216:217], v[216:217], v[52:53] op_sel_hi:[1,0]
v_pk_mul_f32 v[218:219], v[218:219], v[52:53] op_sel_hi:[1,0]
v_pk_mul_f32 v[220:221], v[220:221], v[52:53] op_sel_hi:[1,0]
v_pk_mul_f32 v[222:223], v[222:223], v[52:53] op_sel_hi:[1,0]
v_add_u32 v7, 0xffff0000, v7
v_add_u32 v8, 0xffff0000, v8
CV v148, v216, v217
CV v149, v218, v219
CV v150, v220, v221
CV v151, v222, v223
ds_read_b64 a[88:89], v7 offset:0
ds_read_b64 a[90:91], v8 offset:0
v_pk_mul_f32 v[224:225], v[224:225], v[52:53] op_sel_hi:[1,0]
v_pk_mul_f32 v[226:227], v[226:227], v[52:53] op_sel_hi:[1,0]
v_pk_mul_f32 v[228:229], v[228:229], v[52:53] op_sel_hi:[1,0]
v_pk_mul_f32 v[230:231], v[230:231], v[52:53] op_sel_hi:[1,0]
s_add_u32 m0, s28, 0x1c800
s_add_u32 s30, s42, 0xf000
s_and_b32 s30, s30, 0x1ffff
CV v152, v224, v225
CV v153, v226, v227
CV v154, v228, v229
CV v155, v230, v231
s_add_u32 s30, s30, 0x20000
buffer_load_dwordx4 v14, s[8:11], s30 offen nt lds
v_pk_mul_f32 v[232:233], v[232:233], v[52:53] op_sel_hi:[1,0]
v_pk_mul_f32 v[234:235], v[234:235], v[52:53] op_sel_hi:[1,0]
v_pk_mul_f32 v[236:237], v[236:237], v[52:53] op_sel_hi:[1,0]
v_pk_mul_f32 v[238:239], v[238:239], v[52:53] op_sel_hi:[1,0]
s_add_u32 m0, s28, 0x1d780
ds_read_b64 a[92:93], v7 offset:2048
ds_read_b64 a[94:95], v8 offset:2048
CV v156, v232, v233
CV v157, v234, v235
CV v158, v236, v237
CV v159, v238, v239
buffer_load_dwordx4 v14, s[8:11], s30 offen offset:128 nt lds
v_accvgpr_write_b32 a144, v80
v_accvgpr_write_b32 a145, v81
v_accvgpr_write_b32 a146, v82
v_accvgpr_write_b32 a147, v83
ds_read_b64 a[96:97], v5 offset:4096
ds_read_b64 a[98:99], v6 offset:4096
v_accvgpr_write_b32 a148, v84
v_accvgpr_write_b32 a149, v85
v_accvgpr_write_b32 a150, v86
v_accvgpr_write_b32 a151, v87
ds_read_b64 a[100:101], v5 offset:6144
ds_read_b64 a[102:103], v6 offset:6144
v_accvgpr_write_b32 a152, v88
v_accvgpr_write_b32 a153, v89
v_accvgpr_write_b32 a154, v90
v_accvgpr_write_b32 a155, v91
ds_read_b64 a[104:105], v7 offset:4096
ds_read_b64 a[106:107], v8 offset:4096
v_accvgpr_write_b32 a156, v92
v_accvgpr_write_b32 a157, v93
v_accvgpr_write_b32 a158, v94
v_accvgpr_write_b32 a159, v95
ds_read_b64 a[108:109], v7 offset:6144
ds_read_b64 a[110:111], v8 offset:6144
v_accvgpr_write_b32 a160, v96
v_accvgpr_write_b32 a161, v97
v_accvgpr_write_b32 a162, v98
v_accvgpr_write_b32 a163, v99
v_accvgpr_write_b32 a164, v100
v_accvgpr_write_b32 a165, v101
v_accvgpr_write_b32 a166, v102
v_accvgpr_write_b32 a167, v103
v_accvgpr_write_b32 a168, v104
v_accvgpr_write_b32 a169, v105
v_accvgpr_write_b32 a170, v106
v_accvgpr_write_b32 a171, v107
v_accvgpr_write_b32 a172, v108
v_accvgpr_write_b32 a173, v109
v_accvgpr_write_b32 a174, v110
v_accvgpr_write_b32 a175, v111
v_accvgpr_write_b32 a176, v112
v_accvgpr_write_b32 a177, v113
v_accvgpr_write_b32 a178, v114
v_accvgpr_write_b32 a179, v115
v_accvgpr_write_b32 a180, v116
v_accvgpr_write_b32 a181, v117
v_accvgpr_write_b32 a182, v118
v_accvgpr_write_b32 a183, v119
v_accvgpr_write_b32 a184, v120
v_accvgpr_write_b32 a185, v121
v_accvgpr_write_b32 a186, v122
v_accvgpr_write_b32 a187, v123
v_accvgpr_write_b32 a188, v124
v_accvgpr_write_b32 a189, v125
v_accvgpr_write_b32 a190, v126
v_accvgpr_write_b32 a191, v127
v_accvgpr_write_b32 a192, v128
v_accvgpr_write_b32 a193, v129
v_accvgpr_write_b32 a194, v130
v_accvgpr_write_b32 a195, v131
v_accvgpr_write_b32 a196, v132
v_accvgpr_write_b32 a197, v133
v_accvgpr_write_b32 a198, v134
v_accvgpr_write_b32 a199, v135
v_accvgpr_write_b32 a200, v136
v_accvgpr_write_b32 a201, v137
v_accvgpr_write_b32 a202, v138
v_accvgpr_write_b32 a203, v139
v_accvgpr_write_b32 a204, v140
v_accvgpr_write_b32 a205, v141
v_accvgpr_write_b32 a206, v142
v_accvgpr_write_b32 a207, v143
v_accvgpr_write_b32 a208, v144
v_accvgpr_write_b32 a209, v145
v_accvgpr_write_b32 a210, v146
v_accvgpr_write_b32 a211, v147
v_accvgpr_write_b32 a212, v148
v_accvgpr_write_b32 a213, v149
v_accvgpr_write_b32 a214, v150
v_accvgpr_write_b32 a215, v151
v_accvgpr_write_b32 a216, v152
v_accvgpr_write_b32 a217, v153
v_accvgpr_write_b32 a218, v154
v_accvgpr_write_b32 a219, v155
v_accvgpr_write_b32 a220, v156
v_accvgpr_write_b32 a221, v157
v_accvgpr_write_b32 a222, v158
v_accvgpr_write_b32 a223, v159
s_add_u32 s4, s4, 0x20000
s_addc_u32 s5, s5, 0
s_mov_b32 s6, 0x20000
s_add_u32 s8, s8, 0x20000
s_addc_u32 s9, s9, 0
s_mov_b32 s10, 0x20000
L_YAent1:
s_mov_b32 s99, 0x0
s_waitcnt lgkmcnt(8)
MM v[44:47], a[80:83], a[0:3], v[24:27]
MM v[48:51], a[84:87], a[0:3], v[24:27]
MM v[44:47], a[88:91], a[4:7], v[44:47]
MM v[48:51], a[92:95], a[4:7], v[48:51]
s_waitcnt lgkmcnt(0)
MM v[44:47], a[96:99], a[8:11], v[44:47]
MM v[48:51], a[100:103], a[8:11], v[48:51]
MM v[44:47], a[104:107], a[12:15], v[44:47]
MM v[48:51], a[108:111], a[12:15], v[48:51]
MM v[52:55], a[80:83], a[16:19], v[28:31]
MM v[56:59], a[84:87], a[16:19], v[28:31]
MM v[52:55], a[88:91], a[20:23], v[52:55]
MM v[56:59], a[92:95], a[20:23], v[56:59]
MM v[52:55], a[96:99], a[24:27], v[52:55]
MM v[56:59], a[100:103], a[24:27], v[56:59]
MM v[52:55], a[104:107], a[28:31], v[52:55]
v_exp_f32 v44, v44
MM v[56:59], a[108:111], a[28:31], v[56:59]
v_exp_f32 v45, v45
MM v[60:63], a[80:83], a[32:35], v[32:35]
v_exp_f32 v46, v46
MM v[64:67], a[84:87], a[32:35], v[32:35]
v_exp_f32 v47, v47
MM v[60:63], a[88:91], a[36:39], v[60:63]
CV v240, v44, v45
CV v241, v46, v47
v_exp_f32 v48, v48
v_exp_f32 v49, v49
v_exp_f32 v50, v50
v_exp_f32 v51, v51
MM v[64:67], a[92:95], a[36:39], v[64:67]
CV v242, v48, v49
CV v243, v50, v51
MM v[60:63], a[96:99], a[40:43], v[60:63]
v_exp_f32 v52, v52
MM v[64:67], a[100:103], a[40:43], v[64:67]
v_exp_f32 v53, v53
MM v[60:63], a[104:107], a[44:47], v[60:63]
v_exp_f32 v54, v54
MM v[64:67], a[108:111], a[44:47], v[64:67]
v_exp_f32 v55, v55
MM v[80:83], a[112:115], v[240:243], 0
CV v244, v52, v53
CV v245, v54, v55
MM v[84:87], a[116:119], v[240:243], 0
v_exp_f32 v56, v56
MM v[88:91], a[120:123], v[240:243], 0
v_exp_f32 v57, v57
MM v[92:95], a[124:127], v[240:243], 0
v_exp_f32 v58, v58
MM v[96:99], a[128:131], v[240:243], 0
v_exp_f32 v59, v59
MM v[100:103], a[132:135], v[240:243], 0
CV v246, v56, v57
CV v247, v58, v59
MM v[104:107], a[136:139], v[240:243], 0
v_exp_f32 v60, v60
MM v[108:111], a[140:143], v[240:243], 0
v_exp_f32 v61, v61
MM a[224:227], a[244:247], v[240:243], 0
v_exp_f32 v62, v62
MM v[68:71], a[80:83], a[48:51], v[36:39]
v_exp_f32 v63, v63
MM v[72:75], a[84:87], a[48:51], v[36:39]
CV v248, v60, v61
CV v249, v62, v63
MM v[68:71], a[88:91], a[52:55], v[68:71]
v_exp_f32 v64, v64
MM v[72:75], a[92:95], a[52:55], v[72:75]
v_exp_f32 v65, v65
MM v[68:71], a[96:99], a[56:59], v[68:71]
v_exp_f32 v66, v66
MM v[72:75], a[100:103], a[56:59], v[72:75]
v_exp_f32 v67, v67
MM v[68:71], a[104:107], a[60:63], v[68:71]
CV v250, v64, v65
CV v251, v66, v67
MM v[72:75], a[108:111], a[60:63], v[72:75]
MM v[112:115], a[112:115], v[244:247], 0
MM v[116:119], a[116:119], v[244:247], 0
MM v[120:123], a[120:123], v[244:247], 0
MM v[124:127], a[124:127], v[244:247], 0
MM v[128:131], a[128:131], v[244:247], 0
v_exp_f32 v68, v68
MM v[132:135], a[132:135], v[244:247], 0
v_exp_f32 v69, v69
MM v[136:139], a[136:139], v[244:247], 0
v_exp_f32 v70, v70
MM v[140:143], a[140:143], v[244:247], 0
v_exp_f32 v71, v71
MM a[228:231], a[244:247], v[244:247], 0
s_waitcnt vmcnt(16)
s_barrier
s_add_u32 m0, s28, 0x0
MM v[44:47], a[80:83], a[64:67], v[40:43]
s_add_u32 s30, s42, 0x10000
s_and_b32 s30, s30, 0x1ffff
s_waitcnt vmcnt(4)
MM v[48:51], a[84:87], a[64:67], v[40:43]
buffer_load_dwordx4 v13, s[4:7], s30 offen nt lds
MM v[44:47], a[88:91], a[68:71], v[44:47]
s_add_u32 m0, s28, 0xf80
ds_read_b64 a[80:81], v5 offset:32768
ds_read_b64 a[82:83], v6 offset:32768
MM v[48:51], a[92:95], a[68:71], v[48:51]
buffer_load_dwordx4 v13, s[4:7], s30 offen offset:128 nt lds
MM v[44:47], a[96:99], a[72:75], v[44:47]
ds_read_b64 a[84:85], v5 offset:34816
ds_read_b64 a[86:87], v6 offset:34816
MM v[48:51], a[100:103], a[72:75], v[48:51]
CV v252, v68, v69
CV v253, v70, v71
MM v[44:47], a[104:107], a[76:79], v[44:47]
ds_read_b64 a[88:89], v7 offset:32768
ds_read_b64 a[90:91], v8 offset:32768
MM v[48:51], a[108:111], a[76:79], v[48:51]
v_exp_f32 v72, v72
MM v[144:147], a[112:115], v[248:251], 0
ds_read_b64 a[92:93], v7 offset:34816
ds_read_b64 a[94:95], v8 offset:34816
MM v[148:151], a[116:119], v[248:251], 0
v_exp_f32 v73, v73
MM v[152:155], a[120:123], v[248:251], 0
ds_read_b64 a[96:97], v5 offset:36864
ds_read_b64 a[98:99], v6 offset:36864
MM v[156:159], a[124:127], v[248:251], 0
v_exp_f32 v74, v74
MM v[160:163], a[128:131], v[248:251], 0
ds_read_b64 a[100:101], v5 offset:38912
ds_read_b64 a[102:103], v6 offset:38912
MM v[164:167], a[132:135], v[248:251], 0
v_exp_f32 v75, v75
MM v[168:171], a[136:139], v[248:251], 0
ds_read_b64 a[104:105], v7 offset:36864
ds_read_b64 a[106:107], v8 offset:36864
MM v[172:175], a[140:143], v[248:251], 0
CV v254, v72, v73
CV v255, v74, v75
MM a[232:235], a[244:247], v[248:251], 0
s_waitcnt lgkmcnt(6)
ds_read_b64 a[108:109], v7 offset:38912
ds_read_b64 a[110:111], v8 offset:38912
MM v[52:55], a[80:83], a[0:3], v[24:27]
v_exp_f32 v44, v44
MM v[56:59], a[84:87], a[0:3], v[24:27]
v_exp_f32 v45, v45
MM v[52:55], a[88:91], a[4:7], v[52:55]
v_exp_f32 v46, v46
MM v[56:59], a[92:95], a[4:7], v[56:59]
s_waitcnt lgkmcnt(4)
s_add_u32 m0, s28, 0x800
s_add_u32 s30, s42, 0x11000
MM v[52:55], a[96:99], a[8:11], v[52:55]
s_and_b32 s30, s30, 0x1ffff
s_waitcnt vmcnt(4)
MM v[56:59], a[100:103], a[8:11], v[56:59]
s_waitcnt lgkmcnt(2)
buffer_load_dwordx4 v13, s[4:7], s30 offen nt lds
MM v[52:55], a[104:107], a[12:15], v[52:55]
s_waitcnt lgkmcnt(0)
s_add_u32 m0, s28, 0x1780
MM v[56:59], a[108:111], a[12:15], v[56:59]
buffer_load_dwordx4 v13, s[4:7], s30 offen offset:128 nt lds
MM v[176:179], a[112:115], v[252:255], 0
v_exp_f32 v47, v47
MM v[180:183], a[116:119], v[252:255], 0
CV v240, v44, v45
CV v241, v46, v47
MM v[184:187], a[120:123], v[252:255], 0
v_exp_f32 v48, v48
MM v[188:191], a[124:127], v[252:255], 0
v_exp_f32 v49, v49
MM v[192:195], a[128:131], v[252:255], 0
v_exp_f32 v50, v50
MM v[196:199], a[132:135], v[252:255], 0
v_exp_f32 v51, v51
MM v[200:203], a[136:139], v[252:255], 0
CV v242, v48, v49
CV v243, v50, v51
MM v[204:207], a[140:143], v[252:255], 0
v_exp_f32 v52, v52
MM a[236:239], a[244:247], v[252:255], 0
v_exp_f32 v53, v53
MM v[60:63], a[80:83], a[16:19], v[28:31]
v_exp_f32 v54, v54
MM v[64:67], a[84:87], a[16:19], v[28:31]
v_exp_f32 v55, v55
MM v[60:63], a[88:91], a[20:23], v[60:63]
CV v244, v52, v53
CV v245, v54, v55
MM v[64:67], a[92:95], a[20:23], v[64:67]
v_exp_f32 v56, v56
MM v[60:63], a[96:99], a[24:27], v[60:63]
v_exp_f32 v57, v57
MM v[64:67], a[100:103], a[24:27], v[64:67]
v_exp_f32 v58, v58
MM v[60:63], a[104:107], a[28:31], v[60:63]
v_exp_f32 v59, v59
MM v[64:67], a[108:111], a[28:31], v[64:67]
s_add_u32 m0, s28, 0x4000
s_add_u32 s30, s42, 0x10000
s_and_b32 s30, s30, 0x1ffff
MM v[208:211], a[112:115], v[240:243], 0
s_waitcnt vmcnt(4)
buffer_load_dwordx4 v14, s[8:11], s30 offen nt lds
MM v[212:215], a[116:119], v[240:243], 0
s_add_u32 m0, s28, 0x4f80
TR a[112:113], v1 offset:49152
TR a[114:115], v1 offset:51200
MM v[216:219], a[120:123], v[240:243], 0
buffer_load_dwordx4 v14, s[8:11], s30 offen offset:128 nt lds
MM v[220:223], a[124:127], v[240:243], 0
TR a[116:117], v2 offset:49152
TR a[118:119], v2 offset:51200
MM v[224:227], a[128:131], v[240:243], 0
CV v246, v56, v57
CV v247, v58, v59
MM v[228:231], a[132:135], v[240:243], 0
TR a[120:121], v3 offset:49152
TR a[122:123], v3 offset:51200
MM v[232:235], a[136:139], v[240:243], 0
v_exp_f32 v60, v60
MM v[236:239], a[140:143], v[240:243], 0
TR a[124:125], v4 offset:49152
TR a[126:127], v4 offset:51200
MM a[240:243], a[244:247], v[240:243], 0
v_exp_f32 v61, v61
MM v[68:71], a[80:83], a[32:35], v[32:35]
TR a[128:129], v1 offset:53248
TR a[130:131], v1 offset:55296
MM v[72:75], a[84:87], a[32:35], v[32:35]
v_exp_f32 v62, v62
MM v[68:71], a[88:91], a[36:39], v[68:71]
TR a[132:133], v2 offset:53248
TR a[134:135], v2 offset:55296
MM v[72:75], a[92:95], a[36:39], v[72:75]
v_exp_f32 v63, v63
MM v[68:71], a[96:99], a[40:43], v[68:71]
TR a[136:137], v3 offset:53248
TR a[138:139], v3 offset:55296
MM v[72:75], a[100:103], a[40:43], v[72:75]
CV v248, v60, v61
CV v249, v62, v63
MM v[68:71], a[104:107], a[44:47], v[68:71]
TR a[140:141], v4 offset:53248
TR a[142:143], v4 offset:55296
MM v[72:75], a[108:111], a[44:47], v[72:75]
s_waitcnt lgkmcnt(8)
v_exp_f32 v64, v64
MM v[80:83], a[112:115], v[244:247], v[80:83]
v_exp_f32 v65, v65
MM v[84:87], a[116:119], v[244:247], v[84:87]
v_exp_f32 v66, v66
MM v[88:91], a[120:123], v[244:247], v[88:91]
s_add_u32 m0, s28, 0x4800
s_add_u32 s30, s42, 0x11000
s_and_b32 s30, s30, 0x1ffff
MM v[92:95], a[124:127], v[244:247], v[92:95]
s_waitcnt lgkmcnt(4)
s_waitcnt vmcnt(4)
MM v[96:99], a[128:131], v[244:247], v[96:99]
buffer_load_dwordx4 v14, s[8:11], s30 offen nt lds
MM v[100:103], a[132:135], v[244:247], v[100:103]
s_waitcnt lgkmcnt(2)
s_add_u32 m0, s28, 0x5780
MM v[104:107], a[136:139], v[244:247], v[104:107]
s_waitcnt lgkmcnt(0)
buffer_load_dwordx4 v14, s[8:11], s30 offen offset:128 nt lds
MM v[108:111], a[140:143], v[244:247], v[108:111]
v_exp_f32 v67, v67
MM a[224:227], a[244:247], v[244:247], a[224:227]
CV v250, v64, v65
CV v251, v66, v67
MM v[44:47], a[80:83], a[48:51], v[36:39]
v_exp_f32 v68, v68
MM v[48:51], a[84:87], a[48:51], v[36:39]
v_exp_f32 v69, v69
MM v[44:47], a[88:91], a[52:55], v[44:47]
v_exp_f32 v70, v70
MM v[48:51], a[92:95], a[52:55], v[48:51]
v_exp_f32 v71, v71
MM v[44:47], a[96:99], a[56:59], v[44:47]
CV v252, v68, v69
CV v253, v70, v71
MM v[48:51], a[100:103], a[56:59], v[48:51]
v_exp_f32 v72, v72
MM v[44:47], a[104:107], a[60:63], v[44:47]
v_exp_f32 v73, v73
MM v[48:51], a[108:111], a[60:63], v[48:51]
v_exp_f32 v74, v74
MM v[112:115], a[112:115], v[248:251], v[112:115]
v_exp_f32 v75, v75
MM v[116:119], a[116:119], v[248:251], v[116:119]
CV v254, v72, v73
CV v255, v74, v75
MM v[120:123], a[120:123], v[248:251], v[120:123]
v_exp_f32 v44, v44
MM v[124:127], a[124:127], v[248:251], v[124:127]
v_exp_f32 v45, v45
MM v[128:131], a[128:131], v[248:251], v[128:131]
v_exp_f32 v46, v46
MM v[132:135], a[132:135], v[248:251], v[132:135]
v_exp_f32 v47, v47
MM v[136:139], a[136:139], v[248:251], v[136:139]
CV v240, v44, v45
CV v241, v46, v47
MM v[140:143], a[140:143], v[248:251], v[140:143]
v_exp_f32 v48, v48
MM a[228:231], a[244:247], v[248:251], a[228:231]
s_mov_b32 s96, 3
L_YA1:
s_add_u32 s42, s42, 0x8000
s_add_u32 s99, s99, 0xc000
s_and_b32 s97, s99, 0x20000
s_waitcnt vmcnt(16)
s_barrier
MM v[52:55], a[80:83], a[64:67], v[40:43]
s_add_u32 m0, s28, 0x8000
s_add_u32 s30, s42, 0xa000
s_and_b32 s30, s30, 0x1ffff
MM v[56:59], a[84:87], a[64:67], v[40:43]
s_waitcnt vmcnt(4)
buffer_load_dwordx4 v13, s[4:7], s30 offen nt lds
MM v[52:55], a[88:91], a[68:71], v[52:55]
s_add_u32 m0, s28, 0x8f80
v_add_u32 v5, 0x10000, v5
v_add_u32 v6, 0x10000, v6
MM v[56:59], a[92:95], a[68:71], v[56:59]
buffer_load_dwordx4 v13, s[4:7], s30 offen offset:128 nt lds
MM v[52:55], a[96:99], a[72:75], v[52:55]
ds_read_b64 a[80:81], v5 offset:0
ds_read_b64 a[82:83], v6 offset:0
MM v[56:59], a[100:103], a[72:75], v[56:59]
v_exp_f32 v49, v49
MM v[52:55], a[104:107], a[76:79], v[52:55]
ds_read_b64 a[84:85], v5 offset:2048
ds_read_b64 a[86:87], v6 offset:2048
MM v[56:59], a[108:111], a[76:79], v[56:59]
v_add_u32 v7, 0x10000, v7
v_add_u32 v8, 0x10000, v8
MM v[144:147], a[112:115], v[252:255], v[144:147]
ds_read_b64 a[88:89], v7 offset:0
ds_read_b64 a[90:91], v8 offset:0
MM v[148:151], a[116:119], v[252:255], v[148:151]
v_exp_f32 v50, v50
MM v[152:155], a[120:123], v[252:255], v[152:155]
ds_read_b64 a[92:93], v7 offset:2048
ds_read_b64 a[94:95], v8 offset:2048
MM v[156:159], a[124:127], v[252:255], v[156:159]
v_exp_f32 v51, v51
MM v[160:163], a[128:131], v[252:255], v[160:163]
ds_read_b64 a[96:97], v5 offset:4096
ds_read_b64 a[98:99], v6 offset:4096
MM v[164:167], a[132:135], v[252:255], v[164:167]
CV v242, v48, v49
CV v243, v50, v51
MM v[168:171], a[136:139], v[252:255], v[168:171]
ds_read_b64 a[100:101], v5 offset:6144
ds_read_b64 a[102:103], v6 offset:6144
MM v[172:175], a[140:143], v[252:255], v[172:175]
ds_read_b64 a[104:105], v7 offset:4096
ds_read_b64 a[106:107], v8 offset:4096
MM a[232:235], a[244:247], v[252:255], a[232:235]
s_waitcnt lgkmcnt(8)
ds_read_b64 a[108:109], v7 offset:6144
ds_read_b64 a[110:111], v8 offset:6144
MM v[60:63], a[80:83], a[0:3], v[24:27]
v_exp_f32 v52, v52
MM v[64:67], a[84:87], a[0:3], v[24:27]
v_exp_f32 v53, v53
MM v[60:63], a[88:91], a[4:7], v[60:63]
s_waitcnt lgkmcnt(8)
v_exp_f32 v54, v54
MM v[64:67], a[92:95], a[4:7], v[64:67]
s_waitcnt lgkmcnt(6)
s_add_u32 m0, s28, 0x8800
s_add_u32 s30, s42, 0xb000
MM v[60:63], a[96:99], a[8:11], v[60:63]
s_waitcnt lgkmcnt(4)
s_and_b32 s30, s30, 0x1ffff
s_waitcnt vmcnt(4)
MM v[64:67], a[100:103], a[8:11], v[64:67]
s_waitcnt lgkmcnt(2)
buffer_load_dwordx4 v13, s[4:7], s30 offen nt lds
MM v[60:63], a[104:107], a[12:15], v[60:63]
s_waitcnt lgkmcnt(0)
s_add_u32 m0, s28, 0x9780
v_add_u32 v1, 0x10000, v1
MM v[64:67], a[108:111], a[12:15], v[64:67]
buffer_load_dwordx4 v13, s[4:7], s30 offen offset:128 nt lds
MM v[176:179], a[112:115], v[240:243], v[176:179]
v_exp_f32 v55, v55
MM v[180:183], a[116:119], v[240:243], v[180:183]
CV v244, v52, v53
CV v245, v54, v55
MM v[184:187], a[120:123], v[240:243], v[184:187]
v_exp_f32 v56, v56
MM v[188:191], a[124:127], v[240:243], v[188:191]
v_exp_f32 v57, v57
MM v[192:195], a[128:131], v[240:243], v[192:195]
v_exp_f32 v58, v58
MM v[196:199], a[132:135], v[240:243], v[196:199]
v_exp_f32 v59, v59
MM v[200:203], a[136:139], v[240:243], v[200:203]
CV v246, v56, v57
CV v247, v58, v59
MM v[204:207], a[140:143], v[240:243], v[204:207]
v_exp_f32 v60, v60
MM a[236:239], a[244:247], v[240:243], a[236:239]
v_exp_f32 v61, v61
MM v[68:71], a[80:83], a[16:19], v[28:31]
v_exp_f32 v62, v62
MM v[72:75], a[84:87], a[16:19], v[28:31]
v_exp_f32 v63, v63
MM v[68:71], a[88:91], a[20:23], v[68:71]
CV v248, v60, v61
CV v249, v62, v63
MM v[72:75], a[92:95], a[20:23], v[72:75]
v_exp_f32 v64, v64
MM v[68:71], a[96:99], a[24:27], v[68:71]
v_exp_f32 v65, v65
MM v[72:75], a[100:103], a[24:27], v[72:75]
v_exp_f32 v66, v66
MM v[68:71], a[104:107], a[28:31], v[68:71]
v_exp_f32 v67, v67
MM v[72:75], a[108:111], a[28:31], v[72:75]
s_add_u32 m0, s28, 0xc000
s_add_u32 s30, s42, 0xa000
s_and_b32 s30, s30, 0x1ffff
MM v[208:211], a[112:115], v[244:247], v[208:211]
s_waitcnt vmcnt(4)
buffer_load_dwordx4 v14, s[8:11], s30 offen nt lds
MM v[212:215], a[116:119], v[244:247], v[212:215]
s_add_u32 m0, s28, 0xcf80
TR a[112:113], v1 offset:16384
TR a[114:115], v1 offset:18432
MM v[216:219], a[120:123], v[244:247], v[216:219]
buffer_load_dwordx4 v14, s[8:11], s30 offen offset:128 nt lds
MM v[220:223], a[124:127], v[244:247], v[220:223]
CV v250, v64, v65
v_add_u32 v2, 0x10000, v2
MM v[224:227], a[128:131], v[244:247], v[224:227]
TR a[116:117], v2 offset:16384
TR a[118:119], v2 offset:18432
MM v[228:231], a[132:135], v[244:247], v[228:231]
CV v251, v66, v67
v_add_u32 v3, 0x10000, v3
MM v[232:235], a[136:139], v[244:247], v[232:235]
TR a[120:121], v3 offset:16384
TR a[122:123], v3 offset:18432
MM v[236:239], a[140:143], v[244:247], v[236:239]
v_add_u32 v4, 0x10000, v4
MM a[240:243], a[244:247], v[244:247], a[240:243]
TR a[124:125], v4 offset:16384
TR a[126:127], v4 offset:18432
MM v[44:47], a[80:83], a[32:35], v[32:35]
v_exp_f32 v68, v68
MM v[48:51], a[84:87], a[32:35], v[32:35]
TR a[128:129], v1 offset:20480
TR a[130:131], v1 offset:22528
MM v[44:47], a[88:91], a[36:39], v[44:47]
v_exp_f32 v69, v69
MM v[48:51], a[92:95], a[36:39], v[48:51]
TR a[132:133], v2 offset:20480
TR a[134:135], v2 offset:22528
MM v[44:47], a[96:99], a[40:43], v[44:47]
v_exp_f32 v70, v70
MM v[48:51], a[100:103], a[40:43], v[48:51]
TR a[136:137], v3 offset:20480
TR a[138:139], v3 offset:22528
MM v[44:47], a[104:107], a[44:47], v[44:47]
v_exp_f32 v71, v71
MM v[48:51], a[108:111], a[44:47], v[48:51]
s_waitcnt lgkmcnt(6)
TR a[140:141], v4 offset:20480
TR a[142:143], v4 offset:22528
MM v[80:83], a[112:115], v[248:251], v[80:83]
CV v252, v68, v69
CV v253, v70, v71
MM v[84:87], a[116:119], v[248:251], v[84:87]
v_exp_f32 v72, v72
MM v[88:91], a[120:123], v[248:251], v[88:91]
s_add_u32 m0, s28, 0xc800
s_add_u32 s30, s42, 0xb000
s_and_b32 s30, s30, 0x1ffff
MM v[92:95], a[124:127], v[248:251], v[92:95]
s_waitcnt lgkmcnt(4)
s_waitcnt vmcnt(4)
MM v[96:99], a[128:131], v[248:251], v[96:99]
buffer_load_dwordx4 v14, s[8:11], s30 offen nt lds
MM v[100:103], a[132:135], v[248:251], v[100:103]
s_waitcnt lgkmcnt(2)
s_add_u32 m0, s28, 0xd780
MM v[104:107], a[136:139], v[248:251], v[104:107]
s_waitcnt lgkmcnt(0)
buffer_load_dwordx4 v14, s[8:11], s30 offen offset:128 nt lds
MM v[108:111], a[140:143], v[248:251], v[108:111]
v_exp_f32 v73, v73
MM a[224:227], a[244:247], v[248:251], a[224:227]
v_exp_f32 v74, v74
MM v[52:55], a[80:83], a[48:51], v[36:39]
v_exp_f32 v75, v75
MM v[56:59], a[84:87], a[48:51], v[36:39]
CV v254, v72, v73
CV v255, v74, v75
MM v[52:55], a[88:91], a[52:55], v[52:55]
v_exp_f32 v44, v44
MM v[56:59], a[92:95], a[52:55], v[56:59]
v_exp_f32 v45, v45
MM v[52:55], a[96:99], a[56:59], v[52:55]
v_exp_f32 v46, v46
MM v[56:59], a[100:103], a[56:59], v[56:59]
v_exp_f32 v47, v47
MM v[52:55], a[104:107], a[60:63], v[52:55]
CV v240, v44, v45
CV v241, v46, v47
MM v[56:59], a[108:111], a[60:63], v[56:59]
v_exp_f32 v48, v48
MM v[112:115], a[112:115], v[252:255], v[112:115]
v_exp_f32 v49, v49
MM v[116:119], a[116:119], v[252:255], v[116:119]
v_exp_f32 v50, v50
MM v[120:123], a[120:123], v[252:255], v[120:123]
v_exp_f32 v51, v51
MM v[124:127], a[124:127], v[252:255], v[124:127]
CV v242, v48, v49
CV v243, v50, v51
MM v[128:131], a[128:131], v[252:255], v[128:131]
v_exp_f32 v52, v52
MM v[132:135], a[132:135], v[252:255], v[132:135]
v_exp_f32 v53, v53
MM v[136:139], a[136:139], v[252:255], v[136:139]
v_exp_f32 v54, v54
MM v[140:143], a[140:143], v[252:255], v[140:143]
v_exp_f32 v55, v55
MM a[228:231], a[244:247], v[252:255], a[228:231]
s_waitcnt vmcnt(16)
s_barrier
s_add_u32 m0, s28, 0x10000
MM v[60:63], a[80:83], a[64:67], v[40:43]
s_add_u32 s30, s42, 0xc000
s_and_b32 s30, s30, 0x1ffff
s_waitcnt vmcnt(4)
MM v[64:67], a[84:87], a[64:67], v[40:43]
buffer_load_dwordx4 v13, s[4:7], s30 offen nt lds
MM v[60:63], a[88:91], a[68:71], v[60:63]
s_add_u32 m0, s28, 0x10f80
ds_read_b64 a[80:81], v5 offset:32768
ds_read_b64 a[82:83], v6 offset:32768
MM v[64:67], a[92:95], a[68:71], v[64:67]
buffer_load_dwordx4 v13, s[4:7], s30 offen offset:128 nt lds
MM v[60:63], a[96:99], a[72:75], v[60:63]
ds_read_b64 a[84:85], v5 offset:34816
ds_read_b64 a[86:87], v6 offset:34816
MM v[64:67], a[100:103], a[72:75], v[64:67]
CV v244, v52, v53
CV v245, v54, v55
MM v[60:63], a[104:107], a[76:79], v[60:63]
ds_read_b64 a[88:89], v7 offset:32768
ds_read_b64 a[90:91], v8 offset:32768
MM v[64:67], a[108:111], a[76:79], v[64:67]
v_exp_f32 v56, v56
MM v[144:147], a[112:115], v[240:243], v[144:147]
ds_read_b64 a[92:93], v7 offset:34816
ds_read_b64 a[94:95], v8 offset:34816
MM v[148:151], a[116:119], v[240:243], v[148:151]
v_exp_f32 v57, v57
MM v[152:155], a[120:123], v[240:243], v[152:155]
ds_read_b64 a[96:97], v5 offset:36864
ds_read_b64 a[98:99], v6 offset:36864
MM v[156:159], a[124:127], v[240:243], v[156:159]
v_exp_f32 v58, v58
MM v[160:163], a[128:131], v[240:243], v[160:163]
ds_read_b64 a[100:101], v5 offset:38912
ds_read_b64 a[102:103], v6 offset:38912
MM v[164:167], a[132:135], v[240:243], v[164:167]
v_exp_f32 v59, v59
MM v[168:171], a[136:139], v[240:243], v[168:171]
ds_read_b64 a[104:105], v7 offset:36864
ds_read_b64 a[106:107], v8 offset:36864
MM v[172:175], a[140:143], v[240:243], v[172:175]
CV v246, v56, v57
CV v247, v58, v59
MM a[232:235], a[244:247], v[240:243], a[232:235]
s_waitcnt lgkmcnt(6)
ds_read_b64 a[108:109], v7 offset:38912
ds_read_b64 a[110:111], v8 offset:38912
MM v[68:71], a[80:83], a[0:3], v[24:27]
v_exp_f32 v60, v60
MM v[72:75], a[84:87], a[0:3], v[24:27]
v_exp_f32 v61, v61
MM v[68:71], a[88:91], a[4:7], v[68:71]
v_exp_f32 v62, v62
MM v[72:75], a[92:95], a[4:7], v[72:75]
s_waitcnt lgkmcnt(4)
s_add_u32 m0, s28, 0x10800
s_add_u32 s30, s42, 0xd000
MM v[68:71], a[96:99], a[8:11], v[68:71]
s_and_b32 s30, s30, 0x1ffff
s_waitcnt vmcnt(4)
MM v[72:75], a[100:103], a[8:11], v[72:75]
s_waitcnt lgkmcnt(2)
buffer_load_dwordx4 v13, s[4:7], s30 offen nt lds
MM v[68:71], a[104:107], a[12:15], v[68:71]
s_waitcnt lgkmcnt(0)
s_add_u32 m0, s28, 0x11780
MM v[72:75], a[108:111], a[12:15], v[72:75]
buffer_load_dwordx4 v13, s[4:7], s30 offen offset:128 nt lds
MM v[176:179], a[112:115], v[244:247], v[176:179]
v_exp_f32 v63, v63
MM v[180:183], a[116:119], v[244:247], v[180:183]
CV v248, v60, v61
CV v249, v62, v63
MM v[184:187], a[120:123], v[244:247], v[184:187]
v_exp_f32 v64, v64
MM v[188:191], a[124:127], v[244:247], v[188:191]
v_exp_f32 v65, v65
MM v[192:195], a[128:131], v[244:247], v[192:195]
v_exp_f32 v66, v66
MM v[196:199], a[132:135], v[244:247], v[196:199]
v_exp_f32 v67, v67
MM v[200:203], a[136:139], v[244:247], v[200:203]
CV v250, v64, v65
CV v251, v66, v67
MM v[204:207], a[140:143], v[244:247], v[204:207]
v_exp_f32 v68, v68
MM a[236:239], a[244:247], v[244:247], a[236:239]
v_exp_f32 v69, v69
MM v[44:47], a[80:83], a[16:19], v[28:31]
v_exp_f32 v70, v70
MM v[48:51], a[84:87], a[16:19], v[28:31]
v_exp_f32 v71, v71
MM v[44:47], a[88:91], a[20:23], v[44:47]
CV v252, v68, v69
CV v253, v70, v71
MM v[48:51], a[92:95], a[20:23], v[48:51]
v_exp_f32 v72, v72
MM v[44:47], a[96:99], a[24:27], v[44:47]
v_exp_f32 v73, v73
MM v[48:51], a[100:103], a[24:27], v[48:51]
v_exp_f32 v74, v74
MM v[44:47], a[104:107], a[28:31], v[44:47]
v_exp_f32 v75, v75
MM v[48:51], a[108:111], a[28:31], v[48:51]
s_add_u32 m0, s28, 0x14000
s_add_u32 s30, s42, 0xc000
s_and_b32 s30, s30, 0x1ffff
MM v[208:211], a[112:115], v[248:251], v[208:211]
s_waitcnt vmcnt(4)
buffer_load_dwordx4 v14, s[8:11], s30 offen nt lds
MM v[212:215], a[116:119], v[248:251], v[212:215]
s_add_u32 m0, s28, 0x14f80
TR a[112:113], v1 offset:49152
TR a[114:115], v1 offset:51200
MM v[216:219], a[120:123], v[248:251], v[216:219]
buffer_load_dwordx4 v14, s[8:11], s30 offen offset:128 nt lds
MM v[220:223], a[124:127], v[248:251], v[220:223]
TR a[116:117], v2 offset:49152
TR a[118:119], v2 offset:51200
MM v[224:227], a[128:131], v[248:251], v[224:227]
CV v254, v72, v73
CV v255, v74, v75
MM v[228:231], a[132:135], v[248:251], v[228:231]
TR a[120:121], v3 offset:49152
TR a[122:123], v3 offset:51200
MM v[232:235], a[136:139], v[248:251], v[232:235]
v_exp_f32 v44, v44
MM v[236:239], a[140:143], v[248:251], v[236:239]
TR a[124:125], v4 offset:49152
TR a[126:127], v4 offset:51200
MM a[240:243], a[244:247], v[248:251], a[240:243]
v_exp_f32 v45, v45
MM v[52:55], a[80:83], a[32:35], v[32:35]
TR a[128:129], v1 offset:53248
TR a[130:131], v1 offset:55296
MM v[56:59], a[84:87], a[32:35], v[32:35]
v_exp_f32 v46, v46
MM v[52:55], a[88:91], a[36:39], v[52:55]
TR a[132:133], v2 offset:53248
TR a[134:135], v2 offset:55296
MM v[56:59], a[92:95], a[36:39], v[56:59]
v_exp_f32 v47, v47
MM v[52:55], a[96:99], a[40:43], v[52:55]
TR a[136:137], v3 offset:53248
TR a[138:139], v3 offset:55296
MM v[56:59], a[100:103], a[40:43], v[56:59]
CV v240, v44, v45
CV v241, v46, v47
MM v[52:55], a[104:107], a[44:47], v[52:55]
TR a[140:141], v4 offset:53248
TR a[142:143], v4 offset:55296
MM v[56:59], a[108:111], a[44:47], v[56:59]
s_waitcnt lgkmcnt(8)
v_exp_f32 v48, v48
MM v[80:83], a[112:115], v[252:255], v[80:83]
v_exp_f32 v49, v49
MM v[84:87], a[116:119], v[252:255], v[84:87]
v_exp_f32 v50, v50
MM v[88:91], a[120:123], v[252:255], v[88:91]
s_add_u32 m0, s28, 0x14800
s_add_u32 s30, s42, 0xd000
s_and_b32 s30, s30, 0x1ffff
MM v[92:95], a[124:127], v[252:255], v[92:95]
s_waitcnt lgkmcnt(4)
s_waitcnt vmcnt(4)
v_add_u32 v5, 0xffff0000, v5
MM v[96:99], a[128:131], v[252:255], v[96:99]
buffer_load_dwordx4 v14, s[8:11], s30 offen nt lds
MM v[100:103], a[132:135], v[252:255], v[100:103]
s_waitcnt lgkmcnt(2)
s_add_u32 m0, s28, 0x15780
v_add_u32 v6, 0xffff0000, v6
MM v[104:107], a[136:139], v[252:255], v[104:107]
s_waitcnt lgkmcnt(0)
buffer_load_dwordx4 v14, s[8:11], s30 offen offset:128 nt lds
MM v[108:111], a[140:143], v[252:255], v[108:111]
v_exp_f32 v51, v51
MM a[224:227], a[244:247], v[252:255], a[224:227]
CV v242, v48, v49
CV v243, v50, v51
MM v[60:63], a[80:83], a[48:51], v[36:39]
v_exp_f32 v52, v52
MM v[64:67], a[84:87], a[48:51], v[36:39]
v_exp_f32 v53, v53
MM v[60:63], a[88:91], a[52:55], v[60:63]
v_exp_f32 v54, v54
MM v[64:67], a[92:95], a[52:55], v[64:67]
v_exp_f32 v55, v55
MM v[60:63], a[96:99], a[56:59], v[60:63]
CV v244, v52, v53
CV v245, v54, v55
MM v[64:67], a[100:103], a[56:59], v[64:67]
v_exp_f32 v56, v56
MM v[60:63], a[104:107], a[60:63], v[60:63]
v_exp_f32 v57, v57
MM v[64:67], a[108:111], a[60:63], v[64:67]
v_exp_f32 v58, v58
MM v[112:115], a[112:115], v[240:243], v[112:115]
v_exp_f32 v59, v59
MM v[116:119], a[116:119], v[240:243], v[116:119]
CV v246, v56, v57
CV v247, v58, v59
MM v[120:123], a[120:123], v[240:243], v[120:123]
v_exp_f32 v60, v60
MM v[124:127], a[124:127], v[240:243], v[124:127]
v_exp_f32 v61, v61
MM v[128:131], a[128:131], v[240:243], v[128:131]
v_exp_f32 v62, v62
MM v[132:135], a[132:135], v[240:243], v[132:135]
v_exp_f32 v63, v63
MM v[136:139], a[136:139], v[240:243], v[136:139]
CV v248, v60, v61
CV v249, v62, v63
MM v[140:143], a[140:143], v[240:243], v[140:143]
v_exp_f32 v64, v64
MM a[228:231], a[244:247], v[240:243], a[228:231]
s_waitcnt vmcnt(16)
s_barrier
s_add_u32 m0, s28, 0x18000
MM v[68:71], a[80:83], a[64:67], v[40:43]
s_add_u32 s30, s42, 0xe000
s_and_b32 s30, s30, 0x1ffff
s_waitcnt vmcnt(4)
MM v[72:75], a[84:87], a[64:67], v[40:43]
buffer_load_dwordx4 v13, s[4:7], s30 offen nt lds
MM v[68:71], a[88:91], a[68:71], v[68:71]
s_add_u32 m0, s28, 0x18f80
ds_read_b64 a[80:81], v5 offset:0
ds_read_b64 a[82:83], v6 offset:0
MM v[72:75], a[92:95], a[68:71], v[72:75]
buffer_load_dwordx4 v13, s[4:7], s30 offen offset:128 nt lds
MM v[68:71], a[96:99], a[72:75], v[68:71]
ds_read_b64 a[84:85], v5 offset:2048
ds_read_b64 a[86:87], v6 offset:2048
MM v[72:75], a[100:103], a[72:75], v[72:75]
v_add_u32 v7, 0xffff0000, v7
v_add_u32 v8, 0xffff0000, v8
MM v[68:71], a[104:107], a[76:79], v[68:71]
ds_read_b64 a[88:89], v7 offset:0
ds_read_b64 a[90:91], v8 offset:0
MM v[72:75], a[108:111], a[76:79], v[72:75]
v_exp_f32 v65, v65
MM v[144:147], a[112:115], v[244:247], v[144:147]
ds_read_b64 a[92:93], v7 offset:2048
ds_read_b64 a[94:95], v8 offset:2048
MM v[148:151], a[116:119], v[244:247], v[148:151]
v_exp_f32 v66, v66
MM v[152:155], a[120:123], v[244:247], v[152:155]
ds_read_b64 a[96:97], v5 offset:4096
ds_read_b64 a[98:99], v6 offset:4096
MM v[156:159], a[124:127], v[244:247], v[156:159]
v_exp_f32 v67, v67
MM v[160:163], a[128:131], v[244:247], v[160:163]
ds_read_b64 a[100:101], v5 offset:6144
ds_read_b64 a[102:103], v6 offset:6144
MM v[164:167], a[132:135], v[244:247], v[164:167]
CV v250, v64, v65
CV v251, v66, v67
MM v[168:171], a[136:139], v[244:247], v[168:171]
ds_read_b64 a[104:105], v7 offset:4096
ds_read_b64 a[106:107], v8 offset:4096
MM v[172:175], a[140:143], v[244:247], v[172:175]
v_exp_f32 v68, v68
MM a[232:235], a[244:247], v[244:247], a[232:235]
s_waitcnt lgkmcnt(6)
ds_read_b64 a[108:109], v7 offset:6144
ds_read_b64 a[110:111], v8 offset:6144
MM v[44:47], a[80:83], a[0:3], v[24:27]
v_exp_f32 v69, v69
MM v[48:51], a[84:87], a[0:3], v[24:27]
v_exp_f32 v70, v70
MM v[44:47], a[88:91], a[4:7], v[44:47]
v_exp_f32 v71, v71
MM v[48:51], a[92:95], a[4:7], v[48:51]
s_waitcnt lgkmcnt(4)
s_add_u32 m0, s28, 0x18800
s_add_u32 s30, s42, 0xf000
MM v[44:47], a[96:99], a[8:11], v[44:47]
s_and_b32 s30, s30, 0x1ffff
s_waitcnt vmcnt(4)
CV v252, v68, v69
MM v[48:51], a[100:103], a[8:11], v[48:51]
s_waitcnt lgkmcnt(2)
buffer_load_dwordx4 v13, s[4:7], s30 offen nt lds
MM v[44:47], a[104:107], a[12:15], v[44:47]
s_waitcnt lgkmcnt(0)
s_add_u32 m0, s28, 0x19780
CV v253, v70, v71
MM v[48:51], a[108:111], a[12:15], v[48:51]
buffer_load_dwordx4 v13, s[4:7], s30 offen offset:128 nt lds
MM v[176:179], a[112:115], v[248:251], v[176:179]
v_exp_f32 v72, v72
MM v[180:183], a[116:119], v[248:251], v[180:183]
v_exp_f32 v73, v73
MM v[184:187], a[120:123], v[248:251], v[184:187]
v_exp_f32 v74, v74
MM v[188:191], a[124:127], v[248:251], v[188:191]
v_exp_f32 v75, v75
MM v[192:195], a[128:131], v[248:251], v[192:195]
CV v254, v72, v73
CV v255, v74, v75
MM v[196:199], a[132:135], v[248:251], v[196:199]
v_exp_f32 v44, v44
MM v[200:203], a[136:139], v[248:251], v[200:203]
v_exp_f32 v45, v45
MM v[204:207], a[140:143], v[248:251], v[204:207]
v_exp_f32 v46, v46
MM a[236:239], a[244:247], v[248:251], a[236:239]
v_exp_f32 v47, v47
MM v[52:55], a[80:83], a[16:19], v[28:31]
CV v240, v44, v45
CV v241, v46, v47
MM v[56:59], a[84:87], a[16:19], v[28:31]
v_exp_f32 v48, v48
MM v[52:55], a[88:91], a[20:23], v[52:55]
v_exp_f32 v49, v49
MM v[56:59], a[92:95], a[20:23], v[56:59]
v_exp_f32 v50, v50
MM v[52:55], a[96:99], a[24:27], v[52:55]
v_exp_f32 v51, v51
MM v[56:59], a[100:103], a[24:27], v[56:59]
CV v242, v48, v49
CV v243, v50, v51
MM v[52:55], a[104:107], a[28:31], v[52:55]
v_add_u32 v1, 0xffff0000, v1
v_add_u32 v2, 0xffff0000, v2
MM v[56:59], a[108:111], a[28:31], v[56:59]
s_add_u32 m0, s28, 0x1c000
s_add_u32 s30, s42, 0xe000
s_and_b32 s30, s30, 0x1ffff
MM v[208:211], a[112:115], v[252:255], v[208:211]
s_waitcnt vmcnt(4)
buffer_load_dwordx4 v14, s[8:11], s30 offen nt lds
MM v[212:215], a[116:119], v[252:255], v[212:215]
s_add_u32 m0, s28, 0x1cf80
TR a[112:113], v1 offset:16384
TR a[114:115], v1 offset:18432
MM v[216:219], a[120:123], v[252:255], v[216:219]
buffer_load_dwordx4 v14, s[8:11], s30 offen offset:128 nt lds
MM v[220:223], a[124:127], v[252:255], v[220:223]
TR a[116:117], v2 offset:16384
TR a[118:119], v2 offset:18432
MM v[224:227], a[128:131], v[252:255], v[224:227]
v_add_u32 v3, 0xffff0000, v3
v_add_u32 v4, 0xffff0000, v4
MM v[228:231], a[132:135], v[252:255], v[228:231]
TR a[120:121], v3 offset:16384
TR a[122:123], v3 offset:18432
MM v[232:235], a[136:139], v[252:255], v[232:235]
v_exp_f32 v52, v52
MM v[236:239], a[140:143], v[252:255], v[236:239]
TR a[124:125], v4 offset:16384
TR a[126:127], v4 offset:18432
MM a[240:243], a[244:247], v[252:255], a[240:243]
v_exp_f32 v53, v53
MM v[60:63], a[80:83], a[32:35], v[32:35]
TR a[128:129], v1 offset:20480
TR a[130:131], v1 offset:22528
MM v[64:67], a[84:87], a[32:35], v[32:35]
v_exp_f32 v54, v54
MM v[60:63], a[88:91], a[36:39], v[60:63]
TR a[132:133], v2 offset:20480
TR a[134:135], v2 offset:22528
MM v[64:67], a[92:95], a[36:39], v[64:67]
v_exp_f32 v55, v55
MM v[60:63], a[96:99], a[40:43], v[60:63]
TR a[136:137], v3 offset:20480
TR a[138:139], v3 offset:22528
MM v[64:67], a[100:103], a[40:43], v[64:67]
CV v244, v52, v53
CV v245, v54, v55
MM v[60:63], a[104:107], a[44:47], v[60:63]
TR a[140:141], v4 offset:20480
TR a[142:143], v4 offset:22528
MM v[64:67], a[108:111], a[44:47], v[64:67]
s_waitcnt lgkmcnt(8)
v_exp_f32 v56, v56
MM v[80:83], a[112:115], v[240:243], v[80:83]
v_exp_f32 v57, v57
MM v[84:87], a[116:119], v[240:243], v[84:87]
v_exp_f32 v58, v58
MM v[88:91], a[120:123], v[240:243], v[88:91]
s_add_u32 m0, s28, 0x1c800
s_add_u32 s30, s42, 0xf000
s_and_b32 s30, s30, 0x1ffff
MM v[92:95], a[124:127], v[240:243], v[92:95]
s_waitcnt lgkmcnt(4)
s_waitcnt vmcnt(4)
MM v[96:99], a[128:131], v[240:243], v[96:99]
buffer_load_dwordx4 v14, s[8:11], s30 offen nt lds
MM v[100:103], a[132:135], v[240:243], v[100:103]
s_waitcnt lgkmcnt(2)
s_add_u32 m0, s28, 0x1d780
MM v[104:107], a[136:139], v[240:243], v[104:107]
s_waitcnt lgkmcnt(0)
buffer_load_dwordx4 v14, s[8:11], s30 offen offset:128 nt lds
MM v[108:111], a[140:143], v[240:243], v[108:111]
v_exp_f32 v59, v59
MM a[224:227], a[244:247], v[240:243], a[224:227]
CV v246, v56, v57
CV v247, v58, v59
MM v[68:71], a[80:83], a[48:51], v[36:39]
v_exp_f32 v60, v60
MM v[72:75], a[84:87], a[48:51], v[36:39]
v_exp_f32 v61, v61
MM v[68:71], a[88:91], a[52:55], v[68:71]
v_exp_f32 v62, v62
MM v[72:75], a[92:95], a[52:55], v[72:75]
v_exp_f32 v63, v63
MM v[68:71], a[96:99], a[56:59], v[68:71]
CV v248, v60, v61
CV v249, v62, v63
MM v[72:75], a[100:103], a[56:59], v[72:75]
v_exp_f32 v64, v64
MM v[68:71], a[104:107], a[60:63], v[68:71]
v_exp_f32 v65, v65
MM v[72:75], a[108:111], a[60:63], v[72:75]
v_exp_f32 v66, v66
MM v[112:115], a[112:115], v[244:247], v[112:115]
v_exp_f32 v67, v67
MM v[116:119], a[116:119], v[244:247], v[116:119]
CV v250, v64, v65
CV v251, v66, v67
MM v[120:123], a[120:123], v[244:247], v[120:123]
v_exp_f32 v68, v68
MM v[124:127], a[124:127], v[244:247], v[124:127]
v_exp_f32 v69, v69
MM v[128:131], a[128:131], v[244:247], v[128:131]
v_exp_f32 v70, v70
MM v[132:135], a[132:135], v[244:247], v[132:135]
v_exp_f32 v71, v71
MM v[136:139], a[136:139], v[244:247], v[136:139]
CV v252, v68, v69
CV v253, v70, v71
MM v[140:143], a[140:143], v[244:247], v[140:143]
v_exp_f32 v72, v72
MM a[228:231], a[244:247], v[244:247], a[228:231]
s_waitcnt vmcnt(16)
s_barrier
s_add_u32 m0, s28, 0x0
MM v[44:47], a[80:83], a[64:67], v[40:43]
s_add_u32 s30, s42, 0x10000
s_and_b32 s30, s30, 0x1ffff
s_add_u32 s30, s30, s97
MM v[48:51], a[84:87], a[64:67], v[40:43]
s_waitcnt vmcnt(4)
buffer_load_dwordx4 v13, s[4:7], s30 offen nt lds
MM v[44:47], a[88:91], a[68:71], v[44:47]
s_add_u32 m0, s28, 0xf80
ds_read_b64 a[80:81], v5 offset:32768
ds_read_b64 a[82:83], v6 offset:32768
MM v[48:51], a[92:95], a[68:71], v[48:51]
buffer_load_dwordx4 v13, s[4:7], s30 offen offset:128 nt lds
MM v[44:47], a[96:99], a[72:75], v[44:47]
ds_read_b64 a[84:85], v5 offset:34816
ds_read_b64 a[86:87], v6 offset:34816
MM v[48:51], a[100:103], a[72:75], v[48:51]
v_exp_f32 v73, v73
MM v[44:47], a[104:107], a[76:79], v[44:47]
ds_read_b64 a[88:89], v7 offset:32768
ds_read_b64 a[90:91], v8 offset:32768
MM v[48:51], a[108:111], a[76:79], v[48:51]
v_exp_f32 v74, v74
MM v[144:147], a[112:115], v[248:251], v[144:147]
ds_read_b64 a[92:93], v7 offset:34816
ds_read_b64 a[94:95], v8 offset:34816
MM v[148:151], a[116:119], v[248:251], v[148:151]
v_exp_f32 v75, v75
MM v[152:155], a[120:123], v[248:251], v[152:155]
ds_read_b64 a[96:97], v5 offset:36864
ds_read_b64 a[98:99], v6 offset:36864
MM v[156:159], a[124:127], v[248:251], v[156:159]
CV v254, v72, v73
CV v255, v74, v75
MM v[160:163], a[128:131], v[248:251], v[160:163]
ds_read_b64 a[100:101], v5 offset:38912
ds_read_b64 a[102:103], v6 offset:38912
MM v[164:167], a[132:135], v[248:251], v[164:167]
v_exp_f32 v44, v44
MM v[168:171], a[136:139], v[248:251], v[168:171]
ds_read_b64 a[104:105], v7 offset:36864
ds_read_b64 a[106:107], v8 offset:36864
MM v[172:175], a[140:143], v[248:251], v[172:175]
v_exp_f32 v45, v45
MM a[232:235], a[244:247], v[248:251], a[232:235]
s_waitcnt lgkmcnt(6)
ds_read_b64 a[108:109], v7 offset:38912
ds_read_b64 a[110:111], v8 offset:38912
MM v[52:55], a[80:83], a[0:3], v[24:27]
v_exp_f32 v46, v46
MM v[56:59], a[84:87], a[0:3], v[24:27]
v_exp_f32 v47, v47
MM v[52:55], a[88:91], a[4:7], v[52:55]
CV v240, v44, v45
CV v241, v46, v47
MM v[56:59], a[92:95], a[4:7], v[56:59]
s_waitcnt lgkmcnt(4)
s_add_u32 m0, s28, 0x800
s_add_u32 s30, s42, 0x11000
MM v[52:55], a[96:99], a[8:11], v[52:55]
s_and_b32 s30, s30, 0x1ffff
s_add_u32 s30, s30, s97
s_waitcnt vmcnt(4)
MM v[56:59], a[100:103], a[8:11], v[56:59]
s_waitcnt lgkmcnt(2)
buffer_load_dwordx4 v13, s[4:7], s30 offen nt lds
MM v[52:55], a[104:107], a[12:15], v[52:55]
s_waitcnt lgkmcnt(0)
s_add_u32 m0, s28, 0x1780
MM v[56:59], a[108:111], a[12:15], v[56:59]
buffer_load_dwordx4 v13, s[4:7], s30 offen offset:128 nt lds
MM v[176:179], a[112:115], v[252:255], v[176:179]
v_exp_f32 v48, v48
MM v[180:183], a[116:119], v[252:255], v[180:183]
v_exp_f32 v49, v49
MM v[184:187], a[120:123], v[252:255], v[184:187]
v_exp_f32 v50, v50
MM v[188:191], a[124:127], v[252:255], v[188:191]
v_exp_f32 v51, v51
MM v[192:195], a[128:131], v[252:255], v[192:195]
CV v242, v48, v49
CV v243, v50, v51
MM v[196:199], a[132:135], v[252:255], v[196:199]
v_exp_f32 v52, v52
MM v[200:203], a[136:139], v[252:255], v[200:203]
v_exp_f32 v53, v53
MM v[204:207], a[140:143], v[252:255], v[204:207]
v_exp_f32 v54, v54
MM a[236:239], a[244:247], v[252:255], a[236:239]
v_exp_f32 v55, v55
MM v[60:63], a[80:83], a[16:19], v[28:31]
CV v244, v52, v53
CV v245, v54, v55
MM v[64:67], a[84:87], a[16:19], v[28:31]
v_exp_f32 v56, v56
MM v[60:63], a[88:91], a[20:23], v[60:63]
v_exp_f32 v57, v57
MM v[64:67], a[92:95], a[20:23], v[64:67]
v_exp_f32 v58, v58
MM v[60:63], a[96:99], a[24:27], v[60:63]
v_exp_f32 v59, v59
MM v[64:67], a[100:103], a[24:27], v[64:67]
CV v246, v56, v57
CV v247, v58, v59
MM v[60:63], a[104:107], a[28:31], v[60:63]
MM v[64:67], a[108:111], a[28:31], v[64:67]
s_add_u32 m0, s28, 0x4000
s_add_u32 s30, s42, 0x10000
s_and_b32 s30, s30, 0x1ffff
MM v[208:211], a[112:115], v[240:243], v[208:211]
s_add_u32 s30, s30, s97
s_waitcnt vmcnt(4)
TR a[112:113], v1 offset:49152
MM v[212:215], a[116:119], v[240:243], v[212:215]
buffer_load_dwordx4 v14, s[8:11], s30 offen nt lds
MM v[216:219], a[120:123], v[240:243], v[216:219]
s_add_u32 m0, s28, 0x4f80
TR a[114:115], v1 offset:51200
TR a[116:117], v2 offset:49152
MM v[220:223], a[124:127], v[240:243], v[220:223]
buffer_load_dwordx4 v14, s[8:11], s30 offen offset:128 nt lds
MM v[224:227], a[128:131], v[240:243], v[224:227]
TR a[118:119], v2 offset:51200
TR a[120:121], v3 offset:49152
MM v[228:231], a[132:135], v[240:243], v[228:231]
v_exp_f32 v60, v60
MM v[232:235], a[136:139], v[240:243], v[232:235]
TR a[122:123], v3 offset:51200
TR a[124:125], v4 offset:49152
MM v[236:239], a[140:143], v[240:243], v[236:239]
v_exp_f32 v61, v61
MM a[240:243], a[244:247], v[240:243], a[240:243]
TR a[126:127], v4 offset:51200
TR a[128:129], v1 offset:53248
MM v[68:71], a[80:83], a[32:35], v[32:35]
v_exp_f32 v62, v62
MM v[72:75], a[84:87], a[32:35], v[32:35]
TR a[130:131], v1 offset:55296
TR a[132:133], v2 offset:53248
MM v[68:71], a[88:91], a[36:39], v[68:71]
v_exp_f32 v63, v63
MM v[72:75], a[92:95], a[36:39], v[72:75]
TR a[134:135], v2 offset:55296
TR a[136:137], v3 offset:53248
MM v[68:71], a[96:99], a[40:43], v[68:71]
CV v248, v60, v61
CV v249, v62, v63
MM v[72:75], a[100:103], a[40:43], v[72:75]
TR a[138:139], v3 offset:55296
TR a[140:141], v4 offset:53248
MM v[68:71], a[104:107], a[44:47], v[68:71]
v_exp_f32 v64, v64
MM v[72:75], a[108:111], a[44:47], v[72:75]
s_waitcnt lgkmcnt(7)
TR a[142:143], v4 offset:55296
MM v[80:83], a[112:115], v[244:247], v[80:83]
v_exp_f32 v65, v65
MM v[84:87], a[116:119], v[244:247], v[84:87]
v_exp_f32 v66, v66
MM v[88:91], a[120:123], v[244:247], v[88:91]
v_exp_f32 v67, v67
MM v[92:95], a[124:127], v[244:247], v[92:95]
s_waitcnt lgkmcnt(4)
s_add_u32 m0, s28, 0x4800
s_add_u32 s30, s42, 0x11000
MM v[96:99], a[128:131], v[244:247], v[96:99]
s_and_b32 s30, s30, 0x1ffff
s_add_u32 s30, s30, s97
s_waitcnt vmcnt(4)
MM v[100:103], a[132:135], v[244:247], v[100:103]
s_waitcnt lgkmcnt(2)
buffer_load_dwordx4 v14, s[8:11], s30 offen nt lds
MM v[104:107], a[136:139], v[244:247], v[104:107]
s_waitcnt lgkmcnt(0)
s_add_u32 m0, s28, 0x5780
CV v250, v64, v65
MM v[108:111], a[140:143], v[244:247], v[108:111]
buffer_load_dwordx4 v14, s[8:11], s30 offen offset:128 nt lds
MM a[224:227], a[244:247], v[244:247], a[224:227]
CV v251, v66, v67
MM v[44:47], a[80:83], a[48:51], v[36:39]
v_exp_f32 v68, v68
MM v[48:51], a[84:87], a[48:51], v[36:39]
v_exp_f32 v69, v69
MM v[44:47], a[88:91], a[52:55], v[44:47]
v_exp_f32 v70, v70
MM v[48:51], a[92:95], a[52:55], v[48:51]
v_exp_f32 v71, v71
MM v[44:47], a[96:99], a[56:59], v[44:47]
CV v252, v68, v69
CV v253, v70, v71
MM v[48:51], a[100:103], a[56:59], v[48:51]
v_exp_f32 v72, v72
MM v[44:47], a[104:107], a[60:63], v[44:47]
v_exp_f32 v73, v73
MM v[48:51], a[108:111], a[60:63], v[48:51]
v_exp_f32 v74, v74
MM v[112:115], a[112:115], v[248:251], v[112:115]
v_exp_f32 v75, v75
MM v[116:119], a[116:119], v[248:251], v[116:119]
CV v254, v72, v73
CV v255, v74, v75
MM v[120:123], a[120:123], v[248:251], v[120:123]
v_exp_f32 v44, v44
MM v[124:127], a[124:127], v[248:251], v[124:127]
v_exp_f32 v45, v45
MM v[128:131], a[128:131], v[248:251], v[128:131]
v_exp_f32 v46, v46
MM v[132:135], a[132:135], v[248:251], v[132:135]
v_exp_f32 v47, v47
MM v[136:139], a[136:139], v[248:251], v[136:139]
CV v240, v44, v45
CV v241, v46, v47
MM v[140:143], a[140:143], v[248:251], v[140:143]
v_exp_f32 v48, v48
MM a[228:231], a[244:247], v[248:251], a[228:231]
s_sub_u32 s96, s96, 1
s_cmp_lg_u32 s96, 0
s_cbranch_scc1 L_YA1
s_waitcnt vmcnt(16)
s_barrier
v_add_u32 v5, 0x10000, v5
MM v[52:55], a[80:83], a[64:67], v[40:43]
s_mov_b32 s41, 0x0
s_add_u32 m0, s28, 0x20000
s_add_u32 s30, s31, 0x20000
MM v[56:59], a[84:87], a[64:67], v[40:43]
buffer_load_dwordx4 v17, s[20:23], s30 offen lds
MM v[52:55], a[88:91], a[68:71], v[52:55]
ds_read_b64 a[80:81], v5 offset:0
v_add_u32 v6, 0x10000, v6
MM v[56:59], a[92:95], a[68:71], v[56:59]
s_add_u32 m0, s28, 0x21000
s_add_u32 s30, s31, 0x28000
ds_read_b64 a[82:83], v6 offset:0
MM v[52:55], a[96:99], a[72:75], v[52:55]
buffer_load_dwordx4 v17, s[20:23], s30 offen lds
MM v[56:59], a[100:103], a[72:75], v[56:59]
ds_read_b64 a[84:85], v5 offset:2048
ds_read_b64 a[86:87], v6 offset:2048
MM v[52:55], a[104:107], a[76:79], v[52:55]
s_add_u32 m0, s28, 0x20800
s_add_u32 s30, s31, 0x24000
v_add_u32 v7, 0x10000, v7
MM v[56:59], a[108:111], a[76:79], v[56:59]
buffer_load_dwordx4 v17, s[20:23], s30 offen lds
MM v[144:147], a[112:115], v[252:255], v[144:147]
ds_read_b64 a[88:89], v7 offset:0
v_add_u32 v8, 0x10000, v8
MM v[148:151], a[116:119], v[252:255], v[148:151]
s_add_u32 m0, s28, 0x21800
s_add_u32 s30, s31, 0x2c000
ds_read_b64 a[90:91], v8 offset:0
MM v[152:155], a[120:123], v[252:255], v[152:155]
buffer_load_dwordx4 v17, s[20:23], s30 offen lds
MM v[156:159], a[124:127], v[252:255], v[156:159]
ds_read_b64 a[92:93], v7 offset:2048
ds_read_b64 a[94:95], v8 offset:2048
MM v[160:163], a[128:131], v[252:255], v[160:163]
s_add_u32 m0, s28, 0x24000
s_add_u32 s30, s31, 0x30000
v_add_u32 v1, 0x10000, v1
MM v[164:167], a[132:135], v[252:255], v[164:167]
ds_read_b64 a[96:97], v5 offset:4096
ds_read_b64 a[98:99], v6 offset:4096
MM v[168:171], a[136:139], v[252:255], v[168:171]
buffer_load_dwordx4 v17, s[20:23], s30 offen lds
MM v[172:175], a[140:143], v[252:255], v[172:175]
ds_read_b64 a[100:101], v5 offset:6144
ds_read_b64 a[102:103], v6 offset:6144
MM a[232:235], a[244:247], v[252:255], a[232:235]
s_waitcnt lgkmcnt(8)
s_add_u32 m0, s28, 0x25000
s_add_u32 s30, s31, 0x38000
ds_read_b64 a[104:105], v7 offset:4096
ds_read_b64 a[106:107], v8 offset:4096
MM v[60:63], a[80:83], a[0:3], v[24:27]
ds_read_b64 a[108:109], v7 offset:6144
ds_read_b64 a[110:111], v8 offset:6144
MM v[64:67], a[84:87], a[0:3], v[24:27]
s_waitcnt lgkmcnt(10)
buffer_load_dwordx4 v17, s[20:23], s30 offen lds
MM v[60:63], a[88:91], a[4:7], v[60:63]
s_waitcnt lgkmcnt(8)
v_exp_f32 v49, v49
v_exp_f32 v50, v50
v_exp_f32 v51, v51
buffer_load_dword v22, v23, s[20:23], s41 offen
MM v[64:67], a[92:95], a[4:7], v[64:67]
s_waitcnt lgkmcnt(6)
s_add_u32 m0, s28, 0x24800
s_add_u32 s30, s31, 0x34000
MM v[60:63], a[96:99], a[8:11], v[60:63]
s_waitcnt lgkmcnt(4)
buffer_load_dwordx4 v17, s[20:23], s30 offen lds
MM v[64:67], a[100:103], a[8:11], v[64:67]
s_waitcnt lgkmcnt(2)
CV v242, v48, v49
CV v243, v50, v51
MM v[60:63], a[104:107], a[12:15], v[60:63]
s_waitcnt lgkmcnt(0)
s_add_u32 m0, s28, 0x25800
s_add_u32 s30, s31, 0x3c000
MM v[64:67], a[108:111], a[12:15], v[64:67]
buffer_load_dwordx4 v17, s[20:23], s30 offen lds
MM v[176:179], a[112:115], v[240:243], v[176:179]
v_exp_f32 v52, v52
MM v[180:183], a[116:119], v[240:243], v[180:183]
v_exp_f32 v53, v53
MM v[184:187], a[120:123], v[240:243], v[184:187]
v_exp_f32 v54, v54
MM v[188:191], a[124:127], v[240:243], v[188:191]
v_exp_f32 v55, v55
MM v[192:195], a[128:131], v[240:243], v[192:195]
CV v244, v52, v53
CV v245, v54, v55
MM v[196:199], a[132:135], v[240:243], v[196:199]
v_exp_f32 v56, v56
MM v[200:203], a[136:139], v[240:243], v[200:203]
v_exp_f32 v57, v57
MM v[204:207], a[140:143], v[240:243], v[204:207]
v_exp_f32 v58, v58
MM a[236:239], a[244:247], v[240:243], a[236:239]
v_exp_f32 v59, v59
MM v[68:71], a[80:83], a[16:19], v[28:31]
CV v246, v56, v57
CV v247, v58, v59
MM v[72:75], a[84:87], a[16:19], v[28:31]
v_exp_f32 v60, v60
MM v[68:71], a[88:91], a[20:23], v[68:71]
v_exp_f32 v61, v61
MM v[72:75], a[92:95], a[20:23], v[72:75]
v_exp_f32 v62, v62
MM v[68:71], a[96:99], a[24:27], v[68:71]
v_exp_f32 v63, v63
MM v[72:75], a[100:103], a[24:27], v[72:75]
CV v248, v60, v61
CV v249, v62, v63
MM v[68:71], a[104:107], a[28:31], v[68:71]
v_exp_f32 v64, v64
MM v[72:75], a[108:111], a[28:31], v[72:75]
v_exp_f32 v65, v65
MM v[208:211], a[112:115], v[244:247], v[208:211]
TR a[112:113], v1 offset:16384
TR a[114:115], v1 offset:18432
MM v[212:215], a[116:119], v[244:247], v[212:215]
v_add_u32 v2, 0x10000, v2
v_add_u32 v3, 0x10000, v3
MM v[216:219], a[120:123], v[244:247], v[216:219]
TR a[116:117], v2 offset:16384
TR a[118:119], v2 offset:18432
MM v[220:223], a[124:127], v[244:247], v[220:223]
v_exp_f32 v66, v66
MM v[224:227], a[128:131], v[244:247], v[224:227]
v_exp_f32 v67, v67
MM v[228:231], a[132:135], v[244:247], v[228:231]
TR a[120:121], v3 offset:16384
TR a[122:123], v3 offset:18432
MM v[232:235], a[136:139], v[244:247], v[232:235]
v_add_u32 v4, 0x10000, v4
CV v250, v64, v65
MM v[236:239], a[140:143], v[244:247], v[236:239]
TR a[124:125], v4 offset:16384
TR a[126:127], v4 offset:18432
MM a[240:243], a[244:247], v[244:247], a[240:243]
CV v251, v66, v67
MM v[44:47], a[80:83], a[32:35], v[32:35]
TR a[128:129], v1 offset:20480
TR a[130:131], v1 offset:22528
MM v[48:51], a[84:87], a[32:35], v[32:35]
v_exp_f32 v68, v68
MM v[44:47], a[88:91], a[36:39], v[44:47]
TR a[132:133], v2 offset:20480
TR a[134:135], v2 offset:22528
MM v[48:51], a[92:95], a[36:39], v[48:51]
v_exp_f32 v69, v69
MM v[44:47], a[96:99], a[40:43], v[44:47]
TR a[136:137], v3 offset:20480
TR a[138:139], v3 offset:22528
MM v[48:51], a[100:103], a[40:43], v[48:51]
v_exp_f32 v70, v70
MM v[44:47], a[104:107], a[44:47], v[44:47]
TR a[140:141], v4 offset:20480
TR a[142:143], v4 offset:22528
MM v[48:51], a[108:111], a[44:47], v[48:51]
s_waitcnt lgkmcnt(8)
v_exp_f32 v71, v71
MM v[80:83], a[112:115], v[248:251], v[80:83]
CV v252, v68, v69
CV v253, v70, v71
MM v[84:87], a[116:119], v[248:251], v[84:87]
v_exp_f32 v72, v72
MM v[88:91], a[120:123], v[248:251], v[88:91]
v_exp_f32 v73, v73
MM v[92:95], a[124:127], v[248:251], v[92:95]
s_waitcnt lgkmcnt(4)
v_exp_f32 v74, v74
MM v[96:99], a[128:131], v[248:251], v[96:99]
v_exp_f32 v75, v75
MM v[100:103], a[132:135], v[248:251], v[100:103]
s_waitcnt lgkmcnt(2)
CV v254, v72, v73
CV v255, v74, v75
MM v[104:107], a[136:139], v[248:251], v[104:107]
s_waitcnt lgkmcnt(0)
v_exp_f32 v44, v44
MM v[108:111], a[140:143], v[248:251], v[108:111]
v_exp_f32 v45, v45
MM a[224:227], a[244:247], v[248:251], a[224:227]
v_exp_f32 v46, v46
MM v[52:55], a[80:83], a[48:51], v[36:39]
v_exp_f32 v47, v47
MM v[56:59], a[84:87], a[48:51], v[36:39]
CV v240, v44, v45
CV v241, v46, v47
MM v[52:55], a[88:91], a[52:55], v[52:55]
v_exp_f32 v48, v48
MM v[56:59], a[92:95], a[52:55], v[56:59]
v_exp_f32 v49, v49
MM v[52:55], a[96:99], a[56:59], v[52:55]
v_exp_f32 v50, v50
MM v[56:59], a[100:103], a[56:59], v[56:59]
v_exp_f32 v51, v51
MM v[52:55], a[104:107], a[60:63], v[52:55]
CV v242, v48, v49
CV v243, v50, v51
MM v[56:59], a[108:111], a[60:63], v[56:59]
MM v[112:115], a[112:115], v[252:255], v[112:115]
MM v[116:119], a[116:119], v[252:255], v[116:119]
MM v[120:123], a[120:123], v[252:255], v[120:123]
MM v[124:127], a[124:127], v[252:255], v[124:127]
MM v[128:131], a[128:131], v[252:255], v[128:131]
v_exp_f32 v52, v52
MM v[132:135], a[132:135], v[252:255], v[132:135]
v_exp_f32 v53, v53
MM v[136:139], a[136:139], v[252:255], v[136:139]
v_exp_f32 v54, v54
MM v[140:143], a[140:143], v[252:255], v[140:143]
v_exp_f32 v55, v55
MM a[228:231], a[244:247], v[252:255], a[228:231]
s_waitcnt vmcnt(17)
s_barrier
CV v244, v52, v53
MM v[60:63], a[80:83], a[64:67], v[40:43]
ds_read_b64 a[80:81], v5 offset:32768
ds_read_b64 a[82:83], v6 offset:32768
MM v[64:67], a[84:87], a[64:67], v[40:43]
CV v245, v54, v55
MM v[60:63], a[88:91], a[68:71], v[60:63]
ds_read_b64 a[84:85], v5 offset:34816
ds_read_b64 a[86:87], v6 offset:34816
MM v[64:67], a[92:95], a[68:71], v[64:67]
v_exp_f32 v56, v56
MM v[60:63], a[96:99], a[72:75], v[60:63]
ds_read_b64 a[88:89], v7 offset:32768
ds_read_b64 a[90:91], v8 offset:32768
MM v[64:67], a[100:103], a[72:75], v[64:67]
v_exp_f32 v57, v57
MM v[60:63], a[104:107], a[76:79], v[60:63]
ds_read_b64 a[92:93], v7 offset:34816
ds_read_b64 a[94:95], v8 offset:34816
MM v[64:67], a[108:111], a[76:79], v[64:67]
v_exp_f32 v58, v58
MM v[144:147], a[112:115], v[240:243], v[144:147]
ds_read_b64 a[96:97], v5 offset:36864
ds_read_b64 a[98:99], v6 offset:36864
MM v[148:151], a[116:119], v[240:243], v[148:151]
v_exp_f32 v59, v59
MM v[152:155], a[120:123], v[240:243], v[152:155]
ds_read_b64 a[100:101], v5 offset:38912
ds_read_b64 a[102:103], v6 offset:38912
MM v[156:159], a[124:127], v[240:243], v[156:159]
CV v246, v56, v57
CV v247, v58, v59
MM v[160:163], a[128:131], v[240:243], v[160:163]
ds_read_b64 a[104:105], v7 offset:36864
ds_read_b64 a[106:107], v8 offset:36864
MM v[164:167], a[132:135], v[240:243], v[164:167]
v_exp_f32 v60, v60
MM v[168:171], a[136:139], v[240:243], v[168:171]
ds_read_b64 a[108:109], v7 offset:38912
ds_read_b64 a[110:111], v8 offset:38912
MM v[172:175], a[140:143], v[240:243], v[172:175]
v_exp_f32 v61, v61
MM a[232:235], a[244:247], v[240:243], a[232:235]
s_waitcnt lgkmcnt(8)
v_exp_f32 v62, v62
MM v[68:71], a[80:83], a[0:3], v[24:27]
v_exp_f32 v63, v63
MM v[72:75], a[84:87], a[0:3], v[24:27]
CV v248, v60, v61
CV v249, v62, v63
MM v[68:71], a[88:91], a[4:7], v[68:71]
v_exp_f32 v64, v64
MM v[72:75], a[92:95], a[4:7], v[72:75]
s_waitcnt lgkmcnt(2)
v_exp_f32 v65, v65
MM v[68:71], a[96:99], a[8:11], v[68:71]
v_exp_f32 v66, v66
MM v[72:75], a[100:103], a[8:11], v[72:75]
v_exp_f32 v67, v67
MM v[68:71], a[104:107], a[12:15], v[68:71]
s_waitcnt lgkmcnt(0)
CV v250, v64, v65
CV v251, v66, v67
MM v[72:75], a[108:111], a[12:15], v[72:75]
MM v[176:179], a[112:115], v[244:247], v[176:179]
MM v[180:183], a[116:119], v[244:247], v[180:183]
MM v[184:187], a[120:123], v[244:247], v[184:187]
MM v[188:191], a[124:127], v[244:247], v[188:191]
v_exp_f32 v68, v68
MM v[192:195], a[128:131], v[244:247], v[192:195]
v_exp_f32 v69, v69
MM v[196:199], a[132:135], v[244:247], v[196:199]
v_exp_f32 v70, v70
MM v[200:203], a[136:139], v[244:247], v[200:203]
v_exp_f32 v71, v71
MM v[204:207], a[140:143], v[244:247], v[204:207]
CV v252, v68, v69
CV v253, v70, v71
MM a[236:239], a[244:247], v[244:247], a[236:239]
v_exp_f32 v72, v72
MM v[44:47], a[80:83], a[16:19], v[28:31]
v_exp_f32 v73, v73
MM v[48:51], a[84:87], a[16:19], v[28:31]
v_exp_f32 v74, v74
MM v[44:47], a[88:91], a[20:23], v[44:47]
v_exp_f32 v75, v75
MM v[48:51], a[92:95], a[20:23], v[48:51]
CV v254, v72, v73
CV v255, v74, v75
MM v[44:47], a[96:99], a[24:27], v[44:47]
MM v[48:51], a[100:103], a[24:27], v[48:51]
MM v[44:47], a[104:107], a[28:31], v[44:47]
MM v[48:51], a[108:111], a[28:31], v[48:51]
MM v[208:211], a[112:115], v[248:251], v[208:211]
TR a[112:113], v1 offset:49152
TR a[114:115], v1 offset:51200
MM v[212:215], a[116:119], v[248:251], v[212:215]
MM v[216:219], a[120:123], v[248:251], v[216:219]
TR a[116:117], v2 offset:49152
TR a[118:119], v2 offset:51200
MM v[220:223], a[124:127], v[248:251], v[220:223]
v_exp_f32 v44, v44
MM v[224:227], a[128:131], v[248:251], v[224:227]
TR a[120:121], v3 offset:49152
TR a[122:123], v3 offset:51200
MM v[228:231], a[132:135], v[248:251], v[228:231]
v_exp_f32 v45, v45
MM v[232:235], a[136:139], v[248:251], v[232:235]
TR a[124:125], v4 offset:49152
TR a[126:127], v4 offset:51200
MM v[236:239], a[140:143], v[248:251], v[236:239]
v_exp_f32 v46, v46
MM a[240:243], a[244:247], v[248:251], a[240:243]
TR a[128:129], v1 offset:53248
TR a[130:131], v1 offset:55296
MM v[52:55], a[80:83], a[32:35], v[32:35]
v_exp_f32 v47, v47
MM v[56:59], a[84:87], a[32:35], v[32:35]
TR a[132:133], v2 offset:53248
TR a[134:135], v2 offset:55296
MM v[52:55], a[88:91], a[36:39], v[52:55]
CV v240, v44, v45
CV v241, v46, v47
MM v[56:59], a[92:95], a[36:39], v[56:59]
TR a[136:137], v3 offset:53248
TR a[138:139], v3 offset:55296
MM v[52:55], a[96:99], a[40:43], v[52:55]
v_exp_f32 v48, v48
MM v[56:59], a[100:103], a[40:43], v[56:59]
TR a[140:141], v4 offset:53248
TR a[142:143], v4 offset:55296
MM v[52:55], a[104:107], a[44:47], v[52:55]
v_exp_f32 v49, v49
MM v[56:59], a[108:111], a[44:47], v[56:59]
s_waitcnt lgkmcnt(8)
v_exp_f32 v50, v50
MM v[80:83], a[112:115], v[252:255], v[80:83]
v_exp_f32 v51, v51
MM v[84:87], a[116:119], v[252:255], v[84:87]
CV v242, v48, v49
CV v243, v50, v51
MM v[88:91], a[120:123], v[252:255], v[88:91]
v_exp_f32 v52, v52
MM v[92:95], a[124:127], v[252:255], v[92:95]
s_waitcnt lgkmcnt(2)
v_exp_f32 v53, v53
MM v[96:99], a[128:131], v[252:255], v[96:99]
v_exp_f32 v54, v54
MM v[100:103], a[132:135], v[252:255], v[100:103]
v_exp_f32 v55, v55
MM v[104:107], a[136:139], v[252:255], v[104:107]
s_waitcnt lgkmcnt(0)
CV v244, v52, v53
CV v245, v54, v55
MM v[108:111], a[140:143], v[252:255], v[108:111]
v_exp_f32 v56, v56
MM a[224:227], a[244:247], v[252:255], a[224:227]
v_exp_f32 v57, v57
MM v[60:63], a[80:83], a[48:51], v[36:39]
v_exp_f32 v58, v58
MM v[64:67], a[84:87], a[48:51], v[36:39]
v_exp_f32 v59, v59
MM v[60:63], a[88:91], a[52:55], v[60:63]
CV v246, v56, v57
CV v247, v58, v59
MM v[64:67], a[92:95], a[52:55], v[64:67]
MM v[60:63], a[96:99], a[56:59], v[60:63]
MM v[64:67], a[100:103], a[56:59], v[64:67]
MM v[60:63], a[104:107], a[60:63], v[60:63]
MM v[64:67], a[108:111], a[60:63], v[64:67]
MM v[112:115], a[112:115], v[240:243], v[112:115]
MM v[116:119], a[116:119], v[240:243], v[116:119]
MM v[120:123], a[120:123], v[240:243], v[120:123]
MM v[124:127], a[124:127], v[240:243], v[124:127]
MM v[128:131], a[128:131], v[240:243], v[128:131]
MM v[132:135], a[132:135], v[240:243], v[132:135]
MM v[136:139], a[136:139], v[240:243], v[136:139]
v_exp_f32 v60, v60
MM v[140:143], a[140:143], v[240:243], v[140:143]
v_exp_f32 v61, v61
MM a[228:231], a[244:247], v[240:243], a[228:231]
v_exp_f32 v62, v62
MM v[68:71], a[80:83], a[64:67], v[40:43]
v_exp_f32 v63, v63
MM v[72:75], a[84:87], a[64:67], v[40:43]
CV v248, v60, v61
CV v249, v62, v63
MM v[68:71], a[88:91], a[68:71], v[68:71]
v_exp_f32 v64, v64
MM v[72:75], a[92:95], a[68:71], v[72:75]
v_exp_f32 v65, v65
MM v[68:71], a[96:99], a[72:75], v[68:71]
v_exp_f32 v66, v66
MM v[72:75], a[100:103], a[72:75], v[72:75]
v_exp_f32 v67, v67
MM v[68:71], a[104:107], a[76:79], v[68:71]
CV v250, v64, v65
CV v251, v66, v67
MM v[72:75], a[108:111], a[76:79], v[72:75]
MM v[144:147], a[112:115], v[244:247], v[144:147]
MM v[148:151], a[116:119], v[244:247], v[148:151]
MM v[152:155], a[120:123], v[244:247], v[152:155]
MM v[156:159], a[124:127], v[244:247], v[156:159]
MM v[160:163], a[128:131], v[244:247], v[160:163]
v_exp_f32 v68, v68
MM v[164:167], a[132:135], v[244:247], v[164:167]
v_exp_f32 v69, v69
MM v[168:171], a[136:139], v[244:247], v[168:171]
v_exp_f32 v70, v70
MM v[172:175], a[140:143], v[244:247], v[172:175]
v_exp_f32 v71, v71
MM a[232:235], a[244:247], v[244:247], a[232:235]
CV v252, v68, v69
CV v253, v70, v71
MM v[176:179], a[112:115], v[248:251], v[176:179]
v_exp_f32 v72, v72
MM v[180:183], a[116:119], v[248:251], v[180:183]
v_exp_f32 v73, v73
MM v[184:187], a[120:123], v[248:251], v[184:187]
v_exp_f32 v74, v74
MM v[188:191], a[124:127], v[248:251], v[188:191]
v_exp_f32 v75, v75
MM v[192:195], a[128:131], v[248:251], v[192:195]
CV v254, v72, v73
CV v255, v74, v75
MM v[196:199], a[132:135], v[248:251], v[196:199]
MM v[200:203], a[136:139], v[248:251], v[200:203]
MM v[204:207], a[140:143], v[248:251], v[204:207]
MM a[236:239], a[244:247], v[248:251], a[236:239]
MM v[208:211], a[112:115], v[252:255], v[208:211]
MM v[212:215], a[116:119], v[252:255], v[212:215]
MM v[216:219], a[120:123], v[252:255], v[216:219]
MM v[220:223], a[124:127], v[252:255], v[220:223]
MM v[224:227], a[128:131], v[252:255], v[224:227]
MM v[228:231], a[132:135], v[252:255], v[228:231]
MM v[232:235], a[136:139], v[252:255], v[232:235]
MM v[236:239], a[140:143], v[252:255], v[236:239]
MM a[240:243], a[244:247], v[252:255], a[240:243]
v_accvgpr_read_b32 v44, a224
v_accvgpr_read_b32 v46, a228
v_accvgpr_read_b32 v48, a232
v_accvgpr_read_b32 v50, a236
s_nop 3
v_accvgpr_read_b32 v52, a240
v_subrev_u32 v56, 0x2b800000, v44
v_subrev_u32 v57, 0x2b800000, v46
v_subrev_u32 v58, 0x2b800000, v48
v_subrev_u32 v59, 0x2b800000, v50
v_subrev_u32 v60, 0x2b800000, v52
v_max3_u32 v56, v56, v57, v58
v_max3_u32 v56, v56, v59, v60
v_cmp_lt_u32 vcc, 0x28000000, v56
v_rcp_f32 v44, v44
v_rcp_f32 v46, v46
v_rcp_f32 v48, v48
v_rcp_f32 v50, v50
v_rcp_f32 v52, v52
s_cmp_lg_u64 vcc, 0
s_cselect_b32 s40, 1, 0
v_mov_b32 v57, s40
s_lshl_b32 s40, s33, 2
v_add_u32 v58, 0x8000, v79
v_add_u32 v59, s40, v58
ds_write_b32 v59, v57
v_pk_mul_f32 v[80:81], v[80:81], v[44:45] op_sel_hi:[1,0]
v_pk_mul_f32 v[82:83], v[82:83], v[44:45] op_sel_hi:[1,0]
v_pk_mul_f32 v[84:85], v[84:85], v[44:45] op_sel_hi:[1,0]
v_pk_mul_f32 v[86:87], v[86:87], v[44:45] op_sel_hi:[1,0]
CV v80, v80, v81
CV v81, v82, v83
CV v82, v84, v85
CV v83, v86, v87
v_pk_mul_f32 v[88:89], v[88:89], v[44:45] op_sel_hi:[1,0]
v_pk_mul_f32 v[90:91], v[90:91], v[44:45] op_sel_hi:[1,0]
v_pk_mul_f32 v[92:93], v[92:93], v[44:45] op_sel_hi:[1,0]
v_pk_mul_f32 v[94:95], v[94:95], v[44:45] op_sel_hi:[1,0]
CV v84, v88, v89
CV v85, v90, v91
CV v86, v92, v93
CV v87, v94, v95
s_waitcnt lgkmcnt(0)
s_barrier
ds_read_b128 v[60:63], v58
v_pk_mul_f32 v[96:97], v[96:97], v[44:45] op_sel_hi:[1,0]
v_pk_mul_f32 v[98:99], v[98:99], v[44:45] op_sel_hi:[1,0]
v_pk_mul_f32 v[100:101], v[100:101], v[44:45] op_sel_hi:[1,0]
v_pk_mul_f32 v[102:103], v[102:103], v[44:45] op_sel_hi:[1,0]
CV v88, v96, v97
CV v89, v98, v99
CV v90, v100, v101
CV v91, v102, v103
v_pk_mul_f32 v[104:105], v[104:105], v[44:45] op_sel_hi:[1,0]
v_pk_mul_f32 v[106:107], v[106:107], v[44:45] op_sel_hi:[1,0]
v_pk_mul_f32 v[108:109], v[108:109], v[44:45] op_sel_hi:[1,0]
v_pk_mul_f32 v[110:111], v[110:111], v[44:45] op_sel_hi:[1,0]
CV v92, v104, v105
CV v93, v106, v107
CV v94, v108, v109
CV v95, v110, v111
v_pk_mul_f32 v[112:113], v[112:113], v[46:47] op_sel_hi:[1,0]
v_pk_mul_f32 v[114:115], v[114:115], v[46:47] op_sel_hi:[1,0]
v_pk_mul_f32 v[116:117], v[116:117], v[46:47] op_sel_hi:[1,0]
v_pk_mul_f32 v[118:119], v[118:119], v[46:47] op_sel_hi:[1,0]
CV v96, v112, v113
CV v97, v114, v115
CV v98, v116, v117
CV v99, v118, v119
v_pk_mul_f32 v[120:121], v[120:121], v[46:47] op_sel_hi:[1,0]
v_pk_mul_f32 v[122:123], v[122:123], v[46:47] op_sel_hi:[1,0]
v_pk_mul_f32 v[124:125], v[124:125], v[46:47] op_sel_hi:[1,0]
v_pk_mul_f32 v[126:127], v[126:127], v[46:47] op_sel_hi:[1,0]
s_waitcnt lgkmcnt(0)
v_or3_b32 v60, v60, v61, v62
v_or_b32 v60, v60, v63
CV v100, v120, v121
CV v101, v122, v123
v_readfirstlane_b32 s40, v60
CV v102, v124, v125
CV v103, v126, v127
v_pk_mul_f32 v[128:129], v[128:129], v[46:47] op_sel_hi:[1,0]
v_pk_mul_f32 v[130:131], v[130:131], v[46:47] op_sel_hi:[1,0]
s_or_b32 s40, s40, s36
s_cbranch_scc1 L_YFB1
L_YRet1:
s_waitcnt vmcnt(5)
s_barrier
s_mov_b32 s49, 0x0
s_mov_b32 s40, 0x0
s_mov_b32 s73, 0x300
v_pk_mul_f32 v[132:133], v[132:133], v[46:47] op_sel_hi:[1,0]
v_pk_mul_f32 v[134:135], v[134:135], v[46:47] op_sel_hi:[1,0]
s_add_u32 m0, s28, 0x18000
s_add_u32 s30, s31, 0x0
v_add_u32 v1, 0x8000, v1
CV v104, v128, v129
CV v105, v130, v131
CV v106, v132, v133
buffer_load_dwordx4 v17, s[20:23], s30 offen lds
CV v107, v134, v135
s_add_u32 m0, s28, 0x19000
s_add_u32 s30, s31, 0x8000
TR v[64:65], v1 offset:32768
v_pk_mul_f32 v[136:137], v[136:137], v[46:47] op_sel_hi:[1,0]
v_pk_mul_f32 v[138:139], v[138:139], v[46:47] op_sel_hi:[1,0]
v_pk_mul_f32 v[140:141], v[140:141], v[46:47] op_sel_hi:[1,0]
buffer_load_dwordx4 v17, s[20:23], s30 offen lds
v_pk_mul_f32 v[142:143], v[142:143], v[46:47] op_sel_hi:[1,0]
s_add_u32 m0, s28, 0x18800
s_add_u32 s30, s31, 0x4000
TR v[66:67], v1 offset:34816
CV v108, v136, v137
CV v109, v138, v139
CV v110, v140, v141
buffer_load_dwordx4 v17, s[20:23], s30 offen lds
CV v111, v142, v143
s_add_u32 m0, s28, 0x19800
s_add_u32 s30, s31, 0xc000
v_add_u32 v2, 0x8000, v2
v_pk_mul_f32 v[144:145], v[144:145], v[48:49] op_sel_hi:[1,0]
v_pk_mul_f32 v[146:147], v[146:147], v[48:49] op_sel_hi:[1,0]
v_pk_mul_f32 v[148:149], v[148:149], v[48:49] op_sel_hi:[1,0]
buffer_load_dwordx4 v17, s[20:23], s30 offen lds
v_pk_mul_f32 v[150:151], v[150:151], v[48:49] op_sel_hi:[1,0]
s_add_u32 m0, s28, 0x1c000
s_add_u32 s30, s31, 0x10000
TR v[68:69], v2 offset:32768
CV v112, v144, v145
CV v113, v146, v147
CV v114, v148, v149
buffer_load_dwordx4 v17, s[20:23], s30 offen lds
CV v115, v150, v151
s_add_u32 m0, s28, 0x1d000
s_add_u32 s30, s31, 0x18000
TR v[70:71], v2 offset:34816
v_pk_mul_f32 v[152:153], v[152:153], v[48:49] op_sel_hi:[1,0]
v_pk_mul_f32 v[154:155], v[154:155], v[48:49] op_sel_hi:[1,0]
v_pk_mul_f32 v[156:157], v[156:157], v[48:49] op_sel_hi:[1,0]
buffer_load_dwordx4 v17, s[20:23], s30 offen lds
v_pk_mul_f32 v[158:159], v[158:159], v[48:49] op_sel_hi:[1,0]
s_add_u32 m0, s28, 0x1c800
s_add_u32 s30, s31, 0x14000
v_add_u32 v3, 0x8000, v3
CV v116, v152, v153
CV v117, v154, v155
CV v118, v156, v157
buffer_load_dwordx4 v17, s[20:23], s30 offen lds
CV v119, v158, v159
s_add_u32 m0, s28, 0x1d800
s_add_u32 s30, s31, 0x1c000
TR v[72:73], v3 offset:32768
v_pk_mul_f32 v[160:161], v[160:161], v[48:49] op_sel_hi:[1,0]
v_pk_mul_f32 v[162:163], v[162:163], v[48:49] op_sel_hi:[1,0]
v_pk_mul_f32 v[164:165], v[164:165], v[48:49] op_sel_hi:[1,0]
buffer_load_dwordx4 v17, s[20:23], s30 offen lds
v_pk_mul_f32 v[166:167], v[166:167], v[48:49] op_sel_hi:[1,0]
TR v[74:75], v3 offset:34816
v_add_u32 v4, 0x8000, v4
CV v120, v160, v161
CV v121, v162, v163
CV v122, v164, v165
CV v123, v166, v167
TR v[76:77], v4 offset:32768
TR v[78:79], v4 offset:34816
v_pk_mul_f32 v[168:169], v[168:169], v[48:49] op_sel_hi:[1,0]
v_pk_mul_f32 v[170:171], v[170:171], v[48:49] op_sel_hi:[1,0]
v_pk_mul_f32 v[172:173], v[172:173], v[48:49] op_sel_hi:[1,0]
v_pk_mul_f32 v[174:175], v[174:175], v[48:49] op_sel_hi:[1,0]
CV v124, v168, v169
CV v125, v170, v171
CV v126, v172, v173
CV v127, v174, v175
v_pk_mul_f32 v[176:177], v[176:177], v[50:51] op_sel_hi:[1,0]
v_pk_mul_f32 v[178:179], v[178:179], v[50:51] op_sel_hi:[1,0]
v_pk_mul_f32 v[180:181], v[180:181], v[50:51] op_sel_hi:[1,0]
v_pk_mul_f32 v[182:183], v[182:183], v[50:51] op_sel_hi:[1,0]
CV v128, v176, v177
CV v129, v178, v179
CV v130, v180, v181
CV v131, v182, v183
v_pk_mul_f32 v[184:185], v[184:185], v[50:51] op_sel_hi:[1,0]
v_pk_mul_f32 v[186:187], v[186:187], v[50:51] op_sel_hi:[1,0]
v_pk_mul_f32 v[188:189], v[188:189], v[50:51] op_sel_hi:[1,0]
v_pk_mul_f32 v[190:191], v[190:191], v[50:51] op_sel_hi:[1,0]
CV v132, v184, v185
CV v133, v186, v187
CV v134, v188, v189
CV v135, v190, v191
v_pk_mul_f32 v[192:193], v[192:193], v[50:51] op_sel_hi:[1,0]
v_pk_mul_f32 v[194:195], v[194:195], v[50:51] op_sel_hi:[1,0]
v_pk_mul_f32 v[196:197], v[196:197], v[50:51] op_sel_hi:[1,0]
v_pk_mul_f32 v[198:199], v[198:199], v[50:51] op_sel_hi:[1,0]
CV v136, v192, v193
CV v137, v194, v195
CV v138, v196, v197
CV v139, v198, v199
v_pk_mul_f32 v[200:201], v[200:201], v[50:51] op_sel_hi:[1,0]
v_pk_mul_f32 v[202:203], v[202:203], v[50:51] op_sel_hi:[1,0]
v_pk_mul_f32 v[204:205], v[204:205], v[50:51] op_sel_hi:[1,0]
v_pk_mul_f32 v[206:207], v[206:207], v[50:51] op_sel_hi:[1,0]
CV v140, v200, v201
CV v141, v202, v203
CV v142, v204, v205
CV v143, v206, v207
v_pk_mul_f32 v[208:209], v[208:209], v[52:53] op_sel_hi:[1,0]
v_pk_mul_f32 v[210:211], v[210:211], v[52:53] op_sel_hi:[1,0]
v_pk_mul_f32 v[212:213], v[212:213], v[52:53] op_sel_hi:[1,0]
v_pk_mul_f32 v[214:215], v[214:215], v[52:53] op_sel_hi:[1,0]
CV v144, v208, v209
CV v145, v210, v211
CV v146, v212, v213
CV v147, v214, v215
v_pk_mul_f32 v[216:217], v[216:217], v[52:53] op_sel_hi:[1,0]
v_pk_mul_f32 v[218:219], v[218:219], v[52:53] op_sel_hi:[1,0]
v_pk_mul_f32 v[220:221], v[220:221], v[52:53] op_sel_hi:[1,0]
v_pk_mul_f32 v[222:223], v[222:223], v[52:53] op_sel_hi:[1,0]
CV v148, v216, v217
CV v149, v218, v219
CV v150, v220, v221
CV v151, v222, v223
v_pk_mul_f32 v[224:225], v[224:225], v[52:53] op_sel_hi:[1,0]
v_pk_mul_f32 v[226:227], v[226:227], v[52:53] op_sel_hi:[1,0]
v_pk_mul_f32 v[228:229], v[228:229], v[52:53] op_sel_hi:[1,0]
v_pk_mul_f32 v[230:231], v[230:231], v[52:53] op_sel_hi:[1,0]
CV v152, v224, v225
CV v153, v226, v227
CV v154, v228, v229
CV v155, v230, v231
v_pk_mul_f32 v[232:233], v[232:233], v[52:53] op_sel_hi:[1,0]
v_pk_mul_f32 v[234:235], v[234:235], v[52:53] op_sel_hi:[1,0]
v_pk_mul_f32 v[236:237], v[236:237], v[52:53] op_sel_hi:[1,0]
v_pk_mul_f32 v[238:239], v[238:239], v[52:53] op_sel_hi:[1,0]
CV v156, v232, v233
CV v157, v234, v235
CV v158, v236, v237
CV v159, v238, v239
s_mov_b32 s44, s86
s_mov_b32 s45, s87
s_mov_b32 s46, 4
s_mov_b32 s47, 0x20000
v_mov_b32 v5, 0
buffer_load_dword v6, v5, s[44:47], 0 offen sc1
s_waitcnt lgkmcnt(0)
MM v[160:163], v[64:67], v[80:83], 0
TR v[240:241], v1 offset:36864
TR v[242:243], v1 offset:38912
MM v[164:167], v[68:71], v[80:83], 0
ds_write_b128 v18, v[80:83] offset:0
MM v[168:171], v[72:75], v[80:83], 0
TR v[244:245], v2 offset:36864
TR v[246:247], v2 offset:38912
MM v[172:175], v[76:79], v[80:83], 0
ds_write_b128 v18, v[84:87] offset:1024
MM v[176:179], v[64:67], v[96:99], 0
TR v[248:249], v3 offset:36864
TR v[250:251], v3 offset:38912
MM v[180:183], v[68:71], v[96:99], 0
ds_write_b128 v18, v[88:91] offset:2048
MM v[184:187], v[72:75], v[96:99], 0
TR v[252:253], v4 offset:36864
TR v[254:255], v4 offset:38912
MM v[188:191], v[76:79], v[96:99], 0
ds_write_b128 v18, v[92:95] offset:3072
MM v[192:195], v[64:67], v[112:115], 0
ds_write_b128 v18, v[96:99] offset:4096
MM v[196:199], v[68:71], v[112:115], 0
ds_write_b128 v18, v[100:103] offset:5120
MM v[200:203], v[72:75], v[112:115], 0
ds_write_b128 v18, v[104:107] offset:6144
MM v[204:207], v[76:79], v[112:115], 0
ds_write_b128 v18, v[108:111] offset:7168
MM v[208:211], v[64:67], v[128:131], 0
ds_write_b128 v18, v[112:115] offset:8192
MM v[212:215], v[68:71], v[128:131], 0
ds_write_b128 v18, v[116:119] offset:9216
MM v[216:219], v[72:75], v[128:131], 0
ds_write_b128 v18, v[120:123] offset:10240
MM v[220:223], v[76:79], v[128:131], 0
ds_write_b128 v18, v[124:127] offset:11264
MM v[224:227], v[64:67], v[144:147], 0
ds_write_b128 v18, v[128:131] offset:12288
MM v[228:231], v[68:71], v[144:147], 0
ds_write_b128 v18, v[132:135] offset:13312
MM v[232:235], v[72:75], v[144:147], 0
ds_write_b128 v18, v[136:139] offset:14336
MM v[236:239], v[76:79], v[144:147], 0
s_waitcnt lgkmcnt(12)
ds_write_b128 v18, v[140:143] offset:15360
MM v[160:163], v[240:243], v[84:87], v[160:163]
s_waitcnt vmcnt(9)
s_barrier
s_mov_b32 s41, 0x80
MM v[164:167], v[244:247], v[84:87], v[164:167]
s_add_u32 m0, s28, 0x20000
s_add_u32 s30, s32, 0x20000
TR v[64:65], v1 offset:49152
MM v[168:171], v[248:251], v[84:87], v[168:171]
buffer_load_dwordx4 v17, s[20:23], s30 offen lds
MM v[172:175], v[252:255], v[84:87], v[172:175]
TR v[66:67], v1 offset:51200
TR v[68:69], v2 offset:49152
MM v[176:179], v[240:243], v[100:103], v[176:179]
s_add_u32 m0, s28, 0x21000
s_add_u32 s30, s32, 0x28000
MM v[180:183], v[244:247], v[100:103], v[180:183]
buffer_load_dwordx4 v17, s[20:23], s30 offen lds
MM v[184:187], v[248:251], v[100:103], v[184:187]
TR v[70:71], v2 offset:51200
TR v[72:73], v3 offset:49152
MM v[188:191], v[252:255], v[100:103], v[188:191]
s_add_u32 m0, s28, 0x20800
s_add_u32 s30, s32, 0x24000
MM v[192:195], v[240:243], v[116:119], v[192:195]
buffer_load_dwordx4 v17, s[20:23], s30 offen lds
MM v[196:199], v[244:247], v[116:119], v[196:199]
TR v[74:75], v3 offset:51200
TR v[76:77], v4 offset:49152
MM v[200:203], v[248:251], v[116:119], v[200:203]
s_add_u32 m0, s28, 0x21800
s_add_u32 s30, s32, 0x2c000
MM v[204:207], v[252:255], v[116:119], v[204:207]
TR v[78:79], v4 offset:51200
MM v[208:211], v[240:243], v[132:135], v[208:211]
buffer_load_dwordx4 v17, s[20:23], s30 offen lds
MM v[212:215], v[244:247], v[132:135], v[212:215]
buffer_load_dword v22, v23, s[20:23], s41 offen
MM v[216:219], v[248:251], v[132:135], v[216:219]
ds_write_b128 v18, v[144:147] offset:16384
MM v[220:223], v[252:255], v[132:135], v[220:223]
ds_write_b128 v18, v[148:151] offset:17408
MM v[224:227], v[240:243], v[148:151], v[224:227]
ds_write_b128 v18, v[152:155] offset:18432
MM v[228:231], v[244:247], v[148:151], v[228:231]
ds_write_b128 v18, v[156:159] offset:19456
MM v[232:235], v[248:251], v[148:151], v[232:235]
MM v[236:239], v[252:255], v[148:151], v[236:239]
s_waitcnt lgkmcnt(4)
MM v[160:163], v[64:67], v[88:91], v[160:163]
TR v[240:241], v1 offset:53248
TR v[242:243], v1 offset:55296
MM v[164:167], v[68:71], v[88:91], v[164:167]
MM v[168:171], v[72:75], v[88:91], v[168:171]
TR v[244:245], v2 offset:53248
TR v[246:247], v2 offset:55296
MM v[172:175], v[76:79], v[88:91], v[172:175]
MM v[176:179], v[64:67], v[104:107], v[176:179]
TR v[248:249], v3 offset:53248
TR v[250:251], v3 offset:55296
MM v[180:183], v[68:71], v[104:107], v[180:183]
MM v[184:187], v[72:75], v[104:107], v[184:187]
TR v[252:253], v4 offset:53248
TR v[254:255], v4 offset:55296
MM v[188:191], v[76:79], v[104:107], v[188:191]
MM v[192:195], v[64:67], v[120:123], v[192:195]
MM v[196:199], v[68:71], v[120:123], v[196:199]
MM v[200:203], v[72:75], v[120:123], v[200:203]
MM v[204:207], v[76:79], v[120:123], v[204:207]
MM v[208:211], v[64:67], v[136:139], v[208:211]
MM v[212:215], v[68:71], v[136:139], v[212:215]
MM v[216:219], v[72:75], v[136:139], v[216:219]
MM v[220:223], v[76:79], v[136:139], v[220:223]
MM v[224:227], v[64:67], v[152:155], v[224:227]
MM v[228:231], v[68:71], v[152:155], v[228:231]
MM v[232:235], v[72:75], v[152:155], v[232:235]
MM v[236:239], v[76:79], v[152:155], v[236:239]
s_waitcnt lgkmcnt(0)
MM v[160:163], v[240:243], v[92:95], v[160:163]
s_waitcnt vmcnt(10)
s_barrier
s_add_u32 m0, s28, 0x24000
MM v[164:167], v[244:247], v[92:95], v[164:167]
s_add_u32 s30, s32, 0x30000
buffer_load_dwordx4 v17, s[20:23], s30 offen lds
MM v[168:171], v[248:251], v[92:95], v[168:171]
TR v[64:65], v1 offset:0
TR v[66:67], v1 offset:2048
MM v[172:175], v[252:255], v[92:95], v[172:175]
s_add_u32 m0, s28, 0x25000
s_add_u32 s30, s32, 0x38000
MM v[176:179], v[240:243], v[108:111], v[176:179]
s_barrier
buffer_load_dwordx4 v17, s[20:23], s30 offen lds
MM v[180:183], v[244:247], v[108:111], v[180:183]
TR v[68:69], v2 offset:0
TR v[70:71], v2 offset:2048
MM v[184:187], v[248:251], v[108:111], v[184:187]
s_add_u32 m0, s28, 0x24800
s_add_u32 s30, s32, 0x34000
MM v[188:191], v[252:255], v[108:111], v[188:191]
buffer_load_dwordx4 v17, s[20:23], s30 offen lds
MM v[192:195], v[240:243], v[124:127], v[192:195]
TR v[72:73], v3 offset:0
TR v[74:75], v3 offset:2048
MM v[196:199], v[244:247], v[124:127], v[196:199]
s_add_u32 m0, s28, 0x25800
s_add_u32 s30, s32, 0x3c000
MM v[200:203], v[248:251], v[124:127], v[200:203]
buffer_load_dwordx4 v17, s[20:23], s30 offen lds
MM v[204:207], v[252:255], v[124:127], v[204:207]
TR v[76:77], v4 offset:0
TR v[78:79], v4 offset:2048
MM v[208:211], v[240:243], v[140:143], v[208:211]
MM v[212:215], v[244:247], v[140:143], v[212:215]
ds_read_b128 a[0:3], v19 offset:0
ds_read_b128 a[16:19], v19 offset:4096
MM v[216:219], v[248:251], v[140:143], v[216:219]
MM v[220:223], v[252:255], v[140:143], v[220:223]
ds_read_b128 a[32:35], v19 offset:8192
ds_read_b128 a[48:51], v19 offset:12288
MM v[224:227], v[240:243], v[156:159], v[224:227]
MM v[228:231], v[244:247], v[156:159], v[228:231]
ds_read_b128 a[64:67], v19 offset:16384
ds_read_b128 a[4:7], v19 offset:1024
MM v[232:235], v[248:251], v[156:159], v[232:235]
MM v[236:239], v[252:255], v[156:159], v[236:239]
s_waitcnt lgkmcnt(6)
ds_read_b128 a[20:23], v19 offset:5120
ds_read_b128 a[36:39], v19 offset:9216
MM v[160:163], v[64:67], a[144:147], v[160:163]
MM v[164:167], v[68:71], a[144:147], v[164:167]
TR v[240:241], v1 offset:4096
TR v[242:243], v1 offset:6144
MM v[168:171], v[72:75], a[144:147], v[168:171]
MM v[172:175], v[76:79], a[144:147], v[172:175]
TR v[244:245], v2 offset:4096
TR v[246:247], v2 offset:6144
MM v[176:179], v[64:67], a[160:163], v[176:179]
MM v[180:183], v[68:71], a[160:163], v[180:183]
TR v[248:249], v3 offset:4096
TR v[250:251], v3 offset:6144
MM v[184:187], v[72:75], a[160:163], v[184:187]
MM v[188:191], v[76:79], a[160:163], v[188:191]
TR v[252:253], v4 offset:4096
TR v[254:255], v4 offset:6144
MM v[192:195], v[64:67], a[176:179], v[192:195]
MM v[196:199], v[68:71], a[176:179], v[196:199]
ds_read_b128 a[52:55], v19 offset:13312
ds_read_b128 a[68:71], v19 offset:17408
MM v[200:203], v[72:75], a[176:179], v[200:203]
MM v[204:207], v[76:79], a[176:179], v[204:207]
ds_read_b128 a[8:11], v19 offset:2048
ds_read_b128 a[24:27], v19 offset:6144
MM v[208:211], v[64:67], a[192:195], v[208:211]
MM v[212:215], v[68:71], a[192:195], v[212:215]
ds_read_b128 a[40:43], v19 offset:10240
ds_read_b128 a[56:59], v19 offset:14336
MM v[216:219], v[72:75], a[192:195], v[216:219]
MM v[220:223], v[76:79], a[192:195], v[220:223]
ds_read_b128 a[72:75], v19 offset:18432
ds_read_b128 a[12:15], v19 offset:3072
MM v[224:227], v[64:67], a[208:211], v[224:227]
MM v[228:231], v[68:71], a[208:211], v[228:231]
ds_read_b128 a[28:31], v19 offset:7168
ds_read_b128 a[44:47], v19 offset:11264
MM v[232:235], v[72:75], a[208:211], v[232:235]
ds_read_b128 a[60:63], v19 offset:15360
ds_read_b128 a[76:79], v19 offset:19456
MM v[236:239], v[76:79], a[208:211], v[236:239]
s_waitcnt lgkmcnt(12)
MM v[160:163], v[240:243], a[148:151], v[160:163]
s_waitcnt vmcnt(10)
s_barrier
s_add_u32 m0, s28, 0x18000
MM v[164:167], v[244:247], a[148:151], v[164:167]
s_add_u32 s30, s32, 0x0
buffer_load_dwordx4 v17, s[20:23], s30 offen lds
MM v[168:171], v[248:251], a[148:151], v[168:171]
TR v[64:65], v1 offset:16384
TR v[66:67], v1 offset:18432
MM v[172:175], v[252:255], a[148:151], v[172:175]
s_add_u32 m0, s28, 0x19000
s_add_u32 s30, s32, 0x8000
MM v[176:179], v[240:243], a[164:167], v[176:179]
s_waitcnt lgkmcnt(2)
s_barrier
TR v[68:69], v2 offset:16384
MM v[180:183], v[244:247], a[164:167], v[180:183]
buffer_load_dwordx4 v17, s[20:23], s30 offen lds
MM v[184:187], v[248:251], a[164:167], v[184:187]
TR v[70:71], v2 offset:18432
TR v[72:73], v3 offset:16384
MM v[188:191], v[252:255], a[164:167], v[188:191]
s_add_u32 m0, s28, 0x18800
s_add_u32 s30, s32, 0x4000
MM v[192:195], v[240:243], a[180:183], v[192:195]
buffer_load_dwordx4 v17, s[20:23], s30 offen lds
MM v[196:199], v[244:247], a[180:183], v[196:199]
TR v[74:75], v3 offset:18432
TR v[76:77], v4 offset:16384
MM v[200:203], v[248:251], a[180:183], v[200:203]
s_add_u32 m0, s28, 0x19800
s_add_u32 s30, s32, 0xc000
MM v[204:207], v[252:255], a[180:183], v[204:207]
TR v[78:79], v4 offset:18432
MM v[208:211], v[240:243], a[196:199], v[208:211]
buffer_load_dwordx4 v17, s[20:23], s30 offen lds
MM v[212:215], v[244:247], a[196:199], v[212:215]
ds_write_b128 v18, a[144:147] offset:0
MM v[216:219], v[248:251], a[196:199], v[216:219]
ds_write_b128 v18, a[148:151] offset:1024
MM v[220:223], v[252:255], a[196:199], v[220:223]
ds_write_b128 v18, a[152:155] offset:2048
MM v[224:227], v[240:243], a[212:215], v[224:227]
ds_write_b128 v18, a[156:159] offset:3072
MM v[228:231], v[244:247], a[212:215], v[228:231]
ds_write_b128 v18, a[160:163] offset:4096
MM v[232:235], v[248:251], a[212:215], v[232:235]
ds_write_b128 v18, a[164:167] offset:5120
MM v[236:239], v[252:255], a[212:215], v[236:239]
s_waitcnt lgkmcnt(6)
ds_write_b128 v18, a[168:171] offset:6144
MM v[160:163], v[64:67], a[152:155], v[160:163]
TR v[240:241], v1 offset:20480
TR v[242:243], v1 offset:22528
MM v[164:167], v[68:71], a[152:155], v[164:167]
ds_write_b128 v18, a[172:175] offset:7168
MM v[168:171], v[72:75], a[152:155], v[168:171]
TR v[244:245], v2 offset:20480
TR v[246:247], v2 offset:22528
MM v[172:175], v[76:79], a[152:155], v[172:175]
ds_write_b128 v18, a[176:179] offset:8192
MM v[176:179], v[64:67], a[168:171], v[176:179]
TR v[248:249], v3 offset:20480
TR v[250:251], v3 offset:22528
MM v[180:183], v[68:71], a[168:171], v[180:183]
ds_write_b128 v18, a[180:183] offset:9216
MM v[184:187], v[72:75], a[168:171], v[184:187]
TR v[252:253], v4 offset:20480
TR v[254:255], v4 offset:22528
MM v[188:191], v[76:79], a[168:171], v[188:191]
ds_write_b128 v18, a[184:187] offset:10240
MM v[192:195], v[64:67], a[184:187], v[192:195]
ds_write_b128 v18, a[188:191] offset:11264
MM v[196:199], v[68:71], a[184:187], v[196:199]
ds_write_b128 v18, a[192:195] offset:12288
MM v[200:203], v[72:75], a[184:187], v[200:203]
ds_write_b128 v18, a[196:199] offset:13312
MM v[204:207], v[76:79], a[184:187], v[204:207]
ds_write_b128 v18, a[200:203] offset:14336
MM v[208:211], v[64:67], a[200:203], v[208:211]
ds_write_b128 v18, a[204:207] offset:15360
MM v[212:215], v[68:71], a[200:203], v[212:215]
ds_write_b128 v18, a[208:211] offset:16384
MM v[216:219], v[72:75], a[200:203], v[216:219]
ds_write_b128 v18, a[212:215] offset:17408
MM v[220:223], v[76:79], a[200:203], v[220:223]
ds_write_b128 v18, a[216:219] offset:18432
MM v[224:227], v[64:67], a[216:219], v[224:227]
ds_write_b128 v18, a[220:223] offset:19456
MM v[228:231], v[68:71], a[216:219], v[228:231]
MM v[232:235], v[72:75], a[216:219], v[232:235]
MM v[236:239], v[76:79], a[216:219], v[236:239]
s_waitcnt lgkmcnt(10)
MM v[160:163], v[240:243], a[156:159], v[160:163]
s_waitcnt vmcnt(9)
s_barrier
s_add_u32 m0, s28, 0x1c000
MM v[164:167], v[244:247], a[156:159], v[164:167]
s_add_u32 s30, s32, 0x10000
buffer_load_dwordx4 v17, s[20:23], s30 offen lds
MM v[168:171], v[248:251], a[156:159], v[168:171]
TR v[64:65], v1 offset:32768
TR v[66:67], v1 offset:34816
MM v[172:175], v[252:255], a[156:159], v[172:175]
s_add_u32 m0, s28, 0x1d000
s_add_u32 s30, s32, 0x18000
MM v[176:179], v[240:243], a[172:175], v[176:179]
buffer_load_dwordx4 v17, s[20:23], s30 offen lds
MM v[180:183], v[244:247], a[172:175], v[180:183]
TR v[68:69], v2 offset:32768
TR v[70:71], v2 offset:34816
MM v[184:187], v[248:251], a[172:175], v[184:187]
s_add_u32 m0, s28, 0x1c800
s_add_u32 s30, s32, 0x14000
MM v[188:191], v[252:255], a[172:175], v[188:191]
buffer_load_dwordx4 v17, s[20:23], s30 offen lds
MM v[192:195], v[240:243], a[188:191], v[192:195]
TR v[72:73], v3 offset:32768
TR v[74:75], v3 offset:34816
MM v[196:199], v[244:247], a[188:191], v[196:199]
s_add_u32 m0, s28, 0x1d800
s_add_u32 s30, s32, 0x1c000
MM v[200:203], v[248:251], a[188:191], v[200:203]
buffer_load_dwordx4 v17, s[20:23], s30 offen lds
MM v[204:207], v[252:255], a[188:191], v[204:207]
TR v[76:77], v4 offset:32768
TR v[78:79], v4 offset:34816
MM v[208:211], v[240:243], a[204:207], v[208:211]
MM v[212:215], v[244:247], a[204:207], v[212:215]
MM v[216:219], v[248:251], a[204:207], v[216:219]
MM v[220:223], v[252:255], a[204:207], v[220:223]
MM v[224:227], v[240:243], a[220:223], v[224:227]
MM v[228:231], v[244:247], a[220:223], v[228:231]
MM v[232:235], v[248:251], a[220:223], v[232:235]
MM v[236:239], v[252:255], a[220:223], v[236:239]
s_waitcnt lgkmcnt(0)
MM v[160:163], v[64:67], a[0:3], v[160:163]
TR v[240:241], v1 offset:36864
TR v[242:243], v1 offset:38912
MM v[164:167], v[68:71], a[0:3], v[164:167]
MM v[168:171], v[72:75], a[0:3], v[168:171]
TR v[244:245], v2 offset:36864
TR v[246:247], v2 offset:38912
MM v[172:175], v[76:79], a[0:3], v[172:175]
MM v[176:179], v[64:67], a[16:19], v[176:179]
TR v[248:249], v3 offset:36864
TR v[250:251], v3 offset:38912
MM v[180:183], v[68:71], a[16:19], v[180:183]
MM v[184:187], v[72:75], a[16:19], v[184:187]
TR v[252:253], v4 offset:36864
TR v[254:255], v4 offset:38912
MM v[188:191], v[76:79], a[16:19], v[188:191]
MM v[192:195], v[64:67], a[32:35], v[192:195]
MM v[196:199], v[68:71], a[32:35], v[196:199]
MM v[200:203], v[72:75], a[32:35], v[200:203]
s_cmp_lg_u32 s33, 0
s_cbranch_scc1 L_Yhso
v_readfirstlane_b32 s37, v6
s_nop 3
s_cmp_ge_u32 s37, 8
s_cbranch_scc1 L_Yhso
s_mov_b32 s40, 0x8000
L_Yhs:
buffer_load_dword v6, v5, s[44:47], 0 offen sc1
s_waitcnt vmcnt(0)
v_readfirstlane_b32 s37, v6
s_nop 3
s_sub_u32 s40, s40, 1
s_cbranch_scc1 L_Yhso
s_cmp_lt_u32 s37, 8
s_cbranch_scc1 L_Yhs
L_Yhso:
v_mov_b32 v6, 1
MM v[204:207], v[76:79], a[32:35], v[204:207]
MM v[208:211], v[64:67], a[48:51], v[208:211]
MM v[212:215], v[68:71], a[48:51], v[212:215]
MM v[216:219], v[72:75], a[48:51], v[216:219]
MM v[220:223], v[76:79], a[48:51], v[220:223]
MM v[224:227], v[64:67], a[64:67], v[224:227]
MM v[228:231], v[68:71], a[64:67], v[228:231]
MM v[232:235], v[72:75], a[64:67], v[232:235]
MM v[236:239], v[76:79], a[64:67], v[236:239]
s_waitcnt lgkmcnt(0)
MM v[160:163], v[240:243], a[4:7], v[160:163]
s_waitcnt vmcnt(8)
s_barrier
s_add_u32 m0, s28, 0x20000
MM v[164:167], v[244:247], a[4:7], v[164:167]
s_add_u32 s30, s31, 0x20080
buffer_load_dwordx4 v17, s[20:23], s30 offen lds
MM v[168:171], v[248:251], a[4:7], v[168:171]
TR v[64:65], v1 offset:49152
TR v[66:67], v1 offset:51200
MM v[172:175], v[252:255], a[4:7], v[172:175]
s_add_u32 m0, s28, 0x21000
s_add_u32 s30, s31, 0x28080
MM v[176:179], v[240:243], a[20:23], v[176:179]
s_barrier
buffer_load_dwordx4 v17, s[20:23], s30 offen lds
MM v[180:183], v[244:247], a[20:23], v[180:183]
TR v[68:69], v2 offset:49152
TR v[70:71], v2 offset:51200
MM v[184:187], v[248:251], a[20:23], v[184:187]
s_add_u32 m0, s28, 0x20800
s_add_u32 s30, s31, 0x24080
MM v[188:191], v[252:255], a[20:23], v[188:191]
buffer_load_dwordx4 v17, s[20:23], s30 offen lds
MM v[192:195], v[240:243], a[36:39], v[192:195]
TR v[72:73], v3 offset:49152
TR v[74:75], v3 offset:51200
MM v[196:199], v[244:247], a[36:39], v[196:199]
s_add_u32 m0, s28, 0x21800
s_add_u32 s30, s31, 0x2c080
MM v[200:203], v[248:251], a[36:39], v[200:203]
buffer_load_dwordx4 v17, s[20:23], s30 offen lds
MM v[204:207], v[252:255], a[36:39], v[204:207]
TR v[76:77], v4 offset:49152
TR v[78:79], v4 offset:51200
MM v[208:211], v[240:243], a[52:55], v[208:211]
MM v[212:215], v[244:247], a[52:55], v[212:215]
ds_read_b128 a[80:83], v19 offset:0
ds_read_b128 a[96:99], v19 offset:4096
MM v[216:219], v[248:251], a[52:55], v[216:219]
MM v[220:223], v[252:255], a[52:55], v[220:223]
ds_read_b128 a[112:115], v19 offset:8192
ds_read_b128 a[128:131], v19 offset:12288
MM v[224:227], v[240:243], a[68:71], v[224:227]
MM v[228:231], v[244:247], a[68:71], v[228:231]
ds_read_b128 a[224:227], v19 offset:16384
ds_read_b128 a[84:87], v19 offset:1024
MM v[232:235], v[248:251], a[68:71], v[232:235]
MM v[236:239], v[252:255], a[68:71], v[236:239]
s_waitcnt lgkmcnt(6)
ds_read_b128 a[100:103], v19 offset:5120
ds_read_b128 a[116:119], v19 offset:9216
MM v[160:163], v[64:67], a[8:11], v[160:163]
MM v[164:167], v[68:71], a[8:11], v[164:167]
TR v[240:241], v1 offset:53248
TR v[242:243], v1 offset:55296
MM v[168:171], v[72:75], a[8:11], v[168:171]
MM v[172:175], v[76:79], a[8:11], v[172:175]
TR v[244:245], v2 offset:53248
TR v[246:247], v2 offset:55296
MM v[176:179], v[64:67], a[24:27], v[176:179]
MM v[180:183], v[68:71], a[24:27], v[180:183]
TR v[248:249], v3 offset:53248
TR v[250:251], v3 offset:55296
MM v[184:187], v[72:75], a[24:27], v[184:187]
MM v[188:191], v[76:79], a[24:27], v[188:191]
TR v[252:253], v4 offset:53248
TR v[254:255], v4 offset:55296
MM v[192:195], v[64:67], a[40:43], v[192:195]
MM v[196:199], v[68:71], a[40:43], v[196:199]
ds_read_b128 a[132:135], v19 offset:13312
ds_read_b128 a[228:231], v19 offset:17408
MM v[200:203], v[72:75], a[40:43], v[200:203]
MM v[204:207], v[76:79], a[40:43], v[204:207]
ds_read_b128 a[88:91], v19 offset:2048
ds_read_b128 a[104:107], v19 offset:6144
MM v[208:211], v[64:67], a[56:59], v[208:211]
MM v[212:215], v[68:71], a[56:59], v[212:215]
ds_read_b128 a[120:123], v19 offset:10240
ds_read_b128 a[136:139], v19 offset:14336
MM v[216:219], v[72:75], a[56:59], v[216:219]
MM v[220:223], v[76:79], a[56:59], v[220:223]
ds_read_b128 a[232:235], v19 offset:18432
ds_read_b128 a[92:95], v19 offset:3072
MM v[224:227], v[64:67], a[72:75], v[224:227]
ds_read_b128 a[108:111], v19 offset:7168
ds_read_b128 a[124:127], v19 offset:11264
ds_read_b128 a[140:143], v19 offset:15360
ds_read_b128 a[236:239], v19 offset:19456
MM v[228:231], v[68:71], a[72:75], v[228:231]
MM v[232:235], v[72:75], a[72:75], v[232:235]
MM v[236:239], v[76:79], a[72:75], v[236:239]
s_waitcnt lgkmcnt(12)
MM v[160:163], v[240:243], a[12:15], v[160:163]
s_waitcnt vmcnt(8)
s_barrier
s_add_u32 m0, s28, 0x24000
MM v[164:167], v[244:247], a[12:15], v[164:167]
s_add_u32 s30, s31, 0x30080
buffer_load_dwordx4 v17, s[20:23], s30 offen lds
MM v[168:171], v[248:251], a[12:15], v[168:171]
TR v[64:65], v1 offset:0
TR v[66:67], v1 offset:2048
MM v[172:175], v[252:255], a[12:15], v[172:175]
s_add_u32 m0, s28, 0x25000
s_add_u32 s30, s31, 0x38080
MM v[176:179], v[240:243], a[28:31], v[176:179]
buffer_load_dwordx4 v17, s[20:23], s30 offen lds
MM v[180:183], v[244:247], a[28:31], v[180:183]
TR v[68:69], v2 offset:0
TR v[70:71], v2 offset:2048
MM v[184:187], v[248:251], a[28:31], v[184:187]
s_add_u32 m0, s28, 0x24800
s_add_u32 s30, s31, 0x34080
MM v[188:191], v[252:255], a[28:31], v[188:191]
buffer_load_dwordx4 v17, s[20:23], s30 offen lds
MM v[192:195], v[240:243], a[44:47], v[192:195]
TR v[72:73], v3 offset:0
TR v[74:75], v3 offset:2048
MM v[196:199], v[244:247], a[44:47], v[196:199]
s_add_u32 m0, s28, 0x25800
s_add_u32 s30, s31, 0x3c080
MM v[200:203], v[248:251], a[44:47], v[200:203]
buffer_load_dwordx4 v17, s[20:23], s30 offen lds
MM v[204:207], v[252:255], a[44:47], v[204:207]
TR v[76:77], v4 offset:0
TR v[78:79], v4 offset:2048
MM v[208:211], v[240:243], a[60:63], v[208:211]
MM v[212:215], v[244:247], a[60:63], v[212:215]
MM v[216:219], v[248:251], a[60:63], v[216:219]
MM v[220:223], v[252:255], a[60:63], v[220:223]
MM v[224:227], v[240:243], a[76:79], v[224:227]
MM v[228:231], v[244:247], a[76:79], v[228:231]
s_waitcnt lgkmcnt(8)
MM v[232:235], v[248:251], a[76:79], v[232:235]
MM v[236:239], v[252:255], a[76:79], v[236:239]
s_mov_b32 s96, 3
L_YP:
s_add_u32 s31, s31, 0x80
s_add_u32 s32, s32, 0x80
s_add_u32 s49, s49, 0x2800
s_add_u32 s40, s40, 0x80
s_add_u32 s73, s73, 0x80
s_and_b32 s73, s73, 0x3ff
s_waitcnt lgkmcnt(0)
MM v[160:163], v[64:67], a[80:83], v[160:163]
TR v[240:241], v1 offset:4096
TR v[242:243], v1 offset:6144
MM v[164:167], v[68:71], a[80:83], v[164:167]
MM v[168:171], v[72:75], a[80:83], v[168:171]
TR v[244:245], v2 offset:4096
TR v[246:247], v2 offset:6144
MM v[172:175], v[76:79], a[80:83], v[172:175]
MM v[176:179], v[64:67], a[96:99], v[176:179]
TR v[248:249], v3 offset:4096
TR v[250:251], v3 offset:6144
MM v[180:183], v[68:71], a[96:99], v[180:183]
MM v[184:187], v[72:75], a[96:99], v[184:187]
TR v[252:253], v4 offset:4096
TR v[254:255], v4 offset:6144
MM v[188:191], v[76:79], a[96:99], v[188:191]
MM v[192:195], v[64:67], a[112:115], v[192:195]
MM v[196:199], v[68:71], a[112:115], v[196:199]
MM v[200:203], v[72:75], a[112:115], v[200:203]
MM v[204:207], v[76:79], a[112:115], v[204:207]
MM v[208:211], v[64:67], a[128:131], v[208:211]
MM v[212:215], v[68:71], a[128:131], v[212:215]
MM v[216:219], v[72:75], a[128:131], v[216:219]
MM v[220:223], v[76:79], a[128:131], v[220:223]
MM v[224:227], v[64:67], a[224:227], v[224:227]
MM v[228:231], v[68:71], a[224:227], v[228:231]
MM v[232:235], v[72:75], a[224:227], v[232:235]
MM v[236:239], v[76:79], a[224:227], v[236:239]
s_waitcnt lgkmcnt(0)
MM v[160:163], v[240:243], a[84:87], v[160:163]
s_waitcnt vmcnt(8)
s_barrier
s_add_u32 m0, s28, 0x18000
MM v[164:167], v[244:247], a[84:87], v[164:167]
s_add_u32 s30, s31, 0x0
buffer_load_dwordx4 v17, s[20:23], s30 offen lds
MM v[168:171], v[248:251], a[84:87], v[168:171]
TR v[64:65], v1 offset:16384
TR v[66:67], v1 offset:18432
MM v[172:175], v[252:255], a[84:87], v[172:175]
s_add_u32 m0, s28, 0x19000
s_add_u32 s30, s31, 0x8000
MM v[176:179], v[240:243], a[100:103], v[176:179]
buffer_load_dwordx4 v17, s[20:23], s30 offen lds
MM v[180:183], v[244:247], a[100:103], v[180:183]
TR v[68:69], v2 offset:16384
TR v[70:71], v2 offset:18432
MM v[184:187], v[248:251], a[100:103], v[184:187]
s_add_u32 m0, s28, 0x18800
s_add_u32 s30, s31, 0x4000
MM v[188:191], v[252:255], a[100:103], v[188:191]
buffer_load_dwordx4 v17, s[20:23], s30 offen lds
MM v[192:195], v[240:243], a[116:119], v[192:195]
TR v[72:73], v3 offset:16384
TR v[74:75], v3 offset:18432
MM v[196:199], v[244:247], a[116:119], v[196:199]
s_add_u32 m0, s28, 0x19800
s_add_u32 s30, s31, 0xc000
MM v[200:203], v[248:251], a[116:119], v[200:203]
buffer_load_dwordx4 v17, s[20:23], s30 offen lds
MM v[204:207], v[252:255], a[116:119], v[204:207]
TR v[76:77], v4 offset:16384
TR v[78:79], v4 offset:18432
MM v[208:211], v[240:243], a[132:135], v[208:211]
MM v[212:215], v[244:247], a[132:135], v[212:215]
MM v[216:219], v[248:251], a[132:135], v[216:219]
MM v[220:223], v[252:255], a[132:135], v[220:223]
MM v[224:227], v[240:243], a[228:231], v[224:227]
MM v[228:231], v[244:247], a[228:231], v[228:231]
MM v[232:235], v[248:251], a[228:231], v[232:235]
MM v[236:239], v[252:255], a[228:231], v[236:239]
s_waitcnt lgkmcnt(0)
MM v[160:163], v[64:67], a[88:91], v[160:163]
TR v[240:241], v1 offset:20480
TR v[242:243], v1 offset:22528
MM v[164:167], v[68:71], a[88:91], v[164:167]
MM v[168:171], v[72:75], a[88:91], v[168:171]
TR v[244:245], v2 offset:20480
TR v[246:247], v2 offset:22528
MM v[172:175], v[76:79], a[88:91], v[172:175]
MM v[176:179], v[64:67], a[104:107], v[176:179]
TR v[248:249], v3 offset:20480
TR v[250:251], v3 offset:22528
MM v[180:183], v[68:71], a[104:107], v[180:183]
MM v[184:187], v[72:75], a[104:107], v[184:187]
TR v[252:253], v4 offset:20480
TR v[254:255], v4 offset:22528
MM v[188:191], v[76:79], a[104:107], v[188:191]
MM v[192:195], v[64:67], a[120:123], v[192:195]
MM v[196:199], v[68:71], a[120:123], v[196:199]
MM v[200:203], v[72:75], a[120:123], v[200:203]
MM v[204:207], v[76:79], a[120:123], v[204:207]
MM v[208:211], v[64:67], a[136:139], v[208:211]
MM v[212:215], v[68:71], a[136:139], v[212:215]
MM v[216:219], v[72:75], a[136:139], v[216:219]
MM v[220:223], v[76:79], a[136:139], v[220:223]
MM v[224:227], v[64:67], a[232:235], v[224:227]
MM v[228:231], v[68:71], a[232:235], v[228:231]
MM v[232:235], v[72:75], a[232:235], v[232:235]
MM v[236:239], v[76:79], a[232:235], v[236:239]
s_waitcnt lgkmcnt(0)
MM v[160:163], v[240:243], a[92:95], v[160:163]
s_waitcnt vmcnt(8)
s_barrier
s_add_u32 s41, s40, 0x80
MM v[164:167], v[244:247], a[92:95], v[164:167]
s_add_u32 m0, s28, 0x1c000
s_add_u32 s30, s31, 0x10000
TR v[64:65], v1 offset:32768
MM v[168:171], v[248:251], a[92:95], v[168:171]
s_waitcnt vmcnt(8)
s_barrier
s_cmp_lg_u32 s33, 0
s_cbranch_scc1 L_YsgL
s_mov_b64 exec, 1
buffer_atomic_add v6, v5, s[80:83], s73 offen
s_mov_b64 exec, -1
L_YsgL:
MM v[172:175], v[252:255], a[92:95], v[172:175]
buffer_load_dwordx4 v17, s[20:23], s30 offen lds
MM v[176:179], v[240:243], a[108:111], v[176:179]
TR v[66:67], v1 offset:34816
TR v[68:69], v2 offset:32768
MM v[180:183], v[244:247], a[108:111], v[180:183]
s_add_u32 m0, s28, 0x1d000
s_add_u32 s30, s31, 0x18000
CV v24, v160, v161
MM v[184:187], v[248:251], a[108:111], v[184:187]
buffer_load_dwordx4 v17, s[20:23], s30 offen lds
MM v[188:191], v[252:255], a[108:111], v[188:191]
TR v[70:71], v2 offset:34816
TR v[72:73], v3 offset:32768
MM v[192:195], v[240:243], a[124:127], v[192:195]
s_add_u32 m0, s28, 0x1c800
s_add_u32 s30, s31, 0x14000
CV v25, v162, v163
MM v[196:199], v[244:247], a[124:127], v[196:199]
buffer_load_dwordx4 v17, s[20:23], s30 offen lds
MM v[200:203], v[248:251], a[124:127], v[200:203]
TR v[74:75], v3 offset:34816
TR v[76:77], v4 offset:32768
MM v[204:207], v[252:255], a[124:127], v[204:207]
s_add_u32 m0, s28, 0x1d800
s_add_u32 s30, s31, 0x1c000
TR v[78:79], v4 offset:34816
MM v[208:211], v[240:243], a[140:143], v[208:211]
buffer_load_dwordx4 v17, s[20:23], s30 offen lds
MM v[212:215], v[244:247], a[140:143], v[212:215]
CV v26, v164, v165
CV v27, v166, v167
MM v[216:219], v[248:251], a[140:143], v[216:219]
CV v28, v168, v169
CV v29, v170, v171
MM v[220:223], v[252:255], a[140:143], v[220:223]
CV v30, v172, v173
CV v31, v174, v175
MM v[224:227], v[240:243], a[236:239], v[224:227]
buffer_load_dword v22, v23, s[20:23], s41 offen
MM v[228:231], v[244:247], a[236:239], v[228:231]
CV v32, v176, v177
CV v33, v178, v179
MM v[232:235], v[248:251], a[236:239], v[232:235]
CV v34, v180, v181
CV v35, v182, v183
MM v[236:239], v[252:255], a[236:239], v[236:239]
s_waitcnt lgkmcnt(0)
CV v36, v184, v185
CV v37, v186, v187
MM v[160:163], v[64:67], v[80:83], 0
TR v[240:241], v1 offset:36864
CV v38, v188, v189
MM v[164:167], v[68:71], v[80:83], 0
TR v[242:243], v1 offset:38912
CV v39, v190, v191
MM v[168:171], v[72:75], v[80:83], 0
TR v[244:245], v2 offset:36864
CV v40, v192, v193
MM v[172:175], v[76:79], v[80:83], 0
TR v[246:247], v2 offset:38912
CV v41, v194, v195
MM v[176:179], v[64:67], v[96:99], 0
TR v[248:249], v3 offset:36864
CV v42, v196, v197
MM v[180:183], v[68:71], v[96:99], 0
TR v[250:251], v3 offset:38912
CV v43, v198, v199
MM v[184:187], v[72:75], v[96:99], 0
TR v[252:253], v4 offset:36864
CV v44, v200, v201
MM v[188:191], v[76:79], v[96:99], 0
TR v[254:255], v4 offset:38912
CV v45, v202, v203
MM v[192:195], v[64:67], v[112:115], 0
CV v46, v204, v205
CV v47, v206, v207
MM v[196:199], v[68:71], v[112:115], 0
CV v48, v208, v209
CV v49, v210, v211
MM v[200:203], v[72:75], v[112:115], 0
CV v50, v212, v213
CV v51, v214, v215
MM v[204:207], v[76:79], v[112:115], 0
CV v52, v216, v217
CV v53, v218, v219
MM v[208:211], v[64:67], v[128:131], 0
CV v54, v220, v221
CV v55, v222, v223
MM v[212:215], v[68:71], v[128:131], 0
CV v56, v224, v225
CV v57, v226, v227
MM v[216:219], v[72:75], v[128:131], 0
CV v58, v228, v229
CV v59, v230, v231
MM v[220:223], v[76:79], v[128:131], 0
CV v60, v232, v233
CV v61, v234, v235
MM v[224:227], v[64:67], v[144:147], 0
CV v62, v236, v237
CV v63, v238, v239
MM v[228:231], v[68:71], v[144:147], 0
MM v[232:235], v[72:75], v[144:147], 0
MM v[236:239], v[76:79], v[144:147], 0
s_waitcnt lgkmcnt(0)
MM v[160:163], v[240:243], v[84:87], v[160:163]
s_waitcnt vmcnt(9)
s_barrier
s_add_u32 s37, s49, 0xffffd800
MM v[164:167], v[244:247], v[84:87], v[164:167]
s_add_u32 m0, s28, 0x20000
s_add_u32 s30, s32, 0x20000
TR v[64:65], v1 offset:49152
MM v[168:171], v[248:251], v[84:87], v[168:171]
buffer_load_dwordx4 v17, s[20:23], s30 offen lds
MM v[172:175], v[252:255], v[84:87], v[172:175]
TR v[66:67], v1 offset:51200
TR v[68:69], v2 offset:49152
MM v[176:179], v[240:243], v[100:103], v[176:179]
s_add_u32 m0, s28, 0x21000
s_add_u32 s30, s32, 0x28000
MM v[180:183], v[244:247], v[100:103], v[180:183]
buffer_load_dwordx4 v17, s[20:23], s30 offen lds
MM v[184:187], v[248:251], v[100:103], v[184:187]
TR v[70:71], v2 offset:51200
TR v[72:73], v3 offset:49152
MM v[188:191], v[252:255], v[100:103], v[188:191]
s_add_u32 m0, s28, 0x20800
s_add_u32 s30, s32, 0x24000
MM v[192:195], v[240:243], v[116:119], v[192:195]
buffer_load_dwordx4 v17, s[20:23], s30 offen lds
MM v[196:199], v[244:247], v[116:119], v[196:199]
TR v[74:75], v3 offset:51200
TR v[76:77], v4 offset:49152
MM v[200:203], v[248:251], v[116:119], v[200:203]
s_add_u32 m0, s28, 0x21800
s_add_u32 s30, s32, 0x2c000
MM v[204:207], v[252:255], v[116:119], v[204:207]
TR v[78:79], v4 offset:51200
MM v[208:211], v[240:243], v[132:135], v[208:211]
buffer_store_dwordx4 v[24:27], v20, s[24:27], s37 offen sc1
MM v[212:215], v[244:247], v[132:135], v[212:215]
buffer_load_dwordx4 v17, s[20:23], s30 offen lds
MM v[216:219], v[248:251], v[132:135], v[216:219]
MM v[220:223], v[252:255], v[132:135], v[220:223]
MM v[224:227], v[240:243], v[148:151], v[224:227]
MM v[228:231], v[244:247], v[148:151], v[228:231]
MM v[232:235], v[248:251], v[148:151], v[232:235]
s_add_u32 s37, s49, 0xffffdc00
buffer_store_dwordx4 v[28:31], v20, s[24:27], s37 offen sc1
MM v[236:239], v[252:255], v[148:151], v[236:239]
s_waitcnt lgkmcnt(0)
MM v[160:163], v[64:67], v[88:91], v[160:163]
TR v[240:241], v1 offset:53248
TR v[242:243], v1 offset:55296
MM v[164:167], v[68:71], v[88:91], v[164:167]
MM v[168:171], v[72:75], v[88:91], v[168:171]
TR v[244:245], v2 offset:53248
TR v[246:247], v2 offset:55296
MM v[172:175], v[76:79], v[88:91], v[172:175]
MM v[176:179], v[64:67], v[104:107], v[176:179]
TR v[248:249], v3 offset:53248
TR v[250:251], v3 offset:55296
MM v[180:183], v[68:71], v[104:107], v[180:183]
MM v[184:187], v[72:75], v[104:107], v[184:187]
TR v[252:253], v4 offset:53248
TR v[254:255], v4 offset:55296
MM v[188:191], v[76:79], v[104:107], v[188:191]
MM v[192:195], v[64:67], v[120:123], v[192:195]
MM v[196:199], v[68:71], v[120:123], v[196:199]
MM v[200:203], v[72:75], v[120:123], v[200:203]
MM v[204:207], v[76:79], v[120:123], v[204:207]
MM v[208:211], v[64:67], v[136:139], v[208:211]
MM v[212:215], v[68:71], v[136:139], v[212:215]
MM v[216:219], v[72:75], v[136:139], v[216:219]
MM v[220:223], v[76:79], v[136:139], v[220:223]
MM v[224:227], v[64:67], v[152:155], v[224:227]
s_add_u32 s37, s49, 0xffffe000
buffer_store_dwordx4 v[32:35], v20, s[24:27], s37 offen sc1
MM v[228:231], v[68:71], v[152:155], v[228:231]
MM v[232:235], v[72:75], v[152:155], v[232:235]
MM v[236:239], v[76:79], v[152:155], v[236:239]
s_waitcnt lgkmcnt(0)
MM v[160:163], v[240:243], v[92:95], v[160:163]
s_waitcnt vmcnt(12)
s_barrier
s_add_u32 m0, s28, 0x24000
MM v[164:167], v[244:247], v[92:95], v[164:167]
s_add_u32 s30, s32, 0x30000
buffer_load_dwordx4 v17, s[20:23], s30 offen lds
MM v[168:171], v[248:251], v[92:95], v[168:171]
TR v[64:65], v1 offset:0
TR v[66:67], v1 offset:2048
MM v[172:175], v[252:255], v[92:95], v[172:175]
s_add_u32 m0, s28, 0x25000
s_add_u32 s30, s32, 0x38000
MM v[176:179], v[240:243], v[108:111], v[176:179]
buffer_load_dwordx4 v17, s[20:23], s30 offen lds
MM v[180:183], v[244:247], v[108:111], v[180:183]
TR v[68:69], v2 offset:0
TR v[70:71], v2 offset:2048
MM v[184:187], v[248:251], v[108:111], v[184:187]
s_add_u32 m0, s28, 0x24800
s_add_u32 s30, s32, 0x34000
MM v[188:191], v[252:255], v[108:111], v[188:191]
buffer_load_dwordx4 v17, s[20:23], s30 offen lds
MM v[192:195], v[240:243], v[124:127], v[192:195]
TR v[72:73], v3 offset:0
TR v[74:75], v3 offset:2048
MM v[196:199], v[244:247], v[124:127], v[196:199]
s_add_u32 m0, s28, 0x25800
s_add_u32 s30, s32, 0x3c000
MM v[200:203], v[248:251], v[124:127], v[200:203]
buffer_load_dwordx4 v17, s[20:23], s30 offen lds
MM v[204:207], v[252:255], v[124:127], v[204:207]
TR v[76:77], v4 offset:0
TR v[78:79], v4 offset:2048
MM v[208:211], v[240:243], v[140:143], v[208:211]
MM v[212:215], v[244:247], v[140:143], v[212:215]
MM v[216:219], v[248:251], v[140:143], v[216:219]
s_add_u32 s37, s49, 0xffffe400
buffer_store_dwordx4 v[36:39], v20, s[24:27], s37 offen sc1
MM v[220:223], v[252:255], v[140:143], v[220:223]
MM v[224:227], v[240:243], v[156:159], v[224:227]
MM v[228:231], v[244:247], v[156:159], v[228:231]
MM v[232:235], v[248:251], v[156:159], v[232:235]
MM v[236:239], v[252:255], v[156:159], v[236:239]
s_waitcnt lgkmcnt(0)
MM v[160:163], v[64:67], a[144:147], v[160:163]
TR v[240:241], v1 offset:4096
TR v[242:243], v1 offset:6144
MM v[164:167], v[68:71], a[144:147], v[164:167]
MM v[168:171], v[72:75], a[144:147], v[168:171]
TR v[244:245], v2 offset:4096
TR v[246:247], v2 offset:6144
MM v[172:175], v[76:79], a[144:147], v[172:175]
MM v[176:179], v[64:67], a[160:163], v[176:179]
TR v[248:249], v3 offset:4096
TR v[250:251], v3 offset:6144
MM v[180:183], v[68:71], a[160:163], v[180:183]
MM v[184:187], v[72:75], a[160:163], v[184:187]
TR v[252:253], v4 offset:4096
TR v[254:255], v4 offset:6144
MM v[188:191], v[76:79], a[160:163], v[188:191]
MM v[192:195], v[64:67], a[176:179], v[192:195]
MM v[196:199], v[68:71], a[176:179], v[196:199]
MM v[200:203], v[72:75], a[176:179], v[200:203]
MM v[204:207], v[76:79], a[176:179], v[204:207]
MM v[208:211], v[64:67], a[192:195], v[208:211]
s_add_u32 s37, s49, 0xffffe800
buffer_store_dwordx4 v[40:43], v20, s[24:27], s37 offen sc1
MM v[212:215], v[68:71], a[192:195], v[212:215]
MM v[216:219], v[72:75], a[192:195], v[216:219]
MM v[220:223], v[76:79], a[192:195], v[220:223]
MM v[224:227], v[64:67], a[208:211], v[224:227]
MM v[228:231], v[68:71], a[208:211], v[228:231]
MM v[232:235], v[72:75], a[208:211], v[232:235]
MM v[236:239], v[76:79], a[208:211], v[236:239]
s_waitcnt lgkmcnt(0)
MM v[160:163], v[240:243], a[148:151], v[160:163]
s_waitcnt vmcnt(14)
s_barrier
s_add_u32 m0, s28, 0x18000
MM v[164:167], v[244:247], a[148:151], v[164:167]
s_add_u32 s30, s32, 0x0
buffer_load_dwordx4 v17, s[20:23], s30 offen lds
MM v[168:171], v[248:251], a[148:151], v[168:171]
TR v[64:65], v1 offset:16384
TR v[66:67], v1 offset:18432
MM v[172:175], v[252:255], a[148:151], v[172:175]
s_add_u32 m0, s28, 0x19000
s_add_u32 s30, s32, 0x8000
MM v[176:179], v[240:243], a[164:167], v[176:179]
buffer_load_dwordx4 v17, s[20:23], s30 offen lds
MM v[180:183], v[244:247], a[164:167], v[180:183]
TR v[68:69], v2 offset:16384
TR v[70:71], v2 offset:18432
MM v[184:187], v[248:251], a[164:167], v[184:187]
s_add_u32 m0, s28, 0x18800
s_add_u32 s30, s32, 0x4000
MM v[188:191], v[252:255], a[164:167], v[188:191]
buffer_load_dwordx4 v17, s[20:23], s30 offen lds
MM v[192:195], v[240:243], a[180:183], v[192:195]
TR v[72:73], v3 offset:16384
TR v[74:75], v3 offset:18432
MM v[196:199], v[244:247], a[180:183], v[196:199]
s_add_u32 m0, s28, 0x19800
s_add_u32 s30, s32, 0xc000
MM v[200:203], v[248:251], a[180:183], v[200:203]
s_add_u32 s37, s49, 0xffffec00
buffer_load_dwordx4 v17, s[20:23], s30 offen lds
MM v[204:207], v[252:255], a[180:183], v[204:207]
TR v[76:77], v4 offset:16384
TR v[78:79], v4 offset:18432
MM v[208:211], v[240:243], a[196:199], v[208:211]
buffer_store_dwordx4 v[44:47], v20, s[24:27], s37 offen sc1
MM v[212:215], v[244:247], a[196:199], v[212:215]
MM v[216:219], v[248:251], a[196:199], v[216:219]
MM v[220:223], v[252:255], a[196:199], v[220:223]
MM v[224:227], v[240:243], a[212:215], v[224:227]
MM v[228:231], v[244:247], a[212:215], v[228:231]
MM v[232:235], v[248:251], a[212:215], v[232:235]
MM v[236:239], v[252:255], a[212:215], v[236:239]
s_waitcnt lgkmcnt(0)
MM v[160:163], v[64:67], a[152:155], v[160:163]
TR v[240:241], v1 offset:20480
TR v[242:243], v1 offset:22528
MM v[164:167], v[68:71], a[152:155], v[164:167]
MM v[168:171], v[72:75], a[152:155], v[168:171]
TR v[244:245], v2 offset:20480
TR v[246:247], v2 offset:22528
MM v[172:175], v[76:79], a[152:155], v[172:175]
MM v[176:179], v[64:67], a[168:171], v[176:179]
TR v[248:249], v3 offset:20480
TR v[250:251], v3 offset:22528
MM v[180:183], v[68:71], a[168:171], v[180:183]
MM v[184:187], v[72:75], a[168:171], v[184:187]
TR v[252:253], v4 offset:20480
TR v[254:255], v4 offset:22528
MM v[188:191], v[76:79], a[168:171], v[188:191]
MM v[192:195], v[64:67], a[184:187], v[192:195]
s_add_u32 s37, s49, 0xfffff000
buffer_store_dwordx4 v[48:51], v20, s[24:27], s37 offen sc1
MM v[196:199], v[68:71], a[184:187], v[196:199]
MM v[200:203], v[72:75], a[184:187], v[200:203]
MM v[204:207], v[76:79], a[184:187], v[204:207]
MM v[208:211], v[64:67], a[200:203], v[208:211]
MM v[212:215], v[68:71], a[200:203], v[212:215]
MM v[216:219], v[72:75], a[200:203], v[216:219]
MM v[220:223], v[76:79], a[200:203], v[220:223]
MM v[224:227], v[64:67], a[216:219], v[224:227]
MM v[228:231], v[68:71], a[216:219], v[228:231]
MM v[232:235], v[72:75], a[216:219], v[232:235]
MM v[236:239], v[76:79], a[216:219], v[236:239]
s_waitcnt lgkmcnt(0)
MM v[160:163], v[240:243], a[156:159], v[160:163]
s_waitcnt vmcnt(14)
s_barrier
s_add_u32 m0, s28, 0x1c000
MM v[164:167], v[244:247], a[156:159], v[164:167]
s_add_u32 s30, s32, 0x10000
buffer_load_dwordx4 v17, s[20:23], s30 offen lds
MM v[168:171], v[248:251], a[156:159], v[168:171]
TR v[64:65], v1 offset:32768
TR v[66:67], v1 offset:34816
MM v[172:175], v[252:255], a[156:159], v[172:175]
s_add_u32 m0, s28, 0x1d000
s_add_u32 s30, s32, 0x18000
MM v[176:179], v[240:243], a[172:175], v[176:179]
buffer_load_dwordx4 v17, s[20:23], s30 offen lds
MM v[180:183], v[244:247], a[172:175], v[180:183]
TR v[68:69], v2 offset:32768
TR v[70:71], v2 offset:34816
MM v[184:187], v[248:251], a[172:175], v[184:187]
s_add_u32 m0, s28, 0x1c800
s_add_u32 s30, s32, 0x14000
s_add_u32 s37, s49, 0xfffff400
MM v[188:191], v[252:255], a[172:175], v[188:191]
buffer_load_dwordx4 v17, s[20:23], s30 offen lds
MM v[192:195], v[240:243], a[188:191], v[192:195]
TR v[72:73], v3 offset:32768
TR v[74:75], v3 offset:34816
MM v[196:199], v[244:247], a[188:191], v[196:199]
s_add_u32 m0, s28, 0x1d800
s_add_u32 s30, s32, 0x1c000
MM v[200:203], v[248:251], a[188:191], v[200:203]
buffer_load_dwordx4 v17, s[20:23], s30 offen lds
MM v[204:207], v[252:255], a[188:191], v[204:207]
TR v[76:77], v4 offset:32768
TR v[78:79], v4 offset:34816
MM v[208:211], v[240:243], a[204:207], v[208:211]
buffer_store_dwordx4 v[52:55], v20, s[24:27], s37 offen sc1
MM v[212:215], v[244:247], a[204:207], v[212:215]
MM v[216:219], v[248:251], a[204:207], v[216:219]
MM v[220:223], v[252:255], a[204:207], v[220:223]
MM v[224:227], v[240:243], a[220:223], v[224:227]
MM v[228:231], v[244:247], a[220:223], v[228:231]
MM v[232:235], v[248:251], a[220:223], v[232:235]
MM v[236:239], v[252:255], a[220:223], v[236:239]
s_waitcnt lgkmcnt(0)
MM v[160:163], v[64:67], a[0:3], v[160:163]
TR v[240:241], v1 offset:36864
TR v[242:243], v1 offset:38912
MM v[164:167], v[68:71], a[0:3], v[164:167]
MM v[168:171], v[72:75], a[0:3], v[168:171]
TR v[244:245], v2 offset:36864
TR v[246:247], v2 offset:38912
MM v[172:175], v[76:79], a[0:3], v[172:175]
MM v[176:179], v[64:67], a[16:19], v[176:179]
s_add_u32 s37, s49, 0xfffff800
TR v[248:249], v3 offset:36864
TR v[250:251], v3 offset:38912
MM v[180:183], v[68:71], a[16:19], v[180:183]
buffer_store_dwordx4 v[56:59], v20, s[24:27], s37 offen sc1
MM v[184:187], v[72:75], a[16:19], v[184:187]
TR v[252:253], v4 offset:36864
TR v[254:255], v4 offset:38912
MM v[188:191], v[76:79], a[16:19], v[188:191]
MM v[192:195], v[64:67], a[32:35], v[192:195]
MM v[196:199], v[68:71], a[32:35], v[196:199]
MM v[200:203], v[72:75], a[32:35], v[200:203]
MM v[204:207], v[76:79], a[32:35], v[204:207]
MM v[208:211], v[64:67], a[48:51], v[208:211]
MM v[212:215], v[68:71], a[48:51], v[212:215]
MM v[216:219], v[72:75], a[48:51], v[216:219]
MM v[220:223], v[76:79], a[48:51], v[220:223]
MM v[224:227], v[64:67], a[64:67], v[224:227]
MM v[228:231], v[68:71], a[64:67], v[228:231]
MM v[232:235], v[72:75], a[64:67], v[232:235]
MM v[236:239], v[76:79], a[64:67], v[236:239]
s_waitcnt lgkmcnt(0)
MM v[160:163], v[240:243], a[4:7], v[160:163]
s_waitcnt vmcnt(14)
s_barrier
s_add_u32 m0, s28, 0x20000
MM v[164:167], v[244:247], a[4:7], v[164:167]
s_add_u32 s30, s31, 0x20080
buffer_load_dwordx4 v17, s[20:23], s30 offen lds
MM v[168:171], v[248:251], a[4:7], v[168:171]
s_add_u32 s37, s49, 0xfffffc00
TR v[64:65], v1 offset:49152
TR v[66:67], v1 offset:51200
MM v[172:175], v[252:255], a[4:7], v[172:175]
s_add_u32 m0, s28, 0x21000
s_add_u32 s30, s31, 0x28080
MM v[176:179], v[240:243], a[20:23], v[176:179]
buffer_load_dwordx4 v17, s[20:23], s30 offen lds
MM v[180:183], v[244:247], a[20:23], v[180:183]
TR v[68:69], v2 offset:49152
TR v[70:71], v2 offset:51200
MM v[184:187], v[248:251], a[20:23], v[184:187]
s_add_u32 m0, s28, 0x20800
s_add_u32 s30, s31, 0x24080
MM v[188:191], v[252:255], a[20:23], v[188:191]
buffer_load_dwordx4 v17, s[20:23], s30 offen lds
MM v[192:195], v[240:243], a[36:39], v[192:195]
TR v[72:73], v3 offset:49152
TR v[74:75], v3 offset:51200
MM v[196:199], v[244:247], a[36:39], v[196:199]
s_add_u32 m0, s28, 0x21800
s_add_u32 s30, s31, 0x2c080
MM v[200:203], v[248:251], a[36:39], v[200:203]
buffer_load_dwordx4 v17, s[20:23], s30 offen lds
MM v[204:207], v[252:255], a[36:39], v[204:207]
TR v[76:77], v4 offset:49152
TR v[78:79], v4 offset:51200
MM v[208:211], v[240:243], a[52:55], v[208:211]
buffer_store_dwordx4 v[60:63], v20, s[24:27], s37 offen sc1
MM v[212:215], v[244:247], a[52:55], v[212:215]
MM v[216:219], v[248:251], a[52:55], v[216:219]
MM v[220:223], v[252:255], a[52:55], v[220:223]
MM v[224:227], v[240:243], a[68:71], v[224:227]
MM v[228:231], v[244:247], a[68:71], v[228:231]
MM v[232:235], v[248:251], a[68:71], v[232:235]
MM v[236:239], v[252:255], a[68:71], v[236:239]
s_waitcnt lgkmcnt(0)
MM v[160:163], v[64:67], a[8:11], v[160:163]
TR v[240:241], v1 offset:53248
TR v[242:243], v1 offset:55296
MM v[164:167], v[68:71], a[8:11], v[164:167]
MM v[168:171], v[72:75], a[8:11], v[168:171]
TR v[244:245], v2 offset:53248
TR v[246:247], v2 offset:55296
MM v[172:175], v[76:79], a[8:11], v[172:175]
MM v[176:179], v[64:67], a[24:27], v[176:179]
TR v[248:249], v3 offset:53248
TR v[250:251], v3 offset:55296
MM v[180:183], v[68:71], a[24:27], v[180:183]
MM v[184:187], v[72:75], a[24:27], v[184:187]
TR v[252:253], v4 offset:53248
TR v[254:255], v4 offset:55296
MM v[188:191], v[76:79], a[24:27], v[188:191]
MM v[192:195], v[64:67], a[40:43], v[192:195]
MM v[196:199], v[68:71], a[40:43], v[196:199]
MM v[200:203], v[72:75], a[40:43], v[200:203]
MM v[204:207], v[76:79], a[40:43], v[204:207]
MM v[208:211], v[64:67], a[56:59], v[208:211]
MM v[212:215], v[68:71], a[56:59], v[212:215]
MM v[216:219], v[72:75], a[56:59], v[216:219]
MM v[220:223], v[76:79], a[56:59], v[220:223]
MM v[224:227], v[64:67], a[72:75], v[224:227]
MM v[228:231], v[68:71], a[72:75], v[228:231]
MM v[232:235], v[72:75], a[72:75], v[232:235]
MM v[236:239], v[76:79], a[72:75], v[236:239]
s_waitcnt lgkmcnt(0)
MM v[160:163], v[240:243], a[12:15], v[160:163]
s_waitcnt vmcnt(13)
s_barrier
s_add_u32 m0, s28, 0x24000
MM v[164:167], v[244:247], a[12:15], v[164:167]
s_add_u32 s30, s31, 0x30080
buffer_load_dwordx4 v17, s[20:23], s30 offen lds
MM v[168:171], v[248:251], a[12:15], v[168:171]
TR v[64:65], v1 offset:0
TR v[66:67], v1 offset:2048
MM v[172:175], v[252:255], a[12:15], v[172:175]
s_add_u32 m0, s28, 0x25000
s_add_u32 s30, s31, 0x38080
MM v[176:179], v[240:243], a[28:31], v[176:179]
buffer_load_dwordx4 v17, s[20:23], s30 offen lds
MM v[180:183], v[244:247], a[28:31], v[180:183]
TR v[68:69], v2 offset:0
TR v[70:71], v2 offset:2048
MM v[184:187], v[248:251], a[28:31], v[184:187]
s_add_u32 m0, s28, 0x24800
s_add_u32 s30, s31, 0x34080
MM v[188:191], v[252:255], a[28:31], v[188:191]
buffer_load_dwordx4 v17, s[20:23], s30 offen lds
MM v[192:195], v[240:243], a[44:47], v[192:195]
TR v[72:73], v3 offset:0
TR v[74:75], v3 offset:2048
MM v[196:199], v[244:247], a[44:47], v[196:199]
s_add_u32 m0, s28, 0x25800
s_add_u32 s30, s31, 0x3c080
MM v[200:203], v[248:251], a[44:47], v[200:203]
buffer_load_dwordx4 v17, s[20:23], s30 offen lds
MM v[204:207], v[252:255], a[44:47], v[204:207]
TR v[76:77], v4 offset:0
TR v[78:79], v4 offset:2048
MM v[208:211], v[240:243], a[60:63], v[208:211]
MM v[212:215], v[244:247], a[60:63], v[212:215]
MM v[216:219], v[248:251], a[60:63], v[216:219]
MM v[220:223], v[252:255], a[60:63], v[220:223]
MM v[224:227], v[240:243], a[76:79], v[224:227]
MM v[228:231], v[244:247], a[76:79], v[228:231]
MM v[232:235], v[248:251], a[76:79], v[232:235]
MM v[236:239], v[252:255], a[76:79], v[236:239]
s_sub_u32 s96, s96, 1
s_cmp_lg_u32 s96, 0
s_cbranch_scc1 L_YP
s_add_u32 s73, s73, 0x80
s_and_b32 s73, s73, 0x3ff
s_waitcnt lgkmcnt(0)
MM v[160:163], v[64:67], a[80:83], v[160:163]
TR v[240:241], v1 offset:4096
TR v[242:243], v1 offset:6144
MM v[164:167], v[68:71], a[80:83], v[164:167]
MM v[168:171], v[72:75], a[80:83], v[168:171]
TR v[244:245], v2 offset:4096
TR v[246:247], v2 offset:6144
MM v[172:175], v[76:79], a[80:83], v[172:175]
MM v[176:179], v[64:67], a[96:99], v[176:179]
TR v[248:249], v3 offset:4096
TR v[250:251], v3 offset:6144
MM v[180:183], v[68:71], a[96:99], v[180:183]
MM v[184:187], v[72:75], a[96:99], v[184:187]
TR v[252:253], v4 offset:4096
TR v[254:255], v4 offset:6144
MM v[188:191], v[76:79], a[96:99], v[188:191]
MM v[192:195], v[64:67], a[112:115], v[192:195]
MM v[196:199], v[68:71], a[112:115], v[196:199]
MM v[200:203], v[72:75], a[112:115], v[200:203]
MM v[204:207], v[76:79], a[112:115], v[204:207]
MM v[208:211], v[64:67], a[128:131], v[208:211]
MM v[212:215], v[68:71], a[128:131], v[212:215]
MM v[216:219], v[72:75], a[128:131], v[216:219]
MM v[220:223], v[76:79], a[128:131], v[220:223]
MM v[224:227], v[64:67], a[224:227], v[224:227]
MM v[228:231], v[68:71], a[224:227], v[228:231]
MM v[232:235], v[72:75], a[224:227], v[232:235]
MM v[236:239], v[76:79], a[224:227], v[236:239]
s_waitcnt lgkmcnt(0)
MM v[160:163], v[240:243], a[84:87], v[160:163]
s_waitcnt vmcnt(11)
s_barrier
TR v[64:65], v1 offset:16384
MM v[164:167], v[244:247], a[84:87], v[164:167]
TR v[66:67], v1 offset:18432
MM v[168:171], v[248:251], a[84:87], v[168:171]
TR v[68:69], v2 offset:16384
MM v[172:175], v[252:255], a[84:87], v[172:175]
TR v[70:71], v2 offset:18432
MM v[176:179], v[240:243], a[100:103], v[176:179]
TR v[72:73], v3 offset:16384
MM v[180:183], v[244:247], a[100:103], v[180:183]
TR v[74:75], v3 offset:18432
MM v[184:187], v[248:251], a[100:103], v[184:187]
TR v[76:77], v4 offset:16384
MM v[188:191], v[252:255], a[100:103], v[188:191]
TR v[78:79], v4 offset:18432
MM v[192:195], v[240:243], a[116:119], v[192:195]
MM v[196:199], v[244:247], a[116:119], v[196:199]
MM v[200:203], v[248:251], a[116:119], v[200:203]
s_waitcnt vmcnt(4)
s_barrier
s_cmp_lg_u32 s33, 0
s_cbranch_scc1 L_YsgT
s_mov_b64 exec, 1
buffer_atomic_add v6, v5, s[80:83], s73 offen
s_mov_b64 exec, -1
L_YsgT:
MM v[204:207], v[252:255], a[116:119], v[204:207]
MM v[208:211], v[240:243], a[132:135], v[208:211]
MM v[212:215], v[244:247], a[132:135], v[212:215]
MM v[216:219], v[248:251], a[132:135], v[216:219]
MM v[220:223], v[252:255], a[132:135], v[220:223]
MM v[224:227], v[240:243], a[228:231], v[224:227]
MM v[228:231], v[244:247], a[228:231], v[228:231]
MM v[232:235], v[248:251], a[228:231], v[232:235]
MM v[236:239], v[252:255], a[228:231], v[236:239]
s_waitcnt lgkmcnt(0)
MM v[160:163], v[64:67], a[88:91], v[160:163]
TR v[240:241], v1 offset:20480
TR v[242:243], v1 offset:22528
MM v[164:167], v[68:71], a[88:91], v[164:167]
MM v[168:171], v[72:75], a[88:91], v[168:171]
TR v[244:245], v2 offset:20480
TR v[246:247], v2 offset:22528
MM v[172:175], v[76:79], a[88:91], v[172:175]
MM v[176:179], v[64:67], a[104:107], v[176:179]
TR v[248:249], v3 offset:20480
TR v[250:251], v3 offset:22528
MM v[180:183], v[68:71], a[104:107], v[180:183]
MM v[184:187], v[72:75], a[104:107], v[184:187]
TR v[252:253], v4 offset:20480
TR v[254:255], v4 offset:22528
MM v[188:191], v[76:79], a[104:107], v[188:191]
MM v[192:195], v[64:67], a[120:123], v[192:195]
MM v[196:199], v[68:71], a[120:123], v[196:199]
MM v[200:203], v[72:75], a[120:123], v[200:203]
MM v[204:207], v[76:79], a[120:123], v[204:207]
MM v[208:211], v[64:67], a[136:139], v[208:211]
MM v[212:215], v[68:71], a[136:139], v[212:215]
MM v[216:219], v[72:75], a[136:139], v[216:219]
MM v[220:223], v[76:79], a[136:139], v[220:223]
MM v[224:227], v[64:67], a[232:235], v[224:227]
MM v[228:231], v[68:71], a[232:235], v[228:231]
MM v[232:235], v[72:75], a[232:235], v[232:235]
MM v[236:239], v[76:79], a[232:235], v[236:239]
s_waitcnt lgkmcnt(0)
MM v[160:163], v[240:243], a[92:95], v[160:163]
MM v[164:167], v[244:247], a[92:95], v[164:167]
MM v[168:171], v[248:251], a[92:95], v[168:171]
MM v[172:175], v[252:255], a[92:95], v[172:175]
MM v[176:179], v[240:243], a[108:111], v[176:179]
MM v[180:183], v[244:247], a[108:111], v[180:183]
MM v[184:187], v[248:251], a[108:111], v[184:187]
MM v[188:191], v[252:255], a[108:111], v[188:191]
MM v[192:195], v[240:243], a[124:127], v[192:195]
MM v[196:199], v[244:247], a[124:127], v[196:199]
MM v[200:203], v[248:251], a[124:127], v[200:203]
MM v[204:207], v[252:255], a[124:127], v[204:207]
MM v[208:211], v[240:243], a[140:143], v[208:211]
MM v[212:215], v[244:247], a[140:143], v[212:215]
MM v[216:219], v[248:251], a[140:143], v[216:219]
MM v[220:223], v[252:255], a[140:143], v[220:223]
MM v[224:227], v[240:243], a[236:239], v[224:227]
MM v[228:231], v[244:247], a[236:239], v[228:231]
MM v[232:235], v[248:251], a[236:239], v[232:235]
MM v[236:239], v[252:255], a[236:239], v[236:239]
s_min_u32 s72, s33, 2
s_lshl_b32 s72, s72, 7
buffer_load_dword v7, v5, s[80:83], s72 offen sc1
CV v24, v160, v161
CV v25, v162, v163
CV v26, v164, v165
CV v27, v166, v167
s_add_u32 s37, s49, 0x0
buffer_store_dwordx4 v[24:27], v20, s[24:27], s37 offen sc1
CV v28, v168, v169
CV v29, v170, v171
CV v30, v172, v173
CV v31, v174, v175
s_add_u32 s37, s49, 0x400
buffer_store_dwordx4 v[28:31], v20, s[24:27], s37 offen sc1
CV v32, v176, v177
CV v33, v178, v179
CV v34, v180, v181
CV v35, v182, v183
s_add_u32 s37, s49, 0x800
buffer_store_dwordx4 v[32:35], v20, s[24:27], s37 offen sc1
CV v36, v184, v185
CV v37, v186, v187
CV v38, v188, v189
CV v39, v190, v191
s_add_u32 s37, s49, 0xc00
buffer_store_dwordx4 v[36:39], v20, s[24:27], s37 offen sc1
CV v40, v192, v193
CV v41, v194, v195
CV v42, v196, v197
CV v43, v198, v199
s_add_u32 s37, s49, 0x1000
buffer_store_dwordx4 v[40:43], v20, s[24:27], s37 offen sc1
CV v44, v200, v201
CV v45, v202, v203
CV v46, v204, v205
CV v47, v206, v207
s_add_u32 s37, s49, 0x1400
buffer_store_dwordx4 v[44:47], v20, s[24:27], s37 offen sc1
CV v48, v208, v209
CV v49, v210, v211
CV v50, v212, v213
CV v51, v214, v215
s_add_u32 s37, s49, 0x1800
buffer_store_dwordx4 v[48:51], v20, s[24:27], s37 offen sc1
CV v52, v216, v217
CV v53, v218, v219
CV v54, v220, v221
CV v55, v222, v223
s_add_u32 s37, s49, 0x1c00
buffer_store_dwordx4 v[52:55], v20, s[24:27], s37 offen sc1
CV v56, v224, v225
CV v57, v226, v227
CV v58, v228, v229
CV v59, v230, v231
s_add_u32 s37, s49, 0x2000
buffer_store_dwordx4 v[56:59], v20, s[24:27], s37 offen sc1
CV v60, v232, v233
CV v61, v234, v235
CV v62, v236, v237
CV v63, v238, v239
s_add_u32 s37, s49, 0x2400
buffer_store_dwordx4 v[60:63], v20, s[24:27], s37 offen sc1
s_cmp_eq_u32 s33, 3
s_cselect_b32 s40, 0, s33
s_cselect_b32 s41, 4, 0
s_mul_i32 s37, s40, 10240
s_mul_i32 s43, s41, 2048
s_add_i32 s37, s37, s43
s_add_i32 s8, s37, s74
s_mul_i32 s37, s40, 128
s_mul_i32 s43, s41, 32768
s_add_i32 s37, s37, s43
s_add_i32 s13, s37, s75
s_cmp_eq_u32 s33, 3
s_cselect_b32 s40, 1, s33
s_cselect_b32 s41, 4, 1
s_mul_i32 s37, s40, 10240
s_mul_i32 s43, s41, 2048
s_add_i32 s37, s37, s43
s_add_i32 s9, s37, s74
s_mul_i32 s37, s40, 128
s_mul_i32 s43, s41, 32768
s_add_i32 s37, s37, s43
s_add_i32 s14, s37, s75
s_cmp_eq_u32 s33, 3
s_cselect_b32 s40, 2, s33
s_cselect_b32 s41, 4, 2
s_mul_i32 s37, s40, 10240
s_mul_i32 s43, s41, 2048
s_add_i32 s37, s37, s43
s_add_i32 s10, s37, s74
s_mul_i32 s37, s40, 128
s_mul_i32 s43, s41, 32768
s_add_i32 s37, s37, s43
s_add_i32 s15, s37, s75
s_cmp_eq_u32 s33, 3
s_cselect_b32 s40, 3, s33
s_cselect_b32 s41, 3, 3
s_mul_i32 s37, s40, 10240
s_mul_i32 s43, s41, 2048
s_add_i32 s37, s37, s43
s_add_i32 s11, s37, s74
s_mul_i32 s37, s40, 128
s_mul_i32 s43, s41, 32768
s_add_i32 s37, s37, s43
s_add_i32 s16, s37, s75
s_cmp_eq_u32 s33, 3
s_mov_b32 s40, 3
s_cselect_b32 s41, 4, s33
s_mul_i32 s37, s40, 10240
s_mul_i32 s43, s41, 2048
s_add_i32 s37, s37, s43
s_add_i32 s12, s37, s74
s_mul_i32 s37, s40, 128
s_mul_i32 s43, s41, 32768
s_add_i32 s37, s37, s43
s_add_i32 s17, s37, s75
v_accvgpr_read_b32 v1, a252
v_readfirstlane_b32 s41, v0
v_readfirstlane_b32 s43, v1
v_bfe_u32 v2, v20, 4, 4
v_lshlrev_b32 v2, 11, v2
v_lshrrev_b32 v3, 8, v20
v_lshl_add_u32 v2, v3, 4, v2
s_mov_b32 s4, s84
s_mov_b32 s5, s85
s_mov_b32 s6, 5242880
s_mov_b32 s7, 0x20000
s_mov_b32 s46, 0xffff0000
s_mov_b32 s73, 0x180
s_waitcnt vmcnt(10)
v_readfirstlane_b32 s37, v7
s_nop 3
s_sub_u32 s37, s37, s41
s_cmp_lt_u32 s37, 8
s_cbranch_scc1 L_Yrslow
s_add_u32 s37, s8, 0x0
buffer_load_dwordx4 v[80:83], v20, s[76:79], s37 offen sc1
s_add_u32 s37, s8, 0x28000
buffer_load_dwordx4 v[84:87], v20, s[76:79], s37 offen sc1
s_add_u32 s37, s8, 0x50000
buffer_load_dwordx4 v[88:91], v20, s[76:79], s37 offen sc1
s_add_u32 s37, s8, 0x78000
buffer_load_dwordx4 v[92:95], v20, s[76:79], s37 offen sc1
s_add_u32 s37, s8, 0xa0000
buffer_load_dwordx4 v[96:99], v20, s[76:79], s37 offen sc1
s_add_u32 s37, s8, 0xc8000
buffer_load_dwordx4 v[100:103], v20, s[76:79], s37 offen sc1
s_add_u32 s37, s8, 0xf0000
buffer_load_dwordx4 v[104:107], v20, s[76:79], s37 offen sc1
s_add_u32 s37, s8, 0x118000
buffer_load_dwordx4 v[108:111], v20, s[76:79], s37 offen sc1
s_add_u32 s37, s9, 0x0
buffer_load_dwordx4 v[112:115], v20, s[76:79], s37 offen sc1
s_add_u32 s37, s9, 0x28000
buffer_load_dwordx4 v[116:119], v20, s[76:79], s37 offen sc1
s_waitcnt vmcnt(10)
s_barrier
s_cmp_lg_u32 s33, 0
s_cbranch_scc1 L_YsgE1
s_mov_b64 exec, 1
buffer_atomic_add v6, v5, s[80:83], s73 offen
s_mov_b64 exec, -1
L_YsgE1:
s_branch L_Yrest
L_Yrslow:
s_waitcnt vmcnt(0)
s_barrier
s_cmp_lg_u32 s33, 0
s_cbranch_scc1 L_YsgE2
s_mov_b64 exec, 1
buffer_atomic_add v6, v5, s[80:83], s73 offen
s_mov_b64 exec, -1
L_YsgE2:
s_mov_b32 s40, 0x8000
L_YrA:
buffer_load_dword v25, v5, s[80:83], s72 offen sc1
s_waitcnt vmcnt(0)
v_readfirstlane_b32 s37, v25
s_nop 3
s_sub_u32 s40, s40, 1
s_cbranch_scc1 L_YrAo
s_sub_u32 s37, s37, s41
s_cmp_lt_u32 s37, 8
s_cbranch_scc1 L_YrA
L_YrAo:
s_add_u32 s37, s8, 0x0
buffer_load_dwordx4 v[80:83], v20, s[76:79], s37 offen sc1
s_add_u32 s37, s8, 0x28000
buffer_load_dwordx4 v[84:87], v20, s[76:79], s37 offen sc1
s_add_u32 s37, s8, 0x50000
buffer_load_dwordx4 v[88:91], v20, s[76:79], s37 offen sc1
s_add_u32 s37, s8, 0x78000
buffer_load_dwordx4 v[92:95], v20, s[76:79], s37 offen sc1
s_add_u32 s37, s8, 0xa0000
buffer_load_dwordx4 v[96:99], v20, s[76:79], s37 offen sc1
s_add_u32 s37, s8, 0xc8000
buffer_load_dwordx4 v[100:103], v20, s[76:79], s37 offen sc1
s_add_u32 s37, s8, 0xf0000
buffer_load_dwordx4 v[104:107], v20, s[76:79], s37 offen sc1
s_add_u32 s37, s8, 0x118000
buffer_load_dwordx4 v[108:111], v20, s[76:79], s37 offen sc1
s_add_u32 s37, s9, 0x0
buffer_load_dwordx4 v[112:115], v20, s[76:79], s37 offen sc1
s_add_u32 s37, s9, 0x28000
buffer_load_dwordx4 v[116:119], v20, s[76:79], s37 offen sc1
L_Yrest:
s_add_u32 s37, s9, 0x50000
buffer_load_dwordx4 v[120:123], v20, s[76:79], s37 offen sc1
s_add_u32 s37, s9, 0x78000
buffer_load_dwordx4 v[124:127], v20, s[76:79], s37 offen sc1
s_add_u32 s37, s9, 0xa0000
buffer_load_dwordx4 v[128:131], v20, s[76:79], s37 offen sc1
s_add_u32 s37, s9, 0xc8000
buffer_load_dwordx4 v[132:135], v20, s[76:79], s37 offen sc1
s_add_u32 s37, s9, 0xf0000
buffer_load_dwordx4 v[136:139], v20, s[76:79], s37 offen sc1
s_add_u32 s37, s9, 0x118000
buffer_load_dwordx4 v[140:143], v20, s[76:79], s37 offen sc1
s_add_u32 s37, s10, 0x0
buffer_load_dwordx4 v[144:147], v20, s[76:79], s37 offen sc1
s_add_u32 s37, s10, 0x28000
buffer_load_dwordx4 v[148:151], v20, s[76:79], s37 offen sc1
s_add_u32 s37, s10, 0x50000
buffer_load_dwordx4 v[152:155], v20, s[76:79], s37 offen sc1
s_add_u32 s37, s10, 0x78000
buffer_load_dwordx4 v[156:159], v20, s[76:79], s37 offen sc1
s_add_u32 s37, s10, 0xa0000
buffer_load_dwordx4 v[160:163], v20, s[76:79], s37 offen sc1
s_add_u32 s37, s10, 0xc8000
buffer_load_dwordx4 v[164:167], v20, s[76:79], s37 offen sc1
s_add_u32 s37, s10, 0xf0000
buffer_load_dwordx4 v[168:171], v20, s[76:79], s37 offen sc1
s_add_u32 s37, s10, 0x118000
buffer_load_dwordx4 v[172:175], v20, s[76:79], s37 offen sc1
s_cmp_eq_u32 s33, 3
s_cbranch_scc1 L_Yrw3
s_add_u32 s37, s11, 0x0
buffer_load_dwordx4 v[176:179], v20, s[76:79], s37 offen sc1
s_add_u32 s37, s11, 0x28000
buffer_load_dwordx4 v[180:183], v20, s[76:79], s37 offen sc1
s_add_u32 s37, s11, 0x50000
buffer_load_dwordx4 v[184:187], v20, s[76:79], s37 offen sc1
s_add_u32 s37, s11, 0x78000
buffer_load_dwordx4 v[188:191], v20, s[76:79], s37 offen sc1
s_add_u32 s37, s11, 0xa0000
buffer_load_dwordx4 v[192:195], v20, s[76:79], s37 offen sc1
s_add_u32 s37, s11, 0xc8000
buffer_load_dwordx4 v[196:199], v20, s[76:79], s37 offen sc1
s_add_u32 s37, s11, 0xf0000
buffer_load_dwordx4 v[200:203], v20, s[76:79], s37 offen sc1
s_add_u32 s37, s11, 0x118000
buffer_load_dwordx4 v[204:207], v20, s[76:79], s37 offen sc1
L_Yrw3:
buffer_load_dword v62, v5, s[80:83], s73 offen sc1
s_waitcnt vmcnt(24)
v_lshlrev_b32 v24, 16, v80
v_and_b32 v25, s46, v80
v_lshlrev_b32 v26, 16, v81
v_and_b32 v27, s46, v81
v_lshlrev_b32 v28, 16, v82
v_and_b32 v29, s46, v82
v_lshlrev_b32 v30, 16, v83
v_and_b32 v31, s46, v83
s_waitcnt vmcnt(23)
v_lshlrev_b32 v60, 16, v84
v_and_b32 v61, s46, v84
v_pk_add_f32 v[24:25], v[24:25], v[60:61]
v_lshlrev_b32 v60, 16, v85
v_and_b32 v61, s46, v85
v_pk_add_f32 v[26:27], v[26:27], v[60:61]
v_lshlrev_b32 v60, 16, v86
v_and_b32 v61, s46, v86
v_pk_add_f32 v[28:29], v[28:29], v[60:61]
v_lshlrev_b32 v60, 16, v87
v_and_b32 v61, s46, v87
v_pk_add_f32 v[30:31], v[30:31], v[60:61]
s_waitcnt vmcnt(22)
v_lshlrev_b32 v60, 16, v88
v_and_b32 v61, s46, v88
v_pk_add_f32 v[24:25], v[24:25], v[60:61]
v_lshlrev_b32 v60, 16, v89
v_and_b32 v61, s46, v89
v_pk_add_f32 v[26:27], v[26:27], v[60:61]
v_lshlrev_b32 v60, 16, v90
v_and_b32 v61, s46, v90
v_pk_add_f32 v[28:29], v[28:29], v[60:61]
v_lshlrev_b32 v60, 16, v91
v_and_b32 v61, s46, v91
v_pk_add_f32 v[30:31], v[30:31], v[60:61]
s_waitcnt vmcnt(21)
v_lshlrev_b32 v60, 16, v92
v_and_b32 v61, s46, v92
v_pk_add_f32 v[24:25], v[24:25], v[60:61]
v_lshlrev_b32 v60, 16, v93
v_and_b32 v61, s46, v93
v_pk_add_f32 v[26:27], v[26:27], v[60:61]
v_lshlrev_b32 v60, 16, v94
v_and_b32 v61, s46, v94
v_pk_add_f32 v[28:29], v[28:29], v[60:61]
v_lshlrev_b32 v60, 16, v95
v_and_b32 v61, s46, v95
v_pk_add_f32 v[30:31], v[30:31], v[60:61]
s_waitcnt vmcnt(20)
v_lshlrev_b32 v60, 16, v96
v_and_b32 v61, s46, v96
v_pk_add_f32 v[24:25], v[24:25], v[60:61]
v_lshlrev_b32 v60, 16, v97
v_and_b32 v61, s46, v97
v_pk_add_f32 v[26:27], v[26:27], v[60:61]
v_lshlrev_b32 v60, 16, v98
v_and_b32 v61, s46, v98
v_pk_add_f32 v[28:29], v[28:29], v[60:61]
v_lshlrev_b32 v60, 16, v99
v_and_b32 v61, s46, v99
v_pk_add_f32 v[30:31], v[30:31], v[60:61]
s_waitcnt vmcnt(19)
v_lshlrev_b32 v60, 16, v100
v_and_b32 v61, s46, v100
v_pk_add_f32 v[24:25], v[24:25], v[60:61]
v_lshlrev_b32 v60, 16, v101
v_and_b32 v61, s46, v101
v_pk_add_f32 v[26:27], v[26:27], v[60:61]
v_lshlrev_b32 v60, 16, v102
v_and_b32 v61, s46, v102
v_pk_add_f32 v[28:29], v[28:29], v[60:61]
v_lshlrev_b32 v60, 16, v103
v_and_b32 v61, s46, v103
v_pk_add_f32 v[30:31], v[30:31], v[60:61]
s_waitcnt vmcnt(18)
v_lshlrev_b32 v60, 16, v104
v_and_b32 v61, s46, v104
v_pk_add_f32 v[24:25], v[24:25], v[60:61]
v_lshlrev_b32 v60, 16, v105
v_and_b32 v61, s46, v105
v_pk_add_f32 v[26:27], v[26:27], v[60:61]
v_lshlrev_b32 v60, 16, v106
v_and_b32 v61, s46, v106
v_pk_add_f32 v[28:29], v[28:29], v[60:61]
v_lshlrev_b32 v60, 16, v107
v_and_b32 v61, s46, v107
v_pk_add_f32 v[30:31], v[30:31], v[60:61]
s_waitcnt vmcnt(17)
v_lshlrev_b32 v60, 16, v108
v_and_b32 v61, s46, v108
v_pk_add_f32 v[24:25], v[24:25], v[60:61]
v_lshlrev_b32 v60, 16, v109
v_and_b32 v61, s46, v109
v_pk_add_f32 v[26:27], v[26:27], v[60:61]
v_lshlrev_b32 v60, 16, v110
v_and_b32 v61, s46, v110
v_pk_add_f32 v[28:29], v[28:29], v[60:61]
v_lshlrev_b32 v60, 16, v111
v_and_b32 v61, s46, v111
v_pk_add_f32 v[30:31], v[30:31], v[60:61]
CV v32, v24, v25
CV v33, v26, v27
CV v34, v28, v29
CV v35, v30, v31
s_nop 0
v_permlane32_swap_b32 v32, v34
v_permlane32_swap_b32 v33, v35
s_nop 0
v_permlane16_swap_b32 v32, v34
v_permlane16_swap_b32 v33, v35
buffer_store_dwordx4 v[32:35], v2, s[4:7], s13 offen
s_waitcnt vmcnt(17)
v_lshlrev_b32 v40, 16, v112
v_and_b32 v41, s46, v112
v_lshlrev_b32 v42, 16, v113
v_and_b32 v43, s46, v113
v_lshlrev_b32 v44, 16, v114
v_and_b32 v45, s46, v114
v_lshlrev_b32 v46, 16, v115
v_and_b32 v47, s46, v115
s_waitcnt vmcnt(16)
v_lshlrev_b32 v60, 16, v116
v_and_b32 v61, s46, v116
v_pk_add_f32 v[40:41], v[40:41], v[60:61]
v_lshlrev_b32 v60, 16, v117
v_and_b32 v61, s46, v117
v_pk_add_f32 v[42:43], v[42:43], v[60:61]
v_lshlrev_b32 v60, 16, v118
v_and_b32 v61, s46, v118
v_pk_add_f32 v[44:45], v[44:45], v[60:61]
v_lshlrev_b32 v60, 16, v119
v_and_b32 v61, s46, v119
v_pk_add_f32 v[46:47], v[46:47], v[60:61]
s_waitcnt vmcnt(15)
v_lshlrev_b32 v60, 16, v120
v_and_b32 v61, s46, v120
v_pk_add_f32 v[40:41], v[40:41], v[60:61]
v_lshlrev_b32 v60, 16, v121
v_and_b32 v61, s46, v121
v_pk_add_f32 v[42:43], v[42:43], v[60:61]
v_lshlrev_b32 v60, 16, v122
v_and_b32 v61, s46, v122
v_pk_add_f32 v[44:45], v[44:45], v[60:61]
v_lshlrev_b32 v60, 16, v123
v_and_b32 v61, s46, v123
v_pk_add_f32 v[46:47], v[46:47], v[60:61]
s_waitcnt vmcnt(14)
v_lshlrev_b32 v60, 16, v124
v_and_b32 v61, s46, v124
v_pk_add_f32 v[40:41], v[40:41], v[60:61]
v_lshlrev_b32 v60, 16, v125
v_and_b32 v61, s46, v125
v_pk_add_f32 v[42:43], v[42:43], v[60:61]
v_lshlrev_b32 v60, 16, v126
v_and_b32 v61, s46, v126
v_pk_add_f32 v[44:45], v[44:45], v[60:61]
v_lshlrev_b32 v60, 16, v127
v_and_b32 v61, s46, v127
v_pk_add_f32 v[46:47], v[46:47], v[60:61]
s_waitcnt vmcnt(13)
v_lshlrev_b32 v60, 16, v128
v_and_b32 v61, s46, v128
v_pk_add_f32 v[40:41], v[40:41], v[60:61]
v_lshlrev_b32 v60, 16, v129
v_and_b32 v61, s46, v129
v_pk_add_f32 v[42:43], v[42:43], v[60:61]
v_lshlrev_b32 v60, 16, v130
v_and_b32 v61, s46, v130
v_pk_add_f32 v[44:45], v[44:45], v[60:61]
v_lshlrev_b32 v60, 16, v131
v_and_b32 v61, s46, v131
v_pk_add_f32 v[46:47], v[46:47], v[60:61]
s_waitcnt vmcnt(12)
v_lshlrev_b32 v60, 16, v132
v_and_b32 v61, s46, v132
v_pk_add_f32 v[40:41], v[40:41], v[60:61]
v_lshlrev_b32 v60, 16, v133
v_and_b32 v61, s46, v133
v_pk_add_f32 v[42:43], v[42:43], v[60:61]
v_lshlrev_b32 v60, 16, v134
v_and_b32 v61, s46, v134
v_pk_add_f32 v[44:45], v[44:45], v[60:61]
v_lshlrev_b32 v60, 16, v135
v_and_b32 v61, s46, v135
v_pk_add_f32 v[46:47], v[46:47], v[60:61]
s_waitcnt vmcnt(11)
v_lshlrev_b32 v60, 16, v136
v_and_b32 v61, s46, v136
v_pk_add_f32 v[40:41], v[40:41], v[60:61]
v_lshlrev_b32 v60, 16, v137
v_and_b32 v61, s46, v137
v_pk_add_f32 v[42:43], v[42:43], v[60:61]
v_lshlrev_b32 v60, 16, v138
v_and_b32 v61, s46, v138
v_pk_add_f32 v[44:45], v[44:45], v[60:61]
v_lshlrev_b32 v60, 16, v139
v_and_b32 v61, s46, v139
v_pk_add_f32 v[46:47], v[46:47], v[60:61]
s_waitcnt vmcnt(10)
v_lshlrev_b32 v60, 16, v140
v_and_b32 v61, s46, v140
v_pk_add_f32 v[40:41], v[40:41], v[60:61]
v_lshlrev_b32 v60, 16, v141
v_and_b32 v61, s46, v141
v_pk_add_f32 v[42:43], v[42:43], v[60:61]
v_lshlrev_b32 v60, 16, v142
v_and_b32 v61, s46, v142
v_pk_add_f32 v[44:45], v[44:45], v[60:61]
v_lshlrev_b32 v60, 16, v143
v_and_b32 v61, s46, v143
v_pk_add_f32 v[46:47], v[46:47], v[60:61]
CV v48, v40, v41
CV v49, v42, v43
CV v50, v44, v45
CV v51, v46, v47
s_nop 0
v_permlane32_swap_b32 v48, v50
v_permlane32_swap_b32 v49, v51
s_nop 0
v_permlane16_swap_b32 v48, v50
v_permlane16_swap_b32 v49, v51
buffer_store_dwordx4 v[48:51], v2, s[4:7], s14 offen
s_waitcnt vmcnt(2)
v_readfirstlane_b32 s37, v62
s_nop 3
s_sub_u32 s37, s37, s43
s_cmp_ge_u32 s37, 8
s_cbranch_scc1 L_YrBo
s_mov_b32 s40, 0x8000
L_YrB:
buffer_load_dword v62, v5, s[80:83], s73 offen sc1
s_waitcnt vmcnt(0)
v_readfirstlane_b32 s37, v62
s_nop 3
s_sub_u32 s40, s40, 1
s_cbranch_scc1 L_YrBo
s_sub_u32 s37, s37, s43
s_cmp_lt_u32 s37, 8
s_cbranch_scc1 L_YrB
L_YrBo:
s_cmp_lg_u32 s33, 3
s_cbranch_scc1 L_Yrn3
s_add_u32 s37, s11, 0x0
buffer_load_dwordx4 v[176:179], v20, s[76:79], s37 offen sc1
s_add_u32 s37, s11, 0x28000
buffer_load_dwordx4 v[180:183], v20, s[76:79], s37 offen sc1
s_add_u32 s37, s11, 0x50000
buffer_load_dwordx4 v[184:187], v20, s[76:79], s37 offen sc1
s_add_u32 s37, s11, 0x78000
buffer_load_dwordx4 v[188:191], v20, s[76:79], s37 offen sc1
s_add_u32 s37, s11, 0xa0000
buffer_load_dwordx4 v[192:195], v20, s[76:79], s37 offen sc1
s_add_u32 s37, s11, 0xc8000
buffer_load_dwordx4 v[196:199], v20, s[76:79], s37 offen sc1
s_add_u32 s37, s11, 0xf0000
buffer_load_dwordx4 v[200:203], v20, s[76:79], s37 offen sc1
s_add_u32 s37, s11, 0x118000
buffer_load_dwordx4 v[204:207], v20, s[76:79], s37 offen sc1
L_Yrn3:
s_add_u32 s37, s12, 0x0
buffer_load_dwordx4 v[208:211], v20, s[76:79], s37 offen sc1
s_add_u32 s37, s12, 0x28000
buffer_load_dwordx4 v[212:215], v20, s[76:79], s37 offen sc1
s_add_u32 s37, s12, 0x50000
buffer_load_dwordx4 v[216:219], v20, s[76:79], s37 offen sc1
s_add_u32 s37, s12, 0x78000
buffer_load_dwordx4 v[220:223], v20, s[76:79], s37 offen sc1
s_add_u32 s37, s12, 0xa0000
buffer_load_dwordx4 v[224:227], v20, s[76:79], s37 offen sc1
s_add_u32 s37, s12, 0xc8000
buffer_load_dwordx4 v[228:231], v20, s[76:79], s37 offen sc1
s_add_u32 s37, s12, 0xf0000
buffer_load_dwordx4 v[232:235], v20, s[76:79], s37 offen sc1
s_add_u32 s37, s12, 0x118000
buffer_load_dwordx4 v[236:239], v20, s[76:79], s37 offen sc1
v_lshlrev_b32 v24, 16, v144
v_and_b32 v25, s46, v144
v_lshlrev_b32 v26, 16, v145
v_and_b32 v27, s46, v145
v_lshlrev_b32 v28, 16, v146
v_and_b32 v29, s46, v146
v_lshlrev_b32 v30, 16, v147
v_and_b32 v31, s46, v147
v_lshlrev_b32 v60, 16, v148
v_and_b32 v61, s46, v148
v_pk_add_f32 v[24:25], v[24:25], v[60:61]
v_lshlrev_b32 v60, 16, v149
v_and_b32 v61, s46, v149
v_pk_add_f32 v[26:27], v[26:27], v[60:61]
v_lshlrev_b32 v60, 16, v150
v_and_b32 v61, s46, v150
v_pk_add_f32 v[28:29], v[28:29], v[60:61]
v_lshlrev_b32 v60, 16, v151
v_and_b32 v61, s46, v151
v_pk_add_f32 v[30:31], v[30:31], v[60:61]
v_lshlrev_b32 v60, 16, v152
v_and_b32 v61, s46, v152
v_pk_add_f32 v[24:25], v[24:25], v[60:61]
v_lshlrev_b32 v60, 16, v153
v_and_b32 v61, s46, v153
v_pk_add_f32 v[26:27], v[26:27], v[60:61]
v_lshlrev_b32 v60, 16, v154
v_and_b32 v61, s46, v154
v_pk_add_f32 v[28:29], v[28:29], v[60:61]
v_lshlrev_b32 v60, 16, v155
v_and_b32 v61, s46, v155
v_pk_add_f32 v[30:31], v[30:31], v[60:61]
v_lshlrev_b32 v60, 16, v156
v_and_b32 v61, s46, v156
v_pk_add_f32 v[24:25], v[24:25], v[60:61]
v_lshlrev_b32 v60, 16, v157
v_and_b32 v61, s46, v157
v_pk_add_f32 v[26:27], v[26:27], v[60:61]
v_lshlrev_b32 v60, 16, v158
v_and_b32 v61, s46, v158
v_pk_add_f32 v[28:29], v[28:29], v[60:61]
v_lshlrev_b32 v60, 16, v159
v_and_b32 v61, s46, v159
v_pk_add_f32 v[30:31], v[30:31], v[60:61]
v_lshlrev_b32 v60, 16, v160
v_and_b32 v61, s46, v160
v_pk_add_f32 v[24:25], v[24:25], v[60:61]
v_lshlrev_b32 v60, 16, v161
v_and_b32 v61, s46, v161
v_pk_add_f32 v[26:27], v[26:27], v[60:61]
v_lshlrev_b32 v60, 16, v162
v_and_b32 v61, s46, v162
v_pk_add_f32 v[28:29], v[28:29], v[60:61]
v_lshlrev_b32 v60, 16, v163
v_and_b32 v61, s46, v163
v_pk_add_f32 v[30:31], v[30:31], v[60:61]
v_lshlrev_b32 v60, 16, v164
v_and_b32 v61, s46, v164
v_pk_add_f32 v[24:25], v[24:25], v[60:61]
v_lshlrev_b32 v60, 16, v165
v_and_b32 v61, s46, v165
v_pk_add_f32 v[26:27], v[26:27], v[60:61]
v_lshlrev_b32 v60, 16, v166
v_and_b32 v61, s46, v166
v_pk_add_f32 v[28:29], v[28:29], v[60:61]
v_lshlrev_b32 v60, 16, v167
v_and_b32 v61, s46, v167
v_pk_add_f32 v[30:31], v[30:31], v[60:61]
v_lshlrev_b32 v60, 16, v168
v_and_b32 v61, s46, v168
v_pk_add_f32 v[24:25], v[24:25], v[60:61]
v_lshlrev_b32 v60, 16, v169
v_and_b32 v61, s46, v169
v_pk_add_f32 v[26:27], v[26:27], v[60:61]
v_lshlrev_b32 v60, 16, v170
v_and_b32 v61, s46, v170
v_pk_add_f32 v[28:29], v[28:29], v[60:61]
v_lshlrev_b32 v60, 16, v171
v_and_b32 v61, s46, v171
v_pk_add_f32 v[30:31], v[30:31], v[60:61]
v_lshlrev_b32 v60, 16, v172
v_and_b32 v61, s46, v172
v_pk_add_f32 v[24:25], v[24:25], v[60:61]
v_lshlrev_b32 v60, 16, v173
v_and_b32 v61, s46, v173
v_pk_add_f32 v[26:27], v[26:27], v[60:61]
v_lshlrev_b32 v60, 16, v174
v_and_b32 v61, s46, v174
v_pk_add_f32 v[28:29], v[28:29], v[60:61]
v_lshlrev_b32 v60, 16, v175
v_and_b32 v61, s46, v175
v_pk_add_f32 v[30:31], v[30:31], v[60:61]
CV v32, v24, v25
CV v33, v26, v27
CV v34, v28, v29
CV v35, v30, v31
s_nop 0
v_permlane32_swap_b32 v32, v34
v_permlane32_swap_b32 v33, v35
s_nop 0
v_permlane16_swap_b32 v32, v34
v_permlane16_swap_b32 v33, v35
buffer_store_dwordx4 v[32:35], v2, s[4:7], s15 offen
s_waitcnt vmcnt(9)
v_lshlrev_b32 v40, 16, v176
v_and_b32 v41, s46, v176
v_lshlrev_b32 v42, 16, v177
v_and_b32 v43, s46, v177
v_lshlrev_b32 v44, 16, v178
v_and_b32 v45, s46, v178
v_lshlrev_b32 v46, 16, v179
v_and_b32 v47, s46, v179
v_lshlrev_b32 v60, 16, v180
v_and_b32 v61, s46, v180
v_pk_add_f32 v[40:41], v[40:41], v[60:61]
v_lshlrev_b32 v60, 16, v181
v_and_b32 v61, s46, v181
v_pk_add_f32 v[42:43], v[42:43], v[60:61]
v_lshlrev_b32 v60, 16, v182
v_and_b32 v61, s46, v182
v_pk_add_f32 v[44:45], v[44:45], v[60:61]
v_lshlrev_b32 v60, 16, v183
v_and_b32 v61, s46, v183
v_pk_add_f32 v[46:47], v[46:47], v[60:61]
v_lshlrev_b32 v60, 16, v184
v_and_b32 v61, s46, v184
v_pk_add_f32 v[40:41], v[40:41], v[60:61]
v_lshlrev_b32 v60, 16, v185
v_and_b32 v61, s46, v185
v_pk_add_f32 v[42:43], v[42:43], v[60:61]
v_lshlrev_b32 v60, 16, v186
v_and_b32 v61, s46, v186
v_pk_add_f32 v[44:45], v[44:45], v[60:61]
v_lshlrev_b32 v60, 16, v187
v_and_b32 v61, s46, v187
v_pk_add_f32 v[46:47], v[46:47], v[60:61]
v_lshlrev_b32 v60, 16, v188
v_and_b32 v61, s46, v188
v_pk_add_f32 v[40:41], v[40:41], v[60:61]
v_lshlrev_b32 v60, 16, v189
v_and_b32 v61, s46, v189
v_pk_add_f32 v[42:43], v[42:43], v[60:61]
v_lshlrev_b32 v60, 16, v190
v_and_b32 v61, s46, v190
v_pk_add_f32 v[44:45], v[44:45], v[60:61]
v_lshlrev_b32 v60, 16, v191
v_and_b32 v61, s46, v191
v_pk_add_f32 v[46:47], v[46:47], v[60:61]
v_lshlrev_b32 v60, 16, v192
v_and_b32 v61, s46, v192
v_pk_add_f32 v[40:41], v[40:41], v[60:61]
v_lshlrev_b32 v60, 16, v193
v_and_b32 v61, s46, v193
v_pk_add_f32 v[42:43], v[42:43], v[60:61]
v_lshlrev_b32 v60, 16, v194
v_and_b32 v61, s46, v194
v_pk_add_f32 v[44:45], v[44:45], v[60:61]
v_lshlrev_b32 v60, 16, v195
v_and_b32 v61, s46, v195
v_pk_add_f32 v[46:47], v[46:47], v[60:61]
v_lshlrev_b32 v60, 16, v196
v_and_b32 v61, s46, v196
v_pk_add_f32 v[40:41], v[40:41], v[60:61]
v_lshlrev_b32 v60, 16, v197
v_and_b32 v61, s46, v197
v_pk_add_f32 v[42:43], v[42:43], v[60:61]
v_lshlrev_b32 v60, 16, v198
v_and_b32 v61, s46, v198
v_pk_add_f32 v[44:45], v[44:45], v[60:61]
v_lshlrev_b32 v60, 16, v199
v_and_b32 v61, s46, v199
v_pk_add_f32 v[46:47], v[46:47], v[60:61]
v_lshlrev_b32 v60, 16, v200
v_and_b32 v61, s46, v200
v_pk_add_f32 v[40:41], v[40:41], v[60:61]
v_lshlrev_b32 v60, 16, v201
v_and_b32 v61, s46, v201
v_pk_add_f32 v[42:43], v[42:43], v[60:61]
v_lshlrev_b32 v60, 16, v202
v_and_b32 v61, s46, v202
v_pk_add_f32 v[44:45], v[44:45], v[60:61]
v_lshlrev_b32 v60, 16, v203
v_and_b32 v61, s46, v203
v_pk_add_f32 v[46:47], v[46:47], v[60:61]
v_lshlrev_b32 v60, 16, v204
v_and_b32 v61, s46, v204
v_pk_add_f32 v[40:41], v[40:41], v[60:61]
v_lshlrev_b32 v60, 16, v205
v_and_b32 v61, s46, v205
v_pk_add_f32 v[42:43], v[42:43], v[60:61]
v_lshlrev_b32 v60, 16, v206
v_and_b32 v61, s46, v206
v_pk_add_f32 v[44:45], v[44:45], v[60:61]
v_lshlrev_b32 v60, 16, v207
v_and_b32 v61, s46, v207
v_pk_add_f32 v[46:47], v[46:47], v[60:61]
CV v48, v40, v41
CV v49, v42, v43
CV v50, v44, v45
CV v51, v46, v47
s_nop 0
v_permlane32_swap_b32 v48, v50
v_permlane32_swap_b32 v49, v51
s_nop 0
v_permlane16_swap_b32 v48, v50
v_permlane16_swap_b32 v49, v51
buffer_store_dwordx4 v[48:51], v2, s[4:7], s16 offen
s_waitcnt vmcnt(9)
v_lshlrev_b32 v24, 16, v208
v_and_b32 v25, s46, v208
v_lshlrev_b32 v26, 16, v209
v_and_b32 v27, s46, v209
v_lshlrev_b32 v28, 16, v210
v_and_b32 v29, s46, v210
v_lshlrev_b32 v30, 16, v211
v_and_b32 v31, s46, v211
s_waitcnt vmcnt(8)
v_lshlrev_b32 v60, 16, v212
v_and_b32 v61, s46, v212
v_pk_add_f32 v[24:25], v[24:25], v[60:61]
v_lshlrev_b32 v60, 16, v213
v_and_b32 v61, s46, v213
v_pk_add_f32 v[26:27], v[26:27], v[60:61]
v_lshlrev_b32 v60, 16, v214
v_and_b32 v61, s46, v214
v_pk_add_f32 v[28:29], v[28:29], v[60:61]
v_lshlrev_b32 v60, 16, v215
v_and_b32 v61, s46, v215
v_pk_add_f32 v[30:31], v[30:31], v[60:61]
s_waitcnt vmcnt(7)
v_lshlrev_b32 v60, 16, v216
v_and_b32 v61, s46, v216
v_pk_add_f32 v[24:25], v[24:25], v[60:61]
v_lshlrev_b32 v60, 16, v217
v_and_b32 v61, s46, v217
v_pk_add_f32 v[26:27], v[26:27], v[60:61]
v_lshlrev_b32 v60, 16, v218
v_and_b32 v61, s46, v218
v_pk_add_f32 v[28:29], v[28:29], v[60:61]
v_lshlrev_b32 v60, 16, v219
v_and_b32 v61, s46, v219
v_pk_add_f32 v[30:31], v[30:31], v[60:61]
s_waitcnt vmcnt(6)
v_lshlrev_b32 v60, 16, v220
v_and_b32 v61, s46, v220
v_pk_add_f32 v[24:25], v[24:25], v[60:61]
v_lshlrev_b32 v60, 16, v221
v_and_b32 v61, s46, v221
v_pk_add_f32 v[26:27], v[26:27], v[60:61]
v_lshlrev_b32 v60, 16, v222
v_and_b32 v61, s46, v222
v_pk_add_f32 v[28:29], v[28:29], v[60:61]
v_lshlrev_b32 v60, 16, v223
v_and_b32 v61, s46, v223
v_pk_add_f32 v[30:31], v[30:31], v[60:61]
s_waitcnt vmcnt(5)
v_lshlrev_b32 v60, 16, v224
v_and_b32 v61, s46, v224
v_pk_add_f32 v[24:25], v[24:25], v[60:61]
v_lshlrev_b32 v60, 16, v225
v_and_b32 v61, s46, v225
v_pk_add_f32 v[26:27], v[26:27], v[60:61]
v_lshlrev_b32 v60, 16, v226
v_and_b32 v61, s46, v226
v_pk_add_f32 v[28:29], v[28:29], v[60:61]
v_lshlrev_b32 v60, 16, v227
v_and_b32 v61, s46, v227
v_pk_add_f32 v[30:31], v[30:31], v[60:61]
s_waitcnt vmcnt(4)
v_lshlrev_b32 v60, 16, v228
v_and_b32 v61, s46, v228
v_pk_add_f32 v[24:25], v[24:25], v[60:61]
v_lshlrev_b32 v60, 16, v229
v_and_b32 v61, s46, v229
v_pk_add_f32 v[26:27], v[26:27], v[60:61]
v_lshlrev_b32 v60, 16, v230
v_and_b32 v61, s46, v230
v_pk_add_f32 v[28:29], v[28:29], v[60:61]
v_lshlrev_b32 v60, 16, v231
v_and_b32 v61, s46, v231
v_pk_add_f32 v[30:31], v[30:31], v[60:61]
s_waitcnt vmcnt(3)
v_lshlrev_b32 v60, 16, v232
v_and_b32 v61, s46, v232
v_pk_add_f32 v[24:25], v[24:25], v[60:61]
v_lshlrev_b32 v60, 16, v233
v_and_b32 v61, s46, v233
v_pk_add_f32 v[26:27], v[26:27], v[60:61]
v_lshlrev_b32 v60, 16, v234
v_and_b32 v61, s46, v234
v_pk_add_f32 v[28:29], v[28:29], v[60:61]
v_lshlrev_b32 v60, 16, v235
v_and_b32 v61, s46, v235
v_pk_add_f32 v[30:31], v[30:31], v[60:61]
s_waitcnt vmcnt(2)
v_lshlrev_b32 v60, 16, v236
v_and_b32 v61, s46, v236
v_pk_add_f32 v[24:25], v[24:25], v[60:61]
v_lshlrev_b32 v60, 16, v237
v_and_b32 v61, s46, v237
v_pk_add_f32 v[26:27], v[26:27], v[60:61]
v_lshlrev_b32 v60, 16, v238
v_and_b32 v61, s46, v238
v_pk_add_f32 v[28:29], v[28:29], v[60:61]
v_lshlrev_b32 v60, 16, v239
v_and_b32 v61, s46, v239
v_pk_add_f32 v[30:31], v[30:31], v[60:61]
CV v32, v24, v25
CV v33, v26, v27
CV v34, v28, v29
CV v35, v30, v31
s_nop 0
v_permlane32_swap_b32 v32, v34
v_permlane32_swap_b32 v33, v35
s_nop 0
v_permlane16_swap_b32 v32, v34
v_permlane16_swap_b32 v33, v35
buffer_store_dwordx4 v[32:35], v2, s[4:7], s17 offen
s_endpgm
L_Yend:
L_YFB0:
s_cmp_eq_u32 s36, 0
s_cbranch_scc1 L_YFBgo0
v_mov_b32 v24, 0
v_mov_b32 v25, 0
v_mov_b32 v26, 0
v_mov_b32 v27, 0
v_mov_b32 v28, 0
v_mov_b32 v29, 0
v_mov_b32 v30, 0
v_mov_b32 v31, 0
v_mov_b32 v32, 0
v_mov_b32 v33, 0
v_mov_b32 v34, 0
v_mov_b32 v35, 0
v_mov_b32 v36, 0
v_mov_b32 v37, 0
v_mov_b32 v38, 0
v_mov_b32 v39, 0
v_mov_b32 v40, 0
v_mov_b32 v41, 0
v_mov_b32 v42, 0
v_mov_b32 v43, 0
s_mov_b32 s36, 0
s_branch L_YRet0
L_YFBgo0:
s_waitcnt vmcnt(0) lgkmcnt(0)
s_barrier
v_bfe_u32 v124, v20, 4, 4
v_lshlrev_b32 v124, 8, v124
v_lshrrev_b32 v125, 8, v20
v_lshl_add_u32 v124, v125, 3, v124
v_mov_b32 v116, 0xff800000
v_mov_b32 v117, 0xff800000
v_mov_b32 v118, 0xff800000
v_mov_b32 v119, 0xff800000
v_mov_b32 v120, 0xff800000
s_mov_b32 s40, 0
s_mov_b32 s96, 32
L_YFBloop0:
buffer_load_dwordx2 v[80:81], v124, s[4:7], s40 offen offset:0
buffer_load_dwordx2 v[82:83], v124, s[4:7], s40 offen offset:32
buffer_load_dwordx2 v[84:85], v124, s[4:7], s40 offen offset:64
buffer_load_dwordx2 v[86:87], v124, s[4:7], s40 offen offset:96
buffer_load_dwordx2 v[88:89], v124, s[4:7], s40 offen offset:128
buffer_load_dwordx2 v[90:91], v124, s[4:7], s40 offen offset:160
buffer_load_dwordx2 v[92:93], v124, s[4:7], s40 offen offset:192
buffer_load_dwordx2 v[94:95], v124, s[4:7], s40 offen offset:224
s_waitcnt vmcnt(6)
MM v[96:99], v[80:83], a[144:147], 0
s_waitcnt vmcnt(4)
MM v[96:99], v[84:87], a[148:151], v[96:99]
s_waitcnt vmcnt(2)
MM v[96:99], v[88:91], a[152:155], v[96:99]
s_waitcnt vmcnt(0)
MM v[96:99], v[92:95], a[156:159], v[96:99]
MM v[100:103], v[80:83], a[160:163], 0
MM v[100:103], v[84:87], a[164:167], v[100:103]
MM v[100:103], v[88:91], a[168:171], v[100:103]
MM v[100:103], v[92:95], a[172:175], v[100:103]
MM v[104:107], v[80:83], a[176:179], 0
MM v[104:107], v[84:87], a[180:183], v[104:107]
MM v[104:107], v[88:91], a[184:187], v[104:107]
MM v[104:107], v[92:95], a[188:191], v[104:107]
MM v[108:111], v[80:83], a[192:195], 0
MM v[108:111], v[84:87], a[196:199], v[108:111]
MM v[108:111], v[88:91], a[200:203], v[108:111]
MM v[108:111], v[92:95], a[204:207], v[108:111]
MM v[112:115], v[80:83], a[208:211], 0
MM v[112:115], v[84:87], a[212:215], v[112:115]
MM v[112:115], v[88:91], a[216:219], v[112:115]
MM v[112:115], v[92:95], a[220:223], v[112:115]
v_max3_f32 v116, v116, v96, v97
v_max3_f32 v116, v116, v98, v99
v_max3_f32 v117, v117, v100, v101
v_max3_f32 v117, v117, v102, v103
v_max3_f32 v118, v118, v104, v105
v_max3_f32 v118, v118, v106, v107
v_max3_f32 v119, v119, v108, v109
v_max3_f32 v119, v119, v110, v111
v_max3_f32 v120, v120, v112, v113
v_max3_f32 v120, v120, v114, v115
s_add_u32 s40, s40, 4096
s_sub_u32 s96, s96, 1
s_cmp_lg_u32 s96, 0
s_nop 7
s_cbranch_scc1 L_YFBloop0
v_lshrrev_b32 v124, 2, v20
v_xor_b32 v124, 64, v124
ds_bpermute_b32 v96, v124, v116
ds_bpermute_b32 v97, v124, v117
ds_bpermute_b32 v98, v124, v118
ds_bpermute_b32 v99, v124, v119
ds_bpermute_b32 v100, v124, v120
s_waitcnt lgkmcnt(4)
v_max_f32 v116, v116, v96
s_waitcnt lgkmcnt(3)
v_max_f32 v117, v117, v97
s_waitcnt lgkmcnt(2)
v_max_f32 v118, v118, v98
s_waitcnt lgkmcnt(1)
v_max_f32 v119, v119, v99
s_waitcnt lgkmcnt(0)
v_max_f32 v120, v120, v100
v_lshrrev_b32 v124, 2, v20
v_xor_b32 v124, 128, v124
ds_bpermute_b32 v96, v124, v116
ds_bpermute_b32 v97, v124, v117
ds_bpermute_b32 v98, v124, v118
ds_bpermute_b32 v99, v124, v119
ds_bpermute_b32 v100, v124, v120
s_waitcnt lgkmcnt(4)
v_max_f32 v116, v116, v96
s_waitcnt lgkmcnt(3)
v_max_f32 v117, v117, v97
s_waitcnt lgkmcnt(2)
v_max_f32 v118, v118, v98
s_waitcnt lgkmcnt(1)
v_max_f32 v119, v119, v99
s_waitcnt lgkmcnt(0)
v_max_f32 v120, v120, v100
v_sub_f32 v24, 0, v116
v_sub_f32 v25, 0, v116
v_sub_f32 v26, 0, v116
v_sub_f32 v27, 0, v116
v_sub_f32 v28, 0, v117
v_sub_f32 v29, 0, v117
v_sub_f32 v30, 0, v117
v_sub_f32 v31, 0, v117
v_sub_f32 v32, 0, v118
v_sub_f32 v33, 0, v118
v_sub_f32 v34, 0, v118
v_sub_f32 v35, 0, v118
v_sub_f32 v36, 0, v119
v_sub_f32 v37, 0, v119
v_sub_f32 v38, 0, v119
v_sub_f32 v39, 0, v119
v_sub_f32 v40, 0, v120
v_sub_f32 v41, 0, v120
v_sub_f32 v42, 0, v120
v_sub_f32 v43, 0, v120
s_add_u32 s42, s98, 0x0
v_add_u32 v1, 0xffff0000, v1
v_add_u32 v2, 0xffff0000, v2
v_add_u32 v3, 0xffff0000, v3
v_add_u32 v4, 0xffff0000, v4
v_add_u32 v5, 0xffff0000, v5
v_add_u32 v6, 0xffff0000, v6
v_add_u32 v7, 0xffff0000, v7
v_add_u32 v8, 0xffff0000, v8
s_add_u32 m0, s28, 0x0
s_add_u32 s30, s98, 0x0
s_and_b32 s30, s30, 0x1ffff
buffer_load_dwordx4 v13, s[4:7], s30 offen nt lds
s_add_u32 m0, s28, 0xf80
s_add_u32 s30, s98, 0x0
s_and_b32 s30, s30, 0x1ffff
buffer_load_dwordx4 v13, s[4:7], s30 offen offset:128 nt lds
s_add_u32 m0, s28, 0x800
s_add_u32 s30, s98, 0x1000
s_and_b32 s30, s30, 0x1ffff
buffer_load_dwordx4 v13, s[4:7], s30 offen nt lds
s_add_u32 m0, s28, 0x1780
s_add_u32 s30, s98, 0x1000
s_and_b32 s30, s30, 0x1ffff
buffer_load_dwordx4 v13, s[4:7], s30 offen offset:128 nt lds
s_add_u32 m0, s28, 0x8000
s_add_u32 s30, s98, 0x2000
s_and_b32 s30, s30, 0x1ffff
buffer_load_dwordx4 v13, s[4:7], s30 offen nt lds
s_add_u32 m0, s28, 0x8f80
s_add_u32 s30, s98, 0x2000
s_and_b32 s30, s30, 0x1ffff
buffer_load_dwordx4 v13, s[4:7], s30 offen offset:128 nt lds
s_add_u32 m0, s28, 0x8800
s_add_u32 s30, s98, 0x3000
s_and_b32 s30, s30, 0x1ffff
buffer_load_dwordx4 v13, s[4:7], s30 offen nt lds
s_add_u32 m0, s28, 0x9780
s_add_u32 s30, s98, 0x3000
s_and_b32 s30, s30, 0x1ffff
buffer_load_dwordx4 v13, s[4:7], s30 offen offset:128 nt lds
s_add_u32 m0, s28, 0x10000
s_add_u32 s30, s98, 0x4000
s_and_b32 s30, s30, 0x1ffff
buffer_load_dwordx4 v13, s[4:7], s30 offen nt lds
s_add_u32 m0, s28, 0x10f80
s_add_u32 s30, s98, 0x4000
s_and_b32 s30, s30, 0x1ffff
buffer_load_dwordx4 v13, s[4:7], s30 offen offset:128 nt lds
s_add_u32 m0, s28, 0x10800
s_add_u32 s30, s98, 0x5000
s_and_b32 s30, s30, 0x1ffff
buffer_load_dwordx4 v13, s[4:7], s30 offen nt lds
s_add_u32 m0, s28, 0x11780
s_add_u32 s30, s98, 0x5000
s_and_b32 s30, s30, 0x1ffff
buffer_load_dwordx4 v13, s[4:7], s30 offen offset:128 nt lds
s_add_u32 m0, s28, 0x18000
s_add_u32 s30, s98, 0x6000
s_and_b32 s30, s30, 0x1ffff
buffer_load_dwordx4 v13, s[4:7], s30 offen nt lds
s_add_u32 m0, s28, 0x18f80
s_add_u32 s30, s98, 0x6000
s_and_b32 s30, s30, 0x1ffff
buffer_load_dwordx4 v13, s[4:7], s30 offen offset:128 nt lds
s_add_u32 m0, s28, 0x18800
s_add_u32 s30, s98, 0x7000
s_and_b32 s30, s30, 0x1ffff
buffer_load_dwordx4 v13, s[4:7], s30 offen nt lds
s_add_u32 m0, s28, 0x19780
s_add_u32 s30, s98, 0x7000
s_and_b32 s30, s30, 0x1ffff
buffer_load_dwordx4 v13, s[4:7], s30 offen offset:128 nt lds
s_add_u32 m0, s28, 0x4000
s_add_u32 s30, s98, 0x0
s_and_b32 s30, s30, 0x1ffff
buffer_load_dwordx4 v14, s[8:11], s30 offen nt lds
s_add_u32 m0, s28, 0x4f80
s_add_u32 s30, s98, 0x0
s_and_b32 s30, s30, 0x1ffff
buffer_load_dwordx4 v14, s[8:11], s30 offen offset:128 nt lds
s_add_u32 m0, s28, 0x4800
s_add_u32 s30, s98, 0x1000
s_and_b32 s30, s30, 0x1ffff
buffer_load_dwordx4 v14, s[8:11], s30 offen nt lds
s_add_u32 m0, s28, 0x5780
s_add_u32 s30, s98, 0x1000
s_and_b32 s30, s30, 0x1ffff
buffer_load_dwordx4 v14, s[8:11], s30 offen offset:128 nt lds
s_add_u32 m0, s28, 0xc000
s_add_u32 s30, s98, 0x2000
s_and_b32 s30, s30, 0x1ffff
buffer_load_dwordx4 v14, s[8:11], s30 offen nt lds
s_add_u32 m0, s28, 0xcf80
s_add_u32 s30, s98, 0x2000
s_and_b32 s30, s30, 0x1ffff
buffer_load_dwordx4 v14, s[8:11], s30 offen offset:128 nt lds
s_add_u32 m0, s28, 0xc800
s_add_u32 s30, s98, 0x3000
s_and_b32 s30, s30, 0x1ffff
buffer_load_dwordx4 v14, s[8:11], s30 offen nt lds
s_add_u32 m0, s28, 0xd780
s_add_u32 s30, s98, 0x3000
s_and_b32 s30, s30, 0x1ffff
buffer_load_dwordx4 v14, s[8:11], s30 offen offset:128 nt lds
s_add_u32 m0, s28, 0x14000
s_add_u32 s30, s98, 0x4000
s_and_b32 s30, s30, 0x1ffff
buffer_load_dwordx4 v14, s[8:11], s30 offen nt lds
s_add_u32 m0, s28, 0x14f80
s_add_u32 s30, s98, 0x4000
s_and_b32 s30, s30, 0x1ffff
buffer_load_dwordx4 v14, s[8:11], s30 offen offset:128 nt lds
s_add_u32 m0, s28, 0x14800
s_add_u32 s30, s98, 0x5000
s_and_b32 s30, s30, 0x1ffff
buffer_load_dwordx4 v14, s[8:11], s30 offen nt lds
s_add_u32 m0, s28, 0x15780
s_add_u32 s30, s98, 0x5000
s_and_b32 s30, s30, 0x1ffff
buffer_load_dwordx4 v14, s[8:11], s30 offen offset:128 nt lds
s_add_u32 m0, s28, 0x1c000
s_add_u32 s30, s98, 0x6000
s_and_b32 s30, s30, 0x1ffff
buffer_load_dwordx4 v14, s[8:11], s30 offen nt lds
s_add_u32 m0, s28, 0x1cf80
s_add_u32 s30, s98, 0x6000
s_and_b32 s30, s30, 0x1ffff
buffer_load_dwordx4 v14, s[8:11], s30 offen offset:128 nt lds
s_add_u32 m0, s28, 0x1c800
s_add_u32 s30, s98, 0x7000
s_and_b32 s30, s30, 0x1ffff
buffer_load_dwordx4 v14, s[8:11], s30 offen nt lds
s_add_u32 m0, s28, 0x1d780
s_add_u32 s30, s98, 0x7000
s_and_b32 s30, s30, 0x1ffff
buffer_load_dwordx4 v14, s[8:11], s30 offen offset:128 nt lds
s_waitcnt vmcnt(0)
s_barrier
ds_read_b64 a[80:81], v5 offset:0
ds_read_b64 a[82:83], v6 offset:0
ds_read_b64 a[84:85], v5 offset:2048
ds_read_b64 a[86:87], v6 offset:2048
ds_read_b64 a[88:89], v7 offset:0
ds_read_b64 a[90:91], v8 offset:0
ds_read_b64 a[92:93], v7 offset:2048
ds_read_b64 a[94:95], v8 offset:2048
ds_read_b64 a[96:97], v5 offset:4096
ds_read_b64 a[98:99], v6 offset:4096
ds_read_b64 a[100:101], v5 offset:6144
ds_read_b64 a[102:103], v6 offset:6144
ds_read_b64 a[104:105], v7 offset:4096
ds_read_b64 a[106:107], v8 offset:4096
ds_read_b64 a[108:109], v7 offset:6144
ds_read_b64 a[110:111], v8 offset:6144
TR a[112:113], v1 offset:16384
TR a[114:115], v1 offset:18432
TR a[116:117], v2 offset:16384
TR a[118:119], v2 offset:18432
TR a[120:121], v3 offset:16384
TR a[122:123], v3 offset:18432
TR a[124:125], v4 offset:16384
TR a[126:127], v4 offset:18432
TR a[128:129], v1 offset:20480
TR a[130:131], v1 offset:22528
TR a[132:133], v2 offset:20480
TR a[134:135], v2 offset:22528
TR a[136:137], v3 offset:20480
TR a[138:139], v3 offset:22528
TR a[140:141], v4 offset:20480
TR a[142:143], v4 offset:22528
s_waitcnt lgkmcnt(0)
s_mov_b32 s36, 1
s_branch L_YAent0
L_YFB1:
s_cmp_eq_u32 s36, 0
s_cbranch_scc1 L_YFBgo1
v_mov_b32 v24, 0
v_mov_b32 v25, 0
v_mov_b32 v26, 0
v_mov_b32 v27, 0
v_mov_b32 v28, 0
v_mov_b32 v29, 0
v_mov_b32 v30, 0
v_mov_b32 v31, 0
v_mov_b32 v32, 0
v_mov_b32 v33, 0
v_mov_b32 v34, 0
v_mov_b32 v35, 0
v_mov_b32 v36, 0
v_mov_b32 v37, 0
v_mov_b32 v38, 0
v_mov_b32 v39, 0
v_mov_b32 v40, 0
v_mov_b32 v41, 0
v_mov_b32 v42, 0
v_mov_b32 v43, 0
s_mov_b32 s36, 0
s_branch L_YRet1
L_YFBgo1:
s_waitcnt vmcnt(0) lgkmcnt(0)
s_barrier
v_bfe_u32 v124, v20, 4, 4
v_lshlrev_b32 v124, 8, v124
v_lshrrev_b32 v125, 8, v20
v_lshl_add_u32 v124, v125, 3, v124
v_mov_b32 v116, 0xff800000
v_mov_b32 v117, 0xff800000
v_mov_b32 v118, 0xff800000
v_mov_b32 v119, 0xff800000
v_mov_b32 v120, 0xff800000
s_mov_b32 s40, 0
s_mov_b32 s96, 32
L_YFBloop1:
buffer_load_dwordx2 v[80:81], v124, s[4:7], s40 offen offset:0
buffer_load_dwordx2 v[82:83], v124, s[4:7], s40 offen offset:32
buffer_load_dwordx2 v[84:85], v124, s[4:7], s40 offen offset:64
buffer_load_dwordx2 v[86:87], v124, s[4:7], s40 offen offset:96
buffer_load_dwordx2 v[88:89], v124, s[4:7], s40 offen offset:128
buffer_load_dwordx2 v[90:91], v124, s[4:7], s40 offen offset:160
buffer_load_dwordx2 v[92:93], v124, s[4:7], s40 offen offset:192
buffer_load_dwordx2 v[94:95], v124, s[4:7], s40 offen offset:224
s_waitcnt vmcnt(6)
MM v[96:99], v[80:83], a[0:3], 0
s_waitcnt vmcnt(4)
MM v[96:99], v[84:87], a[4:7], v[96:99]
s_waitcnt vmcnt(2)
MM v[96:99], v[88:91], a[8:11], v[96:99]
s_waitcnt vmcnt(0)
MM v[96:99], v[92:95], a[12:15], v[96:99]
MM v[100:103], v[80:83], a[16:19], 0
MM v[100:103], v[84:87], a[20:23], v[100:103]
MM v[100:103], v[88:91], a[24:27], v[100:103]
MM v[100:103], v[92:95], a[28:31], v[100:103]
MM v[104:107], v[80:83], a[32:35], 0
MM v[104:107], v[84:87], a[36:39], v[104:107]
MM v[104:107], v[88:91], a[40:43], v[104:107]
MM v[104:107], v[92:95], a[44:47], v[104:107]
MM v[108:111], v[80:83], a[48:51], 0
MM v[108:111], v[84:87], a[52:55], v[108:111]
MM v[108:111], v[88:91], a[56:59], v[108:111]
MM v[108:111], v[92:95], a[60:63], v[108:111]
MM v[112:115], v[80:83], a[64:67], 0
MM v[112:115], v[84:87], a[68:71], v[112:115]
MM v[112:115], v[88:91], a[72:75], v[112:115]
MM v[112:115], v[92:95], a[76:79], v[112:115]
v_max3_f32 v116, v116, v96, v97
v_max3_f32 v116, v116, v98, v99
v_max3_f32 v117, v117, v100, v101
v_max3_f32 v117, v117, v102, v103
v_max3_f32 v118, v118, v104, v105
v_max3_f32 v118, v118, v106, v107
v_max3_f32 v119, v119, v108, v109
v_max3_f32 v119, v119, v110, v111
v_max3_f32 v120, v120, v112, v113
v_max3_f32 v120, v120, v114, v115
s_add_u32 s40, s40, 4096
s_sub_u32 s96, s96, 1
s_cmp_lg_u32 s96, 0
s_nop 7
s_cbranch_scc1 L_YFBloop1
v_lshrrev_b32 v124, 2, v20
v_xor_b32 v124, 64, v124
ds_bpermute_b32 v96, v124, v116
ds_bpermute_b32 v97, v124, v117
ds_bpermute_b32 v98, v124, v118
ds_bpermute_b32 v99, v124, v119
ds_bpermute_b32 v100, v124, v120
s_waitcnt lgkmcnt(4)
v_max_f32 v116, v116, v96
s_waitcnt lgkmcnt(3)
v_max_f32 v117, v117, v97
s_waitcnt lgkmcnt(2)
v_max_f32 v118, v118, v98
s_waitcnt lgkmcnt(1)
v_max_f32 v119, v119, v99
s_waitcnt lgkmcnt(0)
v_max_f32 v120, v120, v100
v_lshrrev_b32 v124, 2, v20
v_xor_b32 v124, 128, v124
ds_bpermute_b32 v96, v124, v116
ds_bpermute_b32 v97, v124, v117
ds_bpermute_b32 v98, v124, v118
ds_bpermute_b32 v99, v124, v119
ds_bpermute_b32 v100, v124, v120
s_waitcnt lgkmcnt(4)
v_max_f32 v116, v116, v96
s_waitcnt lgkmcnt(3)
v_max_f32 v117, v117, v97
s_waitcnt lgkmcnt(2)
v_max_f32 v118, v118, v98
s_waitcnt lgkmcnt(1)
v_max_f32 v119, v119, v99
s_waitcnt lgkmcnt(0)
v_max_f32 v120, v120, v100
v_sub_f32 v24, 0, v116
v_sub_f32 v25, 0, v116
v_sub_f32 v26, 0, v116
v_sub_f32 v27, 0, v116
v_sub_f32 v28, 0, v117
v_sub_f32 v29, 0, v117
v_sub_f32 v30, 0, v117
v_sub_f32 v31, 0, v117
v_sub_f32 v32, 0, v118
v_sub_f32 v33, 0, v118
v_sub_f32 v34, 0, v118
v_sub_f32 v35, 0, v118
v_sub_f32 v36, 0, v119
v_sub_f32 v37, 0, v119
v_sub_f32 v38, 0, v119
v_sub_f32 v39, 0, v119
v_sub_f32 v40, 0, v120
v_sub_f32 v41, 0, v120
v_sub_f32 v42, 0, v120
v_sub_f32 v43, 0, v120
s_add_u32 s42, s98, 0x18000
v_add_u32 v1, 0xffff0000, v1
v_add_u32 v2, 0xffff0000, v2
v_add_u32 v3, 0xffff0000, v3
v_add_u32 v4, 0xffff0000, v4
v_add_u32 v5, 0xffff0000, v5
v_add_u32 v6, 0xffff0000, v6
v_add_u32 v7, 0xffff0000, v7
v_add_u32 v8, 0xffff0000, v8
s_add_u32 m0, s28, 0x0
s_add_u32 s30, s98, 0x0
s_and_b32 s30, s30, 0x1ffff
buffer_load_dwordx4 v13, s[4:7], s30 offen nt lds
s_add_u32 m0, s28, 0xf80
s_add_u32 s30, s98, 0x0
s_and_b32 s30, s30, 0x1ffff
buffer_load_dwordx4 v13, s[4:7], s30 offen offset:128 nt lds
s_add_u32 m0, s28, 0x800
s_add_u32 s30, s98, 0x1000
s_and_b32 s30, s30, 0x1ffff
buffer_load_dwordx4 v13, s[4:7], s30 offen nt lds
s_add_u32 m0, s28, 0x1780
s_add_u32 s30, s98, 0x1000
s_and_b32 s30, s30, 0x1ffff
buffer_load_dwordx4 v13, s[4:7], s30 offen offset:128 nt lds
s_add_u32 m0, s28, 0x8000
s_add_u32 s30, s98, 0x2000
s_and_b32 s30, s30, 0x1ffff
buffer_load_dwordx4 v13, s[4:7], s30 offen nt lds
s_add_u32 m0, s28, 0x8f80
s_add_u32 s30, s98, 0x2000
s_and_b32 s30, s30, 0x1ffff
buffer_load_dwordx4 v13, s[4:7], s30 offen offset:128 nt lds
s_add_u32 m0, s28, 0x8800
s_add_u32 s30, s98, 0x3000
s_and_b32 s30, s30, 0x1ffff
buffer_load_dwordx4 v13, s[4:7], s30 offen nt lds
s_add_u32 m0, s28, 0x9780
s_add_u32 s30, s98, 0x3000
s_and_b32 s30, s30, 0x1ffff
buffer_load_dwordx4 v13, s[4:7], s30 offen offset:128 nt lds
s_add_u32 m0, s28, 0x10000
s_add_u32 s30, s98, 0x4000
s_and_b32 s30, s30, 0x1ffff
buffer_load_dwordx4 v13, s[4:7], s30 offen nt lds
s_add_u32 m0, s28, 0x10f80
s_add_u32 s30, s98, 0x4000
s_and_b32 s30, s30, 0x1ffff
buffer_load_dwordx4 v13, s[4:7], s30 offen offset:128 nt lds
s_add_u32 m0, s28, 0x10800
s_add_u32 s30, s98, 0x5000
s_and_b32 s30, s30, 0x1ffff
buffer_load_dwordx4 v13, s[4:7], s30 offen nt lds
s_add_u32 m0, s28, 0x11780
s_add_u32 s30, s98, 0x5000
s_and_b32 s30, s30, 0x1ffff
buffer_load_dwordx4 v13, s[4:7], s30 offen offset:128 nt lds
s_add_u32 m0, s28, 0x18000
s_add_u32 s30, s98, 0x6000
s_and_b32 s30, s30, 0x1ffff
buffer_load_dwordx4 v13, s[4:7], s30 offen nt lds
s_add_u32 m0, s28, 0x18f80
s_add_u32 s30, s98, 0x6000
s_and_b32 s30, s30, 0x1ffff
buffer_load_dwordx4 v13, s[4:7], s30 offen offset:128 nt lds
s_add_u32 m0, s28, 0x18800
s_add_u32 s30, s98, 0x7000
s_and_b32 s30, s30, 0x1ffff
buffer_load_dwordx4 v13, s[4:7], s30 offen nt lds
s_add_u32 m0, s28, 0x19780
s_add_u32 s30, s98, 0x7000
s_and_b32 s30, s30, 0x1ffff
buffer_load_dwordx4 v13, s[4:7], s30 offen offset:128 nt lds
s_add_u32 m0, s28, 0x4000
s_add_u32 s30, s98, 0x0
s_and_b32 s30, s30, 0x1ffff
buffer_load_dwordx4 v14, s[8:11], s30 offen nt lds
s_add_u32 m0, s28, 0x4f80
s_add_u32 s30, s98, 0x0
s_and_b32 s30, s30, 0x1ffff
buffer_load_dwordx4 v14, s[8:11], s30 offen offset:128 nt lds
s_add_u32 m0, s28, 0x4800
s_add_u32 s30, s98, 0x1000
s_and_b32 s30, s30, 0x1ffff
buffer_load_dwordx4 v14, s[8:11], s30 offen nt lds
s_add_u32 m0, s28, 0x5780
s_add_u32 s30, s98, 0x1000
s_and_b32 s30, s30, 0x1ffff
buffer_load_dwordx4 v14, s[8:11], s30 offen offset:128 nt lds
s_add_u32 m0, s28, 0xc000
s_add_u32 s30, s98, 0x2000
s_and_b32 s30, s30, 0x1ffff
buffer_load_dwordx4 v14, s[8:11], s30 offen nt lds
s_add_u32 m0, s28, 0xcf80
s_add_u32 s30, s98, 0x2000
s_and_b32 s30, s30, 0x1ffff
buffer_load_dwordx4 v14, s[8:11], s30 offen offset:128 nt lds
s_add_u32 m0, s28, 0xc800
s_add_u32 s30, s98, 0x3000
s_and_b32 s30, s30, 0x1ffff
buffer_load_dwordx4 v14, s[8:11], s30 offen nt lds
s_add_u32 m0, s28, 0xd780
s_add_u32 s30, s98, 0x3000
s_and_b32 s30, s30, 0x1ffff
buffer_load_dwordx4 v14, s[8:11], s30 offen offset:128 nt lds
s_add_u32 m0, s28, 0x14000
s_add_u32 s30, s98, 0x4000
s_and_b32 s30, s30, 0x1ffff
buffer_load_dwordx4 v14, s[8:11], s30 offen nt lds
s_add_u32 m0, s28, 0x14f80
s_add_u32 s30, s98, 0x4000
s_and_b32 s30, s30, 0x1ffff
buffer_load_dwordx4 v14, s[8:11], s30 offen offset:128 nt lds
s_add_u32 m0, s28, 0x14800
s_add_u32 s30, s98, 0x5000
s_and_b32 s30, s30, 0x1ffff
buffer_load_dwordx4 v14, s[8:11], s30 offen nt lds
s_add_u32 m0, s28, 0x15780
s_add_u32 s30, s98, 0x5000
s_and_b32 s30, s30, 0x1ffff
buffer_load_dwordx4 v14, s[8:11], s30 offen offset:128 nt lds
s_add_u32 m0, s28, 0x1c000
s_add_u32 s30, s98, 0x6000
s_and_b32 s30, s30, 0x1ffff
buffer_load_dwordx4 v14, s[8:11], s30 offen nt lds
s_add_u32 m0, s28, 0x1cf80
s_add_u32 s30, s98, 0x6000
s_and_b32 s30, s30, 0x1ffff
buffer_load_dwordx4 v14, s[8:11], s30 offen offset:128 nt lds
s_add_u32 m0, s28, 0x1c800
s_add_u32 s30, s98, 0x7000
s_and_b32 s30, s30, 0x1ffff
buffer_load_dwordx4 v14, s[8:11], s30 offen nt lds
s_add_u32 m0, s28, 0x1d780
s_add_u32 s30, s98, 0x7000
s_and_b32 s30, s30, 0x1ffff
buffer_load_dwordx4 v14, s[8:11], s30 offen offset:128 nt lds
s_waitcnt vmcnt(0)
s_barrier
ds_read_b64 a[80:81], v5 offset:0
ds_read_b64 a[82:83], v6 offset:0
ds_read_b64 a[84:85], v5 offset:2048
ds_read_b64 a[86:87], v6 offset:2048
ds_read_b64 a[88:89], v7 offset:0
ds_read_b64 a[90:91], v8 offset:0
ds_read_b64 a[92:93], v7 offset:2048
ds_read_b64 a[94:95], v8 offset:2048
ds_read_b64 a[96:97], v5 offset:4096
ds_read_b64 a[98:99], v6 offset:4096
ds_read_b64 a[100:101], v5 offset:6144
ds_read_b64 a[102:103], v6 offset:6144
ds_read_b64 a[104:105], v7 offset:4096
ds_read_b64 a[106:107], v8 offset:4096
ds_read_b64 a[108:109], v7 offset:6144
ds_read_b64 a[110:111], v8 offset:6144
TR a[112:113], v1 offset:16384
TR a[114:115], v1 offset:18432
TR a[116:117], v2 offset:16384
TR a[118:119], v2 offset:18432
TR a[120:121], v3 offset:16384
TR a[122:123], v3 offset:18432
TR a[124:125], v4 offset:16384
TR a[126:127], v4 offset:18432
TR a[128:129], v1 offset:20480
TR a[130:131], v1 offset:22528
TR a[132:133], v2 offset:20480
TR a[134:135], v2 offset:22528
TR a[136:137], v3 offset:20480
TR a[138:139], v3 offset:22528
TR a[140:141], v4 offset:20480
TR a[142:143], v4 offset:22528
s_waitcnt lgkmcnt(0)
s_mov_b32 s36, 1
s_branch L_YAent1
L_end:
s_endpgm

.section .rodata,"a"
.p2align 6
.amdhsa_kernel concat_heads__mha_block_cached__mha_block_cached__near_ridge_kernel
  .amdhsa_next_free_vgpr 512
  .amdhsa_next_free_sgpr 102
  .amdhsa_accum_offset 256
  .amdhsa_group_segment_fixed_size 0
  .amdhsa_kernarg_size 104
  .amdhsa_user_sgpr_count 2
  .amdhsa_user_sgpr_kernarg_segment_ptr 1
  .amdhsa_system_sgpr_workgroup_id_x 1
.end_amdhsa_kernel
```
